```python
import torch

def _softmax(x, axis=-1):
    return torch.softmax(x, dim=axis)
def _gelu(x):
    return torch.nn.functional.gelu(x, approximate="tanh")
def _silu(x):
    return torch.nn.functional.silu(x)
def _sigmoid(x):
    return torch.sigmoid(x)
def _layernorm(x, axis=-1, eps=1e-5):
    m = x.mean(dim=axis, keepdim=True)
    v = x.var(dim=axis, keepdim=True, unbiased=False)
    return (x - m) / torch.sqrt(v + eps)
def _scatter_add(tgt, idx, src, axis=0):
    return tgt.clone().index_add_(axis, idx, src)
def _segment_sum(src, seg, n):
    out = torch.zeros((n,) + src.shape[1:], dtype=src.dtype)
    return out.index_add_(0, seg, src)
def _pad(x, pw):
    flat = tuple(v for pair in reversed(pw) for v in pair)
    return torch.nn.functional.pad(x, flat)

kernel_name = 'recurrent_scan__gqa_block_cached__dense_activation_silu__prompt'

def setup_inputs():

    _w = (lambda a: (lambda t: t.to(torch.bfloat16) if t.is_floating_point() else t)(torch.as_tensor(a)))
    def _A_setup():
        B, Sq, D = 1, 2048, 640
        Hq, Hkv, Sk, Dh = 32, 32, 2048, 128
        assert Hq % Hkv == 0, (Hq, Hkv)
        return {
            "x": _w((lambda *s: torch.randn(*s, dtype=torch.bfloat16) * 0.05)(B, Sq, D)),
            "k_cache": _w((lambda *s: torch.randn(*s, dtype=torch.bfloat16) * 3.2)(B, Hkv, Sk, Dh)),
            "v_cache": _w((lambda *s: torch.randn(*s, dtype=torch.bfloat16) * 3.2)(B, Hkv, Sk, Dh)),
            "wq": _w((lambda *s: torch.randn(*s, dtype=torch.bfloat16) * 3.2)(D, Hq * Dh) * (D ** -0.5)),
            "wo": _w((lambda *s: torch.randn(*s, dtype=torch.bfloat16) * 3.2)(Hq * Dh, D) * ((Hq * Dh) ** -0.5)),
        }
    _A_in = _A_setup()

    def _B_setup():
        B, S, D, F = 1, 2048, 640, 1728
        return {
            "x": _w((lambda *s: torch.randn(*s, dtype=torch.bfloat16) * 0.05)(B, S, D)),
            "w1": _w((lambda *s: torch.randn(*s, dtype=torch.bfloat16) * 3.2)(D, F) * (D ** -0.5)),
            "w2": _w((lambda *s: torch.randn(*s, dtype=torch.bfloat16) * 0.4)(F, D) * (F ** -0.5)),
        }
    _B_in = _B_setup()

    return {
        "A_x": _A_in["x"],
        "A_k_cache": _A_in["k_cache"],
        "A_v_cache": _A_in["v_cache"],
        "A_wq": _A_in["wq"],
        "A_wo": _A_in["wo"],
        "B_x": _B_in["x"],
        "B_w1": _B_in["w1"],
        "B_w2": _B_in["w2"],
    }

def reference(A_x, A_k_cache, A_v_cache, A_wq, A_wo, B_x, B_w1, B_w2):
    def _A_ref(x, k_cache, v_cache, wq, wo):
        B, Sq, D = x.shape
        Hq, Dh = 32, 128
        Hkv = k_cache.shape[1]
        rep = Hq // Hkv
        q = (lambda x, *d: x.permute(*d))((x @ wq).reshape(B, Sq, Hq, Dh), 0, 2, 1, 3)
        k = (lambda x, n, axis: torch.repeat_interleave(x, n, dim=axis))(k_cache, rep, axis=1)
        v = (lambda x, n, axis: torch.repeat_interleave(x, n, dim=axis))(v_cache, rep, axis=1)
        scores = torch.einsum("bhqd,bhkd->bhqk", q, k) * (Dh ** -0.5)
        p = _softmax(scores, axis=-1)
        o = torch.einsum("bhqk,bhkd->bhqd", p, v)
        return (lambda x, *d: x.permute(*d))(o, 0, 2, 1, 3).reshape(B, Sq, Hq * Dh) @ wo

    def _B_ref(x, w1, w2):
        h = torch.einsum("bsd,df->bsf", x, w1)
        h = _silu(h)
        out = torch.einsum("bsf,fd->bsd", h, w2)
        return out

    x = A_x
    xn = _layernorm(x, axis=-1)
    s = _A_ref(xn, A_k_cache, A_v_cache, A_wq, A_wo)
    g = _silu(_B_ref(xn, B_w1, B_w2))
    return x + s * g
```

```asm
; @launch grid=(256,1,1) block=(256,1,1) lds=163840
.amdgcn_target "amdgcn-amd-amdhsa--gfx950"
.text
.globl recurrent_scan__gqa_block_cached__dense_activation_silu__prompt_kernel
.p2align 8
.type recurrent_scan__gqa_block_cached__dense_activation_silu__prompt_kernel,@function
recurrent_scan__gqa_block_cached__dense_activation_silu__prompt_kernel:
    s_cmp_lt_u32 s2, 256
    s_cbranch_scc1 K1_go
    s_endpgm
K1_go:
    s_load_dwordx2 s[80:81], s[0:1], 0
    s_load_dwordx2 s[12:13], s[0:1], 80
    s_load_dwordx4 s[72:75], s[0:1], 24
    s_load_dwordx4 s[52:55], s[0:1], 48
    s_load_dwordx4 s[4:7], s[0:1], 8
    s_load_dwordx2 s[82:83], s[0:1], 64
    v_lshrrev_b32 v8, 4, v0
    v_and_b32 v8, 12, v8
    v_and_or_b32 v8, v0, 3, v8
    v_bfe_u32 v7, v0, 2, 4
    v_mul_u32_u24 v8, 1280, v8
    s_mul_i32 s3, s2, 10240
    v_lshl_add_u32 v8, v7, 4, v8
    s_movk_i32 s38, 10240
    s_mov_b32 s39, 0x20000
    s_waitcnt lgkmcnt(0)
    s_add_u32 s36, s80, s3
    s_addc_u32 s37, s81, 0
    buffer_load_dwordx4 v[12:15], v8, s[36:39], 0 offen offset:0
    buffer_load_dwordx4 v[16:19], v8, s[36:39], 0 offen offset:256
    buffer_load_dwordx4 v[20:23], v8, s[36:39], 0 offen offset:512
    buffer_load_dwordx4 v[24:27], v8, s[36:39], 0 offen offset:768
    buffer_load_dwordx4 v[28:31], v8, s[36:39], 0 offen offset:1024
    s_add_u32 s68, s12, 2686976
    s_addc_u32 s69, s13, 0
    s_mov_b32 s70, 331904
    s_mov_b32 s71, 0x20000
    s_load_dword s0, s[68:69], 331900
    v_lshrrev_b32 v242, 6, v0
    v_and_b32 v243, 63, v0
    v_readfirstlane_b32 s3, v242
    s_lshr_b32 s15, s2, 3
    s_and_b32 s17, s15, 28
    s_add_u32 s17, s17, s3
    s_getpc_b64 s[8:9]
K1_pc:
    s_lshl_b32 s50, s17, 10
    v_and_b32 v250, 7, v243
    v_lshl_add_u32 v250, v250, 7, s50
    s_add_u32 s10, s8, K1_pc-K1_pc+(0)
    s_addc_u32 s11, s9, 0
    v_mad_u64_u32 v[2:3], vcc, v250, 1, s[10:11]
    global_load_dword v1, v[2:3], off
    s_and_b32 s14, s2, 7
    s_lshl_b32 s16, s14, 2
    s_and_b32 s18, s15, 3
    s_add_u32 s16, s16, s18
    s_lshr_b32 s18, s15, 2
    s_lshl_b32 s79, s2, 1
    s_add_u32 s79, s79, s3
    v_and_b32 v247, 3, v243
    s_cmp_lt_u32 s3, 2
    s_cbranch_scc1 K1_ln
    s_lshl_b32 s50, s16, 8
    s_sub_u32 s51, 5242880, s50
    s_add_u32 s24, s72, s50
    s_addc_u32 s25, s73, 0
    s_mov_b32 s26, s51
    s_mov_b32 s27, 0x20000
    s_lshl_b32 s50, s16, 7
    s_sub_u32 s51, 2211840, s50
    s_cmp_lt_u32 s16, 27
    s_cselect_b32 s51, s51, 0
    s_cselect_b32 s50, s50, 0
    s_add_u32 s28, s52, s50
    s_addc_u32 s29, s53, 0
    s_mov_b32 s30, s51
    s_mov_b32 s31, 0x20000
    v_lshrrev_b32 v2, 1, v243
    v_cmp_gt_u32 vcc, 12, v2
    v_mov_b32 v3, 1024
    v_and_b32 v4, 1, v243
    v_cndmask_b32 v3, v3, v2, vcc
    v_lshlrev_b32 v4, 7, v4
    v_lshl_add_u32 v2, v3, 13, v4
    v_mul_u32_u24 v3, 3456, v3
    s_lshl_b32 s51, s18, 1
    s_add_u32 s51, s51, s3
    s_sub_u32 s51, s51, 2
    s_mul_i32 s59, s51, 98304
    buffer_load_dword v5, v2, s[24:27], s59 offen
    s_mul_i32 s59, s51, 41472
    buffer_load_dword v6, v3, s[28:31], s59 offen
    s_add_u32 s10, s8, K1_pc-K1_pc+(32768)
    s_addc_u32 s11, s9, 0
    v_mad_u64_u32 v[80:81], vcc, v250, 1, s[10:11]
    global_load_dword v78, v[80:81], off
    global_load_dword v79, v[80:81], off offset:-2048
    s_branch K1_join
K1_ln:
    s_add_u32 s60, s12, 0
    s_addc_u32 s61, s13, 0
    s_mov_b32 s62, 2621440
    s_mov_b32 s63, 0x20000
    v_lshrrev_b32 v9, 2, v7
    v_lshlrev_b32 v9, 12, v9
    v_and_b32 v10, 3, v7
    v_lshl_add_u32 v9, v10, 8, v9
    v_lshl_add_u32 v9, v247, 4, v9
    s_lshr_b32 s56, s79, 4
    s_mul_i32 s56, s56, 81920
    s_bfe_u32 s57, s79, 0x20002
    s_lshl_b32 s57, s57, 10
    s_add_u32 s56, s56, s57
    s_and_b32 s57, s79, 3
    s_lshl_b32 s57, s57, 6
    s_add_u32 s56, s56, s57
    s_lshl_b32 s57, s79, 7
    s_waitcnt vmcnt(5)
    v_lshlrev_b32 v32, 16, v12
    v_and_b32 v33, 0xffff0000, v12
    v_pk_add_f32 v[10:11], v[32:33], 0 op_sel_hi:[1,0]
    v_lshlrev_b32 v34, 16, v13
    v_and_b32 v35, 0xffff0000, v13
    v_pk_add_f32 v[10:11], v[10:11], v[34:35]
    v_lshlrev_b32 v36, 16, v14
    v_and_b32 v37, 0xffff0000, v14
    v_pk_add_f32 v[10:11], v[10:11], v[36:37]
    v_lshlrev_b32 v38, 16, v15
    v_and_b32 v39, 0xffff0000, v15
    v_pk_add_f32 v[10:11], v[10:11], v[38:39]
    s_waitcnt vmcnt(4)
    v_lshlrev_b32 v40, 16, v16
    v_and_b32 v41, 0xffff0000, v16
    v_pk_add_f32 v[10:11], v[10:11], v[40:41]
    v_lshlrev_b32 v42, 16, v17
    v_and_b32 v43, 0xffff0000, v17
    v_pk_add_f32 v[10:11], v[10:11], v[42:43]
    v_lshlrev_b32 v44, 16, v18
    v_and_b32 v45, 0xffff0000, v18
    v_pk_add_f32 v[10:11], v[10:11], v[44:45]
    v_lshlrev_b32 v46, 16, v19
    v_and_b32 v47, 0xffff0000, v19
    v_pk_add_f32 v[10:11], v[10:11], v[46:47]
    s_waitcnt vmcnt(3)
    v_lshlrev_b32 v48, 16, v20
    v_and_b32 v49, 0xffff0000, v20
    v_pk_add_f32 v[10:11], v[10:11], v[48:49]
    v_lshlrev_b32 v50, 16, v21
    v_and_b32 v51, 0xffff0000, v21
    v_pk_add_f32 v[10:11], v[10:11], v[50:51]
    v_lshlrev_b32 v52, 16, v22
    v_and_b32 v53, 0xffff0000, v22
    v_pk_add_f32 v[10:11], v[10:11], v[52:53]
    v_lshlrev_b32 v54, 16, v23
    v_and_b32 v55, 0xffff0000, v23
    v_pk_add_f32 v[10:11], v[10:11], v[54:55]
    s_waitcnt vmcnt(2)
    v_lshlrev_b32 v56, 16, v24
    v_and_b32 v57, 0xffff0000, v24
    v_pk_add_f32 v[10:11], v[10:11], v[56:57]
    v_lshlrev_b32 v58, 16, v25
    v_and_b32 v59, 0xffff0000, v25
    v_pk_add_f32 v[10:11], v[10:11], v[58:59]
    v_lshlrev_b32 v60, 16, v26
    v_and_b32 v61, 0xffff0000, v26
    v_pk_add_f32 v[10:11], v[10:11], v[60:61]
    v_lshlrev_b32 v62, 16, v27
    v_and_b32 v63, 0xffff0000, v27
    v_pk_add_f32 v[10:11], v[10:11], v[62:63]
    s_waitcnt vmcnt(1)
    v_lshlrev_b32 v64, 16, v28
    v_and_b32 v65, 0xffff0000, v28
    v_pk_add_f32 v[10:11], v[10:11], v[64:65]
    v_lshlrev_b32 v66, 16, v29
    v_and_b32 v67, 0xffff0000, v29
    v_pk_add_f32 v[10:11], v[10:11], v[66:67]
    v_lshlrev_b32 v68, 16, v30
    v_and_b32 v69, 0xffff0000, v30
    v_pk_add_f32 v[10:11], v[10:11], v[68:69]
    v_lshlrev_b32 v70, 16, v31
    v_and_b32 v71, 0xffff0000, v31
    v_pk_add_f32 v[10:11], v[10:11], v[70:71]
    v_add_f32 v10, v10, v11
    s_nop 1
    v_add_f32_dpp v10, v10, v10 row_ror:8 row_mask:0xf bank_mask:0xf
    s_nop 1
    v_add_f32_dpp v10, v10, v10 row_ror:4 row_mask:0xf bank_mask:0xf
    v_mov_b32 v11, v10
    s_nop 1
    v_permlane16_swap_b32 v10, v11
    s_nop 1
    v_add_f32 v10, v10, v11
    v_mov_b32 v11, v10
    s_nop 1
    v_permlane32_swap_b32 v10, v11
    s_nop 1
    v_add_f32 v10, v10, v11
    v_mul_f32 v72, 0xbacccccd, v10
    v_pk_add_f32 v[32:33], v[32:33], v[72:73] op_sel_hi:[1,0]
    v_pk_mul_f32 v[10:11], v[32:33], v[32:33]
    v_pk_add_f32 v[34:35], v[34:35], v[72:73] op_sel_hi:[1,0]
    v_pk_fma_f32 v[10:11], v[34:35], v[34:35], v[10:11]
    v_pk_add_f32 v[36:37], v[36:37], v[72:73] op_sel_hi:[1,0]
    v_pk_fma_f32 v[10:11], v[36:37], v[36:37], v[10:11]
    v_pk_add_f32 v[38:39], v[38:39], v[72:73] op_sel_hi:[1,0]
    v_pk_fma_f32 v[10:11], v[38:39], v[38:39], v[10:11]
    v_pk_add_f32 v[40:41], v[40:41], v[72:73] op_sel_hi:[1,0]
    v_pk_fma_f32 v[10:11], v[40:41], v[40:41], v[10:11]
    v_pk_add_f32 v[42:43], v[42:43], v[72:73] op_sel_hi:[1,0]
    v_pk_fma_f32 v[10:11], v[42:43], v[42:43], v[10:11]
    v_pk_add_f32 v[44:45], v[44:45], v[72:73] op_sel_hi:[1,0]
    v_pk_fma_f32 v[10:11], v[44:45], v[44:45], v[10:11]
    v_pk_add_f32 v[46:47], v[46:47], v[72:73] op_sel_hi:[1,0]
    v_pk_fma_f32 v[10:11], v[46:47], v[46:47], v[10:11]
    v_pk_add_f32 v[48:49], v[48:49], v[72:73] op_sel_hi:[1,0]
    v_pk_fma_f32 v[10:11], v[48:49], v[48:49], v[10:11]
    v_pk_add_f32 v[50:51], v[50:51], v[72:73] op_sel_hi:[1,0]
    v_pk_fma_f32 v[10:11], v[50:51], v[50:51], v[10:11]
    v_pk_add_f32 v[52:53], v[52:53], v[72:73] op_sel_hi:[1,0]
    v_pk_fma_f32 v[10:11], v[52:53], v[52:53], v[10:11]
    v_pk_add_f32 v[54:55], v[54:55], v[72:73] op_sel_hi:[1,0]
    v_pk_fma_f32 v[10:11], v[54:55], v[54:55], v[10:11]
    v_pk_add_f32 v[56:57], v[56:57], v[72:73] op_sel_hi:[1,0]
    v_pk_fma_f32 v[10:11], v[56:57], v[56:57], v[10:11]
    v_pk_add_f32 v[58:59], v[58:59], v[72:73] op_sel_hi:[1,0]
    v_pk_fma_f32 v[10:11], v[58:59], v[58:59], v[10:11]
    v_pk_add_f32 v[60:61], v[60:61], v[72:73] op_sel_hi:[1,0]
    v_pk_fma_f32 v[10:11], v[60:61], v[60:61], v[10:11]
    v_pk_add_f32 v[62:63], v[62:63], v[72:73] op_sel_hi:[1,0]
    v_pk_fma_f32 v[10:11], v[62:63], v[62:63], v[10:11]
    v_pk_add_f32 v[64:65], v[64:65], v[72:73] op_sel_hi:[1,0]
    v_pk_fma_f32 v[10:11], v[64:65], v[64:65], v[10:11]
    v_pk_add_f32 v[66:67], v[66:67], v[72:73] op_sel_hi:[1,0]
    v_pk_fma_f32 v[10:11], v[66:67], v[66:67], v[10:11]
    v_pk_add_f32 v[68:69], v[68:69], v[72:73] op_sel_hi:[1,0]
    v_pk_fma_f32 v[10:11], v[68:69], v[68:69], v[10:11]
    v_pk_add_f32 v[70:71], v[70:71], v[72:73] op_sel_hi:[1,0]
    v_pk_fma_f32 v[10:11], v[70:71], v[70:71], v[10:11]
    v_add_f32 v10, v10, v11
    s_nop 1
    v_add_f32_dpp v10, v10, v10 row_ror:8 row_mask:0xf bank_mask:0xf
    s_nop 1
    v_add_f32_dpp v10, v10, v10 row_ror:4 row_mask:0xf bank_mask:0xf
    v_mov_b32 v11, v10
    s_nop 1
    v_permlane16_swap_b32 v10, v11
    s_nop 1
    v_add_f32 v10, v10, v11
    v_mov_b32 v11, v10
    s_nop 1
    v_permlane32_swap_b32 v10, v11
    s_nop 1
    v_add_f32 v10, v10, v11
    v_mov_b32 v11, 0x3727c5ac
    v_fmac_f32 v11, 0x3acccccd, v10
    v_rsq_f32 v11, v11
    s_nop 0
    v_mul_f32 v72, 0x3e0293ee, v11
    v_pk_mul_f32 v[32:33], v[32:33], v[72:73] op_sel_hi:[1,0]
    v_cvt_pk_bf16_f32 v12, v32, v33
    v_pk_mul_f32 v[34:35], v[34:35], v[72:73] op_sel_hi:[1,0]
    v_cvt_pk_bf16_f32 v13, v34, v35
    v_pk_mul_f32 v[36:37], v[36:37], v[72:73] op_sel_hi:[1,0]
    v_cvt_pk_bf16_f32 v14, v36, v37
    v_pk_mul_f32 v[38:39], v[38:39], v[72:73] op_sel_hi:[1,0]
    v_cvt_pk_bf16_f32 v15, v38, v39
    buffer_store_dwordx4 v[12:15], v9, s[60:63], s56 offen sc1
    s_add_u32 s56, s56, 16384
    v_pk_mul_f32 v[40:41], v[40:41], v[72:73] op_sel_hi:[1,0]
    v_cvt_pk_bf16_f32 v16, v40, v41
    v_pk_mul_f32 v[42:43], v[42:43], v[72:73] op_sel_hi:[1,0]
    v_cvt_pk_bf16_f32 v17, v42, v43
    v_pk_mul_f32 v[44:45], v[44:45], v[72:73] op_sel_hi:[1,0]
    v_cvt_pk_bf16_f32 v18, v44, v45
    v_pk_mul_f32 v[46:47], v[46:47], v[72:73] op_sel_hi:[1,0]
    v_cvt_pk_bf16_f32 v19, v46, v47
    buffer_store_dwordx4 v[16:19], v9, s[60:63], s56 offen sc1
    s_add_u32 s56, s56, 16384
    v_pk_mul_f32 v[48:49], v[48:49], v[72:73] op_sel_hi:[1,0]
    v_cvt_pk_bf16_f32 v20, v48, v49
    v_pk_mul_f32 v[50:51], v[50:51], v[72:73] op_sel_hi:[1,0]
    v_cvt_pk_bf16_f32 v21, v50, v51
    v_pk_mul_f32 v[52:53], v[52:53], v[72:73] op_sel_hi:[1,0]
    v_cvt_pk_bf16_f32 v22, v52, v53
    v_pk_mul_f32 v[54:55], v[54:55], v[72:73] op_sel_hi:[1,0]
    v_cvt_pk_bf16_f32 v23, v54, v55
    buffer_store_dwordx4 v[20:23], v9, s[60:63], s56 offen sc1
    s_add_u32 s56, s56, 16384
    v_pk_mul_f32 v[56:57], v[56:57], v[72:73] op_sel_hi:[1,0]
    v_cvt_pk_bf16_f32 v24, v56, v57
    v_pk_mul_f32 v[58:59], v[58:59], v[72:73] op_sel_hi:[1,0]
    v_cvt_pk_bf16_f32 v25, v58, v59
    v_pk_mul_f32 v[60:61], v[60:61], v[72:73] op_sel_hi:[1,0]
    v_cvt_pk_bf16_f32 v26, v60, v61
    v_pk_mul_f32 v[62:63], v[62:63], v[72:73] op_sel_hi:[1,0]
    v_cvt_pk_bf16_f32 v27, v62, v63
    buffer_store_dwordx4 v[24:27], v9, s[60:63], s56 offen sc1
    s_add_u32 s56, s56, 16384
    v_pk_mul_f32 v[64:65], v[64:65], v[72:73] op_sel_hi:[1,0]
    v_cvt_pk_bf16_f32 v28, v64, v65
    v_pk_mul_f32 v[66:67], v[66:67], v[72:73] op_sel_hi:[1,0]
    v_cvt_pk_bf16_f32 v29, v66, v67
    v_pk_mul_f32 v[68:69], v[68:69], v[72:73] op_sel_hi:[1,0]
    v_cvt_pk_bf16_f32 v30, v68, v69
    v_pk_mul_f32 v[70:71], v[70:71], v[72:73] op_sel_hi:[1,0]
    v_cvt_pk_bf16_f32 v31, v70, v71
    buffer_store_dwordx4 v[28:31], v9, s[60:63], s56 offen sc1
    s_add_u32 s56, s56, 16384
    s_lshl_b32 s50, s16, 8
    s_sub_u32 s51, 5242880, s50
    s_add_u32 s24, s72, s50
    s_addc_u32 s25, s73, 0
    s_mov_b32 s26, s51
    s_mov_b32 s27, 0x20000
    s_lshl_b32 s50, s16, 7
    s_sub_u32 s51, 2211840, s50
    s_cmp_lt_u32 s16, 27
    s_cselect_b32 s51, s51, 0
    s_cselect_b32 s50, s50, 0
    s_add_u32 s28, s52, s50
    s_addc_u32 s29, s53, 0
    s_mov_b32 s30, s51
    s_mov_b32 s31, 0x20000
K1_join:
    v_lshlrev_b32 v240, 4, v243
    v_lshrrev_b32 v244, 4, v243
    v_and_b32 v245, 15, v243
    v_lshrrev_b32 v246, 2, v245
    v_lshlrev_b32 v248, 2, v244
    v_xor_b32 v248, v248, v245
    v_lshlrev_b32 v248, 4, v248
    v_lshl_add_u32 v200, v244, 13, v248
    v_add_u32 v201, 31744, v200
    v_add_u32 v202, 63488, v200
    v_add_u32 v203, 95232, v200
    v_lshrrev_b32 v248, 3, v243
    v_and_b32 v249, 2, v248
    v_mul_u32_u24 v248, 3456, v248
    v_and_b32 v204, 7, v243
    v_xor_b32 v249, v249, v204
    v_lshl_add_u32 v204, v249, 4, v248
    v_xor_b32 v249, 4, v249
    v_lshl_add_u32 v205, v249, 4, v248
    v_add_u32 v205, 26624, v205
    s_mov_b32 s40, 0
    s_lshl_b32 s41, s3, 17
    s_mul_i32 s42, s3, 55296
    s_lshl_b32 s44, s3, 12
    s_lshl_b32 s45, s3, 11
    s_add_u32 s45, s45, 65536
    s_mul_i32 s50, s17, 81920
    s_add_u32 s50, s50, 0
    s_add_u32 s20, s12, s50
    s_addc_u32 s21, s13, 0
    s_mov_b32 s22, 81920
    s_mov_b32 s23, 0x20000
    v_cmp_gt_u32 vcc, 1, v243
    v_mov_b32 v74, 0x1000000
    v_lshlrev_b32 v75, 2, v243
    v_cndmask_b32 v74, v74, v75, vcc
    v_lshlrev_b32 v75, 7, v245
    s_barrier
    s_add_u32 m0, s45, 16384
    s_nop 0
    buffer_load_dwordx4 v204, s[28:31], s42 offen offset:0 lds
    buffer_load_dwordx4 v205, s[28:31], s42 offen offset:1024 lds
    s_add_u32 s42, s42, 221184
    s_add_u32 m0, s44, 16384
    s_nop 0
    buffer_load_dwordx4 v200, s[24:27], s41 offen offset:0 lds
    buffer_load_dwordx4 v201, s[24:27], s41 offen offset:1024 lds
    buffer_load_dwordx4 v202, s[24:27], s41 offen offset:2048 lds
    buffer_load_dwordx4 v203, s[24:27], s41 offen offset:3072 lds
    s_add_u32 s41, s41, 524288
    s_waitcnt lgkmcnt(0)
    s_mul_i32 s0, s0, 0x9e3779b1
    s_add_u32 s0, s0, 0x7f4a7c15
    v_mov_b32 v76, s0
    s_cmp_lt_u32 s3, 2
    s_cbranch_scc0 K1_noln
    s_waitcnt vmcnt(6)
    buffer_store_dword v76, v74, s[68:71], s57 offen offset:1024 sc1
K1_noln:
    s_barrier
    s_add_u32 m0, s45, 32768
    s_nop 0
    buffer_load_dwordx4 v204, s[28:31], s42 offen offset:0 lds
    buffer_load_dwordx4 v205, s[28:31], s42 offen offset:1024 lds
    s_add_u32 s42, s42, 221184
    s_add_u32 m0, s44, 32768
    s_nop 0
    buffer_load_dwordx4 v200, s[24:27], s41 offen offset:0 lds
    buffer_load_dwordx4 v201, s[24:27], s41 offen offset:1024 lds
    buffer_load_dwordx4 v202, s[24:27], s41 offen offset:2048 lds
    buffer_load_dwordx4 v203, s[24:27], s41 offen offset:3072 lds
    s_add_u32 s41, s41, 524288
    s_add_u32 m0, s45, 49152
    s_nop 0
    buffer_load_dwordx4 v204, s[28:31], s42 offen offset:0 lds
    buffer_load_dwordx4 v205, s[28:31], s42 offen offset:1024 lds
    s_add_u32 s42, s42, 221184
    s_add_u32 m0, s44, 49152
    s_nop 0
    buffer_load_dwordx4 v200, s[24:27], s41 offen offset:0 lds
    buffer_load_dwordx4 v201, s[24:27], s41 offen offset:1024 lds
    buffer_load_dwordx4 v202, s[24:27], s41 offen offset:2048 lds
    buffer_load_dwordx4 v203, s[24:27], s41 offen offset:3072 lds
    s_add_u32 s41, s41, 524288
    s_mov_b64 exec, 0
    s_cmp_eq_u32 s3, 0
    s_cbranch_scc1 K1_pg0
    s_cmp_eq_u32 s3, 1
    s_cbranch_scc1 K1_pg1
    s_cmp_eq_u32 s3, 2
    s_cbranch_scc1 K1_pg2
    s_cmp_eq_u32 s3, 3
    s_cbranch_scc1 K1_pg3
K1_wb0:
    s_mov_b64 exec, -1
    s_lshl_b32 s57, s17, 11
    s_mov_b32 s47, 0
    buffer_load_dword v77, v75, s[68:71], s57 offen offset:1024 sc1
    v_lshl_add_u32 v248, v244, 3, v246
    v_lshlrev_b32 v249, 4, v247
    v_lshl_add_u32 v249, v248, 8, v249
    v_xor_b32 v192, 0, v246
    v_lshl_add_u32 v192, v192, 6, v249
    v_xor_b32 v193, 1, v246
    v_lshl_add_u32 v193, v193, 6, v249
    v_xor_b32 v194, 2, v246
    v_lshl_add_u32 v194, v194, 6, v249
    v_xor_b32 v195, 3, v246
    v_lshl_add_u32 v195, v195, 6, v249
    v_lshlrev_b32 v249, 3, v247
    v_lshl_add_u32 v249, v248, 7, v249
    v_add_u32 v249, 65536, v249
    v_and_b32 v248, 1, v244
    v_lshlrev_b32 v248, 1, v248
    v_lshrrev_b32 v196, 1, v246
    v_or_b32 v248, v248, v196
    v_xor_b32 v196, 0, v248
    v_lshl_add_u32 v196, v196, 5, v249
    v_xor_b32 v197, 1, v248
    v_lshl_add_u32 v197, v197, 5, v249
    v_xor_b32 v198, 2, v248
    v_lshl_add_u32 v198, v198, 5, v249
    v_xor_b32 v199, 3, v248
    v_lshl_add_u32 v199, v199, 5, v249
    s_lshr_b32 s50, s15, 2
    s_lshl_b32 s50, s50, 5
    s_add_u32 s50, s50, s16
    s_lshl_b32 s50, s50, 2
    v_cmp_eq_u32 vcc, 0, v0
    v_mov_b32 v251, 0x1000000
    v_mov_b32 v248, s50
    v_cndmask_b32 v251, v251, v248, vcc
K1_lnwait:
    s_waitcnt vmcnt(0)
    v_cmp_ne_u32 vcc, s0, v77
    s_add_u32 s47, s47, 1
    s_cmp_lt_u32 s47, 65536
    s_cbranch_vccz K1_lnok
    buffer_load_dword v77, v75, s[68:71], s57 offen offset:1024 sc1
    s_cbranch_scc1 K1_lnwait
    s_waitcnt vmcnt(0)
    s_branch K1_lnok
.p2align 12
K1_lnok:
K1_pg0:
    s_cbranch_execz K1_pg4
    s_mov_b32 s50, 4096
    s_mov_b32 s40, 8192
    buffer_load_dwordx4 a[64:67], v240, s[20:23], 0 offen offset:0 sc1
    buffer_load_dwordx4 a[80:83], v240, s[20:23], s50 offen offset:0 sc1
    buffer_load_dwordx4 a[68:71], v240, s[20:23], 0 offen offset:1024 sc1
    buffer_load_dwordx4 a[84:87], v240, s[20:23], s50 offen offset:1024 sc1
    buffer_load_dwordx4 a[72:75], v240, s[20:23], 0 offen offset:2048 sc1
    buffer_load_dwordx4 a[88:91], v240, s[20:23], s50 offen offset:2048 sc1
    buffer_load_dwordx4 a[76:79], v240, s[20:23], 0 offen offset:3072 sc1
    buffer_load_dwordx4 a[92:95], v240, s[20:23], s50 offen offset:3072 sc1
    s_lshl_b32 s58, s2, 2
    s_add_u32 s58, s58, s3
    s_mul_i32 s56, s58, 13108
    s_lshr_b32 s56, s56, 16
    s_mul_i32 s57, s56, 5
    s_sub_u32 s57, s58, s57
    s_cmp_lt_u32 s56, 128
    s_cselect_b32 s60, s74, s54
    s_cselect_b32 s61, s75, s55
    s_mov_b32 s62, 2211840
    s_cselect_b32 s62, 5242880, s62
    s_mov_b32 s63, 0x20000
    s_and_b32 s19, s56, 127
    s_mul_i32 s19, s19, 40960
    s_lshl_b32 s50, s57, 8
    s_add_u32 s19, s19, s50
    s_cmp_lt_u32 s56, 182
    s_cselect_b32 s51, 7454720, 0
    s_add_u32 s64, s12, 3145728
    s_addc_u32 s65, s13, 0
    s_mov_b32 s66, s51
    s_mov_b32 s67, 0x20000
    s_mul_i32 s56, s56, 5120
    s_lshl_b32 s57, s57, 3
    s_add_u32 s58, s57, 0
    s_mul_i32 s59, s58, 205
    s_lshr_b32 s59, s59, 10
    s_mul_i32 s59, s59, 926720
    s_lshl_b32 s58, s58, 10
    s_add_u32 s58, s58, s59
    s_add_u32 s72, s58, s56
    s_add_u32 s58, s57, 1
    s_mul_i32 s59, s58, 205
    s_lshr_b32 s59, s59, 10
    s_mul_i32 s59, s59, 926720
    s_lshl_b32 s58, s58, 10
    s_add_u32 s58, s58, s59
    s_add_u32 s73, s58, s56
    s_add_u32 s58, s57, 2
    s_mul_i32 s59, s58, 205
    s_lshr_b32 s59, s59, 10
    s_mul_i32 s59, s59, 926720
    s_lshl_b32 s58, s58, 10
    s_add_u32 s58, s58, s59
    s_add_u32 s74, s58, s56
    s_add_u32 s58, s57, 3
    s_mul_i32 s59, s58, 205
    s_lshr_b32 s59, s59, 10
    s_mul_i32 s59, s59, 926720
    s_lshl_b32 s58, s58, 10
    s_add_u32 s58, s58, s59
    s_add_u32 s75, s58, s56
    s_add_u32 s58, s57, 4
    s_mul_i32 s59, s58, 205
    s_lshr_b32 s59, s59, 10
    s_mul_i32 s59, s59, 926720
    s_lshl_b32 s58, s58, 10
    s_add_u32 s58, s58, s59
    s_add_u32 s76, s58, s56
    s_add_u32 s58, s57, 5
    s_mul_i32 s59, s58, 205
    s_lshr_b32 s59, s59, 10
    s_mul_i32 s59, s59, 926720
    s_lshl_b32 s58, s58, 10
    s_add_u32 s58, s58, s59
    s_add_u32 s77, s58, s56
    s_add_u32 s58, s57, 6
    s_mul_i32 s59, s58, 205
    s_lshr_b32 s59, s59, 10
    s_mul_i32 s59, s59, 926720
    s_lshl_b32 s58, s58, 10
    s_add_u32 s58, s58, s59
    s_add_u32 s78, s58, s56
    s_add_u32 s58, s57, 7
    s_mul_i32 s59, s58, 205
    s_lshr_b32 s59, s59, 10
    s_mul_i32 s59, s59, 926720
    s_lshl_b32 s58, s58, 10
    s_add_u32 s58, s58, s59
    s_add_u32 s79, s58, s56
    s_lshl_b32 s58, s3, 11
    s_add_u32 s58, s58, 131072
    s_barrier
    ds_read_b64_tr_b16 v[128:129], v192 offset:16384
    ds_read_b64_tr_b16 v[130:131], v192 offset:17408
    ds_read_b64_tr_b16 v[132:133], v192 offset:24576
    ds_read_b64_tr_b16 v[134:135], v192 offset:25600
    ds_read_b64_tr_b16 v[136:137], v192 offset:16392
    ds_read_b64_tr_b16 v[138:139], v192 offset:17416
    ds_read_b64_tr_b16 v[140:141], v192 offset:24584
    ds_read_b64_tr_b16 v[142:143], v192 offset:25608
    ds_read_b64_tr_b16 v[144:145], v193 offset:16384
    ds_read_b64_tr_b16 v[146:147], v193 offset:17408
    ds_read_b64_tr_b16 v[148:149], v193 offset:24576
    ds_read_b64_tr_b16 v[150:151], v193 offset:25600
    ds_read_b64_tr_b16 v[152:153], v193 offset:16392
    ds_read_b64_tr_b16 v[154:155], v193 offset:17416
    ds_read_b64_tr_b16 v[156:157], v193 offset:24584
    ds_read_b64_tr_b16 v[158:159], v193 offset:25608
    s_waitcnt vmcnt(6)
    s_waitcnt lgkmcnt(8)
    v_mfma_f32_16x16x32_bf16 v[0:3], v[128:131], a[64:67], 0
    ds_read_b64_tr_b16 v[160:161], v194 offset:16384
    v_mfma_f32_16x16x32_bf16 v[0:3], v[132:135], a[80:83], v[0:3]
    buffer_load_dwordx4 a[96:99], v240, s[20:23], s40 offen offset:0 sc1
    s_waitcnt vmcnt(5)
    v_mfma_f32_16x16x32_bf16 v[32:35], v[132:135], a[84:87], 0
    ds_read_b64_tr_b16 v[162:163], v194 offset:17408
    v_mfma_f32_16x16x32_bf16 v[32:35], v[128:131], a[68:71], v[32:35]
    s_waitcnt vmcnt(3)
    v_mfma_f32_16x16x32_bf16 v[64:67], v[128:131], a[72:75], 0
    ds_read_b64_tr_b16 v[164:165], v194 offset:24576
    v_mfma_f32_16x16x32_bf16 v[64:67], v[132:135], a[88:91], v[64:67]
    buffer_load_dwordx4 a[100:103], v240, s[20:23], s40 offen offset:1024 sc1
    s_waitcnt vmcnt(2)
    v_mfma_f32_16x16x32_bf16 v[96:99], v[132:135], a[92:95], 0
    ds_read_b64_tr_b16 v[166:167], v194 offset:25600
    v_mfma_f32_16x16x32_bf16 v[96:99], v[128:131], a[76:79], v[96:99]
    v_mfma_f32_16x16x32_bf16 v[100:103], v[136:139], a[76:79], 0
    ds_read_b64_tr_b16 v[168:169], v194 offset:16392
    v_mfma_f32_16x16x32_bf16 v[100:103], v[140:143], a[92:95], v[100:103]
    buffer_load_dwordx4 a[104:107], v240, s[20:23], s40 offen offset:2048 sc1
    v_mfma_f32_16x16x32_bf16 v[68:71], v[140:143], a[88:91], 0
    ds_read_b64_tr_b16 v[170:171], v194 offset:17416
    v_mfma_f32_16x16x32_bf16 v[68:71], v[136:139], a[72:75], v[68:71]
    v_mfma_f32_16x16x32_bf16 v[36:39], v[136:139], a[68:71], 0
    ds_read_b64_tr_b16 v[172:173], v194 offset:24584
    v_mfma_f32_16x16x32_bf16 v[36:39], v[140:143], a[84:87], v[36:39]
    buffer_load_dwordx4 a[108:111], v240, s[20:23], s40 offen offset:3072 sc1
    v_mfma_f32_16x16x32_bf16 v[4:7], v[140:143], a[80:83], 0
    ds_read_b64_tr_b16 v[174:175], v194 offset:25608
    s_add_u32 s40, s40, 4096
    v_mfma_f32_16x16x32_bf16 v[4:7], v[136:139], a[64:67], v[4:7]
    s_waitcnt lgkmcnt(8)
    v_mfma_f32_16x16x32_bf16 v[8:11], v[144:147], a[64:67], 0
    ds_read_b64_tr_b16 v[176:177], v195 offset:16384
    v_mfma_f32_16x16x32_bf16 v[8:11], v[148:151], a[80:83], v[8:11]
    buffer_load_dwordx4 a[112:115], v240, s[20:23], s40 offen offset:0 sc1
    v_mfma_f32_16x16x32_bf16 v[40:43], v[148:151], a[84:87], 0
    ds_read_b64_tr_b16 v[178:179], v195 offset:17408
    v_mfma_f32_16x16x32_bf16 v[40:43], v[144:147], a[68:71], v[40:43]
    v_mfma_f32_16x16x32_bf16 v[72:75], v[144:147], a[72:75], 0
    ds_read_b64_tr_b16 v[180:181], v195 offset:24576
    v_mfma_f32_16x16x32_bf16 v[72:75], v[148:151], a[88:91], v[72:75]
    buffer_load_dwordx4 a[116:119], v240, s[20:23], s40 offen offset:1024 sc1
    v_mfma_f32_16x16x32_bf16 v[104:107], v[148:151], a[92:95], 0
    ds_read_b64_tr_b16 v[182:183], v195 offset:25600
    v_mfma_f32_16x16x32_bf16 v[104:107], v[144:147], a[76:79], v[104:107]
    v_mfma_f32_16x16x32_bf16 v[108:111], v[152:155], a[76:79], 0
    ds_read_b64_tr_b16 v[184:185], v195 offset:16392
    v_mfma_f32_16x16x32_bf16 v[108:111], v[156:159], a[92:95], v[108:111]
    buffer_load_dwordx4 a[120:123], v240, s[20:23], s40 offen offset:2048 sc1
    v_mfma_f32_16x16x32_bf16 v[76:79], v[156:159], a[88:91], 0
    ds_read_b64_tr_b16 v[186:187], v195 offset:17416
    v_mfma_f32_16x16x32_bf16 v[76:79], v[152:155], a[72:75], v[76:79]
    v_mfma_f32_16x16x32_bf16 v[44:47], v[152:155], a[68:71], 0
    ds_read_b64_tr_b16 v[188:189], v195 offset:24584
    v_mfma_f32_16x16x32_bf16 v[44:47], v[156:159], a[84:87], v[44:47]
    buffer_load_dwordx4 a[124:127], v240, s[20:23], s40 offen offset:3072 sc1
    v_mfma_f32_16x16x32_bf16 v[12:15], v[156:159], a[80:83], 0
    ds_read_b64_tr_b16 v[190:191], v195 offset:25608
    s_add_u32 s40, s40, 4096
    v_mfma_f32_16x16x32_bf16 v[12:15], v[152:155], a[64:67], v[12:15]
    s_waitcnt lgkmcnt(8)
    v_mfma_f32_16x16x32_bf16 v[16:19], v[160:163], a[64:67], 0
    ds_read_b64_tr_b16 v[128:129], v196 offset:16384
    v_mfma_f32_16x16x32_bf16 v[16:19], v[164:167], a[80:83], v[16:19]
    buffer_load_dwordx4 a[128:131], v240, s[20:23], s40 offen offset:0 sc1
    v_mfma_f32_16x16x32_bf16 v[48:51], v[164:167], a[84:87], 0
    ds_read_b64_tr_b16 v[130:131], v196 offset:16896
    v_mfma_f32_16x16x32_bf16 v[48:51], v[160:163], a[68:71], v[48:51]
    v_mfma_f32_16x16x32_bf16 v[80:83], v[160:163], a[72:75], 0
    ds_read_b64_tr_b16 v[132:133], v196 offset:20480
    v_mfma_f32_16x16x32_bf16 v[80:83], v[164:167], a[88:91], v[80:83]
    buffer_load_dwordx4 a[132:135], v240, s[20:23], s40 offen offset:1024 sc1
    v_mfma_f32_16x16x32_bf16 v[112:115], v[164:167], a[92:95], 0
    ds_read_b64_tr_b16 v[134:135], v196 offset:20992
    v_mfma_f32_16x16x32_bf16 v[112:115], v[160:163], a[76:79], v[112:115]
    v_mfma_f32_16x16x32_bf16 v[116:119], v[168:171], a[76:79], 0
    ds_read_b64_tr_b16 v[136:137], v197 offset:16384
    v_mfma_f32_16x16x32_bf16 v[116:119], v[172:175], a[92:95], v[116:119]
    buffer_load_dwordx4 a[136:139], v240, s[20:23], s40 offen offset:2048 sc1
    v_mfma_f32_16x16x32_bf16 v[84:87], v[172:175], a[88:91], 0
    ds_read_b64_tr_b16 v[138:139], v197 offset:16896
    v_mfma_f32_16x16x32_bf16 v[84:87], v[168:171], a[72:75], v[84:87]
    v_mfma_f32_16x16x32_bf16 v[52:55], v[168:171], a[68:71], 0
    ds_read_b64_tr_b16 v[140:141], v197 offset:20480
    v_mfma_f32_16x16x32_bf16 v[52:55], v[172:175], a[84:87], v[52:55]
    buffer_load_dwordx4 a[140:143], v240, s[20:23], s40 offen offset:3072 sc1
    v_mfma_f32_16x16x32_bf16 v[20:23], v[172:175], a[80:83], 0
    ds_read_b64_tr_b16 v[142:143], v197 offset:20992
    s_add_u32 s40, s40, 4096
    v_mfma_f32_16x16x32_bf16 v[20:23], v[168:171], a[64:67], v[20:23]
    s_waitcnt lgkmcnt(8)
    v_mfma_f32_16x16x32_bf16 v[24:27], v[176:179], a[64:67], 0
    ds_read_b64_tr_b16 v[144:145], v198 offset:16384
    v_mfma_f32_16x16x32_bf16 v[24:27], v[180:183], a[80:83], v[24:27]
    buffer_load_dwordx4 a[144:147], v240, s[20:23], s40 offen offset:0 sc1
    v_mfma_f32_16x16x32_bf16 v[56:59], v[180:183], a[84:87], 0
    ds_read_b64_tr_b16 v[146:147], v198 offset:16896
    v_mfma_f32_16x16x32_bf16 v[56:59], v[176:179], a[68:71], v[56:59]
    v_mfma_f32_16x16x32_bf16 v[88:91], v[176:179], a[72:75], 0
    ds_read_b64_tr_b16 v[148:149], v198 offset:20480
    v_mfma_f32_16x16x32_bf16 v[88:91], v[180:183], a[88:91], v[88:91]
    buffer_load_dwordx4 a[148:151], v240, s[20:23], s40 offen offset:1024 sc1
    v_mfma_f32_16x16x32_bf16 v[120:123], v[180:183], a[92:95], 0
    ds_read_b64_tr_b16 v[150:151], v198 offset:20992
    v_mfma_f32_16x16x32_bf16 v[120:123], v[176:179], a[76:79], v[120:123]
    v_mfma_f32_16x16x32_bf16 v[124:127], v[184:187], a[76:79], 0
    ds_read_b64_tr_b16 v[152:153], v199 offset:16384
    v_mfma_f32_16x16x32_bf16 v[124:127], v[188:191], a[92:95], v[124:127]
    buffer_load_dwordx4 a[152:155], v240, s[20:23], s40 offen offset:2048 sc1
    v_mfma_f32_16x16x32_bf16 v[92:95], v[188:191], a[88:91], 0
    ds_read_b64_tr_b16 v[154:155], v199 offset:16896
    v_mfma_f32_16x16x32_bf16 v[92:95], v[184:187], a[72:75], v[92:95]
    v_mfma_f32_16x16x32_bf16 v[60:63], v[184:187], a[68:71], 0
    ds_read_b64_tr_b16 v[156:157], v199 offset:20480
    v_mfma_f32_16x16x32_bf16 v[60:63], v[188:191], a[84:87], v[60:63]
    buffer_load_dwordx4 a[156:159], v240, s[20:23], s40 offen offset:3072 sc1
    v_mfma_f32_16x16x32_bf16 v[28:31], v[188:191], a[80:83], 0
    ds_read_b64_tr_b16 v[158:159], v199 offset:20992
    s_add_u32 s40, s40, 4096
    v_mfma_f32_16x16x32_bf16 v[28:31], v[184:187], a[64:67], v[28:31]
    s_barrier
    s_waitcnt lgkmcnt(8)
    v_mfma_f32_16x16x32_bf16 a[192:195], v[128:131], a[64:67], 0
    ds_read_b64_tr_b16 v[160:161], v192 offset:32768
    v_mfma_f32_16x16x32_bf16 a[192:195], v[132:135], a[80:83], a[192:195]
    v_mfma_f32_16x16x32_bf16 a[200:203], v[132:135], a[84:87], 0
    ds_read_b64_tr_b16 v[162:163], v192 offset:33792
    v_mfma_f32_16x16x32_bf16 a[200:203], v[128:131], a[68:71], a[200:203]
    v_mfma_f32_16x16x32_bf16 a[208:211], v[128:131], a[72:75], 0
    ds_read_b64_tr_b16 v[164:165], v192 offset:40960
    v_mfma_f32_16x16x32_bf16 a[208:211], v[132:135], a[88:91], a[208:211]
    v_mfma_f32_16x16x32_bf16 a[216:219], v[132:135], a[92:95], 0
    ds_read_b64_tr_b16 v[166:167], v192 offset:41984
    v_mfma_f32_16x16x32_bf16 a[216:219], v[128:131], a[76:79], a[216:219]
    v_mfma_f32_16x16x32_bf16 a[220:223], v[136:139], a[76:79], 0
    ds_read_b64_tr_b16 v[168:169], v192 offset:32776
    v_mfma_f32_16x16x32_bf16 a[220:223], v[140:143], a[92:95], a[220:223]
    v_mfma_f32_16x16x32_bf16 a[212:215], v[140:143], a[88:91], 0
    ds_read_b64_tr_b16 v[170:171], v192 offset:33800
    v_mfma_f32_16x16x32_bf16 a[212:215], v[136:139], a[72:75], a[212:215]
    v_mfma_f32_16x16x32_bf16 a[204:207], v[136:139], a[68:71], 0
    ds_read_b64_tr_b16 v[172:173], v192 offset:40968
    v_mfma_f32_16x16x32_bf16 a[204:207], v[140:143], a[84:87], a[204:207]
    v_mfma_f32_16x16x32_bf16 a[196:199], v[140:143], a[80:83], 0
    ds_read_b64_tr_b16 v[174:175], v192 offset:41992
    v_mfma_f32_16x16x32_bf16 a[196:199], v[136:139], a[64:67], a[196:199]
    s_waitcnt lgkmcnt(8)
    v_mfma_f32_16x16x32_bf16 a[224:227], v[144:147], a[64:67], 0
    ds_read_b64_tr_b16 v[176:177], v193 offset:32768
    v_mfma_f32_16x16x32_bf16 a[224:227], v[148:151], a[80:83], a[224:227]
    v_mfma_f32_16x16x32_bf16 a[232:235], v[148:151], a[84:87], 0
    ds_read_b64_tr_b16 v[178:179], v193 offset:33792
    v_mfma_f32_16x16x32_bf16 a[232:235], v[144:147], a[68:71], a[232:235]
    v_mfma_f32_16x16x32_bf16 a[240:243], v[144:147], a[72:75], 0
    ds_read_b64_tr_b16 v[180:181], v193 offset:40960
    v_mfma_f32_16x16x32_bf16 a[240:243], v[148:151], a[88:91], a[240:243]
    v_mfma_f32_16x16x32_bf16 a[248:251], v[148:151], a[92:95], 0
    ds_read_b64_tr_b16 v[182:183], v193 offset:41984
    v_mfma_f32_16x16x32_bf16 a[248:251], v[144:147], a[76:79], a[248:251]
    v_mfma_f32_16x16x32_bf16 a[252:255], v[152:155], a[76:79], 0
    ds_read_b64_tr_b16 v[184:185], v193 offset:32776
    v_mfma_f32_16x16x32_bf16 a[252:255], v[156:159], a[92:95], a[252:255]
    v_mfma_f32_16x16x32_bf16 a[244:247], v[156:159], a[88:91], 0
    ds_read_b64_tr_b16 v[186:187], v193 offset:33800
    v_mfma_f32_16x16x32_bf16 a[244:247], v[152:155], a[72:75], a[244:247]
    v_mfma_f32_16x16x32_bf16 a[236:239], v[152:155], a[68:71], 0
    ds_read_b64_tr_b16 v[188:189], v193 offset:40968
    v_mfma_f32_16x16x32_bf16 a[236:239], v[156:159], a[84:87], a[236:239]
    v_mfma_f32_16x16x32_bf16 a[228:231], v[156:159], a[80:83], 0
    ds_read_b64_tr_b16 v[190:191], v193 offset:41992
    v_mfma_f32_16x16x32_bf16 a[228:231], v[152:155], a[64:67], a[228:231]
    s_waitcnt vmcnt(8) lgkmcnt(8)
    v_mfma_f32_16x16x32_bf16 v[0:3], v[160:163], a[96:99], v[0:3]
    ds_read_b64_tr_b16 v[128:129], v194 offset:32768
    s_add_u32 m0, s45, 0
    v_mfma_f32_16x16x32_bf16 v[0:3], v[164:167], a[112:115], v[0:3]
    buffer_load_dwordx4 v204, s[28:31], s42 offen offset:0 lds
    v_mfma_f32_16x16x32_bf16 v[32:35], v[164:167], a[116:119], v[32:35]
    ds_read_b64_tr_b16 v[130:131], v194 offset:33792
    v_mfma_f32_16x16x32_bf16 v[32:35], v[160:163], a[100:103], v[32:35]
    v_mfma_f32_16x16x32_bf16 v[64:67], v[160:163], a[104:107], v[64:67]
    ds_read_b64_tr_b16 v[132:133], v194 offset:40960
    v_mfma_f32_16x16x32_bf16 v[64:67], v[164:167], a[120:123], v[64:67]
    v_mfma_f32_16x16x32_bf16 v[96:99], v[164:167], a[124:127], v[96:99]
    ds_read_b64_tr_b16 v[134:135], v194 offset:41984
    v_mfma_f32_16x16x32_bf16 v[96:99], v[160:163], a[108:111], v[96:99]
    buffer_load_dwordx4 v205, s[28:31], s42 offen offset:1024 lds
    v_mfma_f32_16x16x32_bf16 v[100:103], v[168:171], a[108:111], v[100:103]
    ds_read_b64_tr_b16 v[136:137], v194 offset:32776
    s_add_u32 s42, s42, 221184
    v_mfma_f32_16x16x32_bf16 v[100:103], v[172:175], a[124:127], v[100:103]
    s_add_u32 m0, s44, 0
    v_mfma_f32_16x16x32_bf16 v[68:71], v[172:175], a[120:123], v[68:71]
    ds_read_b64_tr_b16 v[138:139], v194 offset:33800
    v_mfma_f32_16x16x32_bf16 v[68:71], v[168:171], a[104:107], v[68:71]
    v_mfma_f32_16x16x32_bf16 v[36:39], v[168:171], a[100:103], v[36:39]
    ds_read_b64_tr_b16 v[140:141], v194 offset:40968
    v_mfma_f32_16x16x32_bf16 v[36:39], v[172:175], a[116:119], v[36:39]
    buffer_load_dwordx4 v200, s[24:27], s41 offen offset:0 lds
    v_mfma_f32_16x16x32_bf16 v[4:7], v[172:175], a[112:115], v[4:7]
    ds_read_b64_tr_b16 v[142:143], v194 offset:41992
    v_mfma_f32_16x16x32_bf16 v[4:7], v[168:171], a[96:99], v[4:7]
    s_waitcnt lgkmcnt(8)
    v_mfma_f32_16x16x32_bf16 v[8:11], v[176:179], a[96:99], v[8:11]
    ds_read_b64_tr_b16 v[144:145], v195 offset:32768
    v_mfma_f32_16x16x32_bf16 v[8:11], v[180:183], a[112:115], v[8:11]
    v_mfma_f32_16x16x32_bf16 v[40:43], v[180:183], a[116:119], v[40:43]
    ds_read_b64_tr_b16 v[146:147], v195 offset:33792
    v_mfma_f32_16x16x32_bf16 v[40:43], v[176:179], a[100:103], v[40:43]
    buffer_load_dwordx4 v201, s[24:27], s41 offen offset:1024 lds
    v_mfma_f32_16x16x32_bf16 v[72:75], v[176:179], a[104:107], v[72:75]
    ds_read_b64_tr_b16 v[148:149], v195 offset:40960
    v_mfma_f32_16x16x32_bf16 v[72:75], v[180:183], a[120:123], v[72:75]
    v_mfma_f32_16x16x32_bf16 v[104:107], v[180:183], a[124:127], v[104:107]
    ds_read_b64_tr_b16 v[150:151], v195 offset:41984
    v_mfma_f32_16x16x32_bf16 v[104:107], v[176:179], a[108:111], v[104:107]
    v_mfma_f32_16x16x32_bf16 v[108:111], v[184:187], a[108:111], v[108:111]
    ds_read_b64_tr_b16 v[152:153], v195 offset:32776
    v_mfma_f32_16x16x32_bf16 v[108:111], v[188:191], a[124:127], v[108:111]
    buffer_load_dwordx4 v202, s[24:27], s41 offen offset:2048 lds
    v_mfma_f32_16x16x32_bf16 v[76:79], v[188:191], a[120:123], v[76:79]
    ds_read_b64_tr_b16 v[154:155], v195 offset:33800
    v_mfma_f32_16x16x32_bf16 v[76:79], v[184:187], a[104:107], v[76:79]
    v_mfma_f32_16x16x32_bf16 v[44:47], v[184:187], a[100:103], v[44:47]
    ds_read_b64_tr_b16 v[156:157], v195 offset:40968
    v_mfma_f32_16x16x32_bf16 v[44:47], v[188:191], a[116:119], v[44:47]
    v_mfma_f32_16x16x32_bf16 v[12:15], v[188:191], a[112:115], v[12:15]
    ds_read_b64_tr_b16 v[158:159], v195 offset:41992
    v_mfma_f32_16x16x32_bf16 v[12:15], v[184:187], a[96:99], v[12:15]
    s_waitcnt lgkmcnt(8)
    v_mfma_f32_16x16x32_bf16 v[16:19], v[128:131], a[96:99], v[16:19]
    ds_read_b64_tr_b16 v[160:161], v196 offset:32768
    v_mfma_f32_16x16x32_bf16 v[16:19], v[132:135], a[112:115], v[16:19]
    buffer_load_dwordx4 v203, s[24:27], s41 offen offset:3072 lds
    v_mfma_f32_16x16x32_bf16 v[48:51], v[132:135], a[116:119], v[48:51]
    ds_read_b64_tr_b16 v[162:163], v196 offset:33280
    s_add_u32 s41, s41, 524288
    v_mfma_f32_16x16x32_bf16 v[48:51], v[128:131], a[100:103], v[48:51]
    v_mfma_f32_16x16x32_bf16 v[80:83], v[128:131], a[104:107], v[80:83]
    ds_read_b64_tr_b16 v[164:165], v196 offset:36864
    v_mfma_f32_16x16x32_bf16 v[80:83], v[132:135], a[120:123], v[80:83]
    v_mfma_f32_16x16x32_bf16 v[112:115], v[132:135], a[124:127], v[112:115]
    ds_read_b64_tr_b16 v[166:167], v196 offset:37376
    v_mfma_f32_16x16x32_bf16 v[112:115], v[128:131], a[108:111], v[112:115]
    buffer_load_dwordx4 a[160:163], v240, s[20:23], s40 offen offset:0 sc1
    v_mfma_f32_16x16x32_bf16 v[116:119], v[136:139], a[108:111], v[116:119]
    ds_read_b64_tr_b16 v[168:169], v197 offset:32768
    v_mfma_f32_16x16x32_bf16 v[116:119], v[140:143], a[124:127], v[116:119]
    v_mfma_f32_16x16x32_bf16 v[84:87], v[140:143], a[120:123], v[84:87]
    ds_read_b64_tr_b16 v[170:171], v197 offset:33280
    v_mfma_f32_16x16x32_bf16 v[84:87], v[136:139], a[104:107], v[84:87]
    v_mfma_f32_16x16x32_bf16 v[52:55], v[136:139], a[100:103], v[52:55]
    ds_read_b64_tr_b16 v[172:173], v197 offset:36864
    v_mfma_f32_16x16x32_bf16 v[52:55], v[140:143], a[116:119], v[52:55]
    buffer_load_dwordx4 a[164:167], v240, s[20:23], s40 offen offset:1024 sc1
    v_mfma_f32_16x16x32_bf16 v[20:23], v[140:143], a[112:115], v[20:23]
    ds_read_b64_tr_b16 v[174:175], v197 offset:37376
    v_mfma_f32_16x16x32_bf16 v[20:23], v[136:139], a[96:99], v[20:23]
    s_waitcnt lgkmcnt(8)
    v_mfma_f32_16x16x32_bf16 v[24:27], v[144:147], a[96:99], v[24:27]
    ds_read_b64_tr_b16 v[176:177], v198 offset:32768
    v_mfma_f32_16x16x32_bf16 v[24:27], v[148:151], a[112:115], v[24:27]
    v_mfma_f32_16x16x32_bf16 v[56:59], v[148:151], a[116:119], v[56:59]
    ds_read_b64_tr_b16 v[178:179], v198 offset:33280
    v_mfma_f32_16x16x32_bf16 v[56:59], v[144:147], a[100:103], v[56:59]
    buffer_load_dwordx4 a[168:171], v240, s[20:23], s40 offen offset:2048 sc1
    v_mfma_f32_16x16x32_bf16 v[88:91], v[144:147], a[104:107], v[88:91]
    ds_read_b64_tr_b16 v[180:181], v198 offset:36864
    v_mfma_f32_16x16x32_bf16 v[88:91], v[148:151], a[120:123], v[88:91]
    v_mfma_f32_16x16x32_bf16 v[120:123], v[148:151], a[124:127], v[120:123]
    ds_read_b64_tr_b16 v[182:183], v198 offset:37376
    v_mfma_f32_16x16x32_bf16 v[120:123], v[144:147], a[108:111], v[120:123]
    v_mfma_f32_16x16x32_bf16 v[124:127], v[152:155], a[108:111], v[124:127]
    ds_read_b64_tr_b16 v[184:185], v199 offset:32768
    v_mfma_f32_16x16x32_bf16 v[124:127], v[156:159], a[124:127], v[124:127]
    buffer_load_dwordx4 a[172:175], v240, s[20:23], s40 offen offset:3072 sc1
    v_mfma_f32_16x16x32_bf16 v[92:95], v[156:159], a[120:123], v[92:95]
    ds_read_b64_tr_b16 v[186:187], v199 offset:33280
    s_add_u32 s40, s40, 4096
    v_mfma_f32_16x16x32_bf16 v[92:95], v[152:155], a[104:107], v[92:95]
    v_mfma_f32_16x16x32_bf16 v[60:63], v[152:155], a[100:103], v[60:63]
    ds_read_b64_tr_b16 v[188:189], v199 offset:36864
    v_mfma_f32_16x16x32_bf16 v[60:63], v[156:159], a[116:119], v[60:63]
    v_mfma_f32_16x16x32_bf16 v[28:31], v[156:159], a[112:115], v[28:31]
    ds_read_b64_tr_b16 v[190:191], v199 offset:37376
    v_mfma_f32_16x16x32_bf16 v[28:31], v[152:155], a[96:99], v[28:31]
    s_barrier
    s_waitcnt lgkmcnt(8)
    v_mfma_f32_16x16x32_bf16 a[192:195], v[160:163], a[96:99], a[192:195]
    ds_read_b64_tr_b16 v[128:129], v192 offset:49152
    v_mfma_f32_16x16x32_bf16 a[192:195], v[164:167], a[112:115], a[192:195]
    buffer_load_dwordx4 a[176:179], v240, s[20:23], s40 offen offset:0 sc1
    v_mfma_f32_16x16x32_bf16 a[200:203], v[164:167], a[116:119], a[200:203]
    ds_read_b64_tr_b16 v[130:131], v192 offset:50176
    v_mfma_f32_16x16x32_bf16 a[200:203], v[160:163], a[100:103], a[200:203]
    v_mfma_f32_16x16x32_bf16 a[208:211], v[160:163], a[104:107], a[208:211]
    ds_read_b64_tr_b16 v[132:133], v192 offset:57344
    v_mfma_f32_16x16x32_bf16 a[208:211], v[164:167], a[120:123], a[208:211]
    v_mfma_f32_16x16x32_bf16 a[216:219], v[164:167], a[124:127], a[216:219]
    ds_read_b64_tr_b16 v[134:135], v192 offset:58368
    v_mfma_f32_16x16x32_bf16 a[216:219], v[160:163], a[108:111], a[216:219]
    buffer_load_dwordx4 a[180:183], v240, s[20:23], s40 offen offset:1024 sc1
    v_mfma_f32_16x16x32_bf16 a[220:223], v[168:171], a[108:111], a[220:223]
    ds_read_b64_tr_b16 v[136:137], v192 offset:49160
    v_mfma_f32_16x16x32_bf16 a[220:223], v[172:175], a[124:127], a[220:223]
    v_mfma_f32_16x16x32_bf16 a[212:215], v[172:175], a[120:123], a[212:215]
    ds_read_b64_tr_b16 v[138:139], v192 offset:50184
    v_mfma_f32_16x16x32_bf16 a[212:215], v[168:171], a[104:107], a[212:215]
    v_mfma_f32_16x16x32_bf16 a[204:207], v[168:171], a[100:103], a[204:207]
    ds_read_b64_tr_b16 v[140:141], v192 offset:57352
    v_mfma_f32_16x16x32_bf16 a[204:207], v[172:175], a[116:119], a[204:207]
    buffer_load_dwordx4 a[184:187], v240, s[20:23], s40 offen offset:2048 sc1
    v_mfma_f32_16x16x32_bf16 a[196:199], v[172:175], a[112:115], a[196:199]
    ds_read_b64_tr_b16 v[142:143], v192 offset:58376
    v_mfma_f32_16x16x32_bf16 a[196:199], v[168:171], a[96:99], a[196:199]
    s_waitcnt lgkmcnt(8)
    v_mfma_f32_16x16x32_bf16 a[224:227], v[176:179], a[96:99], a[224:227]
    ds_read_b64_tr_b16 v[144:145], v193 offset:49152
    v_mfma_f32_16x16x32_bf16 a[224:227], v[180:183], a[112:115], a[224:227]
    v_mfma_f32_16x16x32_bf16 a[232:235], v[180:183], a[116:119], a[232:235]
    ds_read_b64_tr_b16 v[146:147], v193 offset:50176
    v_mfma_f32_16x16x32_bf16 a[232:235], v[176:179], a[100:103], a[232:235]
    buffer_load_dwordx4 a[188:191], v240, s[20:23], s40 offen offset:3072 sc1
    v_mfma_f32_16x16x32_bf16 a[240:243], v[176:179], a[104:107], a[240:243]
    ds_read_b64_tr_b16 v[148:149], v193 offset:57344
    s_add_u32 s40, s40, 4096
    v_mfma_f32_16x16x32_bf16 a[240:243], v[180:183], a[120:123], a[240:243]
    v_mfma_f32_16x16x32_bf16 a[248:251], v[180:183], a[124:127], a[248:251]
    ds_read_b64_tr_b16 v[150:151], v193 offset:58368
    v_mfma_f32_16x16x32_bf16 a[248:251], v[176:179], a[108:111], a[248:251]
    v_mfma_f32_16x16x32_bf16 a[252:255], v[184:187], a[108:111], a[252:255]
    ds_read_b64_tr_b16 v[152:153], v193 offset:49160
    v_mfma_f32_16x16x32_bf16 a[252:255], v[188:191], a[124:127], a[252:255]
    v_mfma_f32_16x16x32_bf16 a[244:247], v[188:191], a[120:123], a[244:247]
    ds_read_b64_tr_b16 v[154:155], v193 offset:50184
    v_mfma_f32_16x16x32_bf16 a[244:247], v[184:187], a[104:107], a[244:247]
    v_mfma_f32_16x16x32_bf16 a[236:239], v[184:187], a[100:103], a[236:239]
    ds_read_b64_tr_b16 v[156:157], v193 offset:57352
    v_mfma_f32_16x16x32_bf16 a[236:239], v[188:191], a[116:119], a[236:239]
    v_mfma_f32_16x16x32_bf16 a[228:231], v[188:191], a[112:115], a[228:231]
    ds_read_b64_tr_b16 v[158:159], v193 offset:58376
    v_mfma_f32_16x16x32_bf16 a[228:231], v[184:187], a[96:99], a[228:231]
    s_waitcnt vmcnt(14) lgkmcnt(8)
    v_mfma_f32_16x16x32_bf16 v[0:3], v[128:131], a[128:131], v[0:3]
    ds_read_b64_tr_b16 v[160:161], v194 offset:49152
    s_add_u32 m0, s45, 16384
    v_mfma_f32_16x16x32_bf16 v[0:3], v[132:135], a[144:147], v[0:3]
    buffer_load_dwordx4 v204, s[28:31], s42 offen offset:0 lds
    v_mfma_f32_16x16x32_bf16 v[32:35], v[132:135], a[148:151], v[32:35]
    ds_read_b64_tr_b16 v[162:163], v194 offset:50176
    s_mov_b32 s49, -4096
    v_mfma_f32_16x16x32_bf16 v[32:35], v[128:131], a[132:135], v[32:35]
    s_cmp_lt_u32 s3, 2
    s_cselect_b32 s4, s4, s6
    s_cselect_b32 s5, s5, s7
    s_cmp_lt_u32 s3, 2
    s_cselect_b32 s49, 12288, s49
    s_cselect_b32 s46, 0, 65536
    s_cmp_lt_u32 s3, 2
    s_cselect_b32 s6, 15, 7
    s_cselect_b32 s7, 0, 1
    v_mfma_f32_16x16x32_bf16 v[64:67], v[128:131], a[136:139], v[64:67]
    ds_read_b64_tr_b16 v[164:165], v194 offset:57344
    s_lshl_b32 s50, s16, 19
    v_mfma_f32_16x16x32_bf16 v[64:67], v[132:135], a[152:155], v[64:67]
    s_add_u32 s32, s4, s50
    s_addc_u32 s33, s5, 0
    s_mov_b32 s34, 524288
    s_mov_b32 s35, 0x20000
    v_mfma_f32_16x16x32_bf16 v[96:99], v[132:135], a[156:159], v[96:99]
    ds_read_b64_tr_b16 v[166:167], v194 offset:58368
    s_and_b32 s50, s3, 1
    v_mfma_f32_16x16x32_bf16 v[96:99], v[128:131], a[140:143], v[96:99]
    buffer_load_dwordx4 v205, s[28:31], s42 offen offset:1024 lds
    v_mfma_f32_16x16x32_bf16 v[100:103], v[136:139], a[140:143], v[100:103]
    ds_read_b64_tr_b16 v[168:169], v194 offset:49160
    s_add_u32 s42, s42, 221184
    v_mfma_f32_16x16x32_bf16 v[100:103], v[140:143], a[156:159], v[100:103]
    s_add_u32 m0, s44, 16384
    s_lshl_b32 s43, s50, 13
    s_add_u32 s46, s46, s43
    v_mfma_f32_16x16x32_bf16 v[68:71], v[140:143], a[152:155], v[68:71]
    ds_read_b64_tr_b16 v[170:171], v194 offset:50184
    s_mul_i32 s50, s17, 745472
    v_mfma_f32_16x16x32_bf16 v[68:71], v[136:139], a[136:139], v[68:71]
    s_add_u32 s50, s50, 11534336
    s_add_u32 s36, s12, s50
    s_addc_u32 s37, s13, 0
    s_mov_b32 s38, 745472
    v_mfma_f32_16x16x32_bf16 v[36:39], v[136:139], a[132:135], v[36:39]
    ds_read_b64_tr_b16 v[172:173], v194 offset:57352
    s_mov_b32 s39, 0x20000
    v_mfma_f32_16x16x32_bf16 v[36:39], v[140:143], a[148:151], v[36:39]
    buffer_load_dwordx4 v200, s[24:27], s41 offen offset:0 lds
    v_mfma_f32_16x16x32_bf16 v[4:7], v[140:143], a[144:147], v[4:7]
    ds_read_b64_tr_b16 v[174:175], v194 offset:58376
    s_mov_b32 s48, 0
    v_mfma_f32_16x16x32_bf16 v[4:7], v[136:139], a[128:131], v[4:7]
    v_add_u32 v248, 0, v244
    v_and_b32 v248, s6, v248
    s_waitcnt lgkmcnt(8)
    v_mfma_f32_16x16x32_bf16 v[8:11], v[144:147], a[128:131], v[8:11]
    ds_read_b64_tr_b16 v[176:177], v195 offset:49152
    v_lshlrev_b32 v248, s7, v248
    v_mfma_f32_16x16x32_bf16 v[8:11], v[148:151], a[144:147], v[8:11]
    v_xor_b32 v248, v248, v245
    v_mfma_f32_16x16x32_bf16 v[40:43], v[148:151], a[148:151], v[40:43]
    ds_read_b64_tr_b16 v[178:179], v195 offset:50176
    v_mfma_f32_16x16x32_bf16 v[40:43], v[144:147], a[132:135], v[40:43]
    buffer_load_dwordx4 v201, s[24:27], s41 offen offset:1024 lds
    v_mfma_f32_16x16x32_bf16 v[72:75], v[144:147], a[136:139], v[72:75]
    ds_read_b64_tr_b16 v[180:181], v195 offset:57344
    v_mfma_f32_16x16x32_bf16 v[72:75], v[148:151], a[152:155], v[72:75]
    v_mfma_f32_16x16x32_bf16 v[104:107], v[148:151], a[156:159], v[104:107]
    ds_read_b64_tr_b16 v[182:183], v195 offset:58368
    v_mfma_f32_16x16x32_bf16 v[104:107], v[144:147], a[140:143], v[104:107]
    v_mfma_f32_16x16x32_bf16 v[108:111], v[152:155], a[140:143], v[108:111]
    ds_read_b64_tr_b16 v[184:185], v195 offset:49160
    v_mfma_f32_16x16x32_bf16 v[108:111], v[156:159], a[156:159], v[108:111]
    buffer_load_dwordx4 v202, s[24:27], s41 offen offset:2048 lds
    v_mfma_f32_16x16x32_bf16 v[76:79], v[156:159], a[152:155], v[76:79]
    ds_read_b64_tr_b16 v[186:187], v195 offset:50184
    v_mfma_f32_16x16x32_bf16 v[76:79], v[152:155], a[136:139], v[76:79]
    v_mfma_f32_16x16x32_bf16 v[44:47], v[152:155], a[132:135], v[44:47]
    ds_read_b64_tr_b16 v[188:189], v195 offset:57352
    v_mfma_f32_16x16x32_bf16 v[44:47], v[156:159], a[148:151], v[44:47]
    v_mfma_f32_16x16x32_bf16 v[12:15], v[156:159], a[144:147], v[12:15]
    ds_read_b64_tr_b16 v[190:191], v195 offset:58376
    v_mfma_f32_16x16x32_bf16 v[12:15], v[152:155], a[128:131], v[12:15]
    s_waitcnt lgkmcnt(8)
    v_mfma_f32_16x16x32_bf16 v[16:19], v[160:163], a[128:131], v[16:19]
    ds_read_b64_tr_b16 v[128:129], v196 offset:49152
    v_mfma_f32_16x16x32_bf16 v[16:19], v[164:167], a[144:147], v[16:19]
    buffer_load_dwordx4 v203, s[24:27], s41 offen offset:3072 lds
    v_mfma_f32_16x16x32_bf16 v[48:51], v[164:167], a[148:151], v[48:51]
    ds_read_b64_tr_b16 v[130:131], v196 offset:49664
    s_add_u32 s41, s41, 524288
    v_mfma_f32_16x16x32_bf16 v[48:51], v[160:163], a[132:135], v[48:51]
    v_mfma_f32_16x16x32_bf16 v[80:83], v[160:163], a[136:139], v[80:83]
    ds_read_b64_tr_b16 v[132:133], v196 offset:53248
    v_mfma_f32_16x16x32_bf16 v[80:83], v[164:167], a[152:155], v[80:83]
    v_mfma_f32_16x16x32_bf16 v[112:115], v[164:167], a[156:159], v[112:115]
    ds_read_b64_tr_b16 v[134:135], v196 offset:53760
    v_mfma_f32_16x16x32_bf16 v[112:115], v[160:163], a[140:143], v[112:115]
    buffer_load_dwordx4 a[64:67], v240, s[20:23], s40 offen offset:0 sc1
    v_mfma_f32_16x16x32_bf16 v[116:119], v[168:171], a[140:143], v[116:119]
    ds_read_b64_tr_b16 v[136:137], v197 offset:49152
    v_mfma_f32_16x16x32_bf16 v[116:119], v[172:175], a[156:159], v[116:119]
K1_pg1:
    s_cbranch_execz K1_pg5
    v_mfma_f32_16x16x32_bf16 v[84:87], v[172:175], a[152:155], v[84:87]
    ds_read_b64_tr_b16 v[138:139], v197 offset:49664
    v_mfma_f32_16x16x32_bf16 v[84:87], v[168:171], a[136:139], v[84:87]
    v_mfma_f32_16x16x32_bf16 v[52:55], v[168:171], a[132:135], v[52:55]
    ds_read_b64_tr_b16 v[140:141], v197 offset:53248
    v_mfma_f32_16x16x32_bf16 v[52:55], v[172:175], a[148:151], v[52:55]
    buffer_load_dwordx4 a[68:71], v240, s[20:23], s40 offen offset:1024 sc1
    v_mfma_f32_16x16x32_bf16 v[20:23], v[172:175], a[144:147], v[20:23]
    ds_read_b64_tr_b16 v[142:143], v197 offset:53760
    v_mfma_f32_16x16x32_bf16 v[20:23], v[168:171], a[128:131], v[20:23]
    s_waitcnt lgkmcnt(8)
    v_mfma_f32_16x16x32_bf16 v[24:27], v[176:179], a[128:131], v[24:27]
    ds_read_b64_tr_b16 v[144:145], v198 offset:49152
    v_mfma_f32_16x16x32_bf16 v[24:27], v[180:183], a[144:147], v[24:27]
    v_mfma_f32_16x16x32_bf16 v[56:59], v[180:183], a[148:151], v[56:59]
    ds_read_b64_tr_b16 v[146:147], v198 offset:49664
    v_mfma_f32_16x16x32_bf16 v[56:59], v[176:179], a[132:135], v[56:59]
    buffer_load_dwordx4 a[72:75], v240, s[20:23], s40 offen offset:2048 sc1
    v_mfma_f32_16x16x32_bf16 v[88:91], v[176:179], a[136:139], v[88:91]
    ds_read_b64_tr_b16 v[148:149], v198 offset:53248
    v_mfma_f32_16x16x32_bf16 v[88:91], v[180:183], a[152:155], v[88:91]
    v_mfma_f32_16x16x32_bf16 v[120:123], v[180:183], a[156:159], v[120:123]
    ds_read_b64_tr_b16 v[150:151], v198 offset:53760
    v_mfma_f32_16x16x32_bf16 v[120:123], v[176:179], a[140:143], v[120:123]
    v_mfma_f32_16x16x32_bf16 v[124:127], v[184:187], a[140:143], v[124:127]
    ds_read_b64_tr_b16 v[152:153], v199 offset:49152
    v_mfma_f32_16x16x32_bf16 v[124:127], v[188:191], a[156:159], v[124:127]
    buffer_load_dwordx4 a[76:79], v240, s[20:23], s40 offen offset:3072 sc1
    v_mfma_f32_16x16x32_bf16 v[92:95], v[188:191], a[152:155], v[92:95]
    ds_read_b64_tr_b16 v[154:155], v199 offset:49664
    s_add_u32 s40, s40, 4096
    v_mfma_f32_16x16x32_bf16 v[92:95], v[184:187], a[136:139], v[92:95]
    v_mfma_f32_16x16x32_bf16 v[60:63], v[184:187], a[132:135], v[60:63]
    ds_read_b64_tr_b16 v[156:157], v199 offset:53248
    v_mfma_f32_16x16x32_bf16 v[60:63], v[188:191], a[148:151], v[60:63]
    v_mfma_f32_16x16x32_bf16 v[28:31], v[188:191], a[144:147], v[28:31]
    ds_read_b64_tr_b16 v[158:159], v199 offset:53760
    v_mfma_f32_16x16x32_bf16 v[28:31], v[184:187], a[128:131], v[28:31]
    s_waitcnt vmcnt(18)
    s_barrier
    s_waitcnt lgkmcnt(8)
    v_mfma_f32_16x16x32_bf16 a[192:195], v[128:131], a[128:131], a[192:195]
    ds_read_b64_tr_b16 v[160:161], v192 offset:0
    v_mfma_f32_16x16x32_bf16 a[192:195], v[132:135], a[144:147], a[192:195]
    buffer_load_dwordx4 a[80:83], v240, s[20:23], s40 offen offset:0 sc1
    v_mfma_f32_16x16x32_bf16 a[200:203], v[132:135], a[148:151], a[200:203]
    ds_read_b64_tr_b16 v[162:163], v192 offset:1024
    v_mfma_f32_16x16x32_bf16 a[200:203], v[128:131], a[132:135], a[200:203]
    v_mfma_f32_16x16x32_bf16 a[208:211], v[128:131], a[136:139], a[208:211]
    ds_read_b64_tr_b16 v[164:165], v192 offset:8192
    v_mfma_f32_16x16x32_bf16 a[208:211], v[132:135], a[152:155], a[208:211]
    v_mfma_f32_16x16x32_bf16 a[216:219], v[132:135], a[156:159], a[216:219]
    ds_read_b64_tr_b16 v[166:167], v192 offset:9216
    v_mfma_f32_16x16x32_bf16 a[216:219], v[128:131], a[140:143], a[216:219]
    buffer_load_dwordx4 a[84:87], v240, s[20:23], s40 offen offset:1024 sc1
    v_mfma_f32_16x16x32_bf16 a[220:223], v[136:139], a[140:143], a[220:223]
    ds_read_b64_tr_b16 v[168:169], v192 offset:8
    v_mfma_f32_16x16x32_bf16 a[220:223], v[140:143], a[156:159], a[220:223]
    v_mfma_f32_16x16x32_bf16 a[212:215], v[140:143], a[152:155], a[212:215]
    ds_read_b64_tr_b16 v[170:171], v192 offset:1032
    v_mfma_f32_16x16x32_bf16 a[212:215], v[136:139], a[136:139], a[212:215]
    v_mfma_f32_16x16x32_bf16 a[204:207], v[136:139], a[132:135], a[204:207]
    ds_read_b64_tr_b16 v[172:173], v192 offset:8200
    v_mfma_f32_16x16x32_bf16 a[204:207], v[140:143], a[148:151], a[204:207]
    buffer_load_dwordx4 a[88:91], v240, s[20:23], s40 offen offset:2048 sc1
    v_mfma_f32_16x16x32_bf16 a[196:199], v[140:143], a[144:147], a[196:199]
    ds_read_b64_tr_b16 v[174:175], v192 offset:9224
    v_mfma_f32_16x16x32_bf16 a[196:199], v[136:139], a[128:131], a[196:199]
    s_waitcnt lgkmcnt(8)
    v_mfma_f32_16x16x32_bf16 a[224:227], v[144:147], a[128:131], a[224:227]
    ds_read_b64_tr_b16 v[176:177], v193 offset:0
    v_mfma_f32_16x16x32_bf16 a[224:227], v[148:151], a[144:147], a[224:227]
    v_mfma_f32_16x16x32_bf16 a[232:235], v[148:151], a[148:151], a[232:235]
    ds_read_b64_tr_b16 v[178:179], v193 offset:1024
    v_mfma_f32_16x16x32_bf16 a[232:235], v[144:147], a[132:135], a[232:235]
    buffer_load_dwordx4 a[92:95], v240, s[20:23], s40 offen offset:3072 sc1
    v_mfma_f32_16x16x32_bf16 a[240:243], v[144:147], a[136:139], a[240:243]
    ds_read_b64_tr_b16 v[180:181], v193 offset:8192
    s_add_u32 s40, s40, 4096
    v_mfma_f32_16x16x32_bf16 a[240:243], v[148:151], a[152:155], a[240:243]
    v_mfma_f32_16x16x32_bf16 a[248:251], v[148:151], a[156:159], a[248:251]
    ds_read_b64_tr_b16 v[182:183], v193 offset:9216
    v_mfma_f32_16x16x32_bf16 a[248:251], v[144:147], a[140:143], a[248:251]
    v_mfma_f32_16x16x32_bf16 a[252:255], v[152:155], a[140:143], a[252:255]
    ds_read_b64_tr_b16 v[184:185], v193 offset:8
    v_mfma_f32_16x16x32_bf16 a[252:255], v[156:159], a[156:159], a[252:255]
    v_mfma_f32_16x16x32_bf16 a[244:247], v[156:159], a[152:155], a[244:247]
    ds_read_b64_tr_b16 v[186:187], v193 offset:1032
    v_mfma_f32_16x16x32_bf16 a[244:247], v[152:155], a[136:139], a[244:247]
    v_mfma_f32_16x16x32_bf16 a[236:239], v[152:155], a[132:135], a[236:239]
    ds_read_b64_tr_b16 v[188:189], v193 offset:8200
    v_mfma_f32_16x16x32_bf16 a[236:239], v[156:159], a[148:151], a[236:239]
    v_mfma_f32_16x16x32_bf16 a[228:231], v[156:159], a[144:147], a[228:231]
    ds_read_b64_tr_b16 v[190:191], v193 offset:9224
    v_mfma_f32_16x16x32_bf16 a[228:231], v[152:155], a[128:131], a[228:231]
    s_waitcnt vmcnt(14) lgkmcnt(8)
    v_mfma_f32_16x16x32_bf16 v[0:3], v[160:163], a[160:163], v[0:3]
    ds_read_b64_tr_b16 v[128:129], v194 offset:0
    s_add_u32 m0, s45, 32768
    v_mfma_f32_16x16x32_bf16 v[0:3], v[164:167], a[176:179], v[0:3]
    buffer_load_dwordx4 v204, s[28:31], s42 offen offset:0 lds
    v_mfma_f32_16x16x32_bf16 v[32:35], v[164:167], a[180:183], v[32:35]
    ds_read_b64_tr_b16 v[130:131], v194 offset:1024
    v_lshlrev_b32 v248, 4, v248
    v_mfma_f32_16x16x32_bf16 v[32:35], v[160:163], a[164:167], v[32:35]
    v_lshl_add_u32 v236, v244, 8, v248
    v_add_u32 v248, 4, v244
    v_mfma_f32_16x16x32_bf16 v[64:67], v[160:163], a[168:171], v[64:67]
    ds_read_b64_tr_b16 v[132:133], v194 offset:8192
    v_and_b32 v248, s6, v248
    v_mfma_f32_16x16x32_bf16 v[64:67], v[164:167], a[184:187], v[64:67]
    v_lshlrev_b32 v248, s7, v248
    v_xor_b32 v248, v248, v245
    v_mfma_f32_16x16x32_bf16 v[96:99], v[164:167], a[188:191], v[96:99]
    ds_read_b64_tr_b16 v[134:135], v194 offset:9216
    v_lshlrev_b32 v248, 4, v248
    v_mfma_f32_16x16x32_bf16 v[96:99], v[160:163], a[172:175], v[96:99]
    buffer_load_dwordx4 v205, s[28:31], s42 offen offset:1024 lds
    v_mfma_f32_16x16x32_bf16 v[100:103], v[168:171], a[172:175], v[100:103]
    ds_read_b64_tr_b16 v[136:137], v194 offset:8
    s_add_u32 s42, s42, 221184
    v_mfma_f32_16x16x32_bf16 v[100:103], v[172:175], a[188:191], v[100:103]
    s_add_u32 m0, s44, 32768
    v_lshl_add_u32 v237, v244, 8, v248
    v_add_u32 v248, 8, v244
    v_mfma_f32_16x16x32_bf16 v[68:71], v[172:175], a[184:187], v[68:71]
    ds_read_b64_tr_b16 v[138:139], v194 offset:1032
    v_and_b32 v248, s6, v248
    v_mfma_f32_16x16x32_bf16 v[68:71], v[168:171], a[168:171], v[68:71]
    v_lshlrev_b32 v248, s7, v248
    v_xor_b32 v248, v248, v245
    v_mfma_f32_16x16x32_bf16 v[36:39], v[168:171], a[164:167], v[36:39]
    ds_read_b64_tr_b16 v[140:141], v194 offset:8200
    v_lshlrev_b32 v248, 4, v248
    v_mfma_f32_16x16x32_bf16 v[36:39], v[172:175], a[180:183], v[36:39]
    buffer_load_dwordx4 v200, s[24:27], s41 offen offset:0 lds
    v_mfma_f32_16x16x32_bf16 v[4:7], v[172:175], a[176:179], v[4:7]
    ds_read_b64_tr_b16 v[142:143], v194 offset:9224
    v_lshl_add_u32 v238, v244, 8, v248
    v_mfma_f32_16x16x32_bf16 v[4:7], v[168:171], a[160:163], v[4:7]
    v_add_u32 v248, 12, v244
    v_and_b32 v248, s6, v248
    s_waitcnt lgkmcnt(8)
    v_mfma_f32_16x16x32_bf16 v[8:11], v[176:179], a[160:163], v[8:11]
    ds_read_b64_tr_b16 v[144:145], v195 offset:0
    v_lshlrev_b32 v248, s7, v248
    v_mfma_f32_16x16x32_bf16 v[8:11], v[180:183], a[176:179], v[8:11]
    v_xor_b32 v248, v248, v245
    v_lshlrev_b32 v248, 4, v248
    v_mfma_f32_16x16x32_bf16 v[40:43], v[180:183], a[180:183], v[40:43]
    ds_read_b64_tr_b16 v[146:147], v195 offset:1024
    v_lshl_add_u32 v239, v244, 8, v248
    v_mfma_f32_16x16x32_bf16 v[40:43], v[176:179], a[164:167], v[40:43]
    buffer_load_dwordx4 v201, s[24:27], s41 offen offset:1024 lds
    v_mfma_f32_16x16x32_bf16 v[72:75], v[176:179], a[168:171], v[72:75]
    ds_read_b64_tr_b16 v[148:149], v195 offset:8192
    v_lshrrev_b32 v248, 2, v243
    v_mfma_f32_16x16x32_bf16 v[72:75], v[180:183], a[184:187], v[72:75]
    v_mfma_f32_16x16x32_bf16 v[104:107], v[180:183], a[188:191], v[104:107]
    ds_read_b64_tr_b16 v[150:151], v195 offset:9216
    v_mfma_f32_16x16x32_bf16 v[104:107], v[176:179], a[172:175], v[104:107]
    v_mfma_f32_16x16x32_bf16 v[108:111], v[184:187], a[172:175], v[108:111]
    ds_read_b64_tr_b16 v[152:153], v195 offset:8
    v_mfma_f32_16x16x32_bf16 v[108:111], v[188:191], a[188:191], v[108:111]
    buffer_load_dwordx4 v202, s[24:27], s41 offen offset:2048 lds
    v_mfma_f32_16x16x32_bf16 v[76:79], v[188:191], a[184:187], v[76:79]
    ds_read_b64_tr_b16 v[154:155], v195 offset:1032
    v_mfma_f32_16x16x32_bf16 v[76:79], v[184:187], a[168:171], v[76:79]
    v_mfma_f32_16x16x32_bf16 v[44:47], v[184:187], a[164:167], v[44:47]
    ds_read_b64_tr_b16 v[156:157], v195 offset:8200
    v_mfma_f32_16x16x32_bf16 v[44:47], v[188:191], a[180:183], v[44:47]
    v_mfma_f32_16x16x32_bf16 v[12:15], v[188:191], a[176:179], v[12:15]
    ds_read_b64_tr_b16 v[158:159], v195 offset:9224
    v_mfma_f32_16x16x32_bf16 v[12:15], v[184:187], a[160:163], v[12:15]
    s_waitcnt lgkmcnt(8)
    v_mfma_f32_16x16x32_bf16 v[16:19], v[128:131], a[160:163], v[16:19]
    ds_read_b64_tr_b16 v[160:161], v196 offset:0
    v_mfma_f32_16x16x32_bf16 v[16:19], v[132:135], a[176:179], v[16:19]
    buffer_load_dwordx4 v203, s[24:27], s41 offen offset:3072 lds
    v_mfma_f32_16x16x32_bf16 v[48:51], v[132:135], a[180:183], v[48:51]
    ds_read_b64_tr_b16 v[162:163], v196 offset:512
    s_add_u32 s41, s41, 524288
    v_mfma_f32_16x16x32_bf16 v[48:51], v[128:131], a[164:167], v[48:51]
    v_mfma_f32_16x16x32_bf16 v[80:83], v[128:131], a[168:171], v[80:83]
    ds_read_b64_tr_b16 v[164:165], v196 offset:4096
    v_mfma_f32_16x16x32_bf16 v[80:83], v[132:135], a[184:187], v[80:83]
    v_mfma_f32_16x16x32_bf16 v[112:115], v[132:135], a[188:191], v[112:115]
    ds_read_b64_tr_b16 v[166:167], v196 offset:4608
    v_mfma_f32_16x16x32_bf16 v[112:115], v[128:131], a[172:175], v[112:115]
    buffer_load_dwordx4 a[96:99], v240, s[20:23], s40 offen offset:0 sc1
    v_mfma_f32_16x16x32_bf16 v[116:119], v[136:139], a[172:175], v[116:119]
    ds_read_b64_tr_b16 v[168:169], v197 offset:0
    v_mfma_f32_16x16x32_bf16 v[116:119], v[140:143], a[188:191], v[116:119]
    v_mfma_f32_16x16x32_bf16 v[84:87], v[140:143], a[184:187], v[84:87]
    ds_read_b64_tr_b16 v[170:171], v197 offset:512
    v_mfma_f32_16x16x32_bf16 v[84:87], v[136:139], a[168:171], v[84:87]
    v_mfma_f32_16x16x32_bf16 v[52:55], v[136:139], a[164:167], v[52:55]
    ds_read_b64_tr_b16 v[172:173], v197 offset:4096
    v_mfma_f32_16x16x32_bf16 v[52:55], v[140:143], a[180:183], v[52:55]
    buffer_load_dwordx4 a[100:103], v240, s[20:23], s40 offen offset:1024 sc1
    v_mfma_f32_16x16x32_bf16 v[20:23], v[140:143], a[176:179], v[20:23]
    ds_read_b64_tr_b16 v[174:175], v197 offset:4608
    v_mfma_f32_16x16x32_bf16 v[20:23], v[136:139], a[160:163], v[20:23]
    s_waitcnt lgkmcnt(8)
    v_mfma_f32_16x16x32_bf16 v[24:27], v[144:147], a[160:163], v[24:27]
    ds_read_b64_tr_b16 v[176:177], v198 offset:0
    v_mfma_f32_16x16x32_bf16 v[24:27], v[148:151], a[176:179], v[24:27]
    v_mfma_f32_16x16x32_bf16 v[56:59], v[148:151], a[180:183], v[56:59]
    ds_read_b64_tr_b16 v[178:179], v198 offset:512
    v_mfma_f32_16x16x32_bf16 v[56:59], v[144:147], a[164:167], v[56:59]
    buffer_load_dwordx4 a[104:107], v240, s[20:23], s40 offen offset:2048 sc1
    v_mfma_f32_16x16x32_bf16 v[88:91], v[144:147], a[168:171], v[88:91]
    ds_read_b64_tr_b16 v[180:181], v198 offset:4096
    v_mfma_f32_16x16x32_bf16 v[88:91], v[148:151], a[184:187], v[88:91]
    v_mfma_f32_16x16x32_bf16 v[120:123], v[148:151], a[188:191], v[120:123]
    ds_read_b64_tr_b16 v[182:183], v198 offset:4608
    v_mfma_f32_16x16x32_bf16 v[120:123], v[144:147], a[172:175], v[120:123]
    v_mfma_f32_16x16x32_bf16 v[124:127], v[152:155], a[172:175], v[124:127]
    ds_read_b64_tr_b16 v[184:185], v199 offset:0
    v_mfma_f32_16x16x32_bf16 v[124:127], v[156:159], a[188:191], v[124:127]
    buffer_load_dwordx4 a[108:111], v240, s[20:23], s40 offen offset:3072 sc1
    v_mfma_f32_16x16x32_bf16 v[92:95], v[156:159], a[184:187], v[92:95]
    ds_read_b64_tr_b16 v[186:187], v199 offset:512
    s_add_u32 s40, s40, 4096
    v_mfma_f32_16x16x32_bf16 v[92:95], v[152:155], a[168:171], v[92:95]
    v_mfma_f32_16x16x32_bf16 v[60:63], v[152:155], a[164:167], v[60:63]
    ds_read_b64_tr_b16 v[188:189], v199 offset:4096
    v_mfma_f32_16x16x32_bf16 v[60:63], v[156:159], a[180:183], v[60:63]
    v_mfma_f32_16x16x32_bf16 v[28:31], v[156:159], a[176:179], v[28:31]
    ds_read_b64_tr_b16 v[190:191], v199 offset:4608
    v_mfma_f32_16x16x32_bf16 v[28:31], v[152:155], a[160:163], v[28:31]
    s_waitcnt vmcnt(18)
    s_barrier
    s_waitcnt lgkmcnt(8)
    v_mfma_f32_16x16x32_bf16 a[192:195], v[160:163], a[160:163], a[192:195]
    ds_read_b64_tr_b16 v[128:129], v192 offset:16384
    v_mfma_f32_16x16x32_bf16 a[192:195], v[164:167], a[176:179], a[192:195]
    buffer_load_dwordx4 a[112:115], v240, s[20:23], s40 offen offset:0 sc1
    v_mfma_f32_16x16x32_bf16 a[200:203], v[164:167], a[180:183], a[200:203]
    ds_read_b64_tr_b16 v[130:131], v192 offset:17408
    v_mfma_f32_16x16x32_bf16 a[200:203], v[160:163], a[164:167], a[200:203]
    v_mfma_f32_16x16x32_bf16 a[208:211], v[160:163], a[168:171], a[208:211]
    ds_read_b64_tr_b16 v[132:133], v192 offset:24576
    v_mfma_f32_16x16x32_bf16 a[208:211], v[164:167], a[184:187], a[208:211]
    v_mfma_f32_16x16x32_bf16 a[216:219], v[164:167], a[188:191], a[216:219]
    ds_read_b64_tr_b16 v[134:135], v192 offset:25600
    v_mfma_f32_16x16x32_bf16 a[216:219], v[160:163], a[172:175], a[216:219]
    buffer_load_dwordx4 a[116:119], v240, s[20:23], s40 offen offset:1024 sc1
    v_mfma_f32_16x16x32_bf16 a[220:223], v[168:171], a[172:175], a[220:223]
    ds_read_b64_tr_b16 v[136:137], v192 offset:16392
    v_mfma_f32_16x16x32_bf16 a[220:223], v[172:175], a[188:191], a[220:223]
    v_mfma_f32_16x16x32_bf16 a[212:215], v[172:175], a[184:187], a[212:215]
    ds_read_b64_tr_b16 v[138:139], v192 offset:17416
    v_mfma_f32_16x16x32_bf16 a[212:215], v[168:171], a[168:171], a[212:215]
    v_mfma_f32_16x16x32_bf16 a[204:207], v[168:171], a[164:167], a[204:207]
    ds_read_b64_tr_b16 v[140:141], v192 offset:24584
    v_mfma_f32_16x16x32_bf16 a[204:207], v[172:175], a[180:183], a[204:207]
    buffer_load_dwordx4 a[120:123], v240, s[20:23], s40 offen offset:2048 sc1
    v_mfma_f32_16x16x32_bf16 a[196:199], v[172:175], a[176:179], a[196:199]
    ds_read_b64_tr_b16 v[142:143], v192 offset:25608
    v_mfma_f32_16x16x32_bf16 a[196:199], v[168:171], a[160:163], a[196:199]
    s_waitcnt lgkmcnt(8)
    v_mfma_f32_16x16x32_bf16 a[224:227], v[176:179], a[160:163], a[224:227]
    ds_read_b64_tr_b16 v[144:145], v193 offset:16384
    v_mfma_f32_16x16x32_bf16 a[224:227], v[180:183], a[176:179], a[224:227]
    v_mfma_f32_16x16x32_bf16 a[232:235], v[180:183], a[180:183], a[232:235]
    ds_read_b64_tr_b16 v[146:147], v193 offset:17408
    v_mfma_f32_16x16x32_bf16 a[232:235], v[176:179], a[164:167], a[232:235]
    buffer_load_dwordx4 a[124:127], v240, s[20:23], s40 offen offset:3072 sc1
    v_mfma_f32_16x16x32_bf16 a[240:243], v[176:179], a[168:171], a[240:243]
    ds_read_b64_tr_b16 v[148:149], v193 offset:24576
    s_add_u32 s40, s40, 4096
    v_mfma_f32_16x16x32_bf16 a[240:243], v[180:183], a[184:187], a[240:243]
    v_mfma_f32_16x16x32_bf16 a[248:251], v[180:183], a[188:191], a[248:251]
    ds_read_b64_tr_b16 v[150:151], v193 offset:25600
    v_mfma_f32_16x16x32_bf16 a[248:251], v[176:179], a[172:175], a[248:251]
    v_mfma_f32_16x16x32_bf16 a[252:255], v[184:187], a[172:175], a[252:255]
    ds_read_b64_tr_b16 v[152:153], v193 offset:16392
    v_mfma_f32_16x16x32_bf16 a[252:255], v[188:191], a[188:191], a[252:255]
    v_mfma_f32_16x16x32_bf16 a[244:247], v[188:191], a[184:187], a[244:247]
    ds_read_b64_tr_b16 v[154:155], v193 offset:17416
    v_mfma_f32_16x16x32_bf16 a[244:247], v[184:187], a[168:171], a[244:247]
    v_mfma_f32_16x16x32_bf16 a[236:239], v[184:187], a[164:167], a[236:239]
    ds_read_b64_tr_b16 v[156:157], v193 offset:24584
    v_mfma_f32_16x16x32_bf16 a[236:239], v[188:191], a[180:183], a[236:239]
    v_mfma_f32_16x16x32_bf16 a[228:231], v[188:191], a[176:179], a[228:231]
    ds_read_b64_tr_b16 v[158:159], v193 offset:25608
    v_mfma_f32_16x16x32_bf16 a[228:231], v[184:187], a[160:163], a[228:231]
    s_waitcnt vmcnt(14) lgkmcnt(8)
    v_mfma_f32_16x16x32_bf16 v[0:3], v[128:131], a[64:67], v[0:3]
    ds_read_b64_tr_b16 v[160:161], v194 offset:16384
    s_add_u32 m0, s45, 49152
    v_mfma_f32_16x16x32_bf16 v[0:3], v[132:135], a[80:83], v[0:3]
    buffer_load_dwordx4 v204, s[28:31], s42 offen offset:0 lds
    v_mfma_f32_16x16x32_bf16 v[32:35], v[132:135], a[84:87], v[32:35]
    ds_read_b64_tr_b16 v[162:163], v194 offset:17408
    v_mul_u32_u24 v248, 1280, v248
    v_mfma_f32_16x16x32_bf16 v[32:35], v[128:131], a[68:71], v[32:35]
    v_lshl_add_u32 v254, v247, 4, v248
    v_add_u32 v255, 19456, v254
    v_mfma_f32_16x16x32_bf16 v[64:67], v[128:131], a[72:75], v[64:67]
    ds_read_b64_tr_b16 v[164:165], v194 offset:24576
    v_xor_b32 v248, v244, v245
    v_mfma_f32_16x16x32_bf16 v[64:67], v[132:135], a[88:91], v[64:67]
    v_lshlrev_b32 v249, 8, v245
    v_xor_b32 v224, 0, v248
    v_mfma_f32_16x16x32_bf16 v[96:99], v[132:135], a[92:95], v[96:99]
    ds_read_b64_tr_b16 v[166:167], v194 offset:25600
    v_lshl_add_u32 v224, v224, 4, v249
    v_mfma_f32_16x16x32_bf16 v[96:99], v[128:131], a[76:79], v[96:99]
    buffer_load_dwordx4 v205, s[28:31], s42 offen offset:1024 lds
    v_mfma_f32_16x16x32_bf16 v[100:103], v[136:139], a[76:79], v[100:103]
    ds_read_b64_tr_b16 v[168:169], v194 offset:16392
    s_add_u32 s42, s42, 221184
    v_mfma_f32_16x16x32_bf16 v[100:103], v[140:143], a[92:95], v[100:103]
    s_add_u32 m0, s44, 49152
    v_xor_b32 v225, 4, v248
    v_lshl_add_u32 v225, v225, 4, v249
    v_mfma_f32_16x16x32_bf16 v[68:71], v[140:143], a[88:91], v[68:71]
    ds_read_b64_tr_b16 v[170:171], v194 offset:17416
    v_xor_b32 v226, 8, v248
    v_mfma_f32_16x16x32_bf16 v[68:71], v[136:139], a[72:75], v[68:71]
    v_lshl_add_u32 v226, v226, 4, v249
    v_xor_b32 v227, 12, v248
    v_mfma_f32_16x16x32_bf16 v[36:39], v[136:139], a[68:71], v[36:39]
    ds_read_b64_tr_b16 v[172:173], v194 offset:24584
    v_lshl_add_u32 v227, v227, 4, v249
    v_mfma_f32_16x16x32_bf16 v[36:39], v[140:143], a[84:87], v[36:39]
    buffer_load_dwordx4 v200, s[24:27], s41 offen offset:0 lds
    v_mfma_f32_16x16x32_bf16 v[4:7], v[140:143], a[80:83], v[4:7]
    ds_read_b64_tr_b16 v[174:175], v194 offset:25608
    v_lshl_add_u32 v248, v244, 2, v246
    v_mfma_f32_16x16x32_bf16 v[4:7], v[136:139], a[64:67], v[4:7]
    v_lshlrev_b32 v249, 3, v247
    v_lshl_add_u32 v249, v248, 8, v249
    s_waitcnt lgkmcnt(8)
    v_mfma_f32_16x16x32_bf16 v[8:11], v[144:147], a[64:67], v[8:11]
    ds_read_b64_tr_b16 v[176:177], v195 offset:16384
    v_add_u32 v249, 65536, v249
    v_mfma_f32_16x16x32_bf16 v[8:11], v[148:151], a[80:83], v[8:11]
    v_and_b32 v248, 7, v248
    v_xor_b32 v228, 0, v248
    v_mfma_f32_16x16x32_bf16 v[40:43], v[148:151], a[84:87], v[40:43]
    ds_read_b64_tr_b16 v[178:179], v195 offset:17408
    v_lshl_add_u32 v228, v228, 5, v249
    v_mfma_f32_16x16x32_bf16 v[40:43], v[144:147], a[68:71], v[40:43]
    buffer_load_dwordx4 v201, s[24:27], s41 offen offset:1024 lds
    v_mfma_f32_16x16x32_bf16 v[72:75], v[144:147], a[72:75], v[72:75]
    ds_read_b64_tr_b16 v[180:181], v195 offset:24576
    v_xor_b32 v229, 1, v248
    v_mfma_f32_16x16x32_bf16 v[72:75], v[148:151], a[88:91], v[72:75]
    v_mfma_f32_16x16x32_bf16 v[104:107], v[148:151], a[92:95], v[104:107]
    ds_read_b64_tr_b16 v[182:183], v195 offset:25600
    v_mfma_f32_16x16x32_bf16 v[104:107], v[144:147], a[76:79], v[104:107]
    v_mfma_f32_16x16x32_bf16 v[108:111], v[152:155], a[76:79], v[108:111]
    ds_read_b64_tr_b16 v[184:185], v195 offset:16392
    v_mfma_f32_16x16x32_bf16 v[108:111], v[156:159], a[92:95], v[108:111]
    buffer_load_dwordx4 v202, s[24:27], s41 offen offset:2048 lds
    v_mfma_f32_16x16x32_bf16 v[76:79], v[156:159], a[88:91], v[76:79]
    ds_read_b64_tr_b16 v[186:187], v195 offset:17416
    v_mfma_f32_16x16x32_bf16 v[76:79], v[152:155], a[72:75], v[76:79]
    v_mfma_f32_16x16x32_bf16 v[44:47], v[152:155], a[68:71], v[44:47]
    ds_read_b64_tr_b16 v[188:189], v195 offset:24584
    v_mfma_f32_16x16x32_bf16 v[44:47], v[156:159], a[84:87], v[44:47]
    v_mfma_f32_16x16x32_bf16 v[12:15], v[156:159], a[80:83], v[12:15]
    ds_read_b64_tr_b16 v[190:191], v195 offset:25608
    v_mfma_f32_16x16x32_bf16 v[12:15], v[152:155], a[64:67], v[12:15]
    s_waitcnt lgkmcnt(8)
    v_mfma_f32_16x16x32_bf16 v[16:19], v[160:163], a[64:67], v[16:19]
    ds_read_b64_tr_b16 v[128:129], v196 offset:16384
    v_mfma_f32_16x16x32_bf16 v[16:19], v[164:167], a[80:83], v[16:19]
    buffer_load_dwordx4 v203, s[24:27], s41 offen offset:3072 lds
    v_mfma_f32_16x16x32_bf16 v[48:51], v[164:167], a[84:87], v[48:51]
    ds_read_b64_tr_b16 v[130:131], v196 offset:16896
    s_add_u32 s41, s41, 524288
    v_mfma_f32_16x16x32_bf16 v[48:51], v[160:163], a[68:71], v[48:51]
    v_mfma_f32_16x16x32_bf16 v[80:83], v[160:163], a[72:75], v[80:83]
    ds_read_b64_tr_b16 v[132:133], v196 offset:20480
    v_mfma_f32_16x16x32_bf16 v[80:83], v[164:167], a[88:91], v[80:83]
    v_mfma_f32_16x16x32_bf16 v[112:115], v[164:167], a[92:95], v[112:115]
    ds_read_b64_tr_b16 v[134:135], v196 offset:20992
    v_mfma_f32_16x16x32_bf16 v[112:115], v[160:163], a[76:79], v[112:115]
    buffer_load_dwordx4 a[128:131], v240, s[20:23], s40 offen offset:0 sc1
    v_mfma_f32_16x16x32_bf16 v[116:119], v[168:171], a[76:79], v[116:119]
    ds_read_b64_tr_b16 v[136:137], v197 offset:16384
    v_mfma_f32_16x16x32_bf16 v[116:119], v[172:175], a[92:95], v[116:119]
    v_mfma_f32_16x16x32_bf16 v[84:87], v[172:175], a[88:91], v[84:87]
    ds_read_b64_tr_b16 v[138:139], v197 offset:16896
    v_mfma_f32_16x16x32_bf16 v[84:87], v[168:171], a[72:75], v[84:87]
    v_mfma_f32_16x16x32_bf16 v[52:55], v[168:171], a[68:71], v[52:55]
    ds_read_b64_tr_b16 v[140:141], v197 offset:20480
    v_mfma_f32_16x16x32_bf16 v[52:55], v[172:175], a[84:87], v[52:55]
    buffer_load_dwordx4 a[132:135], v240, s[20:23], s40 offen offset:1024 sc1
    v_mfma_f32_16x16x32_bf16 v[20:23], v[172:175], a[80:83], v[20:23]
    ds_read_b64_tr_b16 v[142:143], v197 offset:20992
    v_mfma_f32_16x16x32_bf16 v[20:23], v[168:171], a[64:67], v[20:23]
    s_waitcnt lgkmcnt(8)
    v_mfma_f32_16x16x32_bf16 v[24:27], v[176:179], a[64:67], v[24:27]
    ds_read_b64_tr_b16 v[144:145], v198 offset:16384
    v_mfma_f32_16x16x32_bf16 v[24:27], v[180:183], a[80:83], v[24:27]
    v_mfma_f32_16x16x32_bf16 v[56:59], v[180:183], a[84:87], v[56:59]
    ds_read_b64_tr_b16 v[146:147], v198 offset:16896
    v_mfma_f32_16x16x32_bf16 v[56:59], v[176:179], a[68:71], v[56:59]
    buffer_load_dwordx4 a[136:139], v240, s[20:23], s40 offen offset:2048 sc1
    v_mfma_f32_16x16x32_bf16 v[88:91], v[176:179], a[72:75], v[88:91]
    ds_read_b64_tr_b16 v[148:149], v198 offset:20480
    v_mfma_f32_16x16x32_bf16 v[88:91], v[180:183], a[88:91], v[88:91]
    v_mfma_f32_16x16x32_bf16 v[120:123], v[180:183], a[92:95], v[120:123]
    ds_read_b64_tr_b16 v[150:151], v198 offset:20992
    v_mfma_f32_16x16x32_bf16 v[120:123], v[176:179], a[76:79], v[120:123]
    v_mfma_f32_16x16x32_bf16 v[124:127], v[184:187], a[76:79], v[124:127]
    ds_read_b64_tr_b16 v[152:153], v199 offset:16384
    v_mfma_f32_16x16x32_bf16 v[124:127], v[188:191], a[92:95], v[124:127]
    buffer_load_dwordx4 a[140:143], v240, s[20:23], s40 offen offset:3072 sc1
    v_mfma_f32_16x16x32_bf16 v[92:95], v[188:191], a[88:91], v[92:95]
    ds_read_b64_tr_b16 v[154:155], v199 offset:16896
    s_add_u32 s40, s40, 4096
    v_mfma_f32_16x16x32_bf16 v[92:95], v[184:187], a[72:75], v[92:95]
    v_mfma_f32_16x16x32_bf16 v[60:63], v[184:187], a[68:71], v[60:63]
    ds_read_b64_tr_b16 v[156:157], v199 offset:20480
    v_mfma_f32_16x16x32_bf16 v[60:63], v[188:191], a[84:87], v[60:63]
    v_mfma_f32_16x16x32_bf16 v[28:31], v[188:191], a[80:83], v[28:31]
    ds_read_b64_tr_b16 v[158:159], v199 offset:20992
    v_mfma_f32_16x16x32_bf16 v[28:31], v[184:187], a[64:67], v[28:31]
    s_waitcnt vmcnt(18)
    s_barrier
    s_waitcnt lgkmcnt(8)
    v_mfma_f32_16x16x32_bf16 a[192:195], v[128:131], a[64:67], a[192:195]
    ds_read_b64_tr_b16 v[160:161], v192 offset:32768
    v_mfma_f32_16x16x32_bf16 a[192:195], v[132:135], a[80:83], a[192:195]
    buffer_load_dwordx4 a[144:147], v240, s[20:23], s40 offen offset:0 sc1
    v_mfma_f32_16x16x32_bf16 a[200:203], v[132:135], a[84:87], a[200:203]
    ds_read_b64_tr_b16 v[162:163], v192 offset:33792
    v_mfma_f32_16x16x32_bf16 a[200:203], v[128:131], a[68:71], a[200:203]
    v_mfma_f32_16x16x32_bf16 a[208:211], v[128:131], a[72:75], a[208:211]
    ds_read_b64_tr_b16 v[164:165], v192 offset:40960
    v_mfma_f32_16x16x32_bf16 a[208:211], v[132:135], a[88:91], a[208:211]
    v_mfma_f32_16x16x32_bf16 a[216:219], v[132:135], a[92:95], a[216:219]
    ds_read_b64_tr_b16 v[166:167], v192 offset:41984
    v_mfma_f32_16x16x32_bf16 a[216:219], v[128:131], a[76:79], a[216:219]
    buffer_load_dwordx4 a[148:151], v240, s[20:23], s40 offen offset:1024 sc1
    v_mfma_f32_16x16x32_bf16 a[220:223], v[136:139], a[76:79], a[220:223]
    ds_read_b64_tr_b16 v[168:169], v192 offset:32776
    v_mfma_f32_16x16x32_bf16 a[220:223], v[140:143], a[92:95], a[220:223]
    v_mfma_f32_16x16x32_bf16 a[212:215], v[140:143], a[88:91], a[212:215]
    ds_read_b64_tr_b16 v[170:171], v192 offset:33800
    v_mfma_f32_16x16x32_bf16 a[212:215], v[136:139], a[72:75], a[212:215]
    v_mfma_f32_16x16x32_bf16 a[204:207], v[136:139], a[68:71], a[204:207]
    ds_read_b64_tr_b16 v[172:173], v192 offset:40968
    v_mfma_f32_16x16x32_bf16 a[204:207], v[140:143], a[84:87], a[204:207]
    buffer_load_dwordx4 a[152:155], v240, s[20:23], s40 offen offset:2048 sc1
    v_mfma_f32_16x16x32_bf16 a[196:199], v[140:143], a[80:83], a[196:199]
    ds_read_b64_tr_b16 v[174:175], v192 offset:41992
    v_mfma_f32_16x16x32_bf16 a[196:199], v[136:139], a[64:67], a[196:199]
    s_waitcnt lgkmcnt(8)
    v_mfma_f32_16x16x32_bf16 a[224:227], v[144:147], a[64:67], a[224:227]
    ds_read_b64_tr_b16 v[176:177], v193 offset:32768
    v_mfma_f32_16x16x32_bf16 a[224:227], v[148:151], a[80:83], a[224:227]
    v_mfma_f32_16x16x32_bf16 a[232:235], v[148:151], a[84:87], a[232:235]
    ds_read_b64_tr_b16 v[178:179], v193 offset:33792
    v_mfma_f32_16x16x32_bf16 a[232:235], v[144:147], a[68:71], a[232:235]
    buffer_load_dwordx4 a[156:159], v240, s[20:23], s40 offen offset:3072 sc1
    v_mfma_f32_16x16x32_bf16 a[240:243], v[144:147], a[72:75], a[240:243]
    ds_read_b64_tr_b16 v[180:181], v193 offset:40960
    s_add_u32 s40, s40, 4096
    v_mfma_f32_16x16x32_bf16 a[240:243], v[148:151], a[88:91], a[240:243]
    v_mfma_f32_16x16x32_bf16 a[248:251], v[148:151], a[92:95], a[248:251]
    ds_read_b64_tr_b16 v[182:183], v193 offset:41984
    v_mfma_f32_16x16x32_bf16 a[248:251], v[144:147], a[76:79], a[248:251]
    v_mfma_f32_16x16x32_bf16 a[252:255], v[152:155], a[76:79], a[252:255]
    ds_read_b64_tr_b16 v[184:185], v193 offset:32776
    v_mfma_f32_16x16x32_bf16 a[252:255], v[156:159], a[92:95], a[252:255]
    v_mfma_f32_16x16x32_bf16 a[244:247], v[156:159], a[88:91], a[244:247]
    ds_read_b64_tr_b16 v[186:187], v193 offset:33800
    v_mfma_f32_16x16x32_bf16 a[244:247], v[152:155], a[72:75], a[244:247]
    v_mfma_f32_16x16x32_bf16 a[236:239], v[152:155], a[68:71], a[236:239]
    ds_read_b64_tr_b16 v[188:189], v193 offset:40968
    v_mfma_f32_16x16x32_bf16 a[236:239], v[156:159], a[84:87], a[236:239]
    v_mfma_f32_16x16x32_bf16 a[228:231], v[156:159], a[80:83], a[228:231]
    ds_read_b64_tr_b16 v[190:191], v193 offset:41992
    v_mfma_f32_16x16x32_bf16 a[228:231], v[152:155], a[64:67], a[228:231]
    s_waitcnt vmcnt(14) lgkmcnt(8)
    v_mfma_f32_16x16x32_bf16 v[0:3], v[160:163], a[96:99], v[0:3]
    ds_read_b64_tr_b16 v[128:129], v194 offset:32768
    s_add_u32 m0, s45, 0
    v_mfma_f32_16x16x32_bf16 v[0:3], v[164:167], a[112:115], v[0:3]
    buffer_load_dwordx4 v204, s[28:31], s42 offen offset:0 lds
    v_mfma_f32_16x16x32_bf16 v[32:35], v[164:167], a[116:119], v[32:35]
    ds_read_b64_tr_b16 v[130:131], v194 offset:33792
    v_lshl_add_u32 v229, v229, 5, v249
    v_mfma_f32_16x16x32_bf16 v[32:35], v[160:163], a[100:103], v[32:35]
    v_xor_b32 v230, 2, v248
    v_lshl_add_u32 v230, v230, 5, v249
    v_mfma_f32_16x16x32_bf16 v[64:67], v[160:163], a[104:107], v[64:67]
    ds_read_b64_tr_b16 v[132:133], v194 offset:40960
    v_xor_b32 v231, 3, v248
    v_mfma_f32_16x16x32_bf16 v[64:67], v[164:167], a[120:123], v[64:67]
    v_lshl_add_u32 v231, v231, 5, v249
    v_xor_b32 v232, 4, v248
    v_mfma_f32_16x16x32_bf16 v[96:99], v[164:167], a[124:127], v[96:99]
    ds_read_b64_tr_b16 v[134:135], v194 offset:41984
    v_lshl_add_u32 v232, v232, 5, v249
    v_mfma_f32_16x16x32_bf16 v[96:99], v[160:163], a[108:111], v[96:99]
    buffer_load_dwordx4 v205, s[28:31], s42 offen offset:1024 lds
    v_mfma_f32_16x16x32_bf16 v[100:103], v[168:171], a[108:111], v[100:103]
    ds_read_b64_tr_b16 v[136:137], v194 offset:32776
    s_add_u32 s42, s42, 221184
    v_mfma_f32_16x16x32_bf16 v[100:103], v[172:175], a[124:127], v[100:103]
    s_add_u32 m0, s44, 0
    v_xor_b32 v233, 5, v248
    v_lshl_add_u32 v233, v233, 5, v249
    v_mfma_f32_16x16x32_bf16 v[68:71], v[172:175], a[120:123], v[68:71]
    ds_read_b64_tr_b16 v[138:139], v194 offset:33800
    v_xor_b32 v234, 6, v248
    v_mfma_f32_16x16x32_bf16 v[68:71], v[168:171], a[104:107], v[68:71]
    v_lshl_add_u32 v234, v234, 5, v249
    v_xor_b32 v235, 7, v248
    v_mfma_f32_16x16x32_bf16 v[36:39], v[168:171], a[100:103], v[36:39]
    ds_read_b64_tr_b16 v[140:141], v194 offset:40968
    v_lshl_add_u32 v235, v235, 5, v249
    v_mfma_f32_16x16x32_bf16 v[36:39], v[172:175], a[116:119], v[36:39]
    buffer_load_dwordx4 v200, s[24:27], s41 offen offset:0 lds
    v_mfma_f32_16x16x32_bf16 v[4:7], v[172:175], a[112:115], v[4:7]
    ds_read_b64_tr_b16 v[142:143], v194 offset:41992
    v_cmp_eq_u32 vcc, 1, v247
    v_mfma_f32_16x16x32_bf16 v[4:7], v[168:171], a[96:99], v[4:7]
    v_mov_b32 v241, 0x44444444
    v_mov_b32 v248, 0xeeeeeeee
    s_waitcnt lgkmcnt(8)
    v_mfma_f32_16x16x32_bf16 v[8:11], v[176:179], a[96:99], v[8:11]
    ds_read_b64_tr_b16 v[144:145], v195 offset:32768
    v_cndmask_b32 v241, v241, v248, vcc
    v_mfma_f32_16x16x32_bf16 v[8:11], v[180:183], a[112:115], v[8:11]
    v_cmp_gt_u32 vcc, 2, v247
    v_mov_b32 v248, 0x3f803f80
    v_mfma_f32_16x16x32_bf16 v[40:43], v[180:183], a[116:119], v[40:43]
    ds_read_b64_tr_b16 v[146:147], v195 offset:33792
    v_mov_b32 v206, 0
    v_mfma_f32_16x16x32_bf16 v[40:43], v[176:179], a[100:103], v[40:43]
    buffer_load_dwordx4 v201, s[24:27], s41 offen offset:1024 lds
    v_mfma_f32_16x16x32_bf16 v[72:75], v[176:179], a[104:107], v[72:75]
    ds_read_b64_tr_b16 v[148:149], v195 offset:40960
    v_cndmask_b32 v206, v206, v248, vcc
    v_mfma_f32_16x16x32_bf16 v[72:75], v[180:183], a[120:123], v[72:75]
K1_pg2:
    s_cbranch_execz K1_pg6
    v_mfma_f32_16x16x32_bf16 v[104:107], v[180:183], a[124:127], v[104:107]
    ds_read_b64_tr_b16 v[150:151], v195 offset:41984
    v_mfma_f32_16x16x32_bf16 v[104:107], v[176:179], a[108:111], v[104:107]
    v_mfma_f32_16x16x32_bf16 v[108:111], v[184:187], a[108:111], v[108:111]
    ds_read_b64_tr_b16 v[152:153], v195 offset:32776
    v_mfma_f32_16x16x32_bf16 v[108:111], v[188:191], a[124:127], v[108:111]
    buffer_load_dwordx4 v202, s[24:27], s41 offen offset:2048 lds
    v_mfma_f32_16x16x32_bf16 v[76:79], v[188:191], a[120:123], v[76:79]
    ds_read_b64_tr_b16 v[154:155], v195 offset:33800
    v_mfma_f32_16x16x32_bf16 v[76:79], v[184:187], a[104:107], v[76:79]
    v_mfma_f32_16x16x32_bf16 v[44:47], v[184:187], a[100:103], v[44:47]
    ds_read_b64_tr_b16 v[156:157], v195 offset:40968
    v_mfma_f32_16x16x32_bf16 v[44:47], v[188:191], a[116:119], v[44:47]
    v_mfma_f32_16x16x32_bf16 v[12:15], v[188:191], a[112:115], v[12:15]
    ds_read_b64_tr_b16 v[158:159], v195 offset:41992
    v_mfma_f32_16x16x32_bf16 v[12:15], v[184:187], a[96:99], v[12:15]
    s_waitcnt lgkmcnt(8)
    v_mfma_f32_16x16x32_bf16 v[16:19], v[128:131], a[96:99], v[16:19]
    ds_read_b64_tr_b16 v[160:161], v196 offset:32768
    v_mfma_f32_16x16x32_bf16 v[16:19], v[132:135], a[112:115], v[16:19]
    buffer_load_dwordx4 v203, s[24:27], s41 offen offset:3072 lds
    v_mfma_f32_16x16x32_bf16 v[48:51], v[132:135], a[116:119], v[48:51]
    ds_read_b64_tr_b16 v[162:163], v196 offset:33280
    s_add_u32 s41, s41, 524288
    v_mfma_f32_16x16x32_bf16 v[48:51], v[128:131], a[100:103], v[48:51]
    v_mfma_f32_16x16x32_bf16 v[80:83], v[128:131], a[104:107], v[80:83]
    ds_read_b64_tr_b16 v[164:165], v196 offset:36864
    v_mfma_f32_16x16x32_bf16 v[80:83], v[132:135], a[120:123], v[80:83]
    v_mfma_f32_16x16x32_bf16 v[112:115], v[132:135], a[124:127], v[112:115]
    ds_read_b64_tr_b16 v[166:167], v196 offset:37376
    v_mfma_f32_16x16x32_bf16 v[112:115], v[128:131], a[108:111], v[112:115]
    buffer_load_dwordx4 a[160:163], v240, s[20:23], s40 offen offset:0 sc1
    v_mfma_f32_16x16x32_bf16 v[116:119], v[136:139], a[108:111], v[116:119]
    ds_read_b64_tr_b16 v[168:169], v197 offset:32768
    v_mfma_f32_16x16x32_bf16 v[116:119], v[140:143], a[124:127], v[116:119]
    v_mfma_f32_16x16x32_bf16 v[84:87], v[140:143], a[120:123], v[84:87]
    ds_read_b64_tr_b16 v[170:171], v197 offset:33280
    v_mfma_f32_16x16x32_bf16 v[84:87], v[136:139], a[104:107], v[84:87]
    v_mfma_f32_16x16x32_bf16 v[52:55], v[136:139], a[100:103], v[52:55]
    ds_read_b64_tr_b16 v[172:173], v197 offset:36864
    v_mfma_f32_16x16x32_bf16 v[52:55], v[140:143], a[116:119], v[52:55]
    buffer_load_dwordx4 a[164:167], v240, s[20:23], s40 offen offset:1024 sc1
    v_mfma_f32_16x16x32_bf16 v[20:23], v[140:143], a[112:115], v[20:23]
    ds_read_b64_tr_b16 v[174:175], v197 offset:37376
    v_mfma_f32_16x16x32_bf16 v[20:23], v[136:139], a[96:99], v[20:23]
    s_waitcnt lgkmcnt(8)
    v_mfma_f32_16x16x32_bf16 v[24:27], v[144:147], a[96:99], v[24:27]
    ds_read_b64_tr_b16 v[176:177], v198 offset:32768
    v_mfma_f32_16x16x32_bf16 v[24:27], v[148:151], a[112:115], v[24:27]
    v_mfma_f32_16x16x32_bf16 v[56:59], v[148:151], a[116:119], v[56:59]
    ds_read_b64_tr_b16 v[178:179], v198 offset:33280
    v_mfma_f32_16x16x32_bf16 v[56:59], v[144:147], a[100:103], v[56:59]
    buffer_load_dwordx4 a[168:171], v240, s[20:23], s40 offen offset:2048 sc1
    v_mfma_f32_16x16x32_bf16 v[88:91], v[144:147], a[104:107], v[88:91]
    ds_read_b64_tr_b16 v[180:181], v198 offset:36864
    v_mfma_f32_16x16x32_bf16 v[88:91], v[148:151], a[120:123], v[88:91]
    v_mfma_f32_16x16x32_bf16 v[120:123], v[148:151], a[124:127], v[120:123]
    ds_read_b64_tr_b16 v[182:183], v198 offset:37376
    v_mfma_f32_16x16x32_bf16 v[120:123], v[144:147], a[108:111], v[120:123]
    v_mfma_f32_16x16x32_bf16 v[124:127], v[152:155], a[108:111], v[124:127]
    ds_read_b64_tr_b16 v[184:185], v199 offset:32768
    v_mfma_f32_16x16x32_bf16 v[124:127], v[156:159], a[124:127], v[124:127]
    buffer_load_dwordx4 a[172:175], v240, s[20:23], s40 offen offset:3072 sc1
    v_mfma_f32_16x16x32_bf16 v[92:95], v[156:159], a[120:123], v[92:95]
    ds_read_b64_tr_b16 v[186:187], v199 offset:33280
    s_add_u32 s40, s40, 4096
    v_mfma_f32_16x16x32_bf16 v[92:95], v[152:155], a[104:107], v[92:95]
    v_mfma_f32_16x16x32_bf16 v[60:63], v[152:155], a[100:103], v[60:63]
    ds_read_b64_tr_b16 v[188:189], v199 offset:36864
    v_mfma_f32_16x16x32_bf16 v[60:63], v[156:159], a[116:119], v[60:63]
    v_mfma_f32_16x16x32_bf16 v[28:31], v[156:159], a[112:115], v[28:31]
    ds_read_b64_tr_b16 v[190:191], v199 offset:37376
    v_mfma_f32_16x16x32_bf16 v[28:31], v[152:155], a[96:99], v[28:31]
    s_waitcnt vmcnt(18)
    s_barrier
    s_waitcnt lgkmcnt(8)
    v_mfma_f32_16x16x32_bf16 a[192:195], v[160:163], a[96:99], a[192:195]
    ds_read_b64_tr_b16 v[128:129], v192 offset:49152
    v_mfma_f32_16x16x32_bf16 a[192:195], v[164:167], a[112:115], a[192:195]
    buffer_load_dwordx4 a[176:179], v240, s[20:23], s40 offen offset:0 sc1
    v_mfma_f32_16x16x32_bf16 a[200:203], v[164:167], a[116:119], a[200:203]
    ds_read_b64_tr_b16 v[130:131], v192 offset:50176
    v_mfma_f32_16x16x32_bf16 a[200:203], v[160:163], a[100:103], a[200:203]
    v_mfma_f32_16x16x32_bf16 a[208:211], v[160:163], a[104:107], a[208:211]
    ds_read_b64_tr_b16 v[132:133], v192 offset:57344
    v_mfma_f32_16x16x32_bf16 a[208:211], v[164:167], a[120:123], a[208:211]
    v_mfma_f32_16x16x32_bf16 a[216:219], v[164:167], a[124:127], a[216:219]
    ds_read_b64_tr_b16 v[134:135], v192 offset:58368
    v_mfma_f32_16x16x32_bf16 a[216:219], v[160:163], a[108:111], a[216:219]
    buffer_load_dwordx4 a[180:183], v240, s[20:23], s40 offen offset:1024 sc1
    v_mfma_f32_16x16x32_bf16 a[220:223], v[168:171], a[108:111], a[220:223]
    ds_read_b64_tr_b16 v[136:137], v192 offset:49160
    v_mfma_f32_16x16x32_bf16 a[220:223], v[172:175], a[124:127], a[220:223]
    v_mfma_f32_16x16x32_bf16 a[212:215], v[172:175], a[120:123], a[212:215]
    ds_read_b64_tr_b16 v[138:139], v192 offset:50184
    v_mfma_f32_16x16x32_bf16 a[212:215], v[168:171], a[104:107], a[212:215]
    v_mfma_f32_16x16x32_bf16 a[204:207], v[168:171], a[100:103], a[204:207]
    ds_read_b64_tr_b16 v[140:141], v192 offset:57352
    v_mfma_f32_16x16x32_bf16 a[204:207], v[172:175], a[116:119], a[204:207]
    buffer_load_dwordx4 a[184:187], v240, s[20:23], s40 offen offset:2048 sc1
    v_mfma_f32_16x16x32_bf16 a[196:199], v[172:175], a[112:115], a[196:199]
    ds_read_b64_tr_b16 v[142:143], v192 offset:58376
    v_mfma_f32_16x16x32_bf16 a[196:199], v[168:171], a[96:99], a[196:199]
    s_waitcnt lgkmcnt(8)
    v_mfma_f32_16x16x32_bf16 a[224:227], v[176:179], a[96:99], a[224:227]
    ds_read_b64_tr_b16 v[144:145], v193 offset:49152
    v_mfma_f32_16x16x32_bf16 a[224:227], v[180:183], a[112:115], a[224:227]
    v_mfma_f32_16x16x32_bf16 a[232:235], v[180:183], a[116:119], a[232:235]
    ds_read_b64_tr_b16 v[146:147], v193 offset:50176
    v_mfma_f32_16x16x32_bf16 a[232:235], v[176:179], a[100:103], a[232:235]
    buffer_load_dwordx4 a[188:191], v240, s[20:23], s40 offen offset:3072 sc1
    v_mfma_f32_16x16x32_bf16 a[240:243], v[176:179], a[104:107], a[240:243]
    ds_read_b64_tr_b16 v[148:149], v193 offset:57344
    s_add_u32 s40, s40, 4096
    v_mfma_f32_16x16x32_bf16 a[240:243], v[180:183], a[120:123], a[240:243]
    v_mfma_f32_16x16x32_bf16 a[248:251], v[180:183], a[124:127], a[248:251]
    ds_read_b64_tr_b16 v[150:151], v193 offset:58368
    v_mfma_f32_16x16x32_bf16 a[248:251], v[176:179], a[108:111], a[248:251]
    v_mfma_f32_16x16x32_bf16 a[252:255], v[184:187], a[108:111], a[252:255]
    ds_read_b64_tr_b16 v[152:153], v193 offset:49160
    v_mfma_f32_16x16x32_bf16 a[252:255], v[188:191], a[124:127], a[252:255]
    v_mfma_f32_16x16x32_bf16 a[244:247], v[188:191], a[120:123], a[244:247]
    ds_read_b64_tr_b16 v[154:155], v193 offset:50184
    v_mfma_f32_16x16x32_bf16 a[244:247], v[184:187], a[104:107], a[244:247]
    v_mfma_f32_16x16x32_bf16 a[236:239], v[184:187], a[100:103], a[236:239]
    ds_read_b64_tr_b16 v[156:157], v193 offset:57352
    v_mfma_f32_16x16x32_bf16 a[236:239], v[188:191], a[116:119], a[236:239]
    v_mfma_f32_16x16x32_bf16 a[228:231], v[188:191], a[112:115], a[228:231]
    ds_read_b64_tr_b16 v[158:159], v193 offset:58376
    v_mfma_f32_16x16x32_bf16 a[228:231], v[184:187], a[96:99], a[228:231]
    s_waitcnt vmcnt(14) lgkmcnt(8)
    v_mfma_f32_16x16x32_bf16 v[0:3], v[128:131], a[128:131], v[0:3]
    ds_read_b64_tr_b16 v[160:161], v194 offset:49152
    s_add_u32 m0, s45, 16384
    v_mfma_f32_16x16x32_bf16 v[0:3], v[132:135], a[144:147], v[0:3]
    buffer_load_dwordx4 v204, s[28:31], s42 offen offset:0 lds
    v_mfma_f32_16x16x32_bf16 v[32:35], v[132:135], a[148:151], v[32:35]
    ds_read_b64_tr_b16 v[162:163], v194 offset:50176
    s_add_u32 s10, s8, K1_s8-K1_pc+(0)
    s_addc_u32 s11, s9, 0
    v_mfma_f32_16x16x32_bf16 v[32:35], v[128:131], a[132:135], v[32:35]
    v_mad_u64_u32 v[208:209], vcc, v250, 1, s[10:11]
    v_mfma_f32_16x16x32_bf16 v[64:67], v[128:131], a[136:139], v[64:67]
    ds_read_b64_tr_b16 v[164:165], v194 offset:57344
    v_mfma_f32_16x16x32_bf16 v[64:67], v[132:135], a[152:155], v[64:67]
    v_mfma_f32_16x16x32_bf16 v[96:99], v[132:135], a[156:159], v[96:99]
    ds_read_b64_tr_b16 v[166:167], v194 offset:58368
    v_mfma_f32_16x16x32_bf16 v[96:99], v[128:131], a[140:143], v[96:99]
    buffer_load_dwordx4 v205, s[28:31], s42 offen offset:1024 lds
    v_mfma_f32_16x16x32_bf16 v[100:103], v[136:139], a[140:143], v[100:103]
    ds_read_b64_tr_b16 v[168:169], v194 offset:49160
    s_add_u32 s42, s42, 221184
    v_mfma_f32_16x16x32_bf16 v[100:103], v[140:143], a[156:159], v[100:103]
    s_add_u32 m0, s44, 16384
    v_mfma_f32_16x16x32_bf16 v[68:71], v[140:143], a[152:155], v[68:71]
    ds_read_b64_tr_b16 v[170:171], v194 offset:50184
    v_mfma_f32_16x16x32_bf16 v[68:71], v[136:139], a[136:139], v[68:71]
    v_mfma_f32_16x16x32_bf16 v[36:39], v[136:139], a[132:135], v[36:39]
    ds_read_b64_tr_b16 v[172:173], v194 offset:57352
    v_mfma_f32_16x16x32_bf16 v[36:39], v[140:143], a[148:151], v[36:39]
    buffer_load_dwordx4 v200, s[24:27], s41 offen offset:0 lds
    v_mfma_f32_16x16x32_bf16 v[4:7], v[140:143], a[144:147], v[4:7]
    ds_read_b64_tr_b16 v[174:175], v194 offset:58376
    v_mfma_f32_16x16x32_bf16 v[4:7], v[136:139], a[128:131], v[4:7]
    s_waitcnt lgkmcnt(8)
    v_mfma_f32_16x16x32_bf16 v[8:11], v[144:147], a[128:131], v[8:11]
    ds_read_b64_tr_b16 v[176:177], v195 offset:49152
    v_mfma_f32_16x16x32_bf16 v[8:11], v[148:151], a[144:147], v[8:11]
    v_mfma_f32_16x16x32_bf16 v[40:43], v[148:151], a[148:151], v[40:43]
    ds_read_b64_tr_b16 v[178:179], v195 offset:50176
    v_mfma_f32_16x16x32_bf16 v[40:43], v[144:147], a[132:135], v[40:43]
    buffer_load_dwordx4 v201, s[24:27], s41 offen offset:1024 lds
    v_mfma_f32_16x16x32_bf16 v[72:75], v[144:147], a[136:139], v[72:75]
    ds_read_b64_tr_b16 v[180:181], v195 offset:57344
    v_mfma_f32_16x16x32_bf16 v[72:75], v[148:151], a[152:155], v[72:75]
    v_mfma_f32_16x16x32_bf16 v[104:107], v[148:151], a[156:159], v[104:107]
    ds_read_b64_tr_b16 v[182:183], v195 offset:58368
    v_mfma_f32_16x16x32_bf16 v[104:107], v[144:147], a[140:143], v[104:107]
    v_mfma_f32_16x16x32_bf16 v[108:111], v[152:155], a[140:143], v[108:111]
    ds_read_b64_tr_b16 v[184:185], v195 offset:49160
    v_mfma_f32_16x16x32_bf16 v[108:111], v[156:159], a[156:159], v[108:111]
    buffer_load_dwordx4 v202, s[24:27], s41 offen offset:2048 lds
    v_mfma_f32_16x16x32_bf16 v[76:79], v[156:159], a[152:155], v[76:79]
    ds_read_b64_tr_b16 v[186:187], v195 offset:50184
    v_mfma_f32_16x16x32_bf16 v[76:79], v[152:155], a[136:139], v[76:79]
    v_mfma_f32_16x16x32_bf16 v[44:47], v[152:155], a[132:135], v[44:47]
    ds_read_b64_tr_b16 v[188:189], v195 offset:57352
    v_mfma_f32_16x16x32_bf16 v[44:47], v[156:159], a[148:151], v[44:47]
    v_mfma_f32_16x16x32_bf16 v[12:15], v[156:159], a[144:147], v[12:15]
    ds_read_b64_tr_b16 v[190:191], v195 offset:58376
    v_mfma_f32_16x16x32_bf16 v[12:15], v[152:155], a[128:131], v[12:15]
    s_waitcnt lgkmcnt(8)
    v_mfma_f32_16x16x32_bf16 v[16:19], v[160:163], a[128:131], v[16:19]
    ds_read_b64_tr_b16 v[128:129], v196 offset:49152
    v_mfma_f32_16x16x32_bf16 v[16:19], v[164:167], a[144:147], v[16:19]
    buffer_load_dwordx4 v203, s[24:27], s41 offen offset:3072 lds
    v_mfma_f32_16x16x32_bf16 v[48:51], v[164:167], a[148:151], v[48:51]
    ds_read_b64_tr_b16 v[130:131], v196 offset:49664
    s_add_u32 s41, s41, 524288
    v_mfma_f32_16x16x32_bf16 v[48:51], v[160:163], a[132:135], v[48:51]
    v_mfma_f32_16x16x32_bf16 v[80:83], v[160:163], a[136:139], v[80:83]
    ds_read_b64_tr_b16 v[132:133], v196 offset:53248
    v_mfma_f32_16x16x32_bf16 v[80:83], v[164:167], a[152:155], v[80:83]
    v_mfma_f32_16x16x32_bf16 v[112:115], v[164:167], a[156:159], v[112:115]
    ds_read_b64_tr_b16 v[134:135], v196 offset:53760
    v_mfma_f32_16x16x32_bf16 v[112:115], v[160:163], a[140:143], v[112:115]
    buffer_load_dwordx4 a[64:67], v240, s[20:23], s40 offen offset:0 sc1
    v_mfma_f32_16x16x32_bf16 v[116:119], v[168:171], a[140:143], v[116:119]
    ds_read_b64_tr_b16 v[136:137], v197 offset:49152
    v_mfma_f32_16x16x32_bf16 v[116:119], v[172:175], a[156:159], v[116:119]
    v_mfma_f32_16x16x32_bf16 v[84:87], v[172:175], a[152:155], v[84:87]
    ds_read_b64_tr_b16 v[138:139], v197 offset:49664
    v_mfma_f32_16x16x32_bf16 v[84:87], v[168:171], a[136:139], v[84:87]
    v_mfma_f32_16x16x32_bf16 v[52:55], v[168:171], a[132:135], v[52:55]
    ds_read_b64_tr_b16 v[140:141], v197 offset:53248
    v_mfma_f32_16x16x32_bf16 v[52:55], v[172:175], a[148:151], v[52:55]
    buffer_load_dwordx4 a[68:71], v240, s[20:23], s40 offen offset:1024 sc1
    v_mfma_f32_16x16x32_bf16 v[20:23], v[172:175], a[144:147], v[20:23]
    ds_read_b64_tr_b16 v[142:143], v197 offset:53760
    v_mfma_f32_16x16x32_bf16 v[20:23], v[168:171], a[128:131], v[20:23]
    s_waitcnt lgkmcnt(8)
    v_mfma_f32_16x16x32_bf16 v[24:27], v[176:179], a[128:131], v[24:27]
    ds_read_b64_tr_b16 v[144:145], v198 offset:49152
    v_mfma_f32_16x16x32_bf16 v[24:27], v[180:183], a[144:147], v[24:27]
    v_mfma_f32_16x16x32_bf16 v[56:59], v[180:183], a[148:151], v[56:59]
    ds_read_b64_tr_b16 v[146:147], v198 offset:49664
    v_mfma_f32_16x16x32_bf16 v[56:59], v[176:179], a[132:135], v[56:59]
    buffer_load_dwordx4 a[72:75], v240, s[20:23], s40 offen offset:2048 sc1
    v_mfma_f32_16x16x32_bf16 v[88:91], v[176:179], a[136:139], v[88:91]
    ds_read_b64_tr_b16 v[148:149], v198 offset:53248
    v_mfma_f32_16x16x32_bf16 v[88:91], v[180:183], a[152:155], v[88:91]
    v_mfma_f32_16x16x32_bf16 v[120:123], v[180:183], a[156:159], v[120:123]
    ds_read_b64_tr_b16 v[150:151], v198 offset:53760
    v_mfma_f32_16x16x32_bf16 v[120:123], v[176:179], a[140:143], v[120:123]
    v_mfma_f32_16x16x32_bf16 v[124:127], v[184:187], a[140:143], v[124:127]
    ds_read_b64_tr_b16 v[152:153], v199 offset:49152
    v_mfma_f32_16x16x32_bf16 v[124:127], v[188:191], a[156:159], v[124:127]
    buffer_load_dwordx4 a[76:79], v240, s[20:23], s40 offen offset:3072 sc1
    v_mfma_f32_16x16x32_bf16 v[92:95], v[188:191], a[152:155], v[92:95]
    ds_read_b64_tr_b16 v[154:155], v199 offset:49664
    s_add_u32 s40, s40, 4096
    v_mfma_f32_16x16x32_bf16 v[92:95], v[184:187], a[136:139], v[92:95]
    v_mfma_f32_16x16x32_bf16 v[60:63], v[184:187], a[132:135], v[60:63]
    ds_read_b64_tr_b16 v[156:157], v199 offset:53248
    v_mfma_f32_16x16x32_bf16 v[60:63], v[188:191], a[148:151], v[60:63]
    v_mfma_f32_16x16x32_bf16 v[28:31], v[188:191], a[144:147], v[28:31]
    ds_read_b64_tr_b16 v[158:159], v199 offset:53760
    v_mfma_f32_16x16x32_bf16 v[28:31], v[184:187], a[128:131], v[28:31]
    s_waitcnt vmcnt(18)
    s_barrier
    s_waitcnt lgkmcnt(8)
    v_mfma_f32_16x16x32_bf16 a[192:195], v[128:131], a[128:131], a[192:195]
    ds_read_b64_tr_b16 v[160:161], v192 offset:0
    v_mfma_f32_16x16x32_bf16 a[192:195], v[132:135], a[144:147], a[192:195]
    buffer_load_dwordx4 a[80:83], v240, s[20:23], s40 offen offset:0 sc1
    v_mfma_f32_16x16x32_bf16 a[200:203], v[132:135], a[148:151], a[200:203]
    ds_read_b64_tr_b16 v[162:163], v192 offset:1024
    v_mfma_f32_16x16x32_bf16 a[200:203], v[128:131], a[132:135], a[200:203]
    v_mfma_f32_16x16x32_bf16 a[208:211], v[128:131], a[136:139], a[208:211]
    ds_read_b64_tr_b16 v[164:165], v192 offset:8192
    v_mfma_f32_16x16x32_bf16 a[208:211], v[132:135], a[152:155], a[208:211]
    v_mfma_f32_16x16x32_bf16 a[216:219], v[132:135], a[156:159], a[216:219]
    ds_read_b64_tr_b16 v[166:167], v192 offset:9216
    v_mfma_f32_16x16x32_bf16 a[216:219], v[128:131], a[140:143], a[216:219]
    buffer_load_dwordx4 a[84:87], v240, s[20:23], s40 offen offset:1024 sc1
    v_mfma_f32_16x16x32_bf16 a[220:223], v[136:139], a[140:143], a[220:223]
    ds_read_b64_tr_b16 v[168:169], v192 offset:8
    v_mfma_f32_16x16x32_bf16 a[220:223], v[140:143], a[156:159], a[220:223]
    v_mfma_f32_16x16x32_bf16 a[212:215], v[140:143], a[152:155], a[212:215]
    ds_read_b64_tr_b16 v[170:171], v192 offset:1032
    v_mfma_f32_16x16x32_bf16 a[212:215], v[136:139], a[136:139], a[212:215]
    v_mfma_f32_16x16x32_bf16 a[204:207], v[136:139], a[132:135], a[204:207]
    ds_read_b64_tr_b16 v[172:173], v192 offset:8200
    v_mfma_f32_16x16x32_bf16 a[204:207], v[140:143], a[148:151], a[204:207]
    buffer_load_dwordx4 a[88:91], v240, s[20:23], s40 offen offset:2048 sc1
    v_mfma_f32_16x16x32_bf16 a[196:199], v[140:143], a[144:147], a[196:199]
    ds_read_b64_tr_b16 v[174:175], v192 offset:9224
    v_mfma_f32_16x16x32_bf16 a[196:199], v[136:139], a[128:131], a[196:199]
    s_waitcnt lgkmcnt(8)
    v_mfma_f32_16x16x32_bf16 a[224:227], v[144:147], a[128:131], a[224:227]
    ds_read_b64_tr_b16 v[176:177], v193 offset:0
    v_mfma_f32_16x16x32_bf16 a[224:227], v[148:151], a[144:147], a[224:227]
    v_mfma_f32_16x16x32_bf16 a[232:235], v[148:151], a[148:151], a[232:235]
    ds_read_b64_tr_b16 v[178:179], v193 offset:1024
    v_mfma_f32_16x16x32_bf16 a[232:235], v[144:147], a[132:135], a[232:235]
    buffer_load_dwordx4 a[92:95], v240, s[20:23], s40 offen offset:3072 sc1
    v_mfma_f32_16x16x32_bf16 a[240:243], v[144:147], a[136:139], a[240:243]
    ds_read_b64_tr_b16 v[180:181], v193 offset:8192
    s_add_u32 s40, s40, 4096
    v_mfma_f32_16x16x32_bf16 a[240:243], v[148:151], a[152:155], a[240:243]
    v_mfma_f32_16x16x32_bf16 a[248:251], v[148:151], a[156:159], a[248:251]
    ds_read_b64_tr_b16 v[182:183], v193 offset:9216
    v_mfma_f32_16x16x32_bf16 a[248:251], v[144:147], a[140:143], a[248:251]
    v_mfma_f32_16x16x32_bf16 a[252:255], v[152:155], a[140:143], a[252:255]
    ds_read_b64_tr_b16 v[184:185], v193 offset:8
    v_mfma_f32_16x16x32_bf16 a[252:255], v[156:159], a[156:159], a[252:255]
    global_load_dword v207, v[208:209], off
    v_mfma_f32_16x16x32_bf16 a[244:247], v[156:159], a[152:155], a[244:247]
    ds_read_b64_tr_b16 v[186:187], v193 offset:1032
    v_mfma_f32_16x16x32_bf16 a[244:247], v[152:155], a[136:139], a[244:247]
    v_mfma_f32_16x16x32_bf16 a[236:239], v[152:155], a[132:135], a[236:239]
    ds_read_b64_tr_b16 v[188:189], v193 offset:8200
    v_mfma_f32_16x16x32_bf16 a[236:239], v[156:159], a[148:151], a[236:239]
    v_mfma_f32_16x16x32_bf16 a[228:231], v[156:159], a[144:147], a[228:231]
    ds_read_b64_tr_b16 v[190:191], v193 offset:9224
    v_mfma_f32_16x16x32_bf16 a[228:231], v[152:155], a[128:131], a[228:231]
    s_waitcnt vmcnt(15) lgkmcnt(8)
    v_mfma_f32_16x16x32_bf16 v[0:3], v[160:163], a[160:163], v[0:3]
    ds_read_b64_tr_b16 v[128:129], v194 offset:0
    s_add_u32 m0, s45, 32768
    v_mfma_f32_16x16x32_bf16 v[0:3], v[164:167], a[176:179], v[0:3]
    buffer_load_dwordx4 v204, s[28:31], s42 offen offset:0 lds
    v_mfma_f32_16x16x32_bf16 v[32:35], v[164:167], a[180:183], v[32:35]
    ds_read_b64_tr_b16 v[130:131], v194 offset:1024
    v_mfma_f32_16x16x32_bf16 v[32:35], v[160:163], a[164:167], v[32:35]
    v_mfma_f32_16x16x32_bf16 v[64:67], v[160:163], a[168:171], v[64:67]
    ds_read_b64_tr_b16 v[132:133], v194 offset:8192
    v_mfma_f32_16x16x32_bf16 v[64:67], v[164:167], a[184:187], v[64:67]
    v_mfma_f32_16x16x32_bf16 v[96:99], v[164:167], a[188:191], v[96:99]
    ds_read_b64_tr_b16 v[134:135], v194 offset:9216
    v_mfma_f32_16x16x32_bf16 v[96:99], v[160:163], a[172:175], v[96:99]
    buffer_load_dwordx4 v205, s[28:31], s42 offen offset:1024 lds
    v_mfma_f32_16x16x32_bf16 v[100:103], v[168:171], a[172:175], v[100:103]
    ds_read_b64_tr_b16 v[136:137], v194 offset:8
    s_add_u32 s42, s42, 221184
    v_mfma_f32_16x16x32_bf16 v[100:103], v[172:175], a[188:191], v[100:103]
    s_add_u32 m0, s44, 32768
    v_mfma_f32_16x16x32_bf16 v[68:71], v[172:175], a[184:187], v[68:71]
    ds_read_b64_tr_b16 v[138:139], v194 offset:1032
    v_mfma_f32_16x16x32_bf16 v[68:71], v[168:171], a[168:171], v[68:71]
    v_mfma_f32_16x16x32_bf16 v[36:39], v[168:171], a[164:167], v[36:39]
    ds_read_b64_tr_b16 v[140:141], v194 offset:8200
    v_mfma_f32_16x16x32_bf16 v[36:39], v[172:175], a[180:183], v[36:39]
    buffer_load_dwordx4 v200, s[24:27], s41 offen offset:0 lds
    v_mfma_f32_16x16x32_bf16 v[4:7], v[172:175], a[176:179], v[4:7]
    ds_read_b64_tr_b16 v[142:143], v194 offset:9224
    v_mfma_f32_16x16x32_bf16 v[4:7], v[168:171], a[160:163], v[4:7]
    s_waitcnt lgkmcnt(8)
    v_mfma_f32_16x16x32_bf16 v[8:11], v[176:179], a[160:163], v[8:11]
    ds_read_b64_tr_b16 v[144:145], v195 offset:0
    v_mfma_f32_16x16x32_bf16 v[8:11], v[180:183], a[176:179], v[8:11]
    v_mfma_f32_16x16x32_bf16 v[40:43], v[180:183], a[180:183], v[40:43]
    ds_read_b64_tr_b16 v[146:147], v195 offset:1024
    v_mfma_f32_16x16x32_bf16 v[40:43], v[176:179], a[164:167], v[40:43]
    buffer_load_dwordx4 v201, s[24:27], s41 offen offset:1024 lds
    v_mfma_f32_16x16x32_bf16 v[72:75], v[176:179], a[168:171], v[72:75]
    ds_read_b64_tr_b16 v[148:149], v195 offset:8192
    v_mfma_f32_16x16x32_bf16 v[72:75], v[180:183], a[184:187], v[72:75]
    v_mfma_f32_16x16x32_bf16 v[104:107], v[180:183], a[188:191], v[104:107]
    ds_read_b64_tr_b16 v[150:151], v195 offset:9216
    v_mfma_f32_16x16x32_bf16 v[104:107], v[176:179], a[172:175], v[104:107]
    v_mfma_f32_16x16x32_bf16 v[108:111], v[184:187], a[172:175], v[108:111]
    ds_read_b64_tr_b16 v[152:153], v195 offset:8
    v_mfma_f32_16x16x32_bf16 v[108:111], v[188:191], a[188:191], v[108:111]
    buffer_load_dwordx4 v202, s[24:27], s41 offen offset:2048 lds
    v_mfma_f32_16x16x32_bf16 v[76:79], v[188:191], a[184:187], v[76:79]
    ds_read_b64_tr_b16 v[154:155], v195 offset:1032
    v_mfma_f32_16x16x32_bf16 v[76:79], v[184:187], a[168:171], v[76:79]
    v_mfma_f32_16x16x32_bf16 v[44:47], v[184:187], a[164:167], v[44:47]
    ds_read_b64_tr_b16 v[156:157], v195 offset:8200
    v_mfma_f32_16x16x32_bf16 v[44:47], v[188:191], a[180:183], v[44:47]
    v_mfma_f32_16x16x32_bf16 v[12:15], v[188:191], a[176:179], v[12:15]
    ds_read_b64_tr_b16 v[158:159], v195 offset:9224
    v_mfma_f32_16x16x32_bf16 v[12:15], v[184:187], a[160:163], v[12:15]
    s_waitcnt lgkmcnt(8)
    v_mfma_f32_16x16x32_bf16 v[16:19], v[128:131], a[160:163], v[16:19]
    ds_read_b64_tr_b16 v[160:161], v196 offset:0
    v_mfma_f32_16x16x32_bf16 v[16:19], v[132:135], a[176:179], v[16:19]
    buffer_load_dwordx4 v203, s[24:27], s41 offen offset:3072 lds
    v_mfma_f32_16x16x32_bf16 v[48:51], v[132:135], a[180:183], v[48:51]
    ds_read_b64_tr_b16 v[162:163], v196 offset:512
    s_add_u32 s41, s41, 524288
    v_mfma_f32_16x16x32_bf16 v[48:51], v[128:131], a[164:167], v[48:51]
    v_mfma_f32_16x16x32_bf16 v[80:83], v[128:131], a[168:171], v[80:83]
    ds_read_b64_tr_b16 v[164:165], v196 offset:4096
    v_mfma_f32_16x16x32_bf16 v[80:83], v[132:135], a[184:187], v[80:83]
    v_mfma_f32_16x16x32_bf16 v[112:115], v[132:135], a[188:191], v[112:115]
    ds_read_b64_tr_b16 v[166:167], v196 offset:4608
    v_mfma_f32_16x16x32_bf16 v[112:115], v[128:131], a[172:175], v[112:115]
    buffer_load_dwordx4 a[96:99], v240, s[20:23], s40 offen offset:0 sc1
    v_mfma_f32_16x16x32_bf16 v[116:119], v[136:139], a[172:175], v[116:119]
    ds_read_b64_tr_b16 v[168:169], v197 offset:0
    v_mfma_f32_16x16x32_bf16 v[116:119], v[140:143], a[188:191], v[116:119]
    v_mfma_f32_16x16x32_bf16 v[84:87], v[140:143], a[184:187], v[84:87]
    ds_read_b64_tr_b16 v[170:171], v197 offset:512
    v_mfma_f32_16x16x32_bf16 v[84:87], v[136:139], a[168:171], v[84:87]
    v_mfma_f32_16x16x32_bf16 v[52:55], v[136:139], a[164:167], v[52:55]
    ds_read_b64_tr_b16 v[172:173], v197 offset:4096
    v_mfma_f32_16x16x32_bf16 v[52:55], v[140:143], a[180:183], v[52:55]
    buffer_load_dwordx4 a[100:103], v240, s[20:23], s40 offen offset:1024 sc1
    v_mfma_f32_16x16x32_bf16 v[20:23], v[140:143], a[176:179], v[20:23]
    ds_read_b64_tr_b16 v[174:175], v197 offset:4608
    v_mfma_f32_16x16x32_bf16 v[20:23], v[136:139], a[160:163], v[20:23]
    s_waitcnt lgkmcnt(8)
    v_mfma_f32_16x16x32_bf16 v[24:27], v[144:147], a[160:163], v[24:27]
    ds_read_b64_tr_b16 v[176:177], v198 offset:0
    v_mfma_f32_16x16x32_bf16 v[24:27], v[148:151], a[176:179], v[24:27]
    v_mfma_f32_16x16x32_bf16 v[56:59], v[148:151], a[180:183], v[56:59]
    ds_read_b64_tr_b16 v[178:179], v198 offset:512
    v_mfma_f32_16x16x32_bf16 v[56:59], v[144:147], a[164:167], v[56:59]
    buffer_load_dwordx4 a[104:107], v240, s[20:23], s40 offen offset:2048 sc1
    v_mfma_f32_16x16x32_bf16 v[88:91], v[144:147], a[168:171], v[88:91]
    ds_read_b64_tr_b16 v[180:181], v198 offset:4096
    v_mfma_f32_16x16x32_bf16 v[88:91], v[148:151], a[184:187], v[88:91]
    v_mfma_f32_16x16x32_bf16 v[120:123], v[148:151], a[188:191], v[120:123]
    ds_read_b64_tr_b16 v[182:183], v198 offset:4608
    v_mfma_f32_16x16x32_bf16 v[120:123], v[144:147], a[172:175], v[120:123]
    v_mfma_f32_16x16x32_bf16 v[124:127], v[152:155], a[172:175], v[124:127]
    ds_read_b64_tr_b16 v[184:185], v199 offset:0
    v_mfma_f32_16x16x32_bf16 v[124:127], v[156:159], a[188:191], v[124:127]
    buffer_load_dwordx4 a[108:111], v240, s[20:23], s40 offen offset:3072 sc1
    v_mfma_f32_16x16x32_bf16 v[92:95], v[156:159], a[184:187], v[92:95]
    ds_read_b64_tr_b16 v[186:187], v199 offset:512
    s_add_u32 s40, s40, 4096
    v_mfma_f32_16x16x32_bf16 v[92:95], v[152:155], a[168:171], v[92:95]
    v_mfma_f32_16x16x32_bf16 v[60:63], v[152:155], a[164:167], v[60:63]
    ds_read_b64_tr_b16 v[188:189], v199 offset:4096
    v_mfma_f32_16x16x32_bf16 v[60:63], v[156:159], a[180:183], v[60:63]
    v_mfma_f32_16x16x32_bf16 v[28:31], v[156:159], a[176:179], v[28:31]
    ds_read_b64_tr_b16 v[190:191], v199 offset:4608
    v_mfma_f32_16x16x32_bf16 v[28:31], v[152:155], a[160:163], v[28:31]
    s_waitcnt vmcnt(19)
    s_barrier
    s_waitcnt lgkmcnt(8)
    v_mfma_f32_16x16x32_bf16 a[192:195], v[160:163], a[160:163], a[192:195]
    ds_read_b64_tr_b16 v[128:129], v192 offset:16384
    v_mfma_f32_16x16x32_bf16 a[192:195], v[164:167], a[176:179], a[192:195]
    buffer_load_dwordx4 a[112:115], v240, s[20:23], s40 offen offset:0 sc1
    v_mfma_f32_16x16x32_bf16 a[200:203], v[164:167], a[180:183], a[200:203]
    ds_read_b64_tr_b16 v[130:131], v192 offset:17408
    v_mfma_f32_16x16x32_bf16 a[200:203], v[160:163], a[164:167], a[200:203]
    v_mfma_f32_16x16x32_bf16 a[208:211], v[160:163], a[168:171], a[208:211]
    ds_read_b64_tr_b16 v[132:133], v192 offset:24576
    v_mfma_f32_16x16x32_bf16 a[208:211], v[164:167], a[184:187], a[208:211]
    v_mfma_f32_16x16x32_bf16 a[216:219], v[164:167], a[188:191], a[216:219]
    ds_read_b64_tr_b16 v[134:135], v192 offset:25600
    v_mfma_f32_16x16x32_bf16 a[216:219], v[160:163], a[172:175], a[216:219]
    buffer_load_dwordx4 a[116:119], v240, s[20:23], s40 offen offset:1024 sc1
    v_mfma_f32_16x16x32_bf16 a[220:223], v[168:171], a[172:175], a[220:223]
    ds_read_b64_tr_b16 v[136:137], v192 offset:16392
    v_mfma_f32_16x16x32_bf16 a[220:223], v[172:175], a[188:191], a[220:223]
    v_mfma_f32_16x16x32_bf16 a[212:215], v[172:175], a[184:187], a[212:215]
    ds_read_b64_tr_b16 v[138:139], v192 offset:17416
    v_mfma_f32_16x16x32_bf16 a[212:215], v[168:171], a[168:171], a[212:215]
    v_mfma_f32_16x16x32_bf16 a[204:207], v[168:171], a[164:167], a[204:207]
    ds_read_b64_tr_b16 v[140:141], v192 offset:24584
    v_mfma_f32_16x16x32_bf16 a[204:207], v[172:175], a[180:183], a[204:207]
    buffer_load_dwordx4 a[120:123], v240, s[20:23], s40 offen offset:2048 sc1
    v_mfma_f32_16x16x32_bf16 a[196:199], v[172:175], a[176:179], a[196:199]
    ds_read_b64_tr_b16 v[142:143], v192 offset:25608
    v_mfma_f32_16x16x32_bf16 a[196:199], v[168:171], a[160:163], a[196:199]
    s_waitcnt lgkmcnt(8)
    v_mfma_f32_16x16x32_bf16 a[224:227], v[176:179], a[160:163], a[224:227]
    ds_read_b64_tr_b16 v[144:145], v193 offset:16384
    v_mfma_f32_16x16x32_bf16 a[224:227], v[180:183], a[176:179], a[224:227]
    v_mfma_f32_16x16x32_bf16 a[232:235], v[180:183], a[180:183], a[232:235]
    ds_read_b64_tr_b16 v[146:147], v193 offset:17408
    v_mfma_f32_16x16x32_bf16 a[232:235], v[176:179], a[164:167], a[232:235]
    buffer_load_dwordx4 a[124:127], v240, s[20:23], s40 offen offset:3072 sc1
    v_mfma_f32_16x16x32_bf16 a[240:243], v[176:179], a[168:171], a[240:243]
    ds_read_b64_tr_b16 v[148:149], v193 offset:24576
    s_add_u32 s40, s40, 4096
    v_mfma_f32_16x16x32_bf16 a[240:243], v[180:183], a[184:187], a[240:243]
    v_mfma_f32_16x16x32_bf16 a[248:251], v[180:183], a[188:191], a[248:251]
    ds_read_b64_tr_b16 v[150:151], v193 offset:25600
    v_mfma_f32_16x16x32_bf16 a[248:251], v[176:179], a[172:175], a[248:251]
    v_mfma_f32_16x16x32_bf16 a[252:255], v[184:187], a[172:175], a[252:255]
    ds_read_b64_tr_b16 v[152:153], v193 offset:16392
    v_mfma_f32_16x16x32_bf16 a[252:255], v[188:191], a[188:191], a[252:255]
    v_mfma_f32_16x16x32_bf16 a[244:247], v[188:191], a[184:187], a[244:247]
    ds_read_b64_tr_b16 v[154:155], v193 offset:17416
    v_mfma_f32_16x16x32_bf16 a[244:247], v[184:187], a[168:171], a[244:247]
    v_mfma_f32_16x16x32_bf16 a[236:239], v[184:187], a[164:167], a[236:239]
    ds_read_b64_tr_b16 v[156:157], v193 offset:24584
    v_mfma_f32_16x16x32_bf16 a[236:239], v[188:191], a[180:183], a[236:239]
    v_mfma_f32_16x16x32_bf16 a[228:231], v[188:191], a[176:179], a[228:231]
    ds_read_b64_tr_b16 v[158:159], v193 offset:25608
    v_mfma_f32_16x16x32_bf16 a[228:231], v[184:187], a[160:163], a[228:231]
K1_s8:
    s_waitcnt vmcnt(15) lgkmcnt(8)
    v_mfma_f32_16x16x32_bf16 v[0:3], v[128:131], a[64:67], v[0:3]
    ds_read_b64_tr_b16 v[160:161], v194 offset:16384
    s_add_u32 m0, s46, 49152
    v_mfma_f32_16x16x32_bf16 v[0:3], v[132:135], a[80:83], v[0:3]
    buffer_load_dwordx4 v236, s[32:35], s43 offen offset:0 lds
    s_lshr_b32 s40, s14, 1
    v_mfma_f32_16x16x32_bf16 v[32:35], v[132:135], a[84:87], v[32:35]
    ds_read_b64_tr_b16 v[162:163], v194 offset:17408
    s_and_b32 s45, s14, 1
    v_mfma_f32_16x16x32_bf16 v[32:35], v[128:131], a[68:71], v[32:35]
    s_lshl_b32 s45, s45, 3
    s_and_b32 s50, s15, 7
    s_add_u32 s45, s45, s50
    v_mfma_f32_16x16x32_bf16 v[64:67], v[128:131], a[72:75], v[64:67]
    ds_read_b64_tr_b16 v[164:165], v194 offset:24576
    s_lshl_b32 s45, s45, 1
    v_mfma_f32_16x16x32_bf16 v[64:67], v[132:135], a[88:91], v[64:67]
    s_lshr_b32 s18, s3, 1
    s_add_u32 s45, s45, s18
    s_lshr_b32 s44, s15, 3
    v_mfma_f32_16x16x32_bf16 v[96:99], v[132:135], a[92:95], v[96:99]
    ds_read_b64_tr_b16 v[166:167], v194 offset:25600
    s_mul_i32 s50, s45, 745472
    v_mfma_f32_16x16x32_bf16 v[96:99], v[128:131], a[76:79], v[96:99]
    buffer_load_dwordx4 v237, s[32:35], s43 offen offset:1024 lds
    s_add_u32 s50, s50, 11534336
    v_mfma_f32_16x16x32_bf16 v[100:103], v[136:139], a[76:79], v[100:103]
    ds_read_b64_tr_b16 v[168:169], v194 offset:16392
    s_add_u32 s20, s12, s50
    s_addc_u32 s21, s13, 0
    v_mfma_f32_16x16x32_bf16 v[100:103], v[140:143], a[92:95], v[100:103]
    s_mov_b32 s22, 745472
    s_mov_b32 s23, 0x20000
    s_lshl_b32 s50, s44, 1
    v_mfma_f32_16x16x32_bf16 v[68:71], v[140:143], a[88:91], v[68:71]
    ds_read_b64_tr_b16 v[170:171], v194 offset:17416
    s_and_b32 s51, s3, 1
    v_mfma_f32_16x16x32_bf16 v[68:71], v[136:139], a[72:75], v[68:71]
    s_add_u32 s50, s50, s51
    s_mul_i32 s50, s50, 182
    s_add_u32 s50, s50, s18
    v_mfma_f32_16x16x32_bf16 v[36:39], v[136:139], a[68:71], v[36:39]
    ds_read_b64_tr_b16 v[172:173], v194 offset:24584
    s_mul_i32 s50, s50, 5120
    v_mfma_f32_16x16x32_bf16 v[36:39], v[140:143], a[84:87], v[36:39]
    buffer_load_dwordx4 v238, s[32:35], s43 offen offset:2048 lds
    s_add_u32 s50, s50, 3145728
    v_mfma_f32_16x16x32_bf16 v[4:7], v[140:143], a[80:83], v[4:7]
    ds_read_b64_tr_b16 v[174:175], v194 offset:25608
    s_sub_u32 s51, 182, s18
    v_mfma_f32_16x16x32_bf16 v[4:7], v[136:139], a[64:67], v[4:7]
    s_mul_i32 s51, s51, 5120
    s_add_u32 s24, s12, s50
    s_addc_u32 s25, s13, 0
    s_waitcnt lgkmcnt(8)
    v_mfma_f32_16x16x32_bf16 v[8:11], v[144:147], a[64:67], v[8:11]
    ds_read_b64_tr_b16 v[176:177], v195 offset:16384
    s_mov_b32 s26, s51
    v_mfma_f32_16x16x32_bf16 v[8:11], v[148:151], a[80:83], v[8:11]
K1_pg3:
    s_cbranch_execz K1_pg7
    s_mov_b32 s27, 0x20000
    s_lshl_b32 s18, s18, 4
    s_or_b32 s18, s18, 0x100000
    v_mfma_f32_16x16x32_bf16 v[40:43], v[148:151], a[84:87], v[40:43]
    ds_read_b64_tr_b16 v[178:179], v195 offset:17408
    s_mov_b32 s28, s80
    v_mfma_f32_16x16x32_bf16 v[40:43], v[144:147], a[68:71], v[40:43]
    buffer_load_dwordx4 v239, s[32:35], s43 offen offset:3072 lds
    s_add_u32 s43, s43, 4096
    v_mfma_f32_16x16x32_bf16 v[72:75], v[144:147], a[72:75], v[72:75]
    ds_read_b64_tr_b16 v[180:181], v195 offset:24576
    s_add_u32 m0, s46, 53248
    v_mfma_f32_16x16x32_bf16 v[72:75], v[148:151], a[88:91], v[72:75]
    s_mov_b32 s29, s81
    s_mov_b32 s30, 2621440
    s_mov_b32 s31, 0x20000
    v_mfma_f32_16x16x32_bf16 v[104:107], v[148:151], a[92:95], v[104:107]
    ds_read_b64_tr_b16 v[182:183], v195 offset:25600
    s_add_u32 s4, s12, 46137344
    s_addc_u32 s5, s13, 0
    v_mfma_f32_16x16x32_bf16 v[104:107], v[144:147], a[76:79], v[104:107]
    s_mov_b32 s6, 8388608
    s_mov_b32 s7, 0x20000
    s_lshl_b32 s81, s2, 2
    v_mfma_f32_16x16x32_bf16 v[108:111], v[152:155], a[76:79], v[108:111]
    ds_read_b64_tr_b16 v[184:185], v195 offset:16392
    s_add_u32 s81, s81, s3
    v_mfma_f32_16x16x32_bf16 v[108:111], v[156:159], a[92:95], v[108:111]
    buffer_load_dwordx4 v236, s[32:35], s43 offen offset:0 lds
    v_mfma_f32_16x16x32_bf16 v[76:79], v[156:159], a[88:91], v[76:79]
    ds_read_b64_tr_b16 v[186:187], v195 offset:17416
    s_lshl_b32 s81, s81, 13
    v_mfma_f32_16x16x32_bf16 v[76:79], v[152:155], a[72:75], v[76:79]
    s_lshl_b32 s56, s16, 13
    s_add_u32 s56, s56, 524288
    s_mov_b32 s57, 0xc13504f3
    v_mfma_f32_16x16x32_bf16 v[44:47], v[152:155], a[68:71], v[44:47]
    ds_read_b64_tr_b16 v[188:189], v195 offset:24584
    v_accvgpr_write_b32 a144, v206
    v_mfma_f32_16x16x32_bf16 v[44:47], v[156:159], a[84:87], v[44:47]
    v_accvgpr_write_b32 a145, v206
    v_accvgpr_write_b32 a146, v206
    v_mfma_f32_16x16x32_bf16 v[12:15], v[156:159], a[80:83], v[12:15]
    ds_read_b64_tr_b16 v[190:191], v195 offset:25608
    v_accvgpr_write_b32 a147, v206
    v_mfma_f32_16x16x32_bf16 v[12:15], v[152:155], a[64:67], v[12:15]
    v_accvgpr_write_b32 a128, 0
    v_accvgpr_write_b32 a129, 0
    s_waitcnt lgkmcnt(8)
    v_mfma_f32_16x16x32_bf16 v[16:19], v[160:163], a[64:67], v[16:19]
    ds_read_b64_tr_b16 v[128:129], v196 offset:16384
    v_accvgpr_write_b32 a132, 0
    v_mfma_f32_16x16x32_bf16 v[16:19], v[164:167], a[80:83], v[16:19]
    buffer_load_dwordx4 v237, s[32:35], s43 offen offset:1024 lds
    v_mfma_f32_16x16x32_bf16 v[48:51], v[164:167], a[84:87], v[48:51]
    ds_read_b64_tr_b16 v[130:131], v196 offset:16896
    v_accvgpr_write_b32 a133, 0
    v_mfma_f32_16x16x32_bf16 v[48:51], v[160:163], a[68:71], v[48:51]
    v_accvgpr_write_b32 a136, 0
    v_accvgpr_write_b32 a137, 0
    v_mfma_f32_16x16x32_bf16 v[80:83], v[160:163], a[72:75], v[80:83]
    ds_read_b64_tr_b16 v[132:133], v196 offset:20480
    v_accvgpr_write_b32 a140, 0
    v_mfma_f32_16x16x32_bf16 v[80:83], v[164:167], a[88:91], v[80:83]
    v_accvgpr_write_b32 a141, 0
    v_accvgpr_write_b32 a148, -1
    v_mfma_f32_16x16x32_bf16 v[112:115], v[164:167], a[92:95], v[112:115]
    ds_read_b64_tr_b16 v[134:135], v196 offset:20992
    v_accvgpr_write_b32 a149, -1
    v_mfma_f32_16x16x32_bf16 v[112:115], v[160:163], a[76:79], v[112:115]
    buffer_load_dwordx4 v238, s[32:35], s43 offen offset:2048 lds
    v_mfma_f32_16x16x32_bf16 v[116:119], v[168:171], a[76:79], v[116:119]
    ds_read_b64_tr_b16 v[136:137], v197 offset:16384
    v_accvgpr_write_b32 a150, -1
    v_mfma_f32_16x16x32_bf16 v[116:119], v[172:175], a[92:95], v[116:119]
    v_accvgpr_write_b32 a151, -1
    v_accvgpr_write_b32 a184, 0
    v_mfma_f32_16x16x32_bf16 v[84:87], v[172:175], a[88:91], v[84:87]
    ds_read_b64_tr_b16 v[138:139], v197 offset:16896
    v_accvgpr_write_b32 a185, 0
    v_mfma_f32_16x16x32_bf16 v[84:87], v[168:171], a[72:75], v[84:87]
    v_accvgpr_write_b32 a186, 0
    v_accvgpr_write_b32 a187, 0
    v_mfma_f32_16x16x32_bf16 v[52:55], v[168:171], a[68:71], v[52:55]
    ds_read_b64_tr_b16 v[140:141], v197 offset:20480
    v_mfma_f32_16x16x32_bf16 v[52:55], v[172:175], a[84:87], v[52:55]
    buffer_load_dwordx4 v239, s[32:35], s43 offen offset:3072 lds
    v_mfma_f32_16x16x32_bf16 v[20:23], v[172:175], a[80:83], v[20:23]
    ds_read_b64_tr_b16 v[142:143], v197 offset:20992
    s_add_u32 s43, s43, s49
    v_mfma_f32_16x16x32_bf16 v[20:23], v[168:171], a[64:67], v[20:23]
    s_waitcnt lgkmcnt(8)
    v_mfma_f32_16x16x32_bf16 v[24:27], v[176:179], a[64:67], v[24:27]
    ds_read_b64_tr_b16 v[144:145], v198 offset:16384
    v_mfma_f32_16x16x32_bf16 v[24:27], v[180:183], a[80:83], v[24:27]
    v_mfma_f32_16x16x32_bf16 v[56:59], v[180:183], a[84:87], v[56:59]
    ds_read_b64_tr_b16 v[146:147], v198 offset:16896
    v_mfma_f32_16x16x32_bf16 v[56:59], v[176:179], a[68:71], v[56:59]
    v_mfma_f32_16x16x32_bf16 v[88:91], v[176:179], a[72:75], v[88:91]
    ds_read_b64_tr_b16 v[148:149], v198 offset:20480
    v_mfma_f32_16x16x32_bf16 v[88:91], v[180:183], a[88:91], v[88:91]
    v_mfma_f32_16x16x32_bf16 v[120:123], v[180:183], a[92:95], v[120:123]
    ds_read_b64_tr_b16 v[150:151], v198 offset:20992
    v_mfma_f32_16x16x32_bf16 v[120:123], v[176:179], a[76:79], v[120:123]
    v_mfma_f32_16x16x32_bf16 v[124:127], v[184:187], a[76:79], v[124:127]
    ds_read_b64_tr_b16 v[152:153], v199 offset:16384
    v_mfma_f32_16x16x32_bf16 v[124:127], v[188:191], a[92:95], v[124:127]
    v_mfma_f32_16x16x32_bf16 v[92:95], v[188:191], a[88:91], v[92:95]
    ds_read_b64_tr_b16 v[154:155], v199 offset:16896
    v_mfma_f32_16x16x32_bf16 v[92:95], v[184:187], a[72:75], v[92:95]
    v_mfma_f32_16x16x32_bf16 v[60:63], v[184:187], a[68:71], v[60:63]
    ds_read_b64_tr_b16 v[156:157], v199 offset:20480
    v_mfma_f32_16x16x32_bf16 v[60:63], v[188:191], a[84:87], v[60:63]
    v_mfma_f32_16x16x32_bf16 v[28:31], v[188:191], a[80:83], v[28:31]
    ds_read_b64_tr_b16 v[158:159], v199 offset:20992
    v_mfma_f32_16x16x32_bf16 v[28:31], v[184:187], a[64:67], v[28:31]
    s_waitcnt vmcnt(16)
    s_barrier
    s_waitcnt lgkmcnt(8)
    v_mfma_f32_16x16x32_bf16 a[192:195], v[128:131], a[64:67], a[192:195]
    ds_read_b64_tr_b16 v[160:161], v192 offset:32768
    v_mfma_f32_16x16x32_bf16 a[192:195], v[132:135], a[80:83], a[192:195]
    v_mfma_f32_16x16x32_bf16 a[200:203], v[132:135], a[84:87], a[200:203]
    ds_read_b64_tr_b16 v[162:163], v192 offset:33792
    v_mfma_f32_16x16x32_bf16 a[200:203], v[128:131], a[68:71], a[200:203]
    v_mfma_f32_16x16x32_bf16 a[208:211], v[128:131], a[72:75], a[208:211]
    ds_read_b64_tr_b16 v[164:165], v192 offset:40960
    v_mfma_f32_16x16x32_bf16 a[208:211], v[132:135], a[88:91], a[208:211]
    v_mfma_f32_16x16x32_bf16 a[216:219], v[132:135], a[92:95], a[216:219]
    ds_read_b64_tr_b16 v[166:167], v192 offset:41984
    v_mfma_f32_16x16x32_bf16 a[216:219], v[128:131], a[76:79], a[216:219]
    v_mfma_f32_16x16x32_bf16 a[220:223], v[136:139], a[76:79], a[220:223]
    ds_read_b64_tr_b16 v[168:169], v192 offset:32776
    v_mfma_f32_16x16x32_bf16 a[220:223], v[140:143], a[92:95], a[220:223]
    v_mfma_f32_16x16x32_bf16 a[212:215], v[140:143], a[88:91], a[212:215]
    ds_read_b64_tr_b16 v[170:171], v192 offset:33800
    v_mfma_f32_16x16x32_bf16 a[212:215], v[136:139], a[72:75], a[212:215]
    v_mfma_f32_16x16x32_bf16 a[204:207], v[136:139], a[68:71], a[204:207]
    ds_read_b64_tr_b16 v[172:173], v192 offset:40968
    v_mfma_f32_16x16x32_bf16 a[204:207], v[140:143], a[84:87], a[204:207]
    v_mfma_f32_16x16x32_bf16 a[196:199], v[140:143], a[80:83], a[196:199]
    ds_read_b64_tr_b16 v[174:175], v192 offset:41992
    v_mfma_f32_16x16x32_bf16 a[196:199], v[136:139], a[64:67], a[196:199]
    s_waitcnt lgkmcnt(8)
    v_mfma_f32_16x16x32_bf16 a[224:227], v[144:147], a[64:67], a[224:227]
    ds_read_b64_tr_b16 v[176:177], v193 offset:32768
    v_mfma_f32_16x16x32_bf16 a[224:227], v[148:151], a[80:83], a[224:227]
    v_mfma_f32_16x16x32_bf16 a[232:235], v[148:151], a[84:87], a[232:235]
    ds_read_b64_tr_b16 v[178:179], v193 offset:33792
    v_mfma_f32_16x16x32_bf16 a[232:235], v[144:147], a[68:71], a[232:235]
    v_mfma_f32_16x16x32_bf16 a[240:243], v[144:147], a[72:75], a[240:243]
    ds_read_b64_tr_b16 v[180:181], v193 offset:40960
    v_mfma_f32_16x16x32_bf16 a[240:243], v[148:151], a[88:91], a[240:243]
    v_mfma_f32_16x16x32_bf16 a[248:251], v[148:151], a[92:95], a[248:251]
    ds_read_b64_tr_b16 v[182:183], v193 offset:41984
    v_mfma_f32_16x16x32_bf16 a[248:251], v[144:147], a[76:79], a[248:251]
    v_mfma_f32_16x16x32_bf16 a[252:255], v[152:155], a[76:79], a[252:255]
    ds_read_b64_tr_b16 v[184:185], v193 offset:32776
    v_mfma_f32_16x16x32_bf16 a[252:255], v[156:159], a[92:95], a[252:255]
    v_mfma_f32_16x16x32_bf16 a[244:247], v[156:159], a[88:91], a[244:247]
    ds_read_b64_tr_b16 v[186:187], v193 offset:33800
    v_mfma_f32_16x16x32_bf16 a[244:247], v[152:155], a[72:75], a[244:247]
    v_mfma_f32_16x16x32_bf16 a[236:239], v[152:155], a[68:71], a[236:239]
    ds_read_b64_tr_b16 v[188:189], v193 offset:40968
    v_mfma_f32_16x16x32_bf16 a[236:239], v[156:159], a[84:87], a[236:239]
    v_mfma_f32_16x16x32_bf16 a[228:231], v[156:159], a[80:83], a[228:231]
    ds_read_b64_tr_b16 v[190:191], v193 offset:41992
    v_mfma_f32_16x16x32_bf16 a[228:231], v[152:155], a[64:67], a[228:231]
    s_waitcnt vmcnt(8) lgkmcnt(8)
    v_mfma_f32_16x16x32_bf16 v[0:3], v[160:163], a[96:99], v[0:3]
    ds_read_b64_tr_b16 v[128:129], v194 offset:32768
    s_add_u32 m0, s46, 0
    v_mfma_f32_16x16x32_bf16 v[0:3], v[164:167], a[112:115], v[0:3]
    buffer_load_dwordx4 v236, s[32:35], s43 offen offset:0 lds
    v_mfma_f32_16x16x32_bf16 v[32:35], v[164:167], a[116:119], v[32:35]
    ds_read_b64_tr_b16 v[130:131], v194 offset:33792
    v_mfma_f32_16x16x32_bf16 v[32:35], v[160:163], a[100:103], v[32:35]
    v_mfma_f32_16x16x32_bf16 v[64:67], v[160:163], a[104:107], v[64:67]
    ds_read_b64_tr_b16 v[132:133], v194 offset:40960
    v_mfma_f32_16x16x32_bf16 v[64:67], v[164:167], a[120:123], v[64:67]
    buffer_load_dwordx4 v237, s[32:35], s43 offen offset:1024 lds
    v_mfma_f32_16x16x32_bf16 v[96:99], v[164:167], a[124:127], v[96:99]
    ds_read_b64_tr_b16 v[134:135], v194 offset:41984
    v_mfma_f32_16x16x32_bf16 v[96:99], v[160:163], a[108:111], v[96:99]
    v_mfma_f32_16x16x32_bf16 v[4:7], v[168:171], a[96:99], v[4:7]
    ds_read_b64_tr_b16 v[136:137], v194 offset:32776
    v_mfma_f32_16x16x32_bf16 v[4:7], v[172:175], a[112:115], v[4:7]
    buffer_load_dwordx4 v238, s[32:35], s43 offen offset:2048 lds
    v_mfma_f32_16x16x32_bf16 v[36:39], v[172:175], a[116:119], v[36:39]
    ds_read_b64_tr_b16 v[138:139], v194 offset:33800
    v_mfma_f32_16x16x32_bf16 v[36:39], v[168:171], a[100:103], v[36:39]
    v_mfma_f32_16x16x32_bf16 v[68:71], v[168:171], a[104:107], v[68:71]
    ds_read_b64_tr_b16 v[140:141], v194 offset:40968
    v_mfma_f32_16x16x32_bf16 v[68:71], v[172:175], a[120:123], v[68:71]
    buffer_load_dwordx4 v239, s[32:35], s43 offen offset:3072 lds
    v_mfma_f32_16x16x32_bf16 v[100:103], v[172:175], a[124:127], v[100:103]
    ds_read_b64_tr_b16 v[142:143], v194 offset:41992
    s_add_u32 s43, s43, 4096
    v_mfma_f32_16x16x32_bf16 v[100:103], v[168:171], a[108:111], v[100:103]
    s_add_u32 m0, s46, 4096
    s_waitcnt lgkmcnt(8)
    v_mfma_f32_16x16x32_bf16 v[8:11], v[176:179], a[96:99], v[8:11]
    ds_read_b64_tr_b16 v[144:145], v195 offset:32768
    v_cvt_pk_bf16_f32 v0, v0, v1
    v_mfma_f32_16x16x32_bf16 v[8:11], v[180:183], a[112:115], v[8:11]
    buffer_load_dwordx4 v236, s[32:35], s43 offen offset:0 lds
    v_mfma_f32_16x16x32_bf16 v[40:43], v[180:183], a[116:119], v[40:43]
    ds_read_b64_tr_b16 v[146:147], v195 offset:33792
    v_cvt_pk_bf16_f32 v1, v2, v3
    v_mfma_f32_16x16x32_bf16 v[40:43], v[176:179], a[100:103], v[40:43]
    v_cvt_pk_bf16_f32 v2, v4, v5
    v_cvt_pk_bf16_f32 v3, v6, v7
    v_mfma_f32_16x16x32_bf16 v[72:75], v[176:179], a[104:107], v[72:75]
    ds_read_b64_tr_b16 v[148:149], v195 offset:40960
    v_cvt_pk_bf16_f32 v32, v32, v33
    v_mfma_f32_16x16x32_bf16 v[72:75], v[180:183], a[120:123], v[72:75]
    buffer_load_dwordx4 v237, s[32:35], s43 offen offset:1024 lds
    v_mfma_f32_16x16x32_bf16 v[104:107], v[180:183], a[124:127], v[104:107]
    ds_read_b64_tr_b16 v[150:151], v195 offset:41984
    v_cvt_pk_bf16_f32 v33, v34, v35
    v_mfma_f32_16x16x32_bf16 v[104:107], v[176:179], a[108:111], v[104:107]
    v_cvt_pk_bf16_f32 v34, v36, v37
    v_cvt_pk_bf16_f32 v35, v38, v39
    v_mfma_f32_16x16x32_bf16 v[12:15], v[184:187], a[96:99], v[12:15]
    ds_read_b64_tr_b16 v[152:153], v195 offset:32776
    v_cvt_pk_bf16_f32 v64, v64, v65
    v_mfma_f32_16x16x32_bf16 v[12:15], v[188:191], a[112:115], v[12:15]
    buffer_load_dwordx4 v238, s[32:35], s43 offen offset:2048 lds
    v_mfma_f32_16x16x32_bf16 v[44:47], v[188:191], a[116:119], v[44:47]
    ds_read_b64_tr_b16 v[154:155], v195 offset:33800
    v_cvt_pk_bf16_f32 v65, v66, v67
    v_mfma_f32_16x16x32_bf16 v[44:47], v[184:187], a[100:103], v[44:47]
    v_cvt_pk_bf16_f32 v66, v68, v69
    v_cvt_pk_bf16_f32 v67, v70, v71
    v_mfma_f32_16x16x32_bf16 v[76:79], v[184:187], a[104:107], v[76:79]
    ds_read_b64_tr_b16 v[156:157], v195 offset:40968
    v_cvt_pk_bf16_f32 v96, v96, v97
    v_mfma_f32_16x16x32_bf16 v[76:79], v[188:191], a[120:123], v[76:79]
    buffer_load_dwordx4 v239, s[32:35], s43 offen offset:3072 lds
    v_mfma_f32_16x16x32_bf16 v[108:111], v[188:191], a[124:127], v[108:111]
    ds_read_b64_tr_b16 v[158:159], v195 offset:41992
    s_add_u32 s43, s43, 12288
    v_mfma_f32_16x16x32_bf16 v[108:111], v[184:187], a[108:111], v[108:111]
    v_cvt_pk_bf16_f32 v97, v98, v99
    v_cvt_pk_bf16_f32 v98, v100, v101
    s_waitcnt lgkmcnt(8)
    v_mfma_f32_16x16x32_bf16 v[16:19], v[128:131], a[96:99], v[16:19]
    ds_read_b64_tr_b16 v[160:161], v196 offset:32768
    v_cvt_pk_bf16_f32 v99, v102, v103
    v_mfma_f32_16x16x32_bf16 v[16:19], v[132:135], a[112:115], v[16:19]
    v_cvt_pk_bf16_f32 v8, v8, v9
    v_cvt_pk_bf16_f32 v9, v10, v11
    v_mfma_f32_16x16x32_bf16 v[48:51], v[132:135], a[116:119], v[48:51]
    ds_read_b64_tr_b16 v[162:163], v196 offset:33280
    v_cvt_pk_bf16_f32 v10, v12, v13
    v_mfma_f32_16x16x32_bf16 v[48:51], v[128:131], a[100:103], v[48:51]
    v_cvt_pk_bf16_f32 v11, v14, v15
    v_cvt_pk_bf16_f32 v40, v40, v41
    v_mfma_f32_16x16x32_bf16 v[80:83], v[128:131], a[104:107], v[80:83]
    ds_read_b64_tr_b16 v[164:165], v196 offset:36864
    v_cvt_pk_bf16_f32 v41, v42, v43
    v_mfma_f32_16x16x32_bf16 v[80:83], v[132:135], a[120:123], v[80:83]
    v_cvt_pk_bf16_f32 v42, v44, v45
    v_cvt_pk_bf16_f32 v43, v46, v47
    v_mfma_f32_16x16x32_bf16 v[112:115], v[132:135], a[124:127], v[112:115]
    ds_read_b64_tr_b16 v[166:167], v196 offset:37376
    v_cvt_pk_bf16_f32 v72, v72, v73
    v_mfma_f32_16x16x32_bf16 v[112:115], v[128:131], a[108:111], v[112:115]
    v_cvt_pk_bf16_f32 v73, v74, v75
    v_cvt_pk_bf16_f32 v74, v76, v77
    v_mfma_f32_16x16x32_bf16 v[20:23], v[136:139], a[96:99], v[20:23]
    ds_read_b64_tr_b16 v[168:169], v197 offset:32768
    v_cvt_pk_bf16_f32 v75, v78, v79
    v_mfma_f32_16x16x32_bf16 v[20:23], v[140:143], a[112:115], v[20:23]
    v_cvt_pk_bf16_f32 v104, v104, v105
    v_cvt_pk_bf16_f32 v105, v106, v107
    v_mfma_f32_16x16x32_bf16 v[52:55], v[140:143], a[116:119], v[52:55]
    ds_read_b64_tr_b16 v[170:171], v197 offset:33280
    v_cvt_pk_bf16_f32 v106, v108, v109
    v_mfma_f32_16x16x32_bf16 v[52:55], v[136:139], a[100:103], v[52:55]
    v_cvt_pk_bf16_f32 v107, v110, v111
    v_mfma_f32_16x16x32_bf16 v[84:87], v[136:139], a[104:107], v[84:87]
    ds_read_b64_tr_b16 v[172:173], v197 offset:36864
    v_mfma_f32_16x16x32_bf16 v[84:87], v[140:143], a[120:123], v[84:87]
    v_mfma_f32_16x16x32_bf16 v[116:119], v[140:143], a[124:127], v[116:119]
    ds_read_b64_tr_b16 v[174:175], v197 offset:37376
    v_mfma_f32_16x16x32_bf16 v[116:119], v[136:139], a[108:111], v[116:119]
    s_waitcnt vmcnt(8)
    s_barrier
    s_waitcnt lgkmcnt(8)
    v_mfma_f32_16x16x32_bf16 v[24:27], v[144:147], a[96:99], v[24:27]
    ds_read_b64_tr_b16 v[176:177], v198 offset:32768
    s_add_u32 m0, s46, 16384
    v_mfma_f32_16x16x32_bf16 v[24:27], v[148:151], a[112:115], v[24:27]
    buffer_load_dwordx4 v236, s[32:35], s43 offen offset:0 lds
    v_mfma_f32_16x16x32_bf16 v[56:59], v[148:151], a[116:119], v[56:59]
    ds_read_b64_tr_b16 v[178:179], v198 offset:33280
    v_cvt_pk_bf16_f32 v16, v16, v17
    v_mfma_f32_16x16x32_bf16 v[56:59], v[144:147], a[100:103], v[56:59]
    v_cvt_pk_bf16_f32 v17, v18, v19
    v_cvt_pk_bf16_f32 v18, v20, v21
    v_mfma_f32_16x16x32_bf16 v[88:91], v[144:147], a[104:107], v[88:91]
    ds_read_b64_tr_b16 v[180:181], v198 offset:36864
    v_cvt_pk_bf16_f32 v19, v22, v23
    v_mfma_f32_16x16x32_bf16 v[88:91], v[148:151], a[120:123], v[88:91]
    buffer_load_dwordx4 v237, s[32:35], s43 offen offset:1024 lds
    v_mfma_f32_16x16x32_bf16 v[120:123], v[148:151], a[124:127], v[120:123]
    ds_read_b64_tr_b16 v[182:183], v198 offset:37376
    v_cvt_pk_bf16_f32 v48, v48, v49
    v_mfma_f32_16x16x32_bf16 v[120:123], v[144:147], a[108:111], v[120:123]
    v_cvt_pk_bf16_f32 v49, v50, v51
    v_cvt_pk_bf16_f32 v50, v52, v53
    v_mfma_f32_16x16x32_bf16 v[28:31], v[152:155], a[96:99], v[28:31]
    ds_read_b64_tr_b16 v[184:185], v199 offset:32768
    v_cvt_pk_bf16_f32 v51, v54, v55
    v_mfma_f32_16x16x32_bf16 v[28:31], v[156:159], a[112:115], v[28:31]
    buffer_load_dwordx4 v238, s[32:35], s43 offen offset:2048 lds
    v_mfma_f32_16x16x32_bf16 v[60:63], v[156:159], a[116:119], v[60:63]
    ds_read_b64_tr_b16 v[186:187], v199 offset:33280
    v_cvt_pk_bf16_f32 v80, v80, v81
    v_mfma_f32_16x16x32_bf16 v[60:63], v[152:155], a[100:103], v[60:63]
    v_cvt_pk_bf16_f32 v81, v82, v83
    v_cvt_pk_bf16_f32 v82, v84, v85
    v_mfma_f32_16x16x32_bf16 v[92:95], v[152:155], a[104:107], v[92:95]
    ds_read_b64_tr_b16 v[188:189], v199 offset:36864
    v_cvt_pk_bf16_f32 v83, v86, v87
    v_mfma_f32_16x16x32_bf16 v[92:95], v[156:159], a[120:123], v[92:95]
    buffer_load_dwordx4 v239, s[32:35], s43 offen offset:3072 lds
    v_mfma_f32_16x16x32_bf16 v[124:127], v[156:159], a[124:127], v[124:127]
    ds_read_b64_tr_b16 v[190:191], v199 offset:37376
    s_add_u32 s43, s43, 4096
    v_mfma_f32_16x16x32_bf16 v[124:127], v[152:155], a[108:111], v[124:127]
    s_add_u32 m0, s46, 20480
    v_cvt_pk_bf16_f32 v112, v112, v113
    s_waitcnt lgkmcnt(8)
    v_mfma_f32_16x16x32_bf16 a[192:195], v[160:163], a[96:99], a[192:195]
    ds_read_b128 a[64:67], v224 offset:49152
    v_cvt_pk_bf16_f32 v113, v114, v115
    v_mfma_f32_16x16x32_bf16 a[192:195], v[164:167], a[112:115], a[192:195]
    ds_read_b128 a[68:71], v225 offset:49152
    v_cvt_pk_bf16_f32 v114, v116, v117
    v_mfma_f32_16x16x32_bf16 a[200:203], v[164:167], a[116:119], a[200:203]
    ds_read_b128 a[72:75], v226 offset:49152
    v_cvt_pk_bf16_f32 v115, v118, v119
    v_mfma_f32_16x16x32_bf16 a[200:203], v[160:163], a[100:103], a[200:203]
    ds_read_b128 a[76:79], v227 offset:49152
    v_cvt_pk_bf16_f32 v24, v24, v25
    v_mfma_f32_16x16x32_bf16 a[208:211], v[160:163], a[104:107], a[208:211]
    buffer_load_dwordx4 v236, s[32:35], s43 offen offset:0 lds
    v_mfma_f32_16x16x32_bf16 a[208:211], v[164:167], a[120:123], a[208:211]
    v_cvt_pk_bf16_f32 v25, v26, v27
    v_cvt_pk_bf16_f32 v26, v28, v29
    v_mfma_f32_16x16x32_bf16 a[216:219], v[164:167], a[124:127], a[216:219]
    v_cvt_pk_bf16_f32 v27, v30, v31
    v_cvt_pk_bf16_f32 v56, v56, v57
    v_mfma_f32_16x16x32_bf16 a[216:219], v[160:163], a[108:111], a[216:219]
    v_cvt_pk_bf16_f32 v57, v58, v59
    v_cvt_pk_bf16_f32 v58, v60, v61
    s_waitcnt lgkmcnt(0)
    s_barrier
    v_cvt_pk_bf16_f32 v59, v62, v63
    v_mfma_f32_16x16x32_bf16 v[4:7], a[64:67], v[0:3], 0
    ds_read_b128 a[80:83], v224 offset:53248
    v_cvt_pk_bf16_f32 v88, v88, v89
    v_mfma_f32_16x16x32_bf16 v[4:7], a[68:71], v[8:11], v[4:7]
    buffer_load_dwordx4 v237, s[32:35], s43 offen offset:1024 lds
    v_mfma_f32_16x16x32_bf16 v[4:7], a[72:75], v[16:19], v[4:7]
    ds_read_b128 a[84:87], v225 offset:53248
    v_cvt_pk_bf16_f32 v89, v90, v91
    v_mfma_f32_16x16x32_bf16 v[4:7], a[76:79], v[24:27], v[4:7]
    v_cvt_pk_bf16_f32 v90, v92, v93
    v_cvt_pk_bf16_f32 v91, v94, v95
    v_mfma_f32_16x16x32_bf16 v[36:39], a[76:79], v[56:59], 0
    ds_read_b128 a[88:91], v226 offset:53248
    v_cvt_pk_bf16_f32 v120, v120, v121
    v_mfma_f32_16x16x32_bf16 v[36:39], a[72:75], v[48:51], v[36:39]
    buffer_load_dwordx4 v238, s[32:35], s43 offen offset:2048 lds
    v_mfma_f32_16x16x32_bf16 v[36:39], a[68:71], v[40:43], v[36:39]
    ds_read_b128 a[92:95], v227 offset:53248
    v_cvt_pk_bf16_f32 v121, v122, v123
    v_mfma_f32_16x16x32_bf16 v[36:39], a[64:67], v[32:35], v[36:39]
    v_cvt_pk_bf16_f32 v122, v124, v125
    v_cvt_pk_bf16_f32 v123, v126, v127
    v_mfma_f32_16x16x32_bf16 v[68:71], a[64:67], v[64:67], 0
    v_accvgpr_write_b32 a0, v0
    v_accvgpr_write_b32 a1, v1
    v_mfma_f32_16x16x32_bf16 v[68:71], a[68:71], v[72:75], v[68:71]
    buffer_load_dwordx4 v239, s[32:35], s43 offen offset:3072 lds
    v_mfma_f32_16x16x32_bf16 v[68:71], a[72:75], v[80:83], v[68:71]
    s_add_u32 s43, s43, 12288
    s_add_u32 m0, s46, 32768
    v_max3_f32 v242, v4, v5, v6
    v_mfma_f32_16x16x32_bf16 v[68:71], a[76:79], v[88:91], v[68:71]
    v_max_f32 v242, v242, v7
    v_accvgpr_write_b32 a2, v2
    v_mfma_f32_16x16x32_bf16 v[100:103], a[76:79], v[120:123], 0
    v_accvgpr_write_b32 a3, v3
    v_accvgpr_write_b32 a16, v32
    v_mfma_f32_16x16x32_bf16 v[100:103], a[72:75], v[112:115], v[100:103]
    buffer_load_dwordx4 v236, s[32:35], s43 offen offset:0 lds
    v_mfma_f32_16x16x32_bf16 v[100:103], a[68:71], v[104:107], v[100:103]
    v_max3_f32 v243, v36, v37, v38
    v_max_f32 v243, v243, v39
    v_mfma_f32_16x16x32_bf16 v[100:103], a[64:67], v[96:99], v[100:103]
    v_accvgpr_write_b32 a17, v33
    v_accvgpr_write_b32 a18, v34
    s_waitcnt lgkmcnt(0)
    v_mfma_f32_16x16x32_bf16 v[12:15], a[80:83], v[0:3], 0
    ds_read_b128 a[64:67], v224 offset:57344
    v_accvgpr_write_b32 a19, v35
    v_mfma_f32_16x16x32_bf16 v[12:15], a[84:87], v[8:11], v[12:15]
    buffer_load_dwordx4 v237, s[32:35], s43 offen offset:1024 lds
    v_mfma_f32_16x16x32_bf16 v[12:15], a[88:91], v[16:19], v[12:15]
    ds_read_b128 a[68:71], v225 offset:57344
    v_accvgpr_write_b32 a32, v64
    v_mfma_f32_16x16x32_bf16 v[12:15], a[92:95], v[24:27], v[12:15]
    v_max3_f32 v244, v68, v69, v70
    v_max_f32 v244, v244, v71
    v_mfma_f32_16x16x32_bf16 v[44:47], a[92:95], v[56:59], 0
    ds_read_b128 a[72:75], v226 offset:57344
    v_accvgpr_write_b32 a33, v65
    v_mfma_f32_16x16x32_bf16 v[44:47], a[88:91], v[48:51], v[44:47]
    buffer_load_dwordx4 v238, s[32:35], s43 offen offset:2048 lds
    v_mfma_f32_16x16x32_bf16 v[44:47], a[84:87], v[40:43], v[44:47]
    ds_read_b128 a[76:79], v227 offset:57344
    v_accvgpr_write_b32 a34, v66
    v_mfma_f32_16x16x32_bf16 v[44:47], a[80:83], v[32:35], v[44:47]
    v_max3_f32 v245, v100, v101, v102
    v_max_f32 v245, v245, v103
    v_mfma_f32_16x16x32_bf16 v[76:79], a[80:83], v[64:67], 0
    v_accvgpr_write_b32 a35, v67
    v_accvgpr_write_b32 a48, v96
    v_mfma_f32_16x16x32_bf16 v[76:79], a[84:87], v[72:75], v[76:79]
    buffer_load_dwordx4 v239, s[32:35], s43 offen offset:3072 lds
    v_mfma_f32_16x16x32_bf16 v[76:79], a[88:91], v[80:83], v[76:79]
    s_add_u32 s43, s43, 4096
    s_add_u32 m0, s46, 36864
    v_max3_f32 v242, v242, v12, v13
    v_mfma_f32_16x16x32_bf16 v[76:79], a[92:95], v[88:91], v[76:79]
    v_max3_f32 v242, v242, v14, v15
    v_accvgpr_write_b32 a49, v97
    v_mfma_f32_16x16x32_bf16 v[108:111], a[92:95], v[120:123], 0
    v_accvgpr_write_b32 a50, v98
    v_accvgpr_write_b32 a51, v99
    v_mfma_f32_16x16x32_bf16 v[108:111], a[88:91], v[112:115], v[108:111]
    buffer_load_dwordx4 v236, s[32:35], s43 offen offset:0 lds
    v_mfma_f32_16x16x32_bf16 v[108:111], a[84:87], v[104:107], v[108:111]
    v_max3_f32 v243, v243, v44, v45
    v_max3_f32 v243, v243, v46, v47
    v_mfma_f32_16x16x32_bf16 v[108:111], a[80:83], v[96:99], v[108:111]
    v_accvgpr_write_b32 a4, v8
    v_accvgpr_write_b32 a5, v9
    s_waitcnt lgkmcnt(0)
    v_mfma_f32_16x16x32_bf16 v[20:23], a[64:67], v[0:3], 0
    ds_read_b128 a[80:83], v224 offset:61440
    v_accvgpr_write_b32 a6, v10
    v_mfma_f32_16x16x32_bf16 v[20:23], a[68:71], v[8:11], v[20:23]
    buffer_load_dwordx4 v237, s[32:35], s43 offen offset:1024 lds
    v_mfma_f32_16x16x32_bf16 v[20:23], a[72:75], v[16:19], v[20:23]
    ds_read_b128 a[84:87], v225 offset:61440
    v_accvgpr_write_b32 a7, v11
    v_mfma_f32_16x16x32_bf16 v[20:23], a[76:79], v[24:27], v[20:23]
    v_max3_f32 v244, v244, v76, v77
    v_max3_f32 v244, v244, v78, v79
    v_mfma_f32_16x16x32_bf16 v[52:55], a[76:79], v[56:59], 0
    ds_read_b128 a[88:91], v226 offset:61440
    v_accvgpr_write_b32 a20, v40
    v_mfma_f32_16x16x32_bf16 v[52:55], a[72:75], v[48:51], v[52:55]
    buffer_load_dwordx4 v238, s[32:35], s43 offen offset:2048 lds
    v_mfma_f32_16x16x32_bf16 v[52:55], a[68:71], v[40:43], v[52:55]
    ds_read_b128 a[92:95], v227 offset:61440
    v_accvgpr_write_b32 a21, v41
    v_mfma_f32_16x16x32_bf16 v[52:55], a[64:67], v[32:35], v[52:55]
    v_max3_f32 v245, v245, v108, v109
    v_max3_f32 v245, v245, v110, v111
    v_mfma_f32_16x16x32_bf16 v[84:87], a[64:67], v[64:67], 0
    v_accvgpr_write_b32 a22, v42
    v_accvgpr_write_b32 a23, v43
    v_mfma_f32_16x16x32_bf16 v[84:87], a[68:71], v[72:75], v[84:87]
    buffer_load_dwordx4 v239, s[32:35], s43 offen offset:3072 lds
    v_mfma_f32_16x16x32_bf16 v[84:87], a[72:75], v[80:83], v[84:87]
    s_add_u32 s43, s43, 12288
    v_max3_f32 v242, v242, v20, v21
    v_max3_f32 v242, v242, v22, v23
    v_mfma_f32_16x16x32_bf16 v[84:87], a[76:79], v[88:91], v[84:87]
    v_accvgpr_write_b32 a36, v72
    v_accvgpr_write_b32 a37, v73
    v_mfma_f32_16x16x32_bf16 v[116:119], a[76:79], v[120:123], 0
    v_accvgpr_write_b32 a38, v74
    v_accvgpr_write_b32 a39, v75
    v_mfma_f32_16x16x32_bf16 v[116:119], a[72:75], v[112:115], v[116:119]
    v_max3_f32 v243, v243, v52, v53
    v_max3_f32 v243, v243, v54, v55
    v_mfma_f32_16x16x32_bf16 v[116:119], a[68:71], v[104:107], v[116:119]
    v_accvgpr_write_b32 a52, v104
    v_accvgpr_write_b32 a53, v105
    v_mfma_f32_16x16x32_bf16 v[116:119], a[64:67], v[96:99], v[116:119]
    v_accvgpr_write_b32 a54, v106
    v_accvgpr_write_b32 a55, v107
    s_waitcnt lgkmcnt(0)
    v_mfma_f32_16x16x32_bf16 v[28:31], a[80:83], v[0:3], 0
    v_accvgpr_write_b32 a8, v16
    v_accvgpr_write_b32 a9, v17
    v_mfma_f32_16x16x32_bf16 v[28:31], a[84:87], v[8:11], v[28:31]
    v_max3_f32 v244, v244, v84, v85
    v_max3_f32 v244, v244, v86, v87
    v_mfma_f32_16x16x32_bf16 v[28:31], a[88:91], v[16:19], v[28:31]
    v_accvgpr_write_b32 a10, v18
    v_accvgpr_write_b32 a11, v19
    v_mfma_f32_16x16x32_bf16 v[28:31], a[92:95], v[24:27], v[28:31]
    v_accvgpr_write_b32 a24, v48
    v_accvgpr_write_b32 a25, v49
    v_mfma_f32_16x16x32_bf16 v[60:63], a[92:95], v[56:59], 0
    v_accvgpr_write_b32 a26, v50
    v_accvgpr_write_b32 a27, v51
    v_mfma_f32_16x16x32_bf16 v[60:63], a[88:91], v[48:51], v[60:63]
    v_max3_f32 v245, v245, v116, v117
    v_max3_f32 v245, v245, v118, v119
    v_mfma_f32_16x16x32_bf16 v[60:63], a[84:87], v[40:43], v[60:63]
    v_accvgpr_write_b32 a40, v80
    v_accvgpr_write_b32 a41, v81
    v_mfma_f32_16x16x32_bf16 v[60:63], a[80:83], v[32:35], v[60:63]
    v_accvgpr_write_b32 a42, v82
    v_accvgpr_write_b32 a43, v83
    v_mfma_f32_16x16x32_bf16 v[92:95], a[80:83], v[64:67], 0
    v_accvgpr_write_b32 a56, v112
    v_accvgpr_write_b32 a57, v113
K1_pg4:
    s_cbranch_execz K1_pg8
    v_mfma_f32_16x16x32_bf16 v[92:95], a[84:87], v[72:75], v[92:95]
    v_max3_f32 v242, v242, v28, v29
    v_max3_f32 v242, v242, v30, v31
    v_mfma_f32_16x16x32_bf16 v[92:95], a[88:91], v[80:83], v[92:95]
    v_accvgpr_write_b32 a58, v114
    v_accvgpr_write_b32 a59, v115
    v_mfma_f32_16x16x32_bf16 v[92:95], a[92:95], v[88:91], v[92:95]
    v_accvgpr_write_b32 a12, v24
    v_accvgpr_write_b32 a13, v25
    v_mfma_f32_16x16x32_bf16 v[124:127], a[92:95], v[120:123], 0
    v_accvgpr_write_b32 a14, v26
    v_accvgpr_write_b32 a15, v27
    v_mfma_f32_16x16x32_bf16 v[124:127], a[88:91], v[112:115], v[124:127]
    v_max3_f32 v243, v243, v60, v61
    v_max3_f32 v243, v243, v62, v63
    v_mfma_f32_16x16x32_bf16 v[124:127], a[84:87], v[104:107], v[124:127]
    v_accvgpr_write_b32 a28, v56
    v_accvgpr_write_b32 a29, v57
    v_mfma_f32_16x16x32_bf16 v[124:127], a[80:83], v[96:99], v[124:127]
    v_accvgpr_write_b32 a30, v58
    v_accvgpr_write_b32 a31, v59
    s_waitcnt vmcnt(16)
    s_barrier
    v_mfma_f32_16x16x32_bf16 a[196:199], v[168:171], a[96:99], a[196:199]
    ds_read_b128 a[64:67], v224 offset:0
    s_add_u32 m0, s46, 49152
    v_mfma_f32_16x16x32_bf16 a[196:199], v[172:175], a[112:115], a[196:199]
    buffer_load_dwordx4 v236, s[32:35], s43 offen offset:0 lds
    v_mfma_f32_16x16x32_bf16 a[204:207], v[172:175], a[116:119], a[204:207]
    ds_read_b128 a[68:71], v225 offset:0
    v_max3_f32 v244, v244, v92, v93
    v_mfma_f32_16x16x32_bf16 a[204:207], v[168:171], a[100:103], a[204:207]
    v_max3_f32 v244, v244, v94, v95
    v_mfma_f32_16x16x32_bf16 a[212:215], v[168:171], a[104:107], a[212:215]
    ds_read_b128 a[72:75], v226 offset:0
    v_mfma_f32_16x16x32_bf16 a[212:215], v[172:175], a[120:123], a[212:215]
    buffer_load_dwordx4 v237, s[32:35], s43 offen offset:1024 lds
    v_max3_f32 v245, v245, v124, v125
    v_mfma_f32_16x16x32_bf16 a[220:223], v[172:175], a[124:127], a[220:223]
    ds_read_b128 a[76:79], v227 offset:0
    v_max3_f32 v245, v245, v126, v127
    v_mfma_f32_16x16x32_bf16 a[220:223], v[168:171], a[108:111], a[220:223]
    v_mov_b32 v246, v242
    v_mov_b32 v247, v243
    v_mfma_f32_16x16x32_bf16 a[224:227], v[176:179], a[96:99], a[224:227]
    ds_read_b64_tr_b16 a[80:81], v228 offset:0
    v_mov_b32 v248, v244
    v_mfma_f32_16x16x32_bf16 a[224:227], v[180:183], a[112:115], a[224:227]
    v_mov_b32 v249, v245
    v_permlane16_swap_b32 v242, v246
    v_mfma_f32_16x16x32_bf16 a[232:235], v[180:183], a[116:119], a[232:235]
    ds_read_b64_tr_b16 a[82:83], v228 offset:4096
    v_permlane16_swap_b32 v243, v247
    v_mfma_f32_16x16x32_bf16 a[232:235], v[176:179], a[100:103], a[232:235]
    v_permlane16_swap_b32 v244, v248
    v_permlane16_swap_b32 v245, v249
    v_mfma_f32_16x16x32_bf16 a[240:243], v[176:179], a[104:107], a[240:243]
    ds_read_b64_tr_b16 a[84:85], v228 offset:8192
    v_max_f32 v242, v242, v246
    v_mfma_f32_16x16x32_bf16 a[240:243], v[180:183], a[120:123], a[240:243]
    v_max_f32 v243, v243, v247
    v_max_f32 v244, v244, v248
    v_mfma_f32_16x16x32_bf16 a[248:251], v[180:183], a[124:127], a[248:251]
    ds_read_b64_tr_b16 a[86:87], v228 offset:12288
    v_max_f32 v245, v245, v249
    v_mfma_f32_16x16x32_bf16 a[248:251], v[176:179], a[108:111], a[248:251]
    v_mov_b32 v246, v242
    v_mov_b32 v247, v243
    v_mfma_f32_16x16x32_bf16 a[228:231], v[184:187], a[96:99], a[228:231]
    ds_read_b64_tr_b16 a[88:89], v229 offset:0
    v_mov_b32 v248, v244
    v_mfma_f32_16x16x32_bf16 a[228:231], v[188:191], a[112:115], a[228:231]
    v_mov_b32 v249, v245
    v_permlane32_swap_b32 v242, v246
    v_mfma_f32_16x16x32_bf16 a[236:239], v[188:191], a[116:119], a[236:239]
    ds_read_b64_tr_b16 a[90:91], v229 offset:4096
    v_permlane32_swap_b32 v243, v247
    v_mfma_f32_16x16x32_bf16 a[236:239], v[184:187], a[100:103], a[236:239]
    v_permlane32_swap_b32 v244, v248
    v_permlane32_swap_b32 v245, v249
    v_mfma_f32_16x16x32_bf16 a[244:247], v[184:187], a[104:107], a[244:247]
    ds_read_b64_tr_b16 a[92:93], v229 offset:8192
    v_max_f32 v242, v242, v246
    v_mfma_f32_16x16x32_bf16 a[244:247], v[188:191], a[120:123], a[244:247]
    v_max_f32 v243, v243, v247
    v_max_f32 v244, v244, v248
    v_mfma_f32_16x16x32_bf16 a[252:255], v[188:191], a[124:127], a[252:255]
    ds_read_b64_tr_b16 a[94:95], v229 offset:12288
    v_max_f32 v245, v245, v249
    v_mfma_f32_16x16x32_bf16 a[252:255], v[184:187], a[108:111], a[252:255]
    v_sub_f32 v208, 0xc2cc0000, v242
    v_sub_f32 v212, 0xc2cc0000, v243
    v_sub_f32 v216, 0xc2cc0000, v244
    v_sub_f32 v220, 0xc2cc0000, v245
    v_sub_f32 v209, 0xc2cc0000, v242
    v_sub_f32 v213, 0xc2cc0000, v243
    v_sub_f32 v217, 0xc2cc0000, v244
    v_sub_f32 v221, 0xc2cc0000, v245
    v_sub_f32 v210, 0xc2cc0000, v242
    v_sub_f32 v214, 0xc2cc0000, v243
    v_sub_f32 v218, 0xc2cc0000, v244
    v_sub_f32 v222, 0xc2cc0000, v245
    v_sub_f32 v211, 0xc2cc0000, v242
    v_sub_f32 v215, 0xc2cc0000, v243
    v_sub_f32 v219, 0xc2cc0000, v244
    v_sub_f32 v223, 0xc2cc0000, v245
    v_accvgpr_write_b32 a44, v88
    v_accvgpr_write_b32 a45, v89
    v_accvgpr_write_b32 a46, v90
    v_accvgpr_write_b32 a47, v91
    v_accvgpr_write_b32 a60, v120
    v_accvgpr_write_b32 a61, v121
    v_accvgpr_write_b32 a62, v122
    v_accvgpr_write_b32 a63, v123
    v_pk_add_f32 v[4:5], v[4:5], v[208:209]
    v_pk_add_f32 v[6:7], v[6:7], v[208:209]
    v_pk_add_f32 v[12:13], v[12:13], v[208:209]
    v_pk_add_f32 v[14:15], v[14:15], v[208:209]
    v_pk_add_f32 v[20:21], v[20:21], v[208:209]
    v_pk_add_f32 v[22:23], v[22:23], v[208:209]
    v_pk_add_f32 v[28:29], v[28:29], v[208:209]
    v_pk_add_f32 v[30:31], v[30:31], v[208:209]
    v_pk_add_f32 v[36:37], v[36:37], v[212:213]
    v_pk_add_f32 v[38:39], v[38:39], v[212:213]
    v_pk_add_f32 v[44:45], v[44:45], v[212:213]
    v_pk_add_f32 v[46:47], v[46:47], v[212:213]
    v_pk_add_f32 v[52:53], v[52:53], v[212:213]
    v_pk_add_f32 v[54:55], v[54:55], v[212:213]
    v_pk_add_f32 v[60:61], v[60:61], v[212:213]
    v_pk_add_f32 v[62:63], v[62:63], v[212:213]
    v_pk_add_f32 v[68:69], v[68:69], v[216:217]
    v_pk_add_f32 v[70:71], v[70:71], v[216:217]
    v_pk_add_f32 v[76:77], v[76:77], v[216:217]
    v_pk_add_f32 v[78:79], v[78:79], v[216:217]
    v_pk_add_f32 v[84:85], v[84:85], v[216:217]
    v_pk_add_f32 v[86:87], v[86:87], v[216:217]
    v_pk_add_f32 v[92:93], v[92:93], v[216:217]
    v_pk_add_f32 v[94:95], v[94:95], v[216:217]
    v_pk_add_f32 v[100:101], v[100:101], v[220:221]
    v_pk_add_f32 v[102:103], v[102:103], v[220:221]
    v_pk_add_f32 v[108:109], v[108:109], v[220:221]
    v_pk_add_f32 v[110:111], v[110:111], v[220:221]
    v_pk_add_f32 v[116:117], v[116:117], v[220:221]
    v_pk_add_f32 v[118:119], v[118:119], v[220:221]
    v_pk_add_f32 v[204:205], v[124:125], v[220:221]
    v_pk_add_f32 v[206:207], v[126:127], v[220:221]
    v_exp_f32 v4, v4
    v_exp_f32 v5, v5
    v_exp_f32 v6, v6
    v_exp_f32 v7, v7
    v_exp_f32 v12, v12
    v_cvt_pk_bf16_f32 v128, v4, v5
    v_exp_f32 v13, v13
    v_cvt_pk_bf16_f32 v129, v6, v7
    v_exp_f32 v14, v14
    v_exp_f32 v15, v15
    v_exp_f32 v20, v20
    v_cvt_pk_bf16_f32 v130, v12, v13
    v_exp_f32 v21, v21
    v_cvt_pk_bf16_f32 v131, v14, v15
    v_exp_f32 v22, v22
    v_exp_f32 v23, v23
    v_mfma_f32_32x32x16_bf16 v[0:15], a[184:187], a[184:187], 0
    v_exp_f32 v28, v28
    v_cvt_pk_bf16_f32 v132, v20, v21
    v_exp_f32 v29, v29
    v_cvt_pk_bf16_f32 v133, v22, v23
    v_exp_f32 v30, v30
    v_exp_f32 v31, v31
    v_exp_f32 v36, v36
    v_cvt_pk_bf16_f32 v134, v28, v29
    v_exp_f32 v37, v37
    v_cvt_pk_bf16_f32 v135, v30, v31
    v_exp_f32 v38, v38
    v_exp_f32 v39, v39
    v_mfma_f32_32x32x16_bf16 v[16:31], a[184:187], a[184:187], 0
    v_exp_f32 v44, v44
    v_cvt_pk_bf16_f32 v136, v36, v37
    v_exp_f32 v45, v45
    v_cvt_pk_bf16_f32 v137, v38, v39
    v_exp_f32 v46, v46
    v_exp_f32 v47, v47
    v_exp_f32 v52, v52
    v_cvt_pk_bf16_f32 v138, v44, v45
    v_exp_f32 v53, v53
    v_cvt_pk_bf16_f32 v139, v46, v47
    v_exp_f32 v54, v54
    v_exp_f32 v55, v55
    v_mfma_f32_32x32x16_bf16 v[32:47], a[184:187], a[184:187], 0
    v_exp_f32 v60, v60
    v_cvt_pk_bf16_f32 v140, v52, v53
    v_exp_f32 v61, v61
    v_cvt_pk_bf16_f32 v141, v54, v55
    v_exp_f32 v62, v62
    v_exp_f32 v63, v63
    v_exp_f32 v68, v68
    v_cvt_pk_bf16_f32 v142, v60, v61
    v_exp_f32 v69, v69
    v_cvt_pk_bf16_f32 v143, v62, v63
    v_exp_f32 v70, v70
    v_exp_f32 v71, v71
    v_mfma_f32_32x32x16_bf16 v[48:63], a[184:187], a[184:187], 0
    v_exp_f32 v76, v76
    v_cvt_pk_bf16_f32 v144, v68, v69
    v_exp_f32 v77, v77
    v_cvt_pk_bf16_f32 v145, v70, v71
    v_exp_f32 v78, v78
    v_exp_f32 v79, v79
    v_exp_f32 v84, v84
    v_cvt_pk_bf16_f32 v146, v76, v77
    v_exp_f32 v85, v85
    v_cvt_pk_bf16_f32 v147, v78, v79
    v_exp_f32 v86, v86
    v_exp_f32 v87, v87
    v_mfma_f32_32x32x16_bf16 v[64:79], a[184:187], a[184:187], 0
    v_exp_f32 v92, v92
    v_cvt_pk_bf16_f32 v148, v84, v85
    v_exp_f32 v93, v93
    v_cvt_pk_bf16_f32 v149, v86, v87
    v_exp_f32 v94, v94
    v_exp_f32 v95, v95
    v_exp_f32 v100, v100
    v_cvt_pk_bf16_f32 v150, v92, v93
    v_exp_f32 v101, v101
    v_cvt_pk_bf16_f32 v151, v94, v95
    v_exp_f32 v102, v102
    v_exp_f32 v103, v103
    v_mfma_f32_32x32x16_bf16 v[80:95], a[184:187], a[184:187], 0
    v_exp_f32 v108, v108
    v_cvt_pk_bf16_f32 v152, v100, v101
    v_exp_f32 v109, v109
    v_cvt_pk_bf16_f32 v153, v102, v103
    v_exp_f32 v110, v110
    v_exp_f32 v111, v111
    v_exp_f32 v116, v116
    v_cvt_pk_bf16_f32 v154, v108, v109
    v_exp_f32 v117, v117
    v_cvt_pk_bf16_f32 v155, v110, v111
    v_exp_f32 v118, v118
    v_exp_f32 v119, v119
    v_mfma_f32_32x32x16_bf16 v[96:111], a[184:187], a[184:187], 0
    v_cvt_pk_bf16_f32 v156, v116, v117
    v_cvt_pk_bf16_f32 v157, v118, v119
    v_mfma_f32_32x32x16_bf16 v[112:127], a[184:187], a[184:187], 0
    v_and_b32 v242, 0x3c0, v240
    v_bfe_u32 v243, v240, 4, 2
    v_lshl_add_u32 v242, v243, 3, v242
    v_add_u32 v242, s58, v242
    s_waitcnt lgkmcnt(0)
    s_mov_b32 s47, 0
.p2align 3
K1_loopa:
    v_mfma_f32_16x16x32_bf16 v[192:195], a[64:67], a[0:3], v[208:211]
    v_exp_f32 v204, v204
    v_mfma_f32_16x16x32_bf16 v[192:195], a[68:71], a[4:7], v[192:195]
    ds_read_b128 a[96:99], v224 offset:4096
    s_add_u32 s10, s8, K1_loop-K1_pc+(0)
    s_addc_u32 s11, s9, 0
    v_mfma_f32_16x16x32_bf16 v[192:195], a[72:75], a[8:11], v[192:195]
    v_exp_f32 v205, v205
    v_mfma_f32_16x16x32_bf16 v[192:195], a[76:79], a[12:15], v[192:195]
    ds_read_b128 a[100:103], v225 offset:4096
    v_cvt_pk_bf16_f32 v158, v204, v205
    v_mfma_f32_16x16x32_bf16 v[196:199], a[76:79], a[28:31], v[212:215]
    v_exp_f32 v206, v206
    v_mfma_f32_16x16x32_bf16 v[196:199], a[72:75], a[24:27], v[196:199]
    ds_read_b128 a[104:107], v226 offset:4096
    v_accvgpr_read_b32 v249, a193
    v_mfma_f32_16x16x32_bf16 v[196:199], a[68:71], a[20:23], v[196:199]
    v_exp_f32 v207, v207
    v_mfma_f32_16x16x32_bf16 v[196:199], a[64:67], a[16:19], v[196:199]
    ds_read_b128 a[108:111], v227 offset:4096
    v_cvt_pk_bf16_f32 v159, v206, v207
    v_mfma_f32_16x16x32_bf16 v[200:203], a[64:67], a[32:35], v[216:219]
    v_exp_f32 v192, v192
    v_mfma_f32_16x16x32_bf16 v[200:203], a[68:71], a[36:39], v[200:203]
    ds_read_b64_tr_b16 a[112:113], v230 offset:0
    v_mul_f32 v253, s57, v249
    v_mfma_f32_16x16x32_bf16 v[200:203], a[72:75], a[40:43], v[200:203]
    v_exp_f32 v193, v193
    v_mfma_f32_16x16x32_bf16 v[200:203], a[76:79], a[44:47], v[200:203]
    ds_read_b64_tr_b16 a[114:115], v230 offset:4096
    v_cvt_pk_bf16_f32 v160, v192, v193
    v_mfma_f32_16x16x32_bf16 v[204:207], a[76:79], a[60:63], v[220:223]
    v_exp_f32 v194, v194
    v_mfma_f32_16x16x32_bf16 v[204:207], a[72:75], a[56:59], v[204:207]
    buffer_load_dwordx4 v238, s[32:35], s43 offen offset:2048 lds
    v_mfma_f32_16x16x32_bf16 v[204:207], a[68:71], a[52:55], v[204:207]
    v_exp_f32 v195, v195
    v_mfma_f32_16x16x32_bf16 v[204:207], a[64:67], a[48:51], v[204:207]
    ds_read_b64_tr_b16 a[116:117], v230 offset:8192
    v_cvt_pk_bf16_f32 v161, v194, v195
    v_mfma_f32_16x16x32_bf16 v[0:3], a[80:83], v[128:131], v[0:3]
    v_exp_f32 v196, v196
    v_mfma_f32_16x16x32_bf16 v[0:3], a[84:87], v[132:135], v[0:3]
    ds_read_b64_tr_b16 a[118:119], v230 offset:12288
    v_accvgpr_read_b32 v248, a192
    v_mfma_f32_16x16x32_bf16 v[32:35], a[84:87], v[140:143], v[32:35]
    v_exp_f32 v197, v197
    v_mfma_f32_16x16x32_bf16 v[32:35], a[80:83], v[136:139], v[32:35]
    ds_read_b64_tr_b16 a[120:121], v231 offset:0
    v_cvt_pk_bf16_f32 v168, v196, v197
    v_mfma_f32_16x16x32_bf16 v[64:67], a[80:83], v[144:147], v[64:67]
    v_exp_f32 v198, v198
    v_mfma_f32_16x16x32_bf16 v[64:67], a[84:87], v[148:151], v[64:67]
    buffer_load_dwordx4 v239, s[32:35], s43 offen offset:3072 lds
    v_mfma_f32_16x16x32_bf16 v[96:99], a[84:87], v[156:159], v[96:99]
    s_add_u32 s43, s43, 4096
    v_exp_f32 v199, v199
    v_mfma_f32_16x16x32_bf16 v[96:99], a[80:83], v[152:155], v[96:99]
    ds_read_b64_tr_b16 a[122:123], v231 offset:4096
    v_cvt_pk_bf16_f32 v169, v198, v199
    v_mfma_f32_16x16x32_bf16 v[100:103], a[88:91], v[152:155], v[100:103]
    v_exp_f32 v200, v200
    v_mfma_f32_16x16x32_bf16 v[100:103], a[92:95], v[156:159], v[100:103]
    ds_read_b64_tr_b16 a[124:125], v231 offset:8192
    v_mul_f32 v252, s57, v248
    v_mfma_f32_16x16x32_bf16 v[68:71], a[92:95], v[148:151], v[68:71]
    v_exp_f32 v201, v201
    v_mfma_f32_16x16x32_bf16 v[68:71], a[88:91], v[144:147], v[68:71]
    ds_read_b64_tr_b16 a[126:127], v231 offset:12288
    v_cvt_pk_bf16_f32 v176, v200, v201
    v_mfma_f32_16x16x32_bf16 v[36:39], a[88:91], v[136:139], v[36:39]
    s_mov_b32 m0, s58
    v_exp_f32 v202, v202
    v_mfma_f32_16x16x32_bf16 v[36:39], a[92:95], v[140:143], v[36:39]
    buffer_load_dwordx4 v254, s[60:63], s19 offen offset:0 lds
    v_mfma_f32_16x16x32_bf16 v[4:7], a[92:95], v[132:135], v[4:7]
    v_exp_f32 v203, v203
    v_mfma_f32_16x16x32_bf16 v[4:7], a[88:91], v[128:131], v[4:7]
    v_cvt_pk_bf16_f32 v177, v202, v203
    v_exp_f32 v253, v253
    v_smfmac_f32_16x16x64_bf16 a[128:131], a[144:147], v[128:135], v241
    v_exp_f32 v252, v252
    s_waitcnt lgkmcnt(0)
    v_mfma_f32_16x16x32_bf16 v[192:195], a[96:99], a[0:3], v[208:211]
    v_exp_f32 v204, v204
    v_mfma_f32_16x16x32_bf16 v[192:195], a[100:103], a[4:7], v[192:195]
    ds_read_b128 a[64:67], v224 offset:8192
    v_add_f32 v253, 1.0, v253
    v_mfma_f32_16x16x32_bf16 v[192:195], a[104:107], a[8:11], v[192:195]
    v_exp_f32 v205, v205
    v_mfma_f32_16x16x32_bf16 v[192:195], a[108:111], a[12:15], v[192:195]
    ds_read_b128 a[68:71], v225 offset:8192
    v_cvt_pk_bf16_f32 v184, v204, v205
    v_mfma_f32_16x16x32_bf16 v[196:199], a[108:111], a[28:31], v[212:215]
    v_exp_f32 v206, v206
    v_mfma_f32_16x16x32_bf16 v[196:199], a[104:107], a[24:27], v[196:199]
    ds_read_b128 a[72:75], v226 offset:8192
    v_add_f32 v252, 1.0, v252
    v_mfma_f32_16x16x32_bf16 v[196:199], a[100:103], a[20:23], v[196:199]
    v_exp_f32 v207, v207
    v_mfma_f32_16x16x32_bf16 v[196:199], a[96:99], a[16:19], v[196:199]
    ds_read_b128 a[76:79], v227 offset:8192
    v_cvt_pk_bf16_f32 v185, v206, v207
    v_mfma_f32_16x16x32_bf16 v[200:203], a[96:99], a[32:35], v[216:219]
    v_exp_f32 v192, v192
    v_mfma_f32_16x16x32_bf16 v[200:203], a[100:103], a[36:39], v[200:203]
    ds_read_b64_tr_b16 a[80:81], v232 offset:0
    v_rcp_f32 v253, v253
    v_mfma_f32_16x16x32_bf16 v[200:203], a[104:107], a[40:43], v[200:203]
    v_exp_f32 v193, v193
    v_mfma_f32_16x16x32_bf16 v[200:203], a[108:111], a[44:47], v[200:203]
    ds_read_b64_tr_b16 a[82:83], v232 offset:4096
    v_cvt_pk_bf16_f32 v162, v192, v193
    v_mfma_f32_16x16x32_bf16 v[204:207], a[108:111], a[60:63], v[220:223]
    v_exp_f32 v194, v194
    v_mfma_f32_16x16x32_bf16 v[204:207], a[104:107], a[56:59], v[204:207]
    v_rcp_f32 v252, v252
    v_mfma_f32_16x16x32_bf16 v[204:207], a[100:103], a[52:55], v[204:207]
    v_exp_f32 v195, v195
    v_mfma_f32_16x16x32_bf16 v[204:207], a[96:99], a[48:51], v[204:207]
    ds_read_b64_tr_b16 a[84:85], v232 offset:8192
    v_cvt_pk_bf16_f32 v163, v194, v195
    v_mfma_f32_16x16x32_bf16 v[8:11], a[112:115], v[128:131], v[8:11]
    v_exp_f32 v196, v196
    v_mfma_f32_16x16x32_bf16 v[8:11], a[116:119], v[132:135], v[8:11]
    ds_read_b64_tr_b16 a[86:87], v232 offset:12288
    v_mul_f32 v253, v249, v253
    v_mfma_f32_16x16x32_bf16 v[40:43], a[116:119], v[140:143], v[40:43]
    v_exp_f32 v197, v197
    v_mfma_f32_16x16x32_bf16 v[40:43], a[112:115], v[136:139], v[40:43]
    ds_read_b64_tr_b16 a[88:89], v233 offset:0
    v_cvt_pk_bf16_f32 v170, v196, v197
    v_mfma_f32_16x16x32_bf16 v[72:75], a[112:115], v[144:147], v[72:75]
    s_add_u32 m0, s46, 53248
    v_exp_f32 v198, v198
    v_mfma_f32_16x16x32_bf16 v[72:75], a[116:119], v[148:151], v[72:75]
    buffer_load_dwordx4 v236, s[32:35], s43 offen offset:0 lds
    v_mfma_f32_16x16x32_bf16 v[104:107], a[116:119], v[156:159], v[104:107]
    v_exp_f32 v199, v199
    v_mfma_f32_16x16x32_bf16 v[104:107], a[112:115], v[152:155], v[104:107]
    ds_read_b64_tr_b16 a[90:91], v233 offset:4096
    v_cvt_pk_bf16_f32 v171, v198, v199
    v_mfma_f32_16x16x32_bf16 v[108:111], a[120:123], v[152:155], v[108:111]
    v_exp_f32 v200, v200
    v_mfma_f32_16x16x32_bf16 v[108:111], a[124:127], v[156:159], v[108:111]
    ds_read_b64_tr_b16 a[92:93], v233 offset:8192
    v_mul_f32 v244, v248, v252
    v_mfma_f32_16x16x32_bf16 v[76:79], a[124:127], v[148:151], v[76:79]
    v_exp_f32 v201, v201
    v_mfma_f32_16x16x32_bf16 v[76:79], a[120:123], v[144:147], v[76:79]
    ds_read_b64_tr_b16 a[94:95], v233 offset:12288
    v_cvt_pk_bf16_f32 v178, v200, v201
    v_mfma_f32_16x16x32_bf16 v[44:47], a[120:123], v[136:139], v[44:47]
    v_exp_f32 v202, v202
    v_mfma_f32_16x16x32_bf16 v[44:47], a[124:127], v[140:143], v[44:47]
    buffer_load_dwordx4 v237, s[32:35], s43 offen offset:1024 lds
    v_mfma_f32_16x16x32_bf16 v[12:15], a[124:127], v[132:135], v[12:15]
    v_exp_f32 v203, v203
    v_mfma_f32_16x16x32_bf16 v[12:15], a[120:123], v[128:131], v[12:15]
    v_cvt_pk_bf16_f32 v179, v202, v203
    v_cvt_pk_bf16_f32 v244, v244, v253
    v_smfmac_f32_16x16x64_bf16 a[132:135], a[144:147], v[136:143], v241
    v_accvgpr_read_b32 v249, a195
    v_mul_f32 v253, s57, v249
    s_waitcnt lgkmcnt(0)
    v_mfma_f32_16x16x32_bf16 v[192:195], a[64:67], a[0:3], v[208:211]
    v_exp_f32 v204, v204
    v_mfma_f32_16x16x32_bf16 v[192:195], a[68:71], a[4:7], v[192:195]
    ds_read_b128 a[96:99], v224 offset:12288
    v_accvgpr_read_b32 v248, a194
    v_mfma_f32_16x16x32_bf16 v[192:195], a[72:75], a[8:11], v[192:195]
    v_exp_f32 v205, v205
    v_mfma_f32_16x16x32_bf16 v[192:195], a[76:79], a[12:15], v[192:195]
    ds_read_b128 a[100:103], v225 offset:12288
    v_cvt_pk_bf16_f32 v186, v204, v205
    v_mfma_f32_16x16x32_bf16 v[196:199], a[76:79], a[28:31], v[212:215]
    v_exp_f32 v206, v206
    v_mfma_f32_16x16x32_bf16 v[196:199], a[72:75], a[24:27], v[196:199]
    ds_read_b128 a[104:107], v226 offset:12288
    v_mul_f32 v252, s57, v248
    v_mfma_f32_16x16x32_bf16 v[196:199], a[68:71], a[20:23], v[196:199]
    v_exp_f32 v207, v207
    v_mfma_f32_16x16x32_bf16 v[196:199], a[64:67], a[16:19], v[196:199]
    ds_read_b128 a[108:111], v227 offset:12288
    v_cvt_pk_bf16_f32 v187, v206, v207
    v_mfma_f32_16x16x32_bf16 v[200:203], a[64:67], a[32:35], v[216:219]
    v_exp_f32 v192, v192
    v_mfma_f32_16x16x32_bf16 v[200:203], a[68:71], a[36:39], v[200:203]
    ds_read_b64_tr_b16 a[112:113], v234 offset:0
    v_exp_f32 v253, v253
    v_mfma_f32_16x16x32_bf16 v[200:203], a[72:75], a[40:43], v[200:203]
    v_exp_f32 v193, v193
    v_mfma_f32_16x16x32_bf16 v[200:203], a[76:79], a[44:47], v[200:203]
    ds_read_b64_tr_b16 a[114:115], v234 offset:4096
    v_cvt_pk_bf16_f32 v164, v192, v193
    v_mfma_f32_16x16x32_bf16 v[204:207], a[76:79], a[60:63], v[220:223]
    v_exp_f32 v194, v194
    v_mfma_f32_16x16x32_bf16 v[204:207], a[72:75], a[56:59], v[204:207]
    buffer_load_dwordx4 v238, s[32:35], s43 offen offset:2048 lds
    v_mfma_f32_16x16x32_bf16 v[204:207], a[68:71], a[52:55], v[204:207]
    v_exp_f32 v195, v195
    v_mfma_f32_16x16x32_bf16 v[204:207], a[64:67], a[48:51], v[204:207]
    ds_read_b64_tr_b16 a[116:117], v234 offset:8192
    v_cvt_pk_bf16_f32 v165, v194, v195
    v_mfma_f32_16x16x32_bf16 v[16:19], a[80:83], v[128:131], v[16:19]
    v_exp_f32 v196, v196
    v_mfma_f32_16x16x32_bf16 v[16:19], a[84:87], v[132:135], v[16:19]
    ds_read_b64_tr_b16 a[118:119], v234 offset:12288
    v_add_f32 v253, 1.0, v253
    v_mfma_f32_16x16x32_bf16 v[48:51], a[84:87], v[140:143], v[48:51]
    v_exp_f32 v197, v197
    v_mfma_f32_16x16x32_bf16 v[48:51], a[80:83], v[136:139], v[48:51]
    ds_read_b64_tr_b16 a[120:121], v235 offset:0
    v_cvt_pk_bf16_f32 v172, v196, v197
    v_mfma_f32_16x16x32_bf16 v[80:83], a[80:83], v[144:147], v[80:83]
    v_exp_f32 v198, v198
    v_mfma_f32_16x16x32_bf16 v[80:83], a[84:87], v[148:151], v[80:83]
    buffer_load_dwordx4 v239, s[32:35], s43 offen offset:3072 lds
    v_mfma_f32_16x16x32_bf16 v[112:115], a[84:87], v[156:159], v[112:115]
    s_add_u32 s43, s43, 12288
    v_exp_f32 v199, v199
    v_mfma_f32_16x16x32_bf16 v[112:115], a[80:83], v[152:155], v[112:115]
    ds_read_b64_tr_b16 a[122:123], v235 offset:4096
    v_cvt_pk_bf16_f32 v173, v198, v199
    v_mfma_f32_16x16x32_bf16 v[116:119], a[88:91], v[152:155], v[116:119]
    v_exp_f32 v200, v200
    v_mfma_f32_16x16x32_bf16 v[116:119], a[92:95], v[156:159], v[116:119]
    ds_read_b64_tr_b16 a[124:125], v235 offset:8192
    v_rcp_f32 v253, v253
    v_mfma_f32_16x16x32_bf16 v[84:87], a[92:95], v[148:151], v[84:87]
    v_exp_f32 v201, v201
    v_mfma_f32_16x16x32_bf16 v[84:87], a[88:91], v[144:147], v[84:87]
    ds_read_b64_tr_b16 a[126:127], v235 offset:12288
    v_cvt_pk_bf16_f32 v180, v200, v201
    v_mfma_f32_16x16x32_bf16 v[52:55], a[88:91], v[136:139], v[52:55]
    s_mov_b32 m0, s58
    v_exp_f32 v202, v202
    v_mfma_f32_16x16x32_bf16 v[52:55], a[92:95], v[140:143], v[52:55]
    buffer_load_dwordx4 v255, s[60:63], s19 offen offset:1024 lds
    v_mfma_f32_16x16x32_bf16 v[20:23], a[92:95], v[132:135], v[20:23]
    s_add_u32 s19, s19, 64
    v_exp_f32 v203, v203
    v_mfma_f32_16x16x32_bf16 v[20:23], a[88:91], v[128:131], v[20:23]
    s_waitcnt vmcnt(18) lgkmcnt(0)
    v_cvt_pk_bf16_f32 v181, v202, v203
    v_mul_f32 v253, v249, v253
    v_smfmac_f32_16x16x64_bf16 a[136:139], a[144:147], v[144:151], v241
    s_barrier
    v_mfma_f32_16x16x32_bf16 v[192:195], a[96:99], a[0:3], v[208:211]
    v_exp_f32 v204, v204
    v_mfma_f32_16x16x32_bf16 v[192:195], a[100:103], a[4:7], v[192:195]
    ds_read_b128 a[64:67], v224 offset:16384
    v_exp_f32 v252, v252
    v_mfma_f32_16x16x32_bf16 v[192:195], a[104:107], a[8:11], v[192:195]
    v_exp_f32 v205, v205
    v_mfma_f32_16x16x32_bf16 v[192:195], a[108:111], a[12:15], v[192:195]
    ds_read_b128 a[68:71], v225 offset:16384
    v_cvt_pk_bf16_f32 v188, v204, v205
    v_mfma_f32_16x16x32_bf16 v[196:199], a[108:111], a[28:31], v[212:215]
    v_exp_f32 v206, v206
    v_mfma_f32_16x16x32_bf16 v[196:199], a[104:107], a[24:27], v[196:199]
    ds_read_b128 a[72:75], v226 offset:16384
    v_add_f32 v252, 1.0, v252
    v_mfma_f32_16x16x32_bf16 v[196:199], a[100:103], a[20:23], v[196:199]
    v_exp_f32 v207, v207
    v_mfma_f32_16x16x32_bf16 v[196:199], a[96:99], a[16:19], v[196:199]
    ds_read_b128 a[76:79], v227 offset:16384
    v_cvt_pk_bf16_f32 v189, v206, v207
    v_mfma_f32_16x16x32_bf16 v[200:203], a[96:99], a[32:35], v[216:219]
    v_exp_f32 v192, v192
    v_mfma_f32_16x16x32_bf16 v[200:203], a[100:103], a[36:39], v[200:203]
    ds_read_b64_tr_b16 a[80:81], v228 offset:16384
    v_rcp_f32 v252, v252
    v_mfma_f32_16x16x32_bf16 v[200:203], a[104:107], a[40:43], v[200:203]
    v_exp_f32 v193, v193
    v_mfma_f32_16x16x32_bf16 v[200:203], a[108:111], a[44:47], v[200:203]
    ds_read_b64_tr_b16 a[82:83], v228 offset:20480
    v_cvt_pk_bf16_f32 v166, v192, v193
    v_mfma_f32_16x16x32_bf16 v[204:207], a[108:111], a[60:63], v[220:223]
    v_exp_f32 v194, v194
    v_mfma_f32_16x16x32_bf16 v[204:207], a[104:107], a[56:59], v[204:207]
    v_mul_f32 v245, v248, v252
    v_cvt_pk_bf16_f32 v245, v245, v253
    v_mfma_f32_16x16x32_bf16 v[204:207], a[100:103], a[52:55], v[204:207]
    v_exp_f32 v195, v195
    v_mfma_f32_16x16x32_bf16 v[204:207], a[96:99], a[48:51], v[204:207]
    ds_read_b64_tr_b16 a[84:85], v228 offset:24576
    v_cvt_pk_bf16_f32 v167, v194, v195
    v_mfma_f32_16x16x32_bf16 v[24:27], a[112:115], v[128:131], v[24:27]
    v_exp_f32 v196, v196
    v_mfma_f32_16x16x32_bf16 v[24:27], a[116:119], v[132:135], v[24:27]
    ds_read_b64_tr_b16 a[86:87], v228 offset:28672
    v_accvgpr_read_b32 v249, a197
    v_mfma_f32_16x16x32_bf16 v[56:59], a[116:119], v[140:143], v[56:59]
    v_exp_f32 v197, v197
    v_mfma_f32_16x16x32_bf16 v[56:59], a[112:115], v[136:139], v[56:59]
    ds_read_b64_tr_b16 a[88:89], v229 offset:16384
    v_cvt_pk_bf16_f32 v174, v196, v197
    v_mfma_f32_16x16x32_bf16 v[88:91], a[112:115], v[144:147], v[88:91]
    s_add_u32 m0, s46, 0
    v_exp_f32 v198, v198
    v_mfma_f32_16x16x32_bf16 v[88:91], a[116:119], v[148:151], v[88:91]
    buffer_load_dwordx4 v236, s[32:35], s43 offen offset:0 lds
    v_mfma_f32_16x16x32_bf16 v[120:123], a[116:119], v[156:159], v[120:123]
    v_exp_f32 v199, v199
    v_mfma_f32_16x16x32_bf16 v[120:123], a[112:115], v[152:155], v[120:123]
    ds_read_b64_tr_b16 a[90:91], v229 offset:20480
    v_cvt_pk_bf16_f32 v175, v198, v199
    v_mfma_f32_16x16x32_bf16 v[124:127], a[120:123], v[152:155], v[124:127]
    v_exp_f32 v200, v200
    v_mfma_f32_16x16x32_bf16 v[124:127], a[124:127], v[156:159], v[124:127]
    ds_read_b64_tr_b16 a[92:93], v229 offset:24576
    v_mul_f32 v253, s57, v249
    v_mfma_f32_16x16x32_bf16 v[92:95], a[124:127], v[148:151], v[92:95]
    v_exp_f32 v201, v201
    v_mfma_f32_16x16x32_bf16 v[92:95], a[120:123], v[144:147], v[92:95]
    ds_read_b64_tr_b16 a[94:95], v229 offset:28672
    v_cvt_pk_bf16_f32 v182, v200, v201
    v_mfma_f32_16x16x32_bf16 v[60:63], a[120:123], v[136:139], v[60:63]
    v_exp_f32 v202, v202
    v_mfma_f32_16x16x32_bf16 v[60:63], a[124:127], v[140:143], v[60:63]
    buffer_load_dwordx4 v237, s[32:35], s43 offen offset:1024 lds
    v_mfma_f32_16x16x32_bf16 v[28:31], a[124:127], v[132:135], v[28:31]
    v_exp_f32 v203, v203
    v_mfma_f32_16x16x32_bf16 v[28:31], a[120:123], v[128:131], v[28:31]
    v_cvt_pk_bf16_f32 v183, v202, v203
    v_accvgpr_read_b32 v248, a196
    v_smfmac_f32_16x16x64_bf16 a[140:143], a[144:147], v[152:159], v241
    v_exp_f32 v253, v253
    s_waitcnt lgkmcnt(0)
    v_mfma_f32_16x16x32_bf16 v[192:195], a[64:67], a[0:3], v[208:211]
    v_exp_f32 v204, v204
    v_mfma_f32_16x16x32_bf16 v[192:195], a[68:71], a[4:7], v[192:195]
    ds_read_b128 a[96:99], v224 offset:20480
    v_add_f32 v253, 1.0, v253
    v_mfma_f32_16x16x32_bf16 v[192:195], a[72:75], a[8:11], v[192:195]
    v_exp_f32 v205, v205
    v_mfma_f32_16x16x32_bf16 v[192:195], a[76:79], a[12:15], v[192:195]
    ds_read_b128 a[100:103], v225 offset:20480
    v_cvt_pk_bf16_f32 v190, v204, v205
    v_mfma_f32_16x16x32_bf16 v[196:199], a[76:79], a[28:31], v[212:215]
    v_exp_f32 v206, v206
    v_mfma_f32_16x16x32_bf16 v[196:199], a[72:75], a[24:27], v[196:199]
    ds_read_b128 a[104:107], v226 offset:20480
    v_mul_f32 v252, s57, v248
    v_mfma_f32_16x16x32_bf16 v[196:199], a[68:71], a[20:23], v[196:199]
    v_exp_f32 v207, v207
    v_mfma_f32_16x16x32_bf16 v[196:199], a[64:67], a[16:19], v[196:199]
    ds_read_b128 a[108:111], v227 offset:20480
    v_cvt_pk_bf16_f32 v191, v206, v207
    v_mfma_f32_16x16x32_bf16 v[200:203], a[64:67], a[32:35], v[216:219]
K1_pg5:
    s_cbranch_execz K1_pg9
    v_exp_f32 v192, v192
    v_mfma_f32_16x16x32_bf16 v[200:203], a[68:71], a[36:39], v[200:203]
    ds_read_b64_tr_b16 a[112:113], v230 offset:16384
    v_rcp_f32 v253, v253
    v_mfma_f32_16x16x32_bf16 v[200:203], a[72:75], a[40:43], v[200:203]
    v_exp_f32 v193, v193
    v_mfma_f32_16x16x32_bf16 v[200:203], a[76:79], a[44:47], v[200:203]
    ds_read_b64_tr_b16 a[114:115], v230 offset:20480
    v_cvt_pk_bf16_f32 v128, v192, v193
    v_mfma_f32_16x16x32_bf16 v[204:207], a[76:79], a[60:63], v[220:223]
    v_exp_f32 v194, v194
    v_mfma_f32_16x16x32_bf16 v[204:207], a[72:75], a[56:59], v[204:207]
    buffer_load_dwordx4 v238, s[32:35], s43 offen offset:2048 lds
    v_mfma_f32_16x16x32_bf16 v[204:207], a[68:71], a[52:55], v[204:207]
    v_exp_f32 v195, v195
    v_mfma_f32_16x16x32_bf16 v[204:207], a[64:67], a[48:51], v[204:207]
    ds_read_b64_tr_b16 a[116:117], v230 offset:24576
    v_cvt_pk_bf16_f32 v129, v194, v195
    v_mfma_f32_16x16x32_bf16 v[0:3], a[80:83], v[160:163], v[0:3]
    v_exp_f32 v196, v196
    v_mfma_f32_16x16x32_bf16 v[0:3], a[84:87], v[164:167], v[0:3]
    ds_read_b64_tr_b16 a[118:119], v230 offset:28672
    v_mul_f32 v253, v249, v253
    v_mfma_f32_16x16x32_bf16 v[32:35], a[84:87], v[172:175], v[32:35]
    v_exp_f32 v197, v197
    v_mfma_f32_16x16x32_bf16 v[32:35], a[80:83], v[168:171], v[32:35]
    ds_read_b64_tr_b16 a[120:121], v231 offset:16384
    v_cvt_pk_bf16_f32 v136, v196, v197
    v_mfma_f32_16x16x32_bf16 v[64:67], a[80:83], v[176:179], v[64:67]
    v_exp_f32 v198, v198
    v_mfma_f32_16x16x32_bf16 v[64:67], a[84:87], v[180:183], v[64:67]
    buffer_load_dwordx4 v239, s[32:35], s43 offen offset:3072 lds
    v_mfma_f32_16x16x32_bf16 v[96:99], a[84:87], v[188:191], v[96:99]
    s_add_u32 s43, s43, 4096
    v_exp_f32 v199, v199
    v_mfma_f32_16x16x32_bf16 v[96:99], a[80:83], v[184:187], v[96:99]
    ds_read_b64_tr_b16 a[122:123], v231 offset:20480
    v_cvt_pk_bf16_f32 v137, v198, v199
    v_mfma_f32_16x16x32_bf16 v[100:103], a[88:91], v[184:187], v[100:103]
    v_exp_f32 v200, v200
    v_mfma_f32_16x16x32_bf16 v[100:103], a[92:95], v[188:191], v[100:103]
    ds_read_b64_tr_b16 a[124:125], v231 offset:24576
    v_exp_f32 v252, v252
    v_mfma_f32_16x16x32_bf16 v[68:71], a[92:95], v[180:183], v[68:71]
    v_exp_f32 v201, v201
    v_mfma_f32_16x16x32_bf16 v[68:71], a[88:91], v[176:179], v[68:71]
    ds_read_b64_tr_b16 a[126:127], v231 offset:28672
    v_cvt_pk_bf16_f32 v144, v200, v201
    v_mfma_f32_16x16x32_bf16 v[36:39], a[88:91], v[168:171], v[36:39]
    v_exp_f32 v202, v202
    v_mfma_f32_16x16x32_bf16 v[36:39], a[92:95], v[172:175], v[36:39]
    buffer_store_dwordx4 a[148:151], v240, s[4:7], s81 offen offset:0 sc1
    v_mfma_f32_16x16x32_bf16 v[4:7], a[92:95], v[164:167], v[4:7]
    v_exp_f32 v203, v203
    v_mfma_f32_16x16x32_bf16 v[4:7], a[88:91], v[160:163], v[4:7]
    v_cvt_pk_bf16_f32 v145, v202, v203
    v_add_f32 v252, 1.0, v252
    v_smfmac_f32_16x16x64_bf16 a[128:131], a[144:147], v[160:167], v241
    v_rcp_f32 v252, v252
    s_waitcnt lgkmcnt(0)
    v_mfma_f32_16x16x32_bf16 v[192:195], a[96:99], a[0:3], v[208:211]
    v_exp_f32 v204, v204
    v_mfma_f32_16x16x32_bf16 v[192:195], a[100:103], a[4:7], v[192:195]
    ds_read_b128 a[64:67], v224 offset:24576
    v_mul_f32 v246, v248, v252
    v_mfma_f32_16x16x32_bf16 v[192:195], a[104:107], a[8:11], v[192:195]
    v_exp_f32 v205, v205
    v_mfma_f32_16x16x32_bf16 v[192:195], a[108:111], a[12:15], v[192:195]
    ds_read_b128 a[68:71], v225 offset:24576
    v_cvt_pk_bf16_f32 v152, v204, v205
    v_mfma_f32_16x16x32_bf16 v[196:199], a[108:111], a[28:31], v[212:215]
    v_exp_f32 v206, v206
    v_mfma_f32_16x16x32_bf16 v[196:199], a[104:107], a[24:27], v[196:199]
    ds_read_b128 a[72:75], v226 offset:24576
    v_cvt_pk_bf16_f32 v246, v246, v253
    v_mfma_f32_16x16x32_bf16 v[196:199], a[100:103], a[20:23], v[196:199]
    v_exp_f32 v207, v207
    v_mfma_f32_16x16x32_bf16 v[196:199], a[96:99], a[16:19], v[196:199]
    ds_read_b128 a[76:79], v227 offset:24576
    v_cvt_pk_bf16_f32 v153, v206, v207
    v_mfma_f32_16x16x32_bf16 v[200:203], a[96:99], a[32:35], v[216:219]
    v_exp_f32 v192, v192
    v_mfma_f32_16x16x32_bf16 v[200:203], a[100:103], a[36:39], v[200:203]
    ds_read_b64_tr_b16 a[80:81], v232 offset:16384
    v_accvgpr_read_b32 v249, a199
    v_mfma_f32_16x16x32_bf16 v[200:203], a[104:107], a[40:43], v[200:203]
    v_exp_f32 v193, v193
    v_mfma_f32_16x16x32_bf16 v[200:203], a[108:111], a[44:47], v[200:203]
    ds_read_b64_tr_b16 a[82:83], v232 offset:20480
    v_cvt_pk_bf16_f32 v130, v192, v193
    v_mfma_f32_16x16x32_bf16 v[204:207], a[108:111], a[60:63], v[220:223]
    s_add_u32 m0, s46, 4096
    v_exp_f32 v194, v194
    v_mfma_f32_16x16x32_bf16 v[204:207], a[104:107], a[56:59], v[204:207]
    buffer_load_dwordx4 v236, s[32:35], s43 offen offset:0 lds
    v_mfma_f32_16x16x32_bf16 v[204:207], a[100:103], a[52:55], v[204:207]
    v_exp_f32 v195, v195
    v_mfma_f32_16x16x32_bf16 v[204:207], a[96:99], a[48:51], v[204:207]
    ds_read_b64_tr_b16 a[84:85], v232 offset:24576
    v_cvt_pk_bf16_f32 v131, v194, v195
    v_mfma_f32_16x16x32_bf16 v[8:11], a[112:115], v[160:163], v[8:11]
    v_exp_f32 v196, v196
    v_mfma_f32_16x16x32_bf16 v[8:11], a[116:119], v[164:167], v[8:11]
    ds_read_b64_tr_b16 a[86:87], v232 offset:28672
    v_mul_f32 v253, s57, v249
    v_mfma_f32_16x16x32_bf16 v[40:43], a[116:119], v[172:175], v[40:43]
    v_exp_f32 v197, v197
    v_mfma_f32_16x16x32_bf16 v[40:43], a[112:115], v[168:171], v[40:43]
    ds_read_b64_tr_b16 a[88:89], v233 offset:16384
    v_cvt_pk_bf16_f32 v138, v196, v197
    v_mfma_f32_16x16x32_bf16 v[72:75], a[112:115], v[176:179], v[72:75]
    v_exp_f32 v198, v198
    v_mfma_f32_16x16x32_bf16 v[72:75], a[116:119], v[180:183], v[72:75]
    buffer_load_dwordx4 v237, s[32:35], s43 offen offset:1024 lds
    v_mfma_f32_16x16x32_bf16 v[104:107], a[116:119], v[188:191], v[104:107]
    v_exp_f32 v199, v199
    v_mfma_f32_16x16x32_bf16 v[104:107], a[112:115], v[184:187], v[104:107]
    ds_read_b64_tr_b16 a[90:91], v233 offset:20480
    v_cvt_pk_bf16_f32 v139, v198, v199
    v_mfma_f32_16x16x32_bf16 v[108:111], a[120:123], v[184:187], v[108:111]
    v_exp_f32 v200, v200
    v_mfma_f32_16x16x32_bf16 v[108:111], a[124:127], v[188:191], v[108:111]
    ds_read_b64_tr_b16 a[92:93], v233 offset:24576
    v_accvgpr_read_b32 v248, a198
    v_mfma_f32_16x16x32_bf16 v[76:79], a[124:127], v[180:183], v[76:79]
    v_exp_f32 v201, v201
    v_mfma_f32_16x16x32_bf16 v[76:79], a[120:123], v[176:179], v[76:79]
    ds_read_b64_tr_b16 a[94:95], v233 offset:28672
    v_cvt_pk_bf16_f32 v146, v200, v201
    v_mfma_f32_16x16x32_bf16 v[44:47], a[120:123], v[168:171], v[44:47]
    v_exp_f32 v202, v202
    v_mfma_f32_16x16x32_bf16 v[44:47], a[124:127], v[172:175], v[44:47]
    buffer_store_dwordx4 a[148:151], v240, s[4:7], s81 offen offset:1024 sc1
    v_mfma_f32_16x16x32_bf16 v[12:15], a[124:127], v[164:167], v[12:15]
    v_exp_f32 v203, v203
    v_mfma_f32_16x16x32_bf16 v[12:15], a[120:123], v[160:163], v[12:15]
    v_cvt_pk_bf16_f32 v147, v202, v203
    v_mul_f32 v252, s57, v248
    v_smfmac_f32_16x16x64_bf16 a[132:135], a[144:147], v[168:175], v241
    v_exp_f32 v253, v253
    s_waitcnt lgkmcnt(0)
    v_mfma_f32_16x16x32_bf16 v[192:195], a[64:67], a[0:3], v[208:211]
    v_exp_f32 v204, v204
    v_mfma_f32_16x16x32_bf16 v[192:195], a[68:71], a[4:7], v[192:195]
    ds_read_b128 a[96:99], v224 offset:28672
    v_add_f32 v253, 1.0, v253
    v_mfma_f32_16x16x32_bf16 v[192:195], a[72:75], a[8:11], v[192:195]
    v_exp_f32 v205, v205
    v_mfma_f32_16x16x32_bf16 v[192:195], a[76:79], a[12:15], v[192:195]
    ds_read_b128 a[100:103], v225 offset:28672
    v_cvt_pk_bf16_f32 v154, v204, v205
    v_mfma_f32_16x16x32_bf16 v[196:199], a[76:79], a[28:31], v[212:215]
    v_exp_f32 v206, v206
    v_mfma_f32_16x16x32_bf16 v[196:199], a[72:75], a[24:27], v[196:199]
    ds_read_b128 a[104:107], v226 offset:28672
    v_rcp_f32 v253, v253
    v_mfma_f32_16x16x32_bf16 v[196:199], a[68:71], a[20:23], v[196:199]
    v_exp_f32 v207, v207
    v_mfma_f32_16x16x32_bf16 v[196:199], a[64:67], a[16:19], v[196:199]
    ds_read_b128 a[108:111], v227 offset:28672
    v_cvt_pk_bf16_f32 v155, v206, v207
    v_mfma_f32_16x16x32_bf16 v[200:203], a[64:67], a[32:35], v[216:219]
    v_exp_f32 v192, v192
    v_mfma_f32_16x16x32_bf16 v[200:203], a[68:71], a[36:39], v[200:203]
    ds_read_b64_tr_b16 a[112:113], v234 offset:16384
    v_mul_f32 v253, v249, v253
    v_mfma_f32_16x16x32_bf16 v[200:203], a[72:75], a[40:43], v[200:203]
    v_exp_f32 v193, v193
    v_mfma_f32_16x16x32_bf16 v[200:203], a[76:79], a[44:47], v[200:203]
    ds_read_b64_tr_b16 a[114:115], v234 offset:20480
    v_cvt_pk_bf16_f32 v132, v192, v193
    v_mfma_f32_16x16x32_bf16 v[204:207], a[76:79], a[60:63], v[220:223]
    v_exp_f32 v194, v194
    v_mfma_f32_16x16x32_bf16 v[204:207], a[72:75], a[56:59], v[204:207]
    v_exp_f32 v252, v252
    v_mfma_f32_16x16x32_bf16 v[204:207], a[68:71], a[52:55], v[204:207]
    v_exp_f32 v195, v195
    v_mfma_f32_16x16x32_bf16 v[204:207], a[64:67], a[48:51], v[204:207]
    ds_read_b64_tr_b16 a[116:117], v234 offset:24576
    v_cvt_pk_bf16_f32 v133, v194, v195
    v_mfma_f32_16x16x32_bf16 v[16:19], a[80:83], v[160:163], v[16:19]
    v_exp_f32 v196, v196
    v_mfma_f32_16x16x32_bf16 v[16:19], a[84:87], v[164:167], v[16:19]
    ds_read_b64_tr_b16 a[118:119], v234 offset:28672
    v_add_f32 v252, 1.0, v252
    v_mfma_f32_16x16x32_bf16 v[48:51], a[84:87], v[172:175], v[48:51]
    v_exp_f32 v197, v197
    v_mfma_f32_16x16x32_bf16 v[48:51], a[80:83], v[168:171], v[48:51]
    ds_read_b64_tr_b16 a[120:121], v235 offset:16384
    v_cvt_pk_bf16_f32 v140, v196, v197
    v_mfma_f32_16x16x32_bf16 v[80:83], a[80:83], v[176:179], v[80:83]
    v_exp_f32 v198, v198
    v_mfma_f32_16x16x32_bf16 v[80:83], a[84:87], v[180:183], v[80:83]
    buffer_load_dwordx4 v238, s[32:35], s43 offen offset:2048 lds
    v_mfma_f32_16x16x32_bf16 v[112:115], a[84:87], v[188:191], v[112:115]
    v_exp_f32 v199, v199
    v_mfma_f32_16x16x32_bf16 v[112:115], a[80:83], v[184:187], v[112:115]
    ds_read_b64_tr_b16 a[122:123], v235 offset:20480
    v_cvt_pk_bf16_f32 v141, v198, v199
    v_mfma_f32_16x16x32_bf16 v[116:119], a[88:91], v[184:187], v[116:119]
    v_exp_f32 v200, v200
    v_mfma_f32_16x16x32_bf16 v[116:119], a[92:95], v[188:191], v[116:119]
    ds_read_b64_tr_b16 a[124:125], v235 offset:24576
    v_rcp_f32 v252, v252
    v_mfma_f32_16x16x32_bf16 v[84:87], a[92:95], v[180:183], v[84:87]
    v_exp_f32 v201, v201
    v_mfma_f32_16x16x32_bf16 v[84:87], a[88:91], v[176:179], v[84:87]
    ds_read_b64_tr_b16 a[126:127], v235 offset:28672
    v_cvt_pk_bf16_f32 v148, v200, v201
    v_mfma_f32_16x16x32_bf16 v[52:55], a[88:91], v[168:171], v[52:55]
    v_exp_f32 v202, v202
    v_mfma_f32_16x16x32_bf16 v[52:55], a[92:95], v[172:175], v[52:55]
    buffer_load_dwordx4 v239, s[32:35], s43 offen offset:3072 lds
    v_mfma_f32_16x16x32_bf16 v[20:23], a[92:95], v[164:167], v[20:23]
    s_add_u32 s43, s43, 12288
    v_exp_f32 v203, v203
    v_mfma_f32_16x16x32_bf16 v[20:23], a[88:91], v[160:163], v[20:23]
    s_waitcnt vmcnt(20) lgkmcnt(0)
    v_cvt_pk_bf16_f32 v149, v202, v203
    v_mul_f32 v247, v248, v252
    v_smfmac_f32_16x16x64_bf16 a[136:139], a[144:147], v[176:183], v241
    s_barrier
    v_mfma_f32_16x16x32_bf16 v[192:195], a[96:99], a[0:3], v[208:211]
    v_exp_f32 v204, v204
    v_mfma_f32_16x16x32_bf16 v[192:195], a[100:103], a[4:7], v[192:195]
    ds_read_b128 a[64:67], v224 offset:32768
    v_cvt_pk_bf16_f32 v247, v247, v253
    v_mfma_f32_16x16x32_bf16 v[192:195], a[104:107], a[8:11], v[192:195]
    v_exp_f32 v205, v205
    v_mfma_f32_16x16x32_bf16 v[192:195], a[108:111], a[12:15], v[192:195]
    ds_read_b128 a[68:71], v225 offset:32768
    v_cvt_pk_bf16_f32 v156, v204, v205
    v_mfma_f32_16x16x32_bf16 v[196:199], a[108:111], a[28:31], v[212:215]
    v_exp_f32 v206, v206
    v_mfma_f32_16x16x32_bf16 v[196:199], a[104:107], a[24:27], v[196:199]
    ds_read_b128 a[72:75], v226 offset:32768
    v_accvgpr_read_b32 v249, a201
    v_mfma_f32_16x16x32_bf16 v[196:199], a[100:103], a[20:23], v[196:199]
    v_exp_f32 v207, v207
    v_mfma_f32_16x16x32_bf16 v[196:199], a[96:99], a[16:19], v[196:199]
    ds_read_b128 a[76:79], v227 offset:32768
    v_cvt_pk_bf16_f32 v157, v206, v207
    v_mfma_f32_16x16x32_bf16 v[200:203], a[96:99], a[32:35], v[216:219]
    v_exp_f32 v192, v192
    v_mfma_f32_16x16x32_bf16 v[200:203], a[100:103], a[36:39], v[200:203]
    ds_read_b64_tr_b16 a[80:81], v228 offset:32768
    v_mul_f32 v253, s57, v249
    v_mfma_f32_16x16x32_bf16 v[200:203], a[104:107], a[40:43], v[200:203]
    v_exp_f32 v193, v193
    v_mfma_f32_16x16x32_bf16 v[200:203], a[108:111], a[44:47], v[200:203]
    ds_read_b64_tr_b16 a[82:83], v228 offset:36864
    v_cvt_pk_bf16_f32 v134, v192, v193
    v_mfma_f32_16x16x32_bf16 v[204:207], a[108:111], a[60:63], v[220:223]
    v_exp_f32 v194, v194
    v_mfma_f32_16x16x32_bf16 v[204:207], a[104:107], a[56:59], v[204:207]
    v_exp_f32 v253, v253
    v_mfma_f32_16x16x32_bf16 v[204:207], a[100:103], a[52:55], v[204:207]
    v_exp_f32 v195, v195
    v_mfma_f32_16x16x32_bf16 v[204:207], a[96:99], a[48:51], v[204:207]
    ds_read_b64_tr_b16 a[84:85], v228 offset:40960
    v_cvt_pk_bf16_f32 v135, v194, v195
    v_mfma_f32_16x16x32_bf16 v[24:27], a[112:115], v[160:163], v[24:27]
    v_exp_f32 v196, v196
    v_mfma_f32_16x16x32_bf16 v[24:27], a[116:119], v[164:167], v[24:27]
    ds_read_b64_tr_b16 a[86:87], v228 offset:45056
    v_add_f32 v253, 1.0, v253
    v_mfma_f32_16x16x32_bf16 v[56:59], a[116:119], v[172:175], v[56:59]
    v_exp_f32 v197, v197
    v_mfma_f32_16x16x32_bf16 v[56:59], a[112:115], v[168:171], v[56:59]
    ds_read_b64_tr_b16 a[88:89], v229 offset:32768
    v_cvt_pk_bf16_f32 v142, v196, v197
    v_mfma_f32_16x16x32_bf16 v[88:91], a[112:115], v[176:179], v[88:91]
    s_add_u32 m0, s46, 16384
    v_exp_f32 v198, v198
    v_mfma_f32_16x16x32_bf16 v[88:91], a[116:119], v[180:183], v[88:91]
    buffer_load_dwordx4 v236, s[32:35], s43 offen offset:0 lds
    v_mfma_f32_16x16x32_bf16 v[120:123], a[116:119], v[188:191], v[120:123]
    v_exp_f32 v199, v199
    v_mfma_f32_16x16x32_bf16 v[120:123], a[112:115], v[184:187], v[120:123]
    ds_read_b64_tr_b16 a[90:91], v229 offset:36864
    v_cvt_pk_bf16_f32 v143, v198, v199
    v_mfma_f32_16x16x32_bf16 v[124:127], a[120:123], v[184:187], v[124:127]
    v_exp_f32 v200, v200
    v_mfma_f32_16x16x32_bf16 v[124:127], a[124:127], v[188:191], v[124:127]
    ds_read_b64_tr_b16 a[92:93], v229 offset:40960
    v_accvgpr_read_b32 v248, a200
    v_mfma_f32_16x16x32_bf16 v[92:95], a[124:127], v[180:183], v[92:95]
    v_exp_f32 v201, v201
    v_mfma_f32_16x16x32_bf16 v[92:95], a[120:123], v[176:179], v[92:95]
    ds_read_b64_tr_b16 a[94:95], v229 offset:45056
    v_cvt_pk_bf16_f32 v150, v200, v201
    v_mfma_f32_16x16x32_bf16 v[60:63], a[120:123], v[168:171], v[60:63]
    v_exp_f32 v202, v202
    v_mfma_f32_16x16x32_bf16 v[60:63], a[124:127], v[172:175], v[60:63]
    buffer_load_dwordx4 v237, s[32:35], s43 offen offset:1024 lds
    v_mfma_f32_16x16x32_bf16 v[28:31], a[124:127], v[164:167], v[28:31]
    v_exp_f32 v203, v203
    v_mfma_f32_16x16x32_bf16 v[28:31], a[120:123], v[160:163], v[28:31]
    buffer_store_dwordx4 v[244:247], v240, s[36:39], s56 offen offset:0 sc1
    v_cvt_pk_bf16_f32 v151, v202, v203
    v_smfmac_f32_16x16x64_bf16 a[140:143], a[144:147], v[184:191], v241
    v_rcp_f32 v253, v253
    s_waitcnt lgkmcnt(0)
    v_mfma_f32_16x16x32_bf16 v[192:195], a[64:67], a[0:3], v[208:211]
    v_exp_f32 v204, v204
    v_mfma_f32_16x16x32_bf16 v[192:195], a[68:71], a[4:7], v[192:195]
    ds_read_b128 a[96:99], v224 offset:36864
    v_mul_f32 v252, s57, v248
    v_mfma_f32_16x16x32_bf16 v[192:195], a[72:75], a[8:11], v[192:195]
    v_exp_f32 v205, v205
    v_mfma_f32_16x16x32_bf16 v[192:195], a[76:79], a[12:15], v[192:195]
    ds_read_b128 a[100:103], v225 offset:36864
    v_cvt_pk_bf16_f32 v158, v204, v205
    v_mfma_f32_16x16x32_bf16 v[196:199], a[76:79], a[28:31], v[212:215]
    v_exp_f32 v206, v206
    v_mfma_f32_16x16x32_bf16 v[196:199], a[72:75], a[24:27], v[196:199]
    ds_read_b128 a[104:107], v226 offset:36864
    v_mul_f32 v253, v249, v253
    v_mfma_f32_16x16x32_bf16 v[196:199], a[68:71], a[20:23], v[196:199]
    v_exp_f32 v207, v207
    v_mfma_f32_16x16x32_bf16 v[196:199], a[64:67], a[16:19], v[196:199]
    ds_read_b128 a[108:111], v227 offset:36864
    v_cvt_pk_bf16_f32 v159, v206, v207
    v_mfma_f32_16x16x32_bf16 v[200:203], a[64:67], a[32:35], v[216:219]
    v_exp_f32 v192, v192
    v_mfma_f32_16x16x32_bf16 v[200:203], a[68:71], a[36:39], v[200:203]
    ds_read_b64_tr_b16 a[112:113], v230 offset:32768
    v_exp_f32 v252, v252
    v_mfma_f32_16x16x32_bf16 v[200:203], a[72:75], a[40:43], v[200:203]
    v_exp_f32 v193, v193
    v_mfma_f32_16x16x32_bf16 v[200:203], a[76:79], a[44:47], v[200:203]
    ds_read_b64_tr_b16 a[114:115], v230 offset:36864
    v_cvt_pk_bf16_f32 v160, v192, v193
    v_mfma_f32_16x16x32_bf16 v[204:207], a[76:79], a[60:63], v[220:223]
    v_exp_f32 v194, v194
    v_mfma_f32_16x16x32_bf16 v[204:207], a[72:75], a[56:59], v[204:207]
    v_add_f32 v252, 1.0, v252
    v_mfma_f32_16x16x32_bf16 v[204:207], a[68:71], a[52:55], v[204:207]
    v_exp_f32 v195, v195
    v_mfma_f32_16x16x32_bf16 v[204:207], a[64:67], a[48:51], v[204:207]
    ds_read_b64_tr_b16 a[116:117], v230 offset:40960
    v_cvt_pk_bf16_f32 v161, v194, v195
    v_mfma_f32_16x16x32_bf16 v[0:3], a[80:83], v[128:131], v[0:3]
    v_exp_f32 v196, v196
    v_mfma_f32_16x16x32_bf16 v[0:3], a[84:87], v[132:135], v[0:3]
    ds_read_b64_tr_b16 a[118:119], v230 offset:45056
    v_rcp_f32 v252, v252
    v_mfma_f32_16x16x32_bf16 v[32:35], a[84:87], v[140:143], v[32:35]
    v_exp_f32 v197, v197
    v_mfma_f32_16x16x32_bf16 v[32:35], a[80:83], v[136:139], v[32:35]
    ds_read_b64_tr_b16 a[120:121], v231 offset:32768
    v_cvt_pk_bf16_f32 v168, v196, v197
    v_mfma_f32_16x16x32_bf16 v[64:67], a[80:83], v[144:147], v[64:67]
    v_exp_f32 v198, v198
    v_mfma_f32_16x16x32_bf16 v[64:67], a[84:87], v[148:151], v[64:67]
    buffer_load_dwordx4 v238, s[32:35], s43 offen offset:2048 lds
    v_mfma_f32_16x16x32_bf16 v[96:99], a[84:87], v[156:159], v[96:99]
    v_exp_f32 v199, v199
    v_mfma_f32_16x16x32_bf16 v[96:99], a[80:83], v[152:155], v[96:99]
    ds_read_b64_tr_b16 a[122:123], v231 offset:36864
    v_cvt_pk_bf16_f32 v169, v198, v199
    v_mfma_f32_16x16x32_bf16 v[100:103], a[88:91], v[152:155], v[100:103]
    v_exp_f32 v200, v200
    v_mfma_f32_16x16x32_bf16 v[100:103], a[92:95], v[156:159], v[100:103]
    ds_read_b64_tr_b16 a[124:125], v231 offset:40960
    v_mul_f32 v244, v248, v252
    v_mfma_f32_16x16x32_bf16 v[68:71], a[92:95], v[148:151], v[68:71]
    v_exp_f32 v201, v201
    v_mfma_f32_16x16x32_bf16 v[68:71], a[88:91], v[144:147], v[68:71]
    ds_read_b64_tr_b16 a[126:127], v231 offset:45056
    v_cvt_pk_bf16_f32 v176, v200, v201
    v_mfma_f32_16x16x32_bf16 v[36:39], a[88:91], v[136:139], v[36:39]
    v_exp_f32 v202, v202
    v_mfma_f32_16x16x32_bf16 v[36:39], a[92:95], v[140:143], v[36:39]
    buffer_load_dwordx4 v239, s[32:35], s43 offen offset:3072 lds
    v_mfma_f32_16x16x32_bf16 v[4:7], a[92:95], v[132:135], v[4:7]
    s_add_u32 s43, s43, 4096
    v_exp_f32 v203, v203
    v_mfma_f32_16x16x32_bf16 v[4:7], a[88:91], v[128:131], v[4:7]
    v_cvt_pk_bf16_f32 v177, v202, v203
    v_cvt_pk_bf16_f32 v244, v244, v253
    v_smfmac_f32_16x16x64_bf16 a[128:131], a[144:147], v[128:135], v241
    v_accvgpr_read_b32 v249, a203
    v_mul_f32 v253, s57, v249
    s_waitcnt lgkmcnt(0)
    v_mfma_f32_16x16x32_bf16 v[192:195], a[96:99], a[0:3], v[208:211]
    v_exp_f32 v204, v204
    v_mfma_f32_16x16x32_bf16 v[192:195], a[100:103], a[4:7], v[192:195]
    ds_read_b128 a[64:67], v224 offset:40960
    v_accvgpr_read_b32 v248, a202
    v_mfma_f32_16x16x32_bf16 v[192:195], a[104:107], a[8:11], v[192:195]
    v_exp_f32 v205, v205
    v_mfma_f32_16x16x32_bf16 v[192:195], a[108:111], a[12:15], v[192:195]
    ds_read_b128 a[68:71], v225 offset:40960
    v_cvt_pk_bf16_f32 v184, v204, v205
    v_mfma_f32_16x16x32_bf16 v[196:199], a[108:111], a[28:31], v[212:215]
    v_exp_f32 v206, v206
    v_mfma_f32_16x16x32_bf16 v[196:199], a[104:107], a[24:27], v[196:199]
    ds_read_b128 a[72:75], v226 offset:40960
    v_mul_f32 v252, s57, v248
    v_mfma_f32_16x16x32_bf16 v[196:199], a[100:103], a[20:23], v[196:199]
    v_exp_f32 v207, v207
    v_mfma_f32_16x16x32_bf16 v[196:199], a[96:99], a[16:19], v[196:199]
    ds_read_b128 a[76:79], v227 offset:40960
    v_cvt_pk_bf16_f32 v185, v206, v207
    v_mfma_f32_16x16x32_bf16 v[200:203], a[96:99], a[32:35], v[216:219]
    v_exp_f32 v192, v192
    v_mfma_f32_16x16x32_bf16 v[200:203], a[100:103], a[36:39], v[200:203]
    ds_read_b64_tr_b16 a[80:81], v232 offset:32768
    v_exp_f32 v253, v253
    v_mfma_f32_16x16x32_bf16 v[200:203], a[104:107], a[40:43], v[200:203]
    v_exp_f32 v193, v193
    v_mfma_f32_16x16x32_bf16 v[200:203], a[108:111], a[44:47], v[200:203]
    ds_read_b64_tr_b16 a[82:83], v232 offset:36864
    v_cvt_pk_bf16_f32 v162, v192, v193
    v_mfma_f32_16x16x32_bf16 v[204:207], a[108:111], a[60:63], v[220:223]
    v_exp_f32 v194, v194
    v_mfma_f32_16x16x32_bf16 v[204:207], a[104:107], a[56:59], v[204:207]
    ds_read_b64_tr_b16 a[84:85], v232 offset:40960
    v_add_f32 v253, 1.0, v253
    v_mfma_f32_16x16x32_bf16 v[204:207], a[100:103], a[52:55], v[204:207]
    v_exp_f32 v195, v195
    v_mfma_f32_16x16x32_bf16 v[204:207], a[96:99], a[48:51], v[204:207]
    ds_read_b64_tr_b16 a[86:87], v232 offset:45056
    v_cvt_pk_bf16_f32 v163, v194, v195
    v_mfma_f32_16x16x32_bf16 v[8:11], a[112:115], v[128:131], v[8:11]
    v_exp_f32 v196, v196
    v_mfma_f32_16x16x32_bf16 v[8:11], a[116:119], v[132:135], v[8:11]
    ds_read_b64_tr_b16 a[88:89], v233 offset:32768
    v_rcp_f32 v253, v253
    v_mfma_f32_16x16x32_bf16 v[40:43], a[116:119], v[140:143], v[40:43]
    v_exp_f32 v197, v197
    v_mfma_f32_16x16x32_bf16 v[40:43], a[112:115], v[136:139], v[40:43]
    ds_read_b64_tr_b16 a[90:91], v233 offset:36864
    v_cvt_pk_bf16_f32 v170, v196, v197
    v_mfma_f32_16x16x32_bf16 v[72:75], a[112:115], v[144:147], v[72:75]
    v_exp_f32 v198, v198
    v_mfma_f32_16x16x32_bf16 v[72:75], a[116:119], v[148:151], v[72:75]
    ds_read_b64_tr_b16 a[92:93], v233 offset:40960
    v_mul_f32 v253, v249, v253
    v_mfma_f32_16x16x32_bf16 v[104:107], a[116:119], v[156:159], v[104:107]
    v_exp_f32 v199, v199
    v_mfma_f32_16x16x32_bf16 v[104:107], a[112:115], v[152:155], v[104:107]
    ds_read_b64_tr_b16 a[94:95], v233 offset:45056
    v_cvt_pk_bf16_f32 v171, v198, v199
    v_mfma_f32_16x16x32_bf16 v[108:111], a[120:123], v[152:155], v[108:111]
    s_waitcnt vmcnt(15)
    v_exp_f32 v200, v200
    v_mfma_f32_16x16x32_bf16 v[108:111], a[124:127], v[156:159], v[108:111]
    ds_read_b64_tr_b16 a[152:153], v242 offset:0
    v_exp_f32 v252, v252
    v_mfma_f32_16x16x32_bf16 v[76:79], a[124:127], v[148:151], v[76:79]
    v_exp_f32 v201, v201
    v_mfma_f32_16x16x32_bf16 v[76:79], a[120:123], v[144:147], v[76:79]
    ds_read_b64_tr_b16 a[154:155], v242 offset:1024
    v_cvt_pk_bf16_f32 v178, v200, v201
    v_mfma_f32_16x16x32_bf16 v[44:47], a[120:123], v[136:139], v[44:47]
    s_add_u32 m0, s46, 20480
    v_exp_f32 v202, v202
    v_mfma_f32_16x16x32_bf16 v[44:47], a[124:127], v[140:143], v[44:47]
    buffer_load_dwordx4 v236, s[32:35], s43 offen offset:0 lds
    v_mfma_f32_16x16x32_bf16 v[12:15], a[124:127], v[132:135], v[12:15]
    v_exp_f32 v203, v203
    v_mfma_f32_16x16x32_bf16 v[12:15], a[120:123], v[128:131], v[12:15]
    v_cvt_pk_bf16_f32 v179, v202, v203
    v_add_f32 v252, 1.0, v252
    v_smfmac_f32_16x16x64_bf16 a[132:135], a[144:147], v[136:143], v241
    buffer_load_dwordx4 v237, s[32:35], s43 offen offset:1024 lds
    s_waitcnt lgkmcnt(0)
    v_mfma_f32_16x16x32_bf16 v[192:195], a[64:67], a[0:3], v[208:211]
    v_exp_f32 v204, v204
    v_mfma_f32_16x16x32_bf16 v[192:195], a[68:71], a[4:7], v[192:195]
    ds_read_b128 a[96:99], v224 offset:45056
    v_rcp_f32 v252, v252
    v_mfma_f32_16x16x32_bf16 v[192:195], a[72:75], a[8:11], v[192:195]
    v_exp_f32 v205, v205
    v_mfma_f32_16x16x32_bf16 v[192:195], a[76:79], a[12:15], v[192:195]
    ds_read_b128 a[100:103], v225 offset:45056
    v_cvt_pk_bf16_f32 v186, v204, v205
    v_mfma_f32_16x16x32_bf16 v[196:199], a[76:79], a[28:31], v[212:215]
    v_exp_f32 v206, v206
    v_mfma_f32_16x16x32_bf16 v[196:199], a[72:75], a[24:27], v[196:199]
    ds_read_b128 a[104:107], v226 offset:45056
    v_mul_f32 v245, v248, v252
    v_mfma_f32_16x16x32_bf16 v[196:199], a[68:71], a[20:23], v[196:199]
    v_exp_f32 v207, v207
    v_mfma_f32_16x16x32_bf16 v[196:199], a[64:67], a[16:19], v[196:199]
    ds_read_b128 a[108:111], v227 offset:45056
    v_cvt_pk_bf16_f32 v187, v206, v207
    v_mfma_f32_16x16x32_bf16 v[200:203], a[64:67], a[32:35], v[216:219]
    v_exp_f32 v192, v192
    v_mfma_f32_16x16x32_bf16 v[200:203], a[68:71], a[36:39], v[200:203]
    ds_read_b64_tr_b16 a[112:113], v234 offset:32768
    v_cvt_pk_bf16_f32 v245, v245, v253
    v_mfma_f32_16x16x32_bf16 v[200:203], a[72:75], a[40:43], v[200:203]
    v_exp_f32 v193, v193
    v_mfma_f32_16x16x32_bf16 v[200:203], a[76:79], a[44:47], v[200:203]
    ds_read_b64_tr_b16 a[114:115], v234 offset:36864
    v_cvt_pk_bf16_f32 v164, v192, v193
    v_mfma_f32_16x16x32_bf16 v[204:207], a[76:79], a[60:63], v[220:223]
    v_exp_f32 v194, v194
    v_mfma_f32_16x16x32_bf16 v[204:207], a[72:75], a[56:59], v[204:207]
    buffer_load_dwordx4 v238, s[32:35], s43 offen offset:2048 lds
    v_mfma_f32_16x16x32_bf16 v[204:207], a[68:71], a[52:55], v[204:207]
    v_exp_f32 v195, v195
    v_mfma_f32_16x16x32_bf16 v[204:207], a[64:67], a[48:51], v[204:207]
    ds_read_b64_tr_b16 a[116:117], v234 offset:40960
    v_cvt_pk_bf16_f32 v165, v194, v195
    v_mfma_f32_16x16x32_bf16 v[16:19], a[80:83], v[128:131], v[16:19]
    v_exp_f32 v196, v196
    v_mfma_f32_16x16x32_bf16 v[16:19], a[84:87], v[132:135], v[16:19]
    ds_read_b64_tr_b16 a[118:119], v234 offset:45056
    v_accvgpr_read_b32 v249, a205
    v_mfma_f32_16x16x32_bf16 v[48:51], a[84:87], v[140:143], v[48:51]
    v_exp_f32 v197, v197
    v_mfma_f32_16x16x32_bf16 v[48:51], a[80:83], v[136:139], v[48:51]
    ds_read_b64_tr_b16 a[120:121], v235 offset:32768
    v_cvt_pk_bf16_f32 v172, v196, v197
    v_mfma_f32_16x16x32_bf16 v[80:83], a[80:83], v[144:147], v[80:83]
    v_exp_f32 v198, v198
    v_mfma_f32_16x16x32_bf16 v[80:83], a[84:87], v[148:151], v[80:83]
    buffer_load_dwordx4 v239, s[32:35], s43 offen offset:3072 lds
    v_mfma_f32_16x16x32_bf16 v[112:115], a[84:87], v[156:159], v[112:115]
    s_add_u32 s43, s43, 12288
    v_exp_f32 v199, v199
    v_mfma_f32_16x16x32_bf16 v[112:115], a[80:83], v[152:155], v[112:115]
    ds_read_b64_tr_b16 a[122:123], v235 offset:36864
    v_cvt_pk_bf16_f32 v173, v198, v199
    v_mfma_f32_16x16x32_bf16 v[116:119], a[88:91], v[152:155], v[116:119]
    v_exp_f32 v200, v200
    v_mfma_f32_16x16x32_bf16 v[116:119], a[92:95], v[156:159], v[116:119]
    ds_read_b64_tr_b16 a[124:125], v235 offset:40960
    v_mul_f32 v253, s57, v249
    v_mfma_f32_16x16x32_bf16 v[84:87], a[92:95], v[148:151], v[84:87]
    v_exp_f32 v201, v201
    v_mfma_f32_16x16x32_bf16 v[84:87], a[88:91], v[144:147], v[84:87]
    ds_read_b64_tr_b16 a[126:127], v235 offset:45056
    v_cvt_pk_bf16_f32 v180, v200, v201
    v_mfma_f32_16x16x32_bf16 v[52:55], a[88:91], v[136:139], v[52:55]
    v_exp_f32 v202, v202
    v_mfma_f32_16x16x32_bf16 v[52:55], a[92:95], v[140:143], v[52:55]
    buffer_store_dwordx4 a[152:155], v240, s[64:67], s72 offen sc1
    v_mfma_f32_16x16x32_bf16 v[20:23], a[92:95], v[132:135], v[20:23]
    v_exp_f32 v203, v203
    v_mfma_f32_16x16x32_bf16 v[20:23], a[88:91], v[128:131], v[20:23]
    s_waitcnt vmcnt(20) lgkmcnt(0)
    v_cvt_pk_bf16_f32 v181, v202, v203
    v_accvgpr_read_b32 v248, a204
    v_smfmac_f32_16x16x64_bf16 a[136:139], a[144:147], v[144:151], v241
    s_barrier
    v_mfma_f32_16x16x32_bf16 v[192:195], a[96:99], a[0:3], v[208:211]
    v_exp_f32 v204, v204
    v_mfma_f32_16x16x32_bf16 v[192:195], a[100:103], a[4:7], v[192:195]
    ds_read_b128 a[64:67], v224 offset:49152
    v_mul_f32 v252, s57, v248
    v_mfma_f32_16x16x32_bf16 v[192:195], a[104:107], a[8:11], v[192:195]
    v_exp_f32 v205, v205
    v_mfma_f32_16x16x32_bf16 v[192:195], a[108:111], a[12:15], v[192:195]
    ds_read_b128 a[68:71], v225 offset:49152
    v_cvt_pk_bf16_f32 v188, v204, v205
    v_mfma_f32_16x16x32_bf16 v[196:199], a[108:111], a[28:31], v[212:215]
    v_exp_f32 v206, v206
    v_mfma_f32_16x16x32_bf16 v[196:199], a[104:107], a[24:27], v[196:199]
    ds_read_b128 a[72:75], v226 offset:49152
    v_exp_f32 v253, v253
    v_mfma_f32_16x16x32_bf16 v[196:199], a[100:103], a[20:23], v[196:199]
    v_exp_f32 v207, v207
    v_mfma_f32_16x16x32_bf16 v[196:199], a[96:99], a[16:19], v[196:199]
    ds_read_b128 a[76:79], v227 offset:49152
    v_cvt_pk_bf16_f32 v189, v206, v207
    v_mfma_f32_16x16x32_bf16 v[200:203], a[96:99], a[32:35], v[216:219]
    v_exp_f32 v192, v192
    v_mfma_f32_16x16x32_bf16 v[200:203], a[100:103], a[36:39], v[200:203]
    ds_read_b64_tr_b16 a[80:81], v228 offset:49152
    v_add_f32 v253, 1.0, v253
    v_mfma_f32_16x16x32_bf16 v[200:203], a[104:107], a[40:43], v[200:203]
    v_exp_f32 v193, v193
    v_mfma_f32_16x16x32_bf16 v[200:203], a[108:111], a[44:47], v[200:203]
    ds_read_b64_tr_b16 a[82:83], v228 offset:53248
    v_cvt_pk_bf16_f32 v166, v192, v193
    v_mfma_f32_16x16x32_bf16 v[204:207], a[108:111], a[60:63], v[220:223]
    v_exp_f32 v194, v194
    v_mfma_f32_16x16x32_bf16 v[204:207], a[104:107], a[56:59], v[204:207]
    ds_read_b64_tr_b16 a[84:85], v228 offset:57344
    v_rcp_f32 v253, v253
    v_mfma_f32_16x16x32_bf16 v[204:207], a[100:103], a[52:55], v[204:207]
    v_exp_f32 v195, v195
    v_mfma_f32_16x16x32_bf16 v[204:207], a[96:99], a[48:51], v[204:207]
    ds_read_b64_tr_b16 a[86:87], v228 offset:61440
    v_cvt_pk_bf16_f32 v167, v194, v195
    v_mfma_f32_16x16x32_bf16 v[24:27], a[112:115], v[128:131], v[24:27]
    v_exp_f32 v196, v196
    v_mfma_f32_16x16x32_bf16 v[24:27], a[116:119], v[132:135], v[24:27]
    ds_read_b64_tr_b16 a[88:89], v229 offset:49152
    v_mul_f32 v253, v249, v253
    v_mfma_f32_16x16x32_bf16 v[56:59], a[116:119], v[140:143], v[56:59]
K1_pg6:
    s_cbranch_execz K1_pg10
    v_exp_f32 v197, v197
    v_mfma_f32_16x16x32_bf16 v[56:59], a[112:115], v[136:139], v[56:59]
    ds_read_b64_tr_b16 a[90:91], v229 offset:53248
    v_cvt_pk_bf16_f32 v174, v196, v197
    v_mfma_f32_16x16x32_bf16 v[88:91], a[112:115], v[144:147], v[88:91]
    v_exp_f32 v198, v198
    v_mfma_f32_16x16x32_bf16 v[88:91], a[116:119], v[148:151], v[88:91]
    ds_read_b64_tr_b16 a[92:93], v229 offset:57344
    v_exp_f32 v252, v252
    v_mfma_f32_16x16x32_bf16 v[120:123], a[116:119], v[156:159], v[120:123]
    v_exp_f32 v199, v199
    v_mfma_f32_16x16x32_bf16 v[120:123], a[112:115], v[152:155], v[120:123]
    ds_read_b64_tr_b16 a[94:95], v229 offset:61440
    v_cvt_pk_bf16_f32 v175, v198, v199
    v_mfma_f32_16x16x32_bf16 v[124:127], a[120:123], v[152:155], v[124:127]
    v_exp_f32 v200, v200
    v_mfma_f32_16x16x32_bf16 v[124:127], a[124:127], v[156:159], v[124:127]
    ds_read_b64_tr_b16 a[156:157], v242 offset:32
    v_add_f32 v252, 1.0, v252
    v_mfma_f32_16x16x32_bf16 v[92:95], a[124:127], v[148:151], v[92:95]
    v_exp_f32 v201, v201
    v_mfma_f32_16x16x32_bf16 v[92:95], a[120:123], v[144:147], v[92:95]
    ds_read_b64_tr_b16 a[158:159], v242 offset:1056
    v_cvt_pk_bf16_f32 v182, v200, v201
    v_mfma_f32_16x16x32_bf16 v[60:63], a[120:123], v[136:139], v[60:63]
    s_add_u32 m0, s46, 32768
    v_exp_f32 v202, v202
    v_mfma_f32_16x16x32_bf16 v[60:63], a[124:127], v[140:143], v[60:63]
    buffer_load_dwordx4 v236, s[32:35], s43 offen offset:0 lds
    v_mfma_f32_16x16x32_bf16 v[28:31], a[124:127], v[132:135], v[28:31]
    v_exp_f32 v203, v203
    v_mfma_f32_16x16x32_bf16 v[28:31], a[120:123], v[128:131], v[28:31]
    v_cvt_pk_bf16_f32 v183, v202, v203
    v_rcp_f32 v252, v252
    v_smfmac_f32_16x16x64_bf16 a[140:143], a[144:147], v[152:159], v241
    buffer_load_dwordx4 v237, s[32:35], s43 offen offset:1024 lds
    s_waitcnt lgkmcnt(0)
    v_mfma_f32_16x16x32_bf16 v[192:195], a[64:67], a[0:3], v[208:211]
    v_exp_f32 v204, v204
    v_mfma_f32_16x16x32_bf16 v[192:195], a[68:71], a[4:7], v[192:195]
    ds_read_b128 a[96:99], v224 offset:53248
    v_mul_f32 v246, v248, v252
    v_mfma_f32_16x16x32_bf16 v[192:195], a[72:75], a[8:11], v[192:195]
    v_exp_f32 v205, v205
    v_mfma_f32_16x16x32_bf16 v[192:195], a[76:79], a[12:15], v[192:195]
    ds_read_b128 a[100:103], v225 offset:53248
    v_cvt_pk_bf16_f32 v190, v204, v205
    v_mfma_f32_16x16x32_bf16 v[196:199], a[76:79], a[28:31], v[212:215]
    v_exp_f32 v206, v206
    v_mfma_f32_16x16x32_bf16 v[196:199], a[72:75], a[24:27], v[196:199]
    ds_read_b128 a[104:107], v226 offset:53248
    v_cvt_pk_bf16_f32 v246, v246, v253
    v_mfma_f32_16x16x32_bf16 v[196:199], a[68:71], a[20:23], v[196:199]
    v_exp_f32 v207, v207
    v_mfma_f32_16x16x32_bf16 v[196:199], a[64:67], a[16:19], v[196:199]
    ds_read_b128 a[108:111], v227 offset:53248
    v_cvt_pk_bf16_f32 v191, v206, v207
    v_mfma_f32_16x16x32_bf16 v[200:203], a[64:67], a[32:35], v[216:219]
    v_exp_f32 v192, v192
    v_mfma_f32_16x16x32_bf16 v[200:203], a[68:71], a[36:39], v[200:203]
    ds_read_b64_tr_b16 a[112:113], v230 offset:49152
    v_accvgpr_read_b32 v249, a207
    v_mfma_f32_16x16x32_bf16 v[200:203], a[72:75], a[40:43], v[200:203]
    v_exp_f32 v193, v193
    v_mfma_f32_16x16x32_bf16 v[200:203], a[76:79], a[44:47], v[200:203]
    ds_read_b64_tr_b16 a[114:115], v230 offset:53248
    v_cvt_pk_bf16_f32 v128, v192, v193
    v_mfma_f32_16x16x32_bf16 v[204:207], a[76:79], a[60:63], v[220:223]
    v_exp_f32 v194, v194
    v_mfma_f32_16x16x32_bf16 v[204:207], a[72:75], a[56:59], v[204:207]
    buffer_load_dwordx4 v238, s[32:35], s43 offen offset:2048 lds
    v_mfma_f32_16x16x32_bf16 v[204:207], a[68:71], a[52:55], v[204:207]
    v_exp_f32 v195, v195
    v_mfma_f32_16x16x32_bf16 v[204:207], a[64:67], a[48:51], v[204:207]
    ds_read_b64_tr_b16 a[116:117], v230 offset:57344
    v_cvt_pk_bf16_f32 v129, v194, v195
    v_mfma_f32_16x16x32_bf16 v[0:3], a[80:83], v[160:163], v[0:3]
    v_exp_f32 v196, v196
    v_mfma_f32_16x16x32_bf16 v[0:3], a[84:87], v[164:167], v[0:3]
    ds_read_b64_tr_b16 a[118:119], v230 offset:61440
    v_mul_f32 v253, s57, v249
    v_mfma_f32_16x16x32_bf16 v[32:35], a[84:87], v[172:175], v[32:35]
    v_exp_f32 v197, v197
    v_mfma_f32_16x16x32_bf16 v[32:35], a[80:83], v[168:171], v[32:35]
    ds_read_b64_tr_b16 a[120:121], v231 offset:49152
    v_cvt_pk_bf16_f32 v136, v196, v197
    v_mfma_f32_16x16x32_bf16 v[64:67], a[80:83], v[176:179], v[64:67]
    v_exp_f32 v198, v198
    v_mfma_f32_16x16x32_bf16 v[64:67], a[84:87], v[180:183], v[64:67]
    buffer_load_dwordx4 v239, s[32:35], s43 offen offset:3072 lds
    v_mfma_f32_16x16x32_bf16 v[96:99], a[84:87], v[188:191], v[96:99]
    s_add_u32 s43, s43, 4096
    v_exp_f32 v199, v199
    v_mfma_f32_16x16x32_bf16 v[96:99], a[80:83], v[184:187], v[96:99]
    ds_read_b64_tr_b16 a[122:123], v231 offset:53248
    v_cvt_pk_bf16_f32 v137, v198, v199
    v_mfma_f32_16x16x32_bf16 v[100:103], a[88:91], v[184:187], v[100:103]
    v_exp_f32 v200, v200
    v_mfma_f32_16x16x32_bf16 v[100:103], a[92:95], v[188:191], v[100:103]
    ds_read_b64_tr_b16 a[124:125], v231 offset:57344
    v_accvgpr_read_b32 v248, a206
    v_mfma_f32_16x16x32_bf16 v[68:71], a[92:95], v[180:183], v[68:71]
    v_exp_f32 v201, v201
    v_mfma_f32_16x16x32_bf16 v[68:71], a[88:91], v[176:179], v[68:71]
    ds_read_b64_tr_b16 a[126:127], v231 offset:61440
    v_cvt_pk_bf16_f32 v144, v200, v201
    v_mfma_f32_16x16x32_bf16 v[36:39], a[88:91], v[168:171], v[36:39]
    v_exp_f32 v202, v202
    v_mfma_f32_16x16x32_bf16 v[36:39], a[92:95], v[172:175], v[36:39]
    buffer_store_dwordx4 a[156:159], v240, s[64:67], s73 offen sc1
    v_mfma_f32_16x16x32_bf16 v[4:7], a[92:95], v[164:167], v[4:7]
    v_exp_f32 v203, v203
    v_mfma_f32_16x16x32_bf16 v[4:7], a[88:91], v[160:163], v[4:7]
    v_cvt_pk_bf16_f32 v145, v202, v203
    v_mul_f32 v252, s57, v248
    v_smfmac_f32_16x16x64_bf16 a[128:131], a[144:147], v[160:167], v241
    v_exp_f32 v253, v253
    s_waitcnt lgkmcnt(0)
    v_mfma_f32_16x16x32_bf16 v[192:195], a[96:99], a[0:3], v[208:211]
    v_exp_f32 v204, v204
    v_mfma_f32_16x16x32_bf16 v[192:195], a[100:103], a[4:7], v[192:195]
    ds_read_b128 a[64:67], v224 offset:57344
    v_add_f32 v253, 1.0, v253
    v_mfma_f32_16x16x32_bf16 v[192:195], a[104:107], a[8:11], v[192:195]
    v_exp_f32 v205, v205
    v_mfma_f32_16x16x32_bf16 v[192:195], a[108:111], a[12:15], v[192:195]
    ds_read_b128 a[68:71], v225 offset:57344
    v_cvt_pk_bf16_f32 v152, v204, v205
    v_mfma_f32_16x16x32_bf16 v[196:199], a[108:111], a[28:31], v[212:215]
    v_exp_f32 v206, v206
    v_mfma_f32_16x16x32_bf16 v[196:199], a[104:107], a[24:27], v[196:199]
    ds_read_b128 a[72:75], v226 offset:57344
    v_rcp_f32 v253, v253
    v_mfma_f32_16x16x32_bf16 v[196:199], a[100:103], a[20:23], v[196:199]
    v_exp_f32 v207, v207
    v_mfma_f32_16x16x32_bf16 v[196:199], a[96:99], a[16:19], v[196:199]
    ds_read_b128 a[76:79], v227 offset:57344
    v_cvt_pk_bf16_f32 v153, v206, v207
    v_mfma_f32_16x16x32_bf16 v[200:203], a[96:99], a[32:35], v[216:219]
    v_exp_f32 v192, v192
    v_mfma_f32_16x16x32_bf16 v[200:203], a[100:103], a[36:39], v[200:203]
    ds_read_b64_tr_b16 a[80:81], v232 offset:49152
    v_mul_f32 v253, v249, v253
    v_mfma_f32_16x16x32_bf16 v[200:203], a[104:107], a[40:43], v[200:203]
    v_exp_f32 v193, v193
    v_mfma_f32_16x16x32_bf16 v[200:203], a[108:111], a[44:47], v[200:203]
    ds_read_b64_tr_b16 a[82:83], v232 offset:53248
    v_cvt_pk_bf16_f32 v130, v192, v193
    v_mfma_f32_16x16x32_bf16 v[204:207], a[108:111], a[60:63], v[220:223]
    v_exp_f32 v194, v194
    v_mfma_f32_16x16x32_bf16 v[204:207], a[104:107], a[56:59], v[204:207]
    v_exp_f32 v252, v252
    v_mfma_f32_16x16x32_bf16 v[204:207], a[100:103], a[52:55], v[204:207]
    v_exp_f32 v195, v195
    v_mfma_f32_16x16x32_bf16 v[204:207], a[96:99], a[48:51], v[204:207]
    ds_read_b64_tr_b16 a[84:85], v232 offset:57344
    v_cvt_pk_bf16_f32 v131, v194, v195
    v_mfma_f32_16x16x32_bf16 v[8:11], a[112:115], v[160:163], v[8:11]
    v_exp_f32 v196, v196
    v_mfma_f32_16x16x32_bf16 v[8:11], a[116:119], v[164:167], v[8:11]
    ds_read_b64_tr_b16 a[86:87], v232 offset:61440
    v_add_f32 v252, 1.0, v252
    v_mfma_f32_16x16x32_bf16 v[40:43], a[116:119], v[172:175], v[40:43]
    v_exp_f32 v197, v197
    v_mfma_f32_16x16x32_bf16 v[40:43], a[112:115], v[168:171], v[40:43]
    ds_read_b64_tr_b16 a[88:89], v233 offset:49152
    v_cvt_pk_bf16_f32 v138, v196, v197
    v_mfma_f32_16x16x32_bf16 v[72:75], a[112:115], v[176:179], v[72:75]
    s_add_u32 m0, s46, 36864
    v_exp_f32 v198, v198
    v_mfma_f32_16x16x32_bf16 v[72:75], a[116:119], v[180:183], v[72:75]
    buffer_load_dwordx4 v236, s[32:35], s43 offen offset:0 lds
    v_mfma_f32_16x16x32_bf16 v[104:107], a[116:119], v[188:191], v[104:107]
    v_exp_f32 v199, v199
    v_mfma_f32_16x16x32_bf16 v[104:107], a[112:115], v[184:187], v[104:107]
    ds_read_b64_tr_b16 a[90:91], v233 offset:53248
    v_cvt_pk_bf16_f32 v139, v198, v199
    v_mfma_f32_16x16x32_bf16 v[108:111], a[120:123], v[184:187], v[108:111]
    v_exp_f32 v200, v200
    v_mfma_f32_16x16x32_bf16 v[108:111], a[124:127], v[188:191], v[108:111]
    ds_read_b64_tr_b16 a[92:93], v233 offset:57344
    v_rcp_f32 v252, v252
    v_mfma_f32_16x16x32_bf16 v[76:79], a[124:127], v[180:183], v[76:79]
    v_exp_f32 v201, v201
    v_mfma_f32_16x16x32_bf16 v[76:79], a[120:123], v[176:179], v[76:79]
    ds_read_b64_tr_b16 a[94:95], v233 offset:61440
    v_cvt_pk_bf16_f32 v146, v200, v201
    v_mfma_f32_16x16x32_bf16 v[44:47], a[120:123], v[168:171], v[44:47]
    v_exp_f32 v202, v202
    v_mfma_f32_16x16x32_bf16 v[44:47], a[124:127], v[172:175], v[44:47]
    buffer_load_dwordx4 v237, s[32:35], s43 offen offset:1024 lds
    v_mfma_f32_16x16x32_bf16 v[12:15], a[124:127], v[164:167], v[12:15]
    v_exp_f32 v203, v203
    v_mfma_f32_16x16x32_bf16 v[12:15], a[120:123], v[160:163], v[12:15]
    v_cvt_pk_bf16_f32 v147, v202, v203
    v_mul_f32 v247, v248, v252
    v_smfmac_f32_16x16x64_bf16 a[132:135], a[144:147], v[168:175], v241
    v_cvt_pk_bf16_f32 v247, v247, v253
    v_mad_u64_u32 v[248:249], vcc, v250, 1, s[10:11]
    s_waitcnt lgkmcnt(0)
    v_mfma_f32_16x16x32_bf16 v[192:195], a[64:67], a[0:3], v[208:211]
    v_exp_f32 v204, v204
    v_mfma_f32_16x16x32_bf16 v[192:195], a[68:71], a[4:7], v[192:195]
    ds_read_b128 a[96:99], v224 offset:61440
    v_mfma_f32_16x16x32_bf16 v[192:195], a[72:75], a[8:11], v[192:195]
    v_exp_f32 v205, v205
    v_mfma_f32_16x16x32_bf16 v[192:195], a[76:79], a[12:15], v[192:195]
    ds_read_b128 a[100:103], v225 offset:61440
    v_cvt_pk_bf16_f32 v154, v204, v205
    v_mfma_f32_16x16x32_bf16 v[196:199], a[76:79], a[28:31], v[212:215]
    v_exp_f32 v206, v206
    v_mfma_f32_16x16x32_bf16 v[196:199], a[72:75], a[24:27], v[196:199]
    ds_read_b128 a[104:107], v226 offset:61440
    v_mfma_f32_16x16x32_bf16 v[196:199], a[68:71], a[20:23], v[196:199]
    v_exp_f32 v207, v207
    v_mfma_f32_16x16x32_bf16 v[196:199], a[64:67], a[16:19], v[196:199]
    ds_read_b128 a[108:111], v227 offset:61440
    v_cvt_pk_bf16_f32 v155, v206, v207
    v_mfma_f32_16x16x32_bf16 v[200:203], a[64:67], a[32:35], v[216:219]
    v_exp_f32 v192, v192
    v_mfma_f32_16x16x32_bf16 v[200:203], a[68:71], a[36:39], v[200:203]
    ds_read_b64_tr_b16 a[112:113], v234 offset:49152
    v_mfma_f32_16x16x32_bf16 v[200:203], a[72:75], a[40:43], v[200:203]
    v_exp_f32 v193, v193
    v_mfma_f32_16x16x32_bf16 v[200:203], a[76:79], a[44:47], v[200:203]
    ds_read_b64_tr_b16 a[114:115], v234 offset:53248
    v_cvt_pk_bf16_f32 v132, v192, v193
    v_mfma_f32_16x16x32_bf16 v[204:207], a[76:79], a[60:63], v[220:223]
    v_exp_f32 v194, v194
    v_mfma_f32_16x16x32_bf16 v[204:207], a[72:75], a[56:59], v[204:207]
    buffer_load_dwordx4 v238, s[32:35], s43 offen offset:2048 lds
    v_mfma_f32_16x16x32_bf16 v[204:207], a[68:71], a[52:55], v[204:207]
    v_exp_f32 v195, v195
    v_mfma_f32_16x16x32_bf16 v[204:207], a[64:67], a[48:51], v[204:207]
    ds_read_b64_tr_b16 a[116:117], v234 offset:57344
    v_cvt_pk_bf16_f32 v133, v194, v195
    v_mfma_f32_16x16x32_bf16 v[16:19], a[80:83], v[160:163], v[16:19]
    v_exp_f32 v196, v196
    v_mfma_f32_16x16x32_bf16 v[16:19], a[84:87], v[164:167], v[16:19]
    ds_read_b64_tr_b16 a[118:119], v234 offset:61440
    v_mfma_f32_16x16x32_bf16 v[48:51], a[84:87], v[172:175], v[48:51]
    v_exp_f32 v197, v197
    v_mfma_f32_16x16x32_bf16 v[48:51], a[80:83], v[168:171], v[48:51]
    ds_read_b64_tr_b16 a[120:121], v235 offset:49152
    v_cvt_pk_bf16_f32 v140, v196, v197
    v_mfma_f32_16x16x32_bf16 v[80:83], a[80:83], v[176:179], v[80:83]
    v_exp_f32 v198, v198
    v_mfma_f32_16x16x32_bf16 v[80:83], a[84:87], v[180:183], v[80:83]
    buffer_load_dwordx4 v239, s[32:35], s43 offen offset:3072 lds
    v_mfma_f32_16x16x32_bf16 v[112:115], a[84:87], v[188:191], v[112:115]
    s_add_u32 s43, s43, 12288
    v_exp_f32 v199, v199
    v_mfma_f32_16x16x32_bf16 v[112:115], a[80:83], v[184:187], v[112:115]
    ds_read_b64_tr_b16 a[122:123], v235 offset:53248
    v_cvt_pk_bf16_f32 v141, v198, v199
    v_mfma_f32_16x16x32_bf16 v[116:119], a[88:91], v[184:187], v[116:119]
    v_exp_f32 v200, v200
    v_mfma_f32_16x16x32_bf16 v[116:119], a[92:95], v[188:191], v[116:119]
    ds_read_b64_tr_b16 a[124:125], v235 offset:57344
    v_mfma_f32_16x16x32_bf16 v[84:87], a[92:95], v[180:183], v[84:87]
    v_exp_f32 v201, v201
    v_mfma_f32_16x16x32_bf16 v[84:87], a[88:91], v[176:179], v[84:87]
    ds_read_b64_tr_b16 a[126:127], v235 offset:61440
    v_cvt_pk_bf16_f32 v148, v200, v201
    v_mfma_f32_16x16x32_bf16 v[52:55], a[88:91], v[168:171], v[52:55]
    v_exp_f32 v202, v202
    v_mfma_f32_16x16x32_bf16 v[52:55], a[92:95], v[172:175], v[52:55]
    buffer_store_dwordx4 v[244:247], v240, s[36:39], s56 offen offset:1024 sc1
    v_mfma_f32_16x16x32_bf16 v[20:23], a[92:95], v[164:167], v[20:23]
    v_exp_f32 v203, v203
    v_mfma_f32_16x16x32_bf16 v[20:23], a[88:91], v[160:163], v[20:23]
    s_waitcnt vmcnt(20) lgkmcnt(0)
    v_cvt_pk_bf16_f32 v149, v202, v203
    v_smfmac_f32_16x16x64_bf16 a[136:139], a[144:147], v[176:183], v241
    s_barrier
    v_mfma_f32_16x16x32_bf16 v[192:195], a[96:99], a[0:3], v[208:211]
    v_exp_f32 v204, v204
    v_mfma_f32_16x16x32_bf16 v[192:195], a[100:103], a[4:7], v[192:195]
    ds_read_b128 a[64:67], v224 offset:0
    v_mfma_f32_16x16x32_bf16 v[192:195], a[104:107], a[8:11], v[192:195]
    v_exp_f32 v205, v205
    v_mfma_f32_16x16x32_bf16 v[192:195], a[108:111], a[12:15], v[192:195]
    ds_read_b128 a[68:71], v225 offset:0
    v_cvt_pk_bf16_f32 v156, v204, v205
    v_mfma_f32_16x16x32_bf16 v[196:199], a[108:111], a[28:31], v[212:215]
    v_exp_f32 v206, v206
    v_mfma_f32_16x16x32_bf16 v[196:199], a[104:107], a[24:27], v[196:199]
    ds_read_b128 a[72:75], v226 offset:0
    v_mfma_f32_16x16x32_bf16 v[196:199], a[100:103], a[20:23], v[196:199]
    v_exp_f32 v207, v207
    v_mfma_f32_16x16x32_bf16 v[196:199], a[96:99], a[16:19], v[196:199]
    ds_read_b128 a[76:79], v227 offset:0
    v_cvt_pk_bf16_f32 v157, v206, v207
    v_mfma_f32_16x16x32_bf16 v[200:203], a[96:99], a[32:35], v[216:219]
    v_exp_f32 v192, v192
    v_mfma_f32_16x16x32_bf16 v[200:203], a[100:103], a[36:39], v[200:203]
    ds_read_b64_tr_b16 a[80:81], v228 offset:0
    v_mfma_f32_16x16x32_bf16 v[200:203], a[104:107], a[40:43], v[200:203]
    v_exp_f32 v193, v193
    v_mfma_f32_16x16x32_bf16 v[200:203], a[108:111], a[44:47], v[200:203]
    ds_read_b64_tr_b16 a[82:83], v228 offset:4096
    v_cvt_pk_bf16_f32 v134, v192, v193
    v_mfma_f32_16x16x32_bf16 v[204:207], a[108:111], a[60:63], v[220:223]
    s_add_u32 m0, s46, 49152
    v_exp_f32 v194, v194
    v_mfma_f32_16x16x32_bf16 v[204:207], a[104:107], a[56:59], v[204:207]
    buffer_load_dwordx4 v236, s[32:35], s43 offen offset:0 lds
    v_mfma_f32_16x16x32_bf16 v[204:207], a[100:103], a[52:55], v[204:207]
    v_exp_f32 v195, v195
    v_mfma_f32_16x16x32_bf16 v[204:207], a[96:99], a[48:51], v[204:207]
    ds_read_b64_tr_b16 a[84:85], v228 offset:8192
    v_cvt_pk_bf16_f32 v135, v194, v195
    v_mfma_f32_16x16x32_bf16 v[24:27], a[112:115], v[160:163], v[24:27]
    v_exp_f32 v196, v196
    v_mfma_f32_16x16x32_bf16 v[24:27], a[116:119], v[164:167], v[24:27]
    ds_read_b64_tr_b16 a[86:87], v228 offset:12288
    v_mfma_f32_16x16x32_bf16 v[56:59], a[116:119], v[172:175], v[56:59]
    v_exp_f32 v197, v197
    v_mfma_f32_16x16x32_bf16 v[56:59], a[112:115], v[168:171], v[56:59]
    ds_read_b64_tr_b16 a[88:89], v229 offset:0
    v_cvt_pk_bf16_f32 v142, v196, v197
    v_mfma_f32_16x16x32_bf16 v[88:91], a[112:115], v[176:179], v[88:91]
    v_exp_f32 v198, v198
    v_mfma_f32_16x16x32_bf16 v[88:91], a[116:119], v[180:183], v[88:91]
    buffer_load_dwordx4 v237, s[32:35], s43 offen offset:1024 lds
    v_mfma_f32_16x16x32_bf16 v[120:123], a[116:119], v[188:191], v[120:123]
    v_exp_f32 v199, v199
    v_mfma_f32_16x16x32_bf16 v[120:123], a[112:115], v[184:187], v[120:123]
    ds_read_b64_tr_b16 a[90:91], v229 offset:4096
    v_cvt_pk_bf16_f32 v143, v198, v199
    v_mfma_f32_16x16x32_bf16 v[124:127], a[120:123], v[184:187], v[124:127]
    v_exp_f32 v200, v200
    v_mfma_f32_16x16x32_bf16 v[124:127], a[124:127], v[188:191], v[124:127]
    ds_read_b64_tr_b16 a[92:93], v229 offset:8192
    v_mfma_f32_16x16x32_bf16 v[92:95], a[124:127], v[180:183], v[92:95]
    v_exp_f32 v201, v201
    v_mfma_f32_16x16x32_bf16 v[92:95], a[120:123], v[176:179], v[92:95]
    ds_read_b64_tr_b16 a[94:95], v229 offset:12288
    v_cvt_pk_bf16_f32 v150, v200, v201
    v_mfma_f32_16x16x32_bf16 v[60:63], a[120:123], v[168:171], v[60:63]
    s_add_u32 s47, s47, 1
    v_exp_f32 v202, v202
    v_mfma_f32_16x16x32_bf16 v[60:63], a[124:127], v[172:175], v[60:63]
    global_load_dword a188, v[248:249], off
    v_mfma_f32_16x16x32_bf16 v[28:31], a[124:127], v[164:167], v[28:31]
    s_cmp_eq_u32 s47, 4
    v_exp_f32 v203, v203
    v_mfma_f32_16x16x32_bf16 v[28:31], a[120:123], v[160:163], v[28:31]
    v_cvt_pk_bf16_f32 v151, v202, v203
    v_smfmac_f32_16x16x64_bf16 a[140:143], a[144:147], v[184:191], v241
    s_waitcnt lgkmcnt(0)
    s_cbranch_scc1 K1_p1
    v_mfma_f32_32x32x16_bf16 a[192:207], a[184:187], a[184:187], a[208:223]
    s_mov_b64 s[72:73], s[74:75]
    s_mov_b64 s[74:75], s[76:77]
    s_mov_b64 s[76:77], s[78:79]
    s_add_u32 s56, s56, 2048
    v_mfma_f32_32x32x16_bf16 a[208:223], a[184:187], a[184:187], a[224:239]
    s_add_u32 s81, s81, 2048
    v_mfma_f32_32x32x16_bf16 a[224:239], a[184:187], a[184:187], a[240:255]
    s_branch K1_loopa
K1_p1:
.p2align 3
K1_loop:
    v_mfma_f32_16x16x32_bf16 v[192:195], a[64:67], a[0:3], v[208:211]
    v_exp_f32 v204, v204
    v_mfma_f32_16x16x32_bf16 v[192:195], a[68:71], a[4:7], v[192:195]
    ds_read_b128 a[96:99], v224 offset:4096
    v_mfma_f32_16x16x32_bf16 v[192:195], a[72:75], a[8:11], v[192:195]
    v_exp_f32 v205, v205
    v_mfma_f32_16x16x32_bf16 v[192:195], a[76:79], a[12:15], v[192:195]
    ds_read_b128 a[100:103], v225 offset:4096
    v_cvt_pk_bf16_f32 v158, v204, v205
    v_mfma_f32_16x16x32_bf16 v[196:199], a[76:79], a[28:31], v[212:215]
    v_exp_f32 v206, v206
    v_mfma_f32_16x16x32_bf16 v[196:199], a[72:75], a[24:27], v[196:199]
    ds_read_b128 a[104:107], v226 offset:4096
    v_mfma_f32_16x16x32_bf16 v[196:199], a[68:71], a[20:23], v[196:199]
    v_exp_f32 v207, v207
    v_mfma_f32_16x16x32_bf16 v[196:199], a[64:67], a[16:19], v[196:199]
    ds_read_b128 a[108:111], v227 offset:4096
    v_cvt_pk_bf16_f32 v159, v206, v207
    v_mfma_f32_16x16x32_bf16 v[200:203], a[64:67], a[32:35], v[216:219]
    v_exp_f32 v192, v192
    v_mfma_f32_16x16x32_bf16 v[200:203], a[68:71], a[36:39], v[200:203]
    ds_read_b64_tr_b16 a[112:113], v230 offset:0
    v_mfma_f32_16x16x32_bf16 v[200:203], a[72:75], a[40:43], v[200:203]
    v_exp_f32 v193, v193
    v_mfma_f32_16x16x32_bf16 v[200:203], a[76:79], a[44:47], v[200:203]
    ds_read_b64_tr_b16 a[114:115], v230 offset:4096
    v_cvt_pk_bf16_f32 v160, v192, v193
    v_mfma_f32_16x16x32_bf16 v[204:207], a[76:79], a[60:63], v[220:223]
    v_exp_f32 v194, v194
    v_mfma_f32_16x16x32_bf16 v[204:207], a[72:75], a[56:59], v[204:207]
    ds_read_b64_tr_b16 a[116:117], v230 offset:8192
    v_mfma_f32_16x16x32_bf16 v[204:207], a[68:71], a[52:55], v[204:207]
    v_exp_f32 v195, v195
    v_mfma_f32_16x16x32_bf16 v[204:207], a[64:67], a[48:51], v[204:207]
    ds_read_b64_tr_b16 a[118:119], v230 offset:12288
    v_cvt_pk_bf16_f32 v161, v194, v195
    v_mfma_f32_16x16x32_bf16 v[0:3], a[80:83], v[128:131], v[0:3]
    v_exp_f32 v196, v196
    v_mfma_f32_16x16x32_bf16 v[0:3], a[84:87], v[132:135], v[0:3]
    ds_read_b64_tr_b16 a[120:121], v231 offset:0
    v_mfma_f32_16x16x32_bf16 v[32:35], a[84:87], v[140:143], v[32:35]
    v_exp_f32 v197, v197
    v_mfma_f32_16x16x32_bf16 v[32:35], a[80:83], v[136:139], v[32:35]
    ds_read_b64_tr_b16 a[122:123], v231 offset:4096
    v_cvt_pk_bf16_f32 v168, v196, v197
    v_mfma_f32_16x16x32_bf16 v[64:67], a[80:83], v[144:147], v[64:67]
    v_exp_f32 v198, v198
    v_mfma_f32_16x16x32_bf16 v[64:67], a[84:87], v[148:151], v[64:67]
    buffer_load_dwordx4 v238, s[32:35], s43 offen offset:2048 lds
    v_mfma_f32_16x16x32_bf16 v[96:99], a[84:87], v[156:159], v[96:99]
    v_exp_f32 v199, v199
    v_mfma_f32_16x16x32_bf16 v[96:99], a[80:83], v[152:155], v[96:99]
    ds_read_b64_tr_b16 a[124:125], v231 offset:8192
    v_cvt_pk_bf16_f32 v169, v198, v199
    v_mfma_f32_16x16x32_bf16 v[100:103], a[88:91], v[152:155], v[100:103]
    v_exp_f32 v200, v200
    v_mfma_f32_16x16x32_bf16 v[100:103], a[92:95], v[156:159], v[100:103]
    ds_read_b64_tr_b16 a[126:127], v231 offset:12288
    v_mfma_f32_16x16x32_bf16 v[68:71], a[92:95], v[148:151], v[68:71]
    v_exp_f32 v201, v201
    v_mfma_f32_16x16x32_bf16 v[68:71], a[88:91], v[144:147], v[68:71]
    v_cvt_pk_bf16_f32 v176, v200, v201
    v_mfma_f32_16x16x32_bf16 v[36:39], a[88:91], v[136:139], v[36:39]
    v_exp_f32 v202, v202
    v_mfma_f32_16x16x32_bf16 v[36:39], a[92:95], v[140:143], v[36:39]
    buffer_load_dwordx4 v239, s[32:35], s43 offen offset:3072 lds
    v_mfma_f32_16x16x32_bf16 v[4:7], a[92:95], v[132:135], v[4:7]
    s_add_u32 s43, s43, 4096
    v_exp_f32 v203, v203
    v_mfma_f32_16x16x32_bf16 v[4:7], a[88:91], v[128:131], v[4:7]
    v_cvt_pk_bf16_f32 v177, v202, v203
    v_smfmac_f32_16x16x64_bf16 a[128:131], a[144:147], v[128:135], v241
    s_waitcnt lgkmcnt(0)
    v_mfma_f32_16x16x32_bf16 v[192:195], a[96:99], a[0:3], v[208:211]
    v_exp_f32 v204, v204
    v_mfma_f32_16x16x32_bf16 v[192:195], a[100:103], a[4:7], v[192:195]
    ds_read_b128 a[64:67], v224 offset:8192
    v_mfma_f32_16x16x32_bf16 v[192:195], a[104:107], a[8:11], v[192:195]
    v_exp_f32 v205, v205
    v_mfma_f32_16x16x32_bf16 v[192:195], a[108:111], a[12:15], v[192:195]
    ds_read_b128 a[68:71], v225 offset:8192
    v_cvt_pk_bf16_f32 v184, v204, v205
    v_mfma_f32_16x16x32_bf16 v[196:199], a[108:111], a[28:31], v[212:215]
    v_exp_f32 v206, v206
    v_mfma_f32_16x16x32_bf16 v[196:199], a[104:107], a[24:27], v[196:199]
    ds_read_b128 a[72:75], v226 offset:8192
    v_mfma_f32_16x16x32_bf16 v[196:199], a[100:103], a[20:23], v[196:199]
    v_exp_f32 v207, v207
    v_mfma_f32_16x16x32_bf16 v[196:199], a[96:99], a[16:19], v[196:199]
    ds_read_b128 a[76:79], v227 offset:8192
    v_cvt_pk_bf16_f32 v185, v206, v207
    v_mfma_f32_16x16x32_bf16 v[200:203], a[96:99], a[32:35], v[216:219]
    v_exp_f32 v192, v192
    v_mfma_f32_16x16x32_bf16 v[200:203], a[100:103], a[36:39], v[200:203]
    ds_read_b64_tr_b16 a[80:81], v232 offset:0
    v_mfma_f32_16x16x32_bf16 v[200:203], a[104:107], a[40:43], v[200:203]
    v_exp_f32 v193, v193
    v_mfma_f32_16x16x32_bf16 v[200:203], a[108:111], a[44:47], v[200:203]
    ds_read_b64_tr_b16 a[82:83], v232 offset:4096
    v_cvt_pk_bf16_f32 v162, v192, v193
    v_mfma_f32_16x16x32_bf16 v[204:207], a[108:111], a[60:63], v[220:223]
    v_exp_f32 v194, v194
    v_mfma_f32_16x16x32_bf16 v[204:207], a[104:107], a[56:59], v[204:207]
    ds_read_b64_tr_b16 a[84:85], v232 offset:8192
    v_mfma_f32_16x16x32_bf16 v[204:207], a[100:103], a[52:55], v[204:207]
    v_exp_f32 v195, v195
    v_mfma_f32_16x16x32_bf16 v[204:207], a[96:99], a[48:51], v[204:207]
    ds_read_b64_tr_b16 a[86:87], v232 offset:12288
    v_cvt_pk_bf16_f32 v163, v194, v195
    v_mfma_f32_16x16x32_bf16 v[8:11], a[112:115], v[128:131], v[8:11]
    v_exp_f32 v196, v196
    v_mfma_f32_16x16x32_bf16 v[8:11], a[116:119], v[132:135], v[8:11]
    ds_read_b64_tr_b16 a[88:89], v233 offset:0
    v_mfma_f32_16x16x32_bf16 v[40:43], a[116:119], v[140:143], v[40:43]
    v_exp_f32 v197, v197
    v_mfma_f32_16x16x32_bf16 v[40:43], a[112:115], v[136:139], v[40:43]
    ds_read_b64_tr_b16 a[90:91], v233 offset:4096
    v_cvt_pk_bf16_f32 v170, v196, v197
    v_mfma_f32_16x16x32_bf16 v[72:75], a[112:115], v[144:147], v[72:75]
    s_add_u32 m0, s46, 53248
    v_exp_f32 v198, v198
    v_mfma_f32_16x16x32_bf16 v[72:75], a[116:119], v[148:151], v[72:75]
    buffer_load_dwordx4 v236, s[32:35], s43 offen offset:0 lds
    v_mfma_f32_16x16x32_bf16 v[104:107], a[116:119], v[156:159], v[104:107]
    v_exp_f32 v199, v199
    v_mfma_f32_16x16x32_bf16 v[104:107], a[112:115], v[152:155], v[104:107]
    ds_read_b64_tr_b16 a[92:93], v233 offset:8192
    v_cvt_pk_bf16_f32 v171, v198, v199
    v_mfma_f32_16x16x32_bf16 v[108:111], a[120:123], v[152:155], v[108:111]
    v_exp_f32 v200, v200
    v_mfma_f32_16x16x32_bf16 v[108:111], a[124:127], v[156:159], v[108:111]
    ds_read_b64_tr_b16 a[94:95], v233 offset:12288
    v_mfma_f32_16x16x32_bf16 v[76:79], a[124:127], v[148:151], v[76:79]
    v_exp_f32 v201, v201
    v_mfma_f32_16x16x32_bf16 v[76:79], a[120:123], v[144:147], v[76:79]
    v_cvt_pk_bf16_f32 v178, v200, v201
    v_mfma_f32_16x16x32_bf16 v[44:47], a[120:123], v[136:139], v[44:47]
    v_exp_f32 v202, v202
    v_mfma_f32_16x16x32_bf16 v[44:47], a[124:127], v[140:143], v[44:47]
    buffer_load_dwordx4 v237, s[32:35], s43 offen offset:1024 lds
    v_mfma_f32_16x16x32_bf16 v[12:15], a[124:127], v[132:135], v[12:15]
    v_exp_f32 v203, v203
    v_mfma_f32_16x16x32_bf16 v[12:15], a[120:123], v[128:131], v[12:15]
    v_cvt_pk_bf16_f32 v179, v202, v203
    v_smfmac_f32_16x16x64_bf16 a[132:135], a[144:147], v[136:143], v241
    s_waitcnt lgkmcnt(0)
    v_mfma_f32_16x16x32_bf16 v[192:195], a[64:67], a[0:3], v[208:211]
    v_exp_f32 v204, v204
    v_mfma_f32_16x16x32_bf16 v[192:195], a[68:71], a[4:7], v[192:195]
    ds_read_b128 a[96:99], v224 offset:12288
    v_mfma_f32_16x16x32_bf16 v[192:195], a[72:75], a[8:11], v[192:195]
    v_exp_f32 v205, v205
    v_mfma_f32_16x16x32_bf16 v[192:195], a[76:79], a[12:15], v[192:195]
    ds_read_b128 a[100:103], v225 offset:12288
    v_cvt_pk_bf16_f32 v186, v204, v205
    v_mfma_f32_16x16x32_bf16 v[196:199], a[76:79], a[28:31], v[212:215]
    v_exp_f32 v206, v206
    v_mfma_f32_16x16x32_bf16 v[196:199], a[72:75], a[24:27], v[196:199]
    ds_read_b128 a[104:107], v226 offset:12288
    v_mfma_f32_16x16x32_bf16 v[196:199], a[68:71], a[20:23], v[196:199]
    v_exp_f32 v207, v207
    v_mfma_f32_16x16x32_bf16 v[196:199], a[64:67], a[16:19], v[196:199]
    ds_read_b128 a[108:111], v227 offset:12288
    v_cvt_pk_bf16_f32 v187, v206, v207
    v_mfma_f32_16x16x32_bf16 v[200:203], a[64:67], a[32:35], v[216:219]
    v_exp_f32 v192, v192
    v_mfma_f32_16x16x32_bf16 v[200:203], a[68:71], a[36:39], v[200:203]
    ds_read_b64_tr_b16 a[112:113], v234 offset:0
    v_mfma_f32_16x16x32_bf16 v[200:203], a[72:75], a[40:43], v[200:203]
    v_exp_f32 v193, v193
    v_mfma_f32_16x16x32_bf16 v[200:203], a[76:79], a[44:47], v[200:203]
    ds_read_b64_tr_b16 a[114:115], v234 offset:4096
    v_cvt_pk_bf16_f32 v164, v192, v193
    v_mfma_f32_16x16x32_bf16 v[204:207], a[76:79], a[60:63], v[220:223]
    v_exp_f32 v194, v194
    v_mfma_f32_16x16x32_bf16 v[204:207], a[72:75], a[56:59], v[204:207]
    ds_read_b64_tr_b16 a[116:117], v234 offset:8192
    v_mfma_f32_16x16x32_bf16 v[204:207], a[68:71], a[52:55], v[204:207]
    v_exp_f32 v195, v195
    v_mfma_f32_16x16x32_bf16 v[204:207], a[64:67], a[48:51], v[204:207]
    ds_read_b64_tr_b16 a[118:119], v234 offset:12288
    v_cvt_pk_bf16_f32 v165, v194, v195
    v_mfma_f32_16x16x32_bf16 v[16:19], a[80:83], v[128:131], v[16:19]
    v_exp_f32 v196, v196
    v_mfma_f32_16x16x32_bf16 v[16:19], a[84:87], v[132:135], v[16:19]
    ds_read_b64_tr_b16 a[120:121], v235 offset:0
    v_mfma_f32_16x16x32_bf16 v[48:51], a[84:87], v[140:143], v[48:51]
    v_exp_f32 v197, v197
    v_mfma_f32_16x16x32_bf16 v[48:51], a[80:83], v[136:139], v[48:51]
    ds_read_b64_tr_b16 a[122:123], v235 offset:4096
    v_cvt_pk_bf16_f32 v172, v196, v197
    v_mfma_f32_16x16x32_bf16 v[80:83], a[80:83], v[144:147], v[80:83]
    v_exp_f32 v198, v198
    v_mfma_f32_16x16x32_bf16 v[80:83], a[84:87], v[148:151], v[80:83]
    buffer_load_dwordx4 v238, s[32:35], s43 offen offset:2048 lds
    v_mfma_f32_16x16x32_bf16 v[112:115], a[84:87], v[156:159], v[112:115]
    v_exp_f32 v199, v199
    v_mfma_f32_16x16x32_bf16 v[112:115], a[80:83], v[152:155], v[112:115]
    ds_read_b64_tr_b16 a[124:125], v235 offset:8192
    v_cvt_pk_bf16_f32 v173, v198, v199
    v_mfma_f32_16x16x32_bf16 v[116:119], a[88:91], v[152:155], v[116:119]
    v_exp_f32 v200, v200
    v_mfma_f32_16x16x32_bf16 v[116:119], a[92:95], v[156:159], v[116:119]
    ds_read_b64_tr_b16 a[126:127], v235 offset:12288
    v_mfma_f32_16x16x32_bf16 v[84:87], a[92:95], v[148:151], v[84:87]
    v_exp_f32 v201, v201
    v_mfma_f32_16x16x32_bf16 v[84:87], a[88:91], v[144:147], v[84:87]
    v_cvt_pk_bf16_f32 v180, v200, v201
    v_mfma_f32_16x16x32_bf16 v[52:55], a[88:91], v[136:139], v[52:55]
    v_exp_f32 v202, v202
    v_mfma_f32_16x16x32_bf16 v[52:55], a[92:95], v[140:143], v[52:55]
    buffer_load_dwordx4 v239, s[32:35], s43 offen offset:3072 lds
    v_mfma_f32_16x16x32_bf16 v[20:23], a[92:95], v[132:135], v[20:23]
    s_add_u32 s43, s43, 12288
    v_exp_f32 v203, v203
    v_mfma_f32_16x16x32_bf16 v[20:23], a[88:91], v[128:131], v[20:23]
    s_waitcnt vmcnt(16) lgkmcnt(0)
    v_cvt_pk_bf16_f32 v181, v202, v203
    v_smfmac_f32_16x16x64_bf16 a[136:139], a[144:147], v[144:151], v241
    s_barrier
    v_mfma_f32_16x16x32_bf16 v[192:195], a[96:99], a[0:3], v[208:211]
    v_exp_f32 v204, v204
    v_mfma_f32_16x16x32_bf16 v[192:195], a[100:103], a[4:7], v[192:195]
    ds_read_b128 a[64:67], v224 offset:16384
    v_mfma_f32_16x16x32_bf16 v[192:195], a[104:107], a[8:11], v[192:195]
K1_pg7:
    s_cbranch_execz K1_pg11
    v_exp_f32 v205, v205
    v_mfma_f32_16x16x32_bf16 v[192:195], a[108:111], a[12:15], v[192:195]
    ds_read_b128 a[68:71], v225 offset:16384
    v_cvt_pk_bf16_f32 v188, v204, v205
    v_mfma_f32_16x16x32_bf16 v[196:199], a[108:111], a[28:31], v[212:215]
    v_exp_f32 v206, v206
    v_mfma_f32_16x16x32_bf16 v[196:199], a[104:107], a[24:27], v[196:199]
    ds_read_b128 a[72:75], v226 offset:16384
    v_mfma_f32_16x16x32_bf16 v[196:199], a[100:103], a[20:23], v[196:199]
    v_exp_f32 v207, v207
    v_mfma_f32_16x16x32_bf16 v[196:199], a[96:99], a[16:19], v[196:199]
    ds_read_b128 a[76:79], v227 offset:16384
    v_cvt_pk_bf16_f32 v189, v206, v207
    v_mfma_f32_16x16x32_bf16 v[200:203], a[96:99], a[32:35], v[216:219]
    v_exp_f32 v192, v192
    v_mfma_f32_16x16x32_bf16 v[200:203], a[100:103], a[36:39], v[200:203]
    ds_read_b64_tr_b16 a[80:81], v228 offset:16384
    v_mfma_f32_16x16x32_bf16 v[200:203], a[104:107], a[40:43], v[200:203]
    v_exp_f32 v193, v193
    v_mfma_f32_16x16x32_bf16 v[200:203], a[108:111], a[44:47], v[200:203]
    ds_read_b64_tr_b16 a[82:83], v228 offset:20480
    v_cvt_pk_bf16_f32 v166, v192, v193
    v_mfma_f32_16x16x32_bf16 v[204:207], a[108:111], a[60:63], v[220:223]
    v_exp_f32 v194, v194
    v_mfma_f32_16x16x32_bf16 v[204:207], a[104:107], a[56:59], v[204:207]
    ds_read_b64_tr_b16 a[84:85], v228 offset:24576
    v_mfma_f32_16x16x32_bf16 v[204:207], a[100:103], a[52:55], v[204:207]
    v_exp_f32 v195, v195
    v_mfma_f32_16x16x32_bf16 v[204:207], a[96:99], a[48:51], v[204:207]
    ds_read_b64_tr_b16 a[86:87], v228 offset:28672
    v_cvt_pk_bf16_f32 v167, v194, v195
    v_mfma_f32_16x16x32_bf16 v[24:27], a[112:115], v[128:131], v[24:27]
    v_exp_f32 v196, v196
    v_mfma_f32_16x16x32_bf16 v[24:27], a[116:119], v[132:135], v[24:27]
    ds_read_b64_tr_b16 a[88:89], v229 offset:16384
    v_mfma_f32_16x16x32_bf16 v[56:59], a[116:119], v[140:143], v[56:59]
    v_exp_f32 v197, v197
    v_mfma_f32_16x16x32_bf16 v[56:59], a[112:115], v[136:139], v[56:59]
    ds_read_b64_tr_b16 a[90:91], v229 offset:20480
    v_cvt_pk_bf16_f32 v174, v196, v197
    v_mfma_f32_16x16x32_bf16 v[88:91], a[112:115], v[144:147], v[88:91]
    s_add_u32 m0, s46, 0
    v_exp_f32 v198, v198
    v_mfma_f32_16x16x32_bf16 v[88:91], a[116:119], v[148:151], v[88:91]
    buffer_load_dwordx4 v236, s[32:35], s43 offen offset:0 lds
    v_mfma_f32_16x16x32_bf16 v[120:123], a[116:119], v[156:159], v[120:123]
    v_exp_f32 v199, v199
    v_mfma_f32_16x16x32_bf16 v[120:123], a[112:115], v[152:155], v[120:123]
    ds_read_b64_tr_b16 a[92:93], v229 offset:24576
    v_cvt_pk_bf16_f32 v175, v198, v199
    v_mfma_f32_16x16x32_bf16 v[124:127], a[120:123], v[152:155], v[124:127]
    v_exp_f32 v200, v200
    v_mfma_f32_16x16x32_bf16 v[124:127], a[124:127], v[156:159], v[124:127]
    ds_read_b64_tr_b16 a[94:95], v229 offset:28672
    v_mfma_f32_16x16x32_bf16 v[92:95], a[124:127], v[148:151], v[92:95]
    v_exp_f32 v201, v201
    v_mfma_f32_16x16x32_bf16 v[92:95], a[120:123], v[144:147], v[92:95]
    v_cvt_pk_bf16_f32 v182, v200, v201
    v_mfma_f32_16x16x32_bf16 v[60:63], a[120:123], v[136:139], v[60:63]
    v_exp_f32 v202, v202
    v_mfma_f32_16x16x32_bf16 v[60:63], a[124:127], v[140:143], v[60:63]
    buffer_load_dwordx4 v237, s[32:35], s43 offen offset:1024 lds
    v_mfma_f32_16x16x32_bf16 v[28:31], a[124:127], v[132:135], v[28:31]
    v_exp_f32 v203, v203
    v_mfma_f32_16x16x32_bf16 v[28:31], a[120:123], v[128:131], v[28:31]
    v_cvt_pk_bf16_f32 v183, v202, v203
    v_smfmac_f32_16x16x64_bf16 a[140:143], a[144:147], v[152:159], v241
    s_waitcnt lgkmcnt(0)
    v_mfma_f32_16x16x32_bf16 v[192:195], a[64:67], a[0:3], v[208:211]
    v_exp_f32 v204, v204
    v_mfma_f32_16x16x32_bf16 v[192:195], a[68:71], a[4:7], v[192:195]
    ds_read_b128 a[96:99], v224 offset:20480
    v_mfma_f32_16x16x32_bf16 v[192:195], a[72:75], a[8:11], v[192:195]
    v_exp_f32 v205, v205
    v_mfma_f32_16x16x32_bf16 v[192:195], a[76:79], a[12:15], v[192:195]
    ds_read_b128 a[100:103], v225 offset:20480
    v_cvt_pk_bf16_f32 v190, v204, v205
    v_mfma_f32_16x16x32_bf16 v[196:199], a[76:79], a[28:31], v[212:215]
    v_exp_f32 v206, v206
    v_mfma_f32_16x16x32_bf16 v[196:199], a[72:75], a[24:27], v[196:199]
    ds_read_b128 a[104:107], v226 offset:20480
    v_mfma_f32_16x16x32_bf16 v[196:199], a[68:71], a[20:23], v[196:199]
    v_exp_f32 v207, v207
    v_mfma_f32_16x16x32_bf16 v[196:199], a[64:67], a[16:19], v[196:199]
    ds_read_b128 a[108:111], v227 offset:20480
    v_cvt_pk_bf16_f32 v191, v206, v207
    v_mfma_f32_16x16x32_bf16 v[200:203], a[64:67], a[32:35], v[216:219]
    v_exp_f32 v192, v192
    v_mfma_f32_16x16x32_bf16 v[200:203], a[68:71], a[36:39], v[200:203]
    ds_read_b64_tr_b16 a[112:113], v230 offset:16384
    v_mfma_f32_16x16x32_bf16 v[200:203], a[72:75], a[40:43], v[200:203]
    v_exp_f32 v193, v193
    v_mfma_f32_16x16x32_bf16 v[200:203], a[76:79], a[44:47], v[200:203]
    ds_read_b64_tr_b16 a[114:115], v230 offset:20480
    v_cvt_pk_bf16_f32 v128, v192, v193
    v_mfma_f32_16x16x32_bf16 v[204:207], a[76:79], a[60:63], v[220:223]
    v_exp_f32 v194, v194
    v_mfma_f32_16x16x32_bf16 v[204:207], a[72:75], a[56:59], v[204:207]
    ds_read_b64_tr_b16 a[116:117], v230 offset:24576
    v_mfma_f32_16x16x32_bf16 v[204:207], a[68:71], a[52:55], v[204:207]
    v_exp_f32 v195, v195
    v_mfma_f32_16x16x32_bf16 v[204:207], a[64:67], a[48:51], v[204:207]
    ds_read_b64_tr_b16 a[118:119], v230 offset:28672
    v_cvt_pk_bf16_f32 v129, v194, v195
    v_mfma_f32_16x16x32_bf16 v[0:3], a[80:83], v[160:163], v[0:3]
    v_exp_f32 v196, v196
    v_mfma_f32_16x16x32_bf16 v[0:3], a[84:87], v[164:167], v[0:3]
    ds_read_b64_tr_b16 a[120:121], v231 offset:16384
    v_mfma_f32_16x16x32_bf16 v[32:35], a[84:87], v[172:175], v[32:35]
    v_exp_f32 v197, v197
    v_mfma_f32_16x16x32_bf16 v[32:35], a[80:83], v[168:171], v[32:35]
    ds_read_b64_tr_b16 a[122:123], v231 offset:20480
    v_cvt_pk_bf16_f32 v136, v196, v197
    v_mfma_f32_16x16x32_bf16 v[64:67], a[80:83], v[176:179], v[64:67]
    v_exp_f32 v198, v198
    v_mfma_f32_16x16x32_bf16 v[64:67], a[84:87], v[180:183], v[64:67]
    buffer_load_dwordx4 v238, s[32:35], s43 offen offset:2048 lds
    v_mfma_f32_16x16x32_bf16 v[96:99], a[84:87], v[188:191], v[96:99]
    v_exp_f32 v199, v199
    v_mfma_f32_16x16x32_bf16 v[96:99], a[80:83], v[184:187], v[96:99]
    ds_read_b64_tr_b16 a[124:125], v231 offset:24576
    v_cvt_pk_bf16_f32 v137, v198, v199
    v_mfma_f32_16x16x32_bf16 v[100:103], a[88:91], v[184:187], v[100:103]
    v_exp_f32 v200, v200
    v_mfma_f32_16x16x32_bf16 v[100:103], a[92:95], v[188:191], v[100:103]
    ds_read_b64_tr_b16 a[126:127], v231 offset:28672
    v_mfma_f32_16x16x32_bf16 v[68:71], a[92:95], v[180:183], v[68:71]
    v_exp_f32 v201, v201
    v_mfma_f32_16x16x32_bf16 v[68:71], a[88:91], v[176:179], v[68:71]
    v_cvt_pk_bf16_f32 v144, v200, v201
    v_mfma_f32_16x16x32_bf16 v[36:39], a[88:91], v[168:171], v[36:39]
    v_exp_f32 v202, v202
    v_mfma_f32_16x16x32_bf16 v[36:39], a[92:95], v[172:175], v[36:39]
    buffer_load_dwordx4 v239, s[32:35], s43 offen offset:3072 lds
    v_mfma_f32_16x16x32_bf16 v[4:7], a[92:95], v[164:167], v[4:7]
    s_add_u32 s43, s43, 4096
    v_exp_f32 v203, v203
    v_mfma_f32_16x16x32_bf16 v[4:7], a[88:91], v[160:163], v[4:7]
    v_cvt_pk_bf16_f32 v145, v202, v203
    v_smfmac_f32_16x16x64_bf16 a[128:131], a[144:147], v[160:167], v241
    s_waitcnt lgkmcnt(0)
    v_mfma_f32_16x16x32_bf16 v[192:195], a[96:99], a[0:3], v[208:211]
    v_exp_f32 v204, v204
    v_mfma_f32_16x16x32_bf16 v[192:195], a[100:103], a[4:7], v[192:195]
    ds_read_b128 a[64:67], v224 offset:24576
    v_mfma_f32_16x16x32_bf16 v[192:195], a[104:107], a[8:11], v[192:195]
    v_exp_f32 v205, v205
    v_mfma_f32_16x16x32_bf16 v[192:195], a[108:111], a[12:15], v[192:195]
    ds_read_b128 a[68:71], v225 offset:24576
    v_cvt_pk_bf16_f32 v152, v204, v205
    v_mfma_f32_16x16x32_bf16 v[196:199], a[108:111], a[28:31], v[212:215]
    v_exp_f32 v206, v206
    v_mfma_f32_16x16x32_bf16 v[196:199], a[104:107], a[24:27], v[196:199]
    ds_read_b128 a[72:75], v226 offset:24576
    v_mfma_f32_16x16x32_bf16 v[196:199], a[100:103], a[20:23], v[196:199]
    v_exp_f32 v207, v207
    v_mfma_f32_16x16x32_bf16 v[196:199], a[96:99], a[16:19], v[196:199]
    ds_read_b128 a[76:79], v227 offset:24576
    v_cvt_pk_bf16_f32 v153, v206, v207
    v_mfma_f32_16x16x32_bf16 v[200:203], a[96:99], a[32:35], v[216:219]
    v_exp_f32 v192, v192
    v_mfma_f32_16x16x32_bf16 v[200:203], a[100:103], a[36:39], v[200:203]
    ds_read_b64_tr_b16 a[80:81], v232 offset:16384
    v_mfma_f32_16x16x32_bf16 v[200:203], a[104:107], a[40:43], v[200:203]
    v_exp_f32 v193, v193
    v_mfma_f32_16x16x32_bf16 v[200:203], a[108:111], a[44:47], v[200:203]
    ds_read_b64_tr_b16 a[82:83], v232 offset:20480
    v_cvt_pk_bf16_f32 v130, v192, v193
    v_mfma_f32_16x16x32_bf16 v[204:207], a[108:111], a[60:63], v[220:223]
    s_add_u32 m0, s46, 4096
    v_exp_f32 v194, v194
    v_mfma_f32_16x16x32_bf16 v[204:207], a[104:107], a[56:59], v[204:207]
    buffer_load_dwordx4 v236, s[32:35], s43 offen offset:0 lds
    v_mfma_f32_16x16x32_bf16 v[204:207], a[100:103], a[52:55], v[204:207]
    v_exp_f32 v195, v195
    v_mfma_f32_16x16x32_bf16 v[204:207], a[96:99], a[48:51], v[204:207]
    ds_read_b64_tr_b16 a[84:85], v232 offset:24576
    v_cvt_pk_bf16_f32 v131, v194, v195
    v_mfma_f32_16x16x32_bf16 v[8:11], a[112:115], v[160:163], v[8:11]
    v_exp_f32 v196, v196
    v_mfma_f32_16x16x32_bf16 v[8:11], a[116:119], v[164:167], v[8:11]
    ds_read_b64_tr_b16 a[86:87], v232 offset:28672
    v_mfma_f32_16x16x32_bf16 v[40:43], a[116:119], v[172:175], v[40:43]
    v_exp_f32 v197, v197
    v_mfma_f32_16x16x32_bf16 v[40:43], a[112:115], v[168:171], v[40:43]
    ds_read_b64_tr_b16 a[88:89], v233 offset:16384
    v_cvt_pk_bf16_f32 v138, v196, v197
    v_mfma_f32_16x16x32_bf16 v[72:75], a[112:115], v[176:179], v[72:75]
    v_exp_f32 v198, v198
    v_mfma_f32_16x16x32_bf16 v[72:75], a[116:119], v[180:183], v[72:75]
    buffer_load_dwordx4 v237, s[32:35], s43 offen offset:1024 lds
    v_mfma_f32_16x16x32_bf16 v[104:107], a[116:119], v[188:191], v[104:107]
    v_exp_f32 v199, v199
    v_mfma_f32_16x16x32_bf16 v[104:107], a[112:115], v[184:187], v[104:107]
    ds_read_b64_tr_b16 a[90:91], v233 offset:20480
    v_cvt_pk_bf16_f32 v139, v198, v199
    v_mfma_f32_16x16x32_bf16 v[108:111], a[120:123], v[184:187], v[108:111]
    v_exp_f32 v200, v200
    v_mfma_f32_16x16x32_bf16 v[108:111], a[124:127], v[188:191], v[108:111]
    ds_read_b64_tr_b16 a[92:93], v233 offset:24576
    v_mfma_f32_16x16x32_bf16 v[76:79], a[124:127], v[180:183], v[76:79]
    v_exp_f32 v201, v201
    v_mfma_f32_16x16x32_bf16 v[76:79], a[120:123], v[176:179], v[76:79]
    ds_read_b64_tr_b16 a[94:95], v233 offset:28672
    v_cvt_pk_bf16_f32 v146, v200, v201
    v_mfma_f32_16x16x32_bf16 v[44:47], a[120:123], v[168:171], v[44:47]
    v_exp_f32 v202, v202
    v_mfma_f32_16x16x32_bf16 v[44:47], a[124:127], v[172:175], v[44:47]
    buffer_load_dwordx4 v[252:255], v240, s[68:71], 0 offen sc1
    v_mfma_f32_16x16x32_bf16 v[12:15], a[124:127], v[164:167], v[12:15]
    v_exp_f32 v203, v203
    v_mfma_f32_16x16x32_bf16 v[12:15], a[120:123], v[160:163], v[12:15]
    v_cvt_pk_bf16_f32 v147, v202, v203
    v_smfmac_f32_16x16x64_bf16 a[132:135], a[144:147], v[168:175], v241
    s_waitcnt lgkmcnt(0)
    v_mfma_f32_16x16x32_bf16 v[192:195], a[64:67], a[0:3], v[208:211]
    v_exp_f32 v204, v204
    v_mfma_f32_16x16x32_bf16 v[192:195], a[68:71], a[4:7], v[192:195]
    ds_read_b128 a[96:99], v224 offset:28672
    v_mfma_f32_16x16x32_bf16 v[192:195], a[72:75], a[8:11], v[192:195]
    v_exp_f32 v205, v205
    v_mfma_f32_16x16x32_bf16 v[192:195], a[76:79], a[12:15], v[192:195]
    ds_read_b128 a[100:103], v225 offset:28672
    v_cvt_pk_bf16_f32 v154, v204, v205
    v_mfma_f32_16x16x32_bf16 v[196:199], a[76:79], a[28:31], v[212:215]
    v_exp_f32 v206, v206
    v_mfma_f32_16x16x32_bf16 v[196:199], a[72:75], a[24:27], v[196:199]
    ds_read_b128 a[104:107], v226 offset:28672
    v_mfma_f32_16x16x32_bf16 v[196:199], a[68:71], a[20:23], v[196:199]
    v_exp_f32 v207, v207
    v_mfma_f32_16x16x32_bf16 v[196:199], a[64:67], a[16:19], v[196:199]
    ds_read_b128 a[108:111], v227 offset:28672
    v_cvt_pk_bf16_f32 v155, v206, v207
    v_mfma_f32_16x16x32_bf16 v[200:203], a[64:67], a[32:35], v[216:219]
    v_exp_f32 v192, v192
    v_mfma_f32_16x16x32_bf16 v[200:203], a[68:71], a[36:39], v[200:203]
    ds_read_b64_tr_b16 a[112:113], v234 offset:16384
    v_mfma_f32_16x16x32_bf16 v[200:203], a[72:75], a[40:43], v[200:203]
    v_exp_f32 v193, v193
    v_mfma_f32_16x16x32_bf16 v[200:203], a[76:79], a[44:47], v[200:203]
    ds_read_b64_tr_b16 a[114:115], v234 offset:20480
    v_cvt_pk_bf16_f32 v132, v192, v193
    v_mfma_f32_16x16x32_bf16 v[204:207], a[76:79], a[60:63], v[220:223]
    v_exp_f32 v194, v194
    v_mfma_f32_16x16x32_bf16 v[204:207], a[72:75], a[56:59], v[204:207]
    ds_read_b64_tr_b16 a[116:117], v234 offset:24576
    v_mfma_f32_16x16x32_bf16 v[204:207], a[68:71], a[52:55], v[204:207]
    v_exp_f32 v195, v195
    v_mfma_f32_16x16x32_bf16 v[204:207], a[64:67], a[48:51], v[204:207]
    ds_read_b64_tr_b16 a[118:119], v234 offset:28672
    v_cvt_pk_bf16_f32 v133, v194, v195
    v_mfma_f32_16x16x32_bf16 v[16:19], a[80:83], v[160:163], v[16:19]
    v_exp_f32 v196, v196
    v_mfma_f32_16x16x32_bf16 v[16:19], a[84:87], v[164:167], v[16:19]
    ds_read_b64_tr_b16 a[120:121], v235 offset:16384
    v_mfma_f32_16x16x32_bf16 v[48:51], a[84:87], v[172:175], v[48:51]
    v_exp_f32 v197, v197
    v_mfma_f32_16x16x32_bf16 v[48:51], a[80:83], v[168:171], v[48:51]
    ds_read_b64_tr_b16 a[122:123], v235 offset:20480
    v_cvt_pk_bf16_f32 v140, v196, v197
    v_mfma_f32_16x16x32_bf16 v[80:83], a[80:83], v[176:179], v[80:83]
    v_exp_f32 v198, v198
    v_mfma_f32_16x16x32_bf16 v[80:83], a[84:87], v[180:183], v[80:83]
    buffer_load_dwordx4 v238, s[32:35], s43 offen offset:2048 lds
    v_mfma_f32_16x16x32_bf16 v[112:115], a[84:87], v[188:191], v[112:115]
    v_exp_f32 v199, v199
    v_mfma_f32_16x16x32_bf16 v[112:115], a[80:83], v[184:187], v[112:115]
    ds_read_b64_tr_b16 a[124:125], v235 offset:24576
    v_cvt_pk_bf16_f32 v141, v198, v199
    v_mfma_f32_16x16x32_bf16 v[116:119], a[88:91], v[184:187], v[116:119]
    v_exp_f32 v200, v200
    v_mfma_f32_16x16x32_bf16 v[116:119], a[92:95], v[188:191], v[116:119]
    ds_read_b64_tr_b16 a[126:127], v235 offset:28672
    v_mfma_f32_16x16x32_bf16 v[84:87], a[92:95], v[180:183], v[84:87]
    v_exp_f32 v201, v201
    v_mfma_f32_16x16x32_bf16 v[84:87], a[88:91], v[176:179], v[84:87]
    v_cvt_pk_bf16_f32 v148, v200, v201
    v_mfma_f32_16x16x32_bf16 v[52:55], a[88:91], v[168:171], v[52:55]
    v_exp_f32 v202, v202
    v_mfma_f32_16x16x32_bf16 v[52:55], a[92:95], v[172:175], v[52:55]
    buffer_load_dwordx4 v239, s[32:35], s43 offen offset:3072 lds
    v_mfma_f32_16x16x32_bf16 v[20:23], a[92:95], v[164:167], v[20:23]
    s_add_u32 s43, s43, 12288
    v_exp_f32 v203, v203
    v_mfma_f32_16x16x32_bf16 v[20:23], a[88:91], v[160:163], v[20:23]
    s_waitcnt vmcnt(16) lgkmcnt(0)
    v_cvt_pk_bf16_f32 v149, v202, v203
    v_smfmac_f32_16x16x64_bf16 a[136:139], a[144:147], v[176:183], v241
    s_barrier
    v_mfma_f32_16x16x32_bf16 v[192:195], a[96:99], a[0:3], v[208:211]
    v_exp_f32 v204, v204
    v_mfma_f32_16x16x32_bf16 v[192:195], a[100:103], a[4:7], v[192:195]
    ds_read_b128 a[64:67], v224 offset:32768
    v_mfma_f32_16x16x32_bf16 v[192:195], a[104:107], a[8:11], v[192:195]
    v_exp_f32 v205, v205
    v_mfma_f32_16x16x32_bf16 v[192:195], a[108:111], a[12:15], v[192:195]
    ds_read_b128 a[68:71], v225 offset:32768
    v_cvt_pk_bf16_f32 v156, v204, v205
    v_mfma_f32_16x16x32_bf16 v[196:199], a[108:111], a[28:31], v[212:215]
    v_exp_f32 v206, v206
    v_mfma_f32_16x16x32_bf16 v[196:199], a[104:107], a[24:27], v[196:199]
    ds_read_b128 a[72:75], v226 offset:32768
    v_mfma_f32_16x16x32_bf16 v[196:199], a[100:103], a[20:23], v[196:199]
    v_exp_f32 v207, v207
    v_mfma_f32_16x16x32_bf16 v[196:199], a[96:99], a[16:19], v[196:199]
    ds_read_b128 a[76:79], v227 offset:32768
    v_cvt_pk_bf16_f32 v157, v206, v207
    v_mfma_f32_16x16x32_bf16 v[200:203], a[96:99], a[32:35], v[216:219]
    v_exp_f32 v192, v192
    v_mfma_f32_16x16x32_bf16 v[200:203], a[100:103], a[36:39], v[200:203]
    ds_read_b64_tr_b16 a[80:81], v228 offset:32768
    v_mfma_f32_16x16x32_bf16 v[200:203], a[104:107], a[40:43], v[200:203]
    v_exp_f32 v193, v193
    v_mfma_f32_16x16x32_bf16 v[200:203], a[108:111], a[44:47], v[200:203]
    ds_read_b64_tr_b16 a[82:83], v228 offset:36864
    v_cvt_pk_bf16_f32 v134, v192, v193
    v_mfma_f32_16x16x32_bf16 v[204:207], a[108:111], a[60:63], v[220:223]
    v_exp_f32 v194, v194
    v_mfma_f32_16x16x32_bf16 v[204:207], a[104:107], a[56:59], v[204:207]
    ds_read_b64_tr_b16 a[84:85], v228 offset:40960
    v_mfma_f32_16x16x32_bf16 v[204:207], a[100:103], a[52:55], v[204:207]
    v_exp_f32 v195, v195
    v_mfma_f32_16x16x32_bf16 v[204:207], a[96:99], a[48:51], v[204:207]
    ds_read_b64_tr_b16 a[86:87], v228 offset:45056
    v_cvt_pk_bf16_f32 v135, v194, v195
    v_mfma_f32_16x16x32_bf16 v[24:27], a[112:115], v[160:163], v[24:27]
    v_exp_f32 v196, v196
    v_mfma_f32_16x16x32_bf16 v[24:27], a[116:119], v[164:167], v[24:27]
    ds_read_b64_tr_b16 a[88:89], v229 offset:32768
    v_mfma_f32_16x16x32_bf16 v[56:59], a[116:119], v[172:175], v[56:59]
    v_exp_f32 v197, v197
    v_mfma_f32_16x16x32_bf16 v[56:59], a[112:115], v[168:171], v[56:59]
    ds_read_b64_tr_b16 a[90:91], v229 offset:36864
    v_cvt_pk_bf16_f32 v142, v196, v197
    v_mfma_f32_16x16x32_bf16 v[88:91], a[112:115], v[176:179], v[88:91]
    s_add_u32 m0, s46, 16384
    v_exp_f32 v198, v198
    v_mfma_f32_16x16x32_bf16 v[88:91], a[116:119], v[180:183], v[88:91]
    buffer_load_dwordx4 v236, s[32:35], s43 offen offset:0 lds
    v_mfma_f32_16x16x32_bf16 v[120:123], a[116:119], v[188:191], v[120:123]
    v_exp_f32 v199, v199
    v_mfma_f32_16x16x32_bf16 v[120:123], a[112:115], v[184:187], v[120:123]
    ds_read_b64_tr_b16 a[92:93], v229 offset:40960
    v_cvt_pk_bf16_f32 v143, v198, v199
    v_mfma_f32_16x16x32_bf16 v[124:127], a[120:123], v[184:187], v[124:127]
    v_exp_f32 v200, v200
    v_mfma_f32_16x16x32_bf16 v[124:127], a[124:127], v[188:191], v[124:127]
    ds_read_b64_tr_b16 a[94:95], v229 offset:45056
    v_mfma_f32_16x16x32_bf16 v[92:95], a[124:127], v[180:183], v[92:95]
    v_exp_f32 v201, v201
    v_mfma_f32_16x16x32_bf16 v[92:95], a[120:123], v[176:179], v[92:95]
    v_cvt_pk_bf16_f32 v150, v200, v201
    v_mfma_f32_16x16x32_bf16 v[60:63], a[120:123], v[168:171], v[60:63]
    v_exp_f32 v202, v202
    v_mfma_f32_16x16x32_bf16 v[60:63], a[124:127], v[172:175], v[60:63]
    buffer_load_dwordx4 v237, s[32:35], s43 offen offset:1024 lds
    v_mfma_f32_16x16x32_bf16 v[28:31], a[124:127], v[164:167], v[28:31]
    v_exp_f32 v203, v203
    v_mfma_f32_16x16x32_bf16 v[28:31], a[120:123], v[160:163], v[28:31]
    v_cvt_pk_bf16_f32 v151, v202, v203
    v_smfmac_f32_16x16x64_bf16 a[140:143], a[144:147], v[184:191], v241
    s_waitcnt lgkmcnt(0)
    v_mfma_f32_16x16x32_bf16 v[192:195], a[64:67], a[0:3], v[208:211]
    v_exp_f32 v204, v204
    v_mfma_f32_16x16x32_bf16 v[192:195], a[68:71], a[4:7], v[192:195]
    ds_read_b128 a[96:99], v224 offset:36864
    s_add_u32 s10, s8, K1_end-K1_pc+(-32768)
    s_addc_u32 s11, s9, 0
    v_mfma_f32_16x16x32_bf16 v[192:195], a[72:75], a[8:11], v[192:195]
    v_exp_f32 v205, v205
    v_mfma_f32_16x16x32_bf16 v[192:195], a[76:79], a[12:15], v[192:195]
    ds_read_b128 a[100:103], v225 offset:36864
    v_cvt_pk_bf16_f32 v158, v204, v205
    v_mfma_f32_16x16x32_bf16 v[196:199], a[76:79], a[28:31], v[212:215]
    v_exp_f32 v206, v206
    v_mfma_f32_16x16x32_bf16 v[196:199], a[72:75], a[24:27], v[196:199]
    ds_read_b128 a[104:107], v226 offset:36864
    v_mad_u64_u32 v[244:245], vcc, v250, 1, s[10:11]
    v_mfma_f32_16x16x32_bf16 v[196:199], a[68:71], a[20:23], v[196:199]
    v_exp_f32 v207, v207
    v_mfma_f32_16x16x32_bf16 v[196:199], a[64:67], a[16:19], v[196:199]
    ds_read_b128 a[108:111], v227 offset:36864
    v_cvt_pk_bf16_f32 v159, v206, v207
    v_mfma_f32_16x16x32_bf16 v[200:203], a[64:67], a[32:35], v[216:219]
    v_exp_f32 v192, v192
    v_mfma_f32_16x16x32_bf16 v[200:203], a[68:71], a[36:39], v[200:203]
    ds_read_b64_tr_b16 a[112:113], v230 offset:32768
    v_mfma_f32_16x16x32_bf16 v[200:203], a[72:75], a[40:43], v[200:203]
    v_exp_f32 v193, v193
    v_mfma_f32_16x16x32_bf16 v[200:203], a[76:79], a[44:47], v[200:203]
    ds_read_b64_tr_b16 a[114:115], v230 offset:36864
    v_cvt_pk_bf16_f32 v160, v192, v193
    v_mfma_f32_16x16x32_bf16 v[204:207], a[76:79], a[60:63], v[220:223]
    v_exp_f32 v194, v194
    v_mfma_f32_16x16x32_bf16 v[204:207], a[72:75], a[56:59], v[204:207]
    ds_read_b64_tr_b16 a[116:117], v230 offset:40960
    v_mfma_f32_16x16x32_bf16 v[204:207], a[68:71], a[52:55], v[204:207]
    v_exp_f32 v195, v195
    v_mfma_f32_16x16x32_bf16 v[204:207], a[64:67], a[48:51], v[204:207]
    ds_read_b64_tr_b16 a[118:119], v230 offset:45056
    v_cvt_pk_bf16_f32 v161, v194, v195
    v_mfma_f32_16x16x32_bf16 v[0:3], a[80:83], v[128:131], v[0:3]
    v_exp_f32 v196, v196
    v_mfma_f32_16x16x32_bf16 v[0:3], a[84:87], v[132:135], v[0:3]
    ds_read_b64_tr_b16 a[120:121], v231 offset:32768
    v_mfma_f32_16x16x32_bf16 v[32:35], a[84:87], v[140:143], v[32:35]
    v_exp_f32 v197, v197
    v_mfma_f32_16x16x32_bf16 v[32:35], a[80:83], v[136:139], v[32:35]
    ds_read_b64_tr_b16 a[122:123], v231 offset:36864
    v_cvt_pk_bf16_f32 v168, v196, v197
    v_mfma_f32_16x16x32_bf16 v[64:67], a[80:83], v[144:147], v[64:67]
    v_exp_f32 v198, v198
    v_mfma_f32_16x16x32_bf16 v[64:67], a[84:87], v[148:151], v[64:67]
    buffer_load_dwordx4 v238, s[32:35], s43 offen offset:2048 lds
    v_mfma_f32_16x16x32_bf16 v[96:99], a[84:87], v[156:159], v[96:99]
    v_exp_f32 v199, v199
    v_mfma_f32_16x16x32_bf16 v[96:99], a[80:83], v[152:155], v[96:99]
    ds_read_b64_tr_b16 a[124:125], v231 offset:40960
    v_cvt_pk_bf16_f32 v169, v198, v199
    v_mfma_f32_16x16x32_bf16 v[100:103], a[88:91], v[152:155], v[100:103]
    v_exp_f32 v200, v200
    v_mfma_f32_16x16x32_bf16 v[100:103], a[92:95], v[156:159], v[100:103]
    ds_read_b64_tr_b16 a[126:127], v231 offset:45056
    v_mfma_f32_16x16x32_bf16 v[68:71], a[92:95], v[148:151], v[68:71]
    v_exp_f32 v201, v201
    v_mfma_f32_16x16x32_bf16 v[68:71], a[88:91], v[144:147], v[68:71]
    v_cvt_pk_bf16_f32 v176, v200, v201
    v_mfma_f32_16x16x32_bf16 v[36:39], a[88:91], v[136:139], v[36:39]
    v_exp_f32 v202, v202
    v_mfma_f32_16x16x32_bf16 v[36:39], a[92:95], v[140:143], v[36:39]
    buffer_load_dwordx4 v239, s[32:35], s43 offen offset:3072 lds
    v_mfma_f32_16x16x32_bf16 v[4:7], a[92:95], v[132:135], v[4:7]
    s_add_u32 s43, s43, 4096
    v_exp_f32 v203, v203
    v_mfma_f32_16x16x32_bf16 v[4:7], a[88:91], v[128:131], v[4:7]
    v_cvt_pk_bf16_f32 v177, v202, v203
    v_smfmac_f32_16x16x64_bf16 a[128:131], a[144:147], v[128:135], v241
    s_waitcnt lgkmcnt(0)
    v_mfma_f32_16x16x32_bf16 v[192:195], a[96:99], a[0:3], v[208:211]
    v_exp_f32 v204, v204
    v_mfma_f32_16x16x32_bf16 v[192:195], a[100:103], a[4:7], v[192:195]
    ds_read_b128 a[64:67], v224 offset:40960
    v_mfma_f32_16x16x32_bf16 v[192:195], a[104:107], a[8:11], v[192:195]
    v_exp_f32 v205, v205
    v_mfma_f32_16x16x32_bf16 v[192:195], a[108:111], a[12:15], v[192:195]
    ds_read_b128 a[68:71], v225 offset:40960
    v_cvt_pk_bf16_f32 v184, v204, v205
    v_mfma_f32_16x16x32_bf16 v[196:199], a[108:111], a[28:31], v[212:215]
    v_exp_f32 v206, v206
    v_mfma_f32_16x16x32_bf16 v[196:199], a[104:107], a[24:27], v[196:199]
    ds_read_b128 a[72:75], v226 offset:40960
    v_mfma_f32_16x16x32_bf16 v[196:199], a[100:103], a[20:23], v[196:199]
    v_exp_f32 v207, v207
    v_mfma_f32_16x16x32_bf16 v[196:199], a[96:99], a[16:19], v[196:199]
    ds_read_b128 a[76:79], v227 offset:40960
    v_cvt_pk_bf16_f32 v185, v206, v207
    v_mfma_f32_16x16x32_bf16 v[200:203], a[96:99], a[32:35], v[216:219]
    v_exp_f32 v192, v192
    v_mfma_f32_16x16x32_bf16 v[200:203], a[100:103], a[36:39], v[200:203]
    ds_read_b64_tr_b16 a[80:81], v232 offset:32768
    v_mfma_f32_16x16x32_bf16 v[200:203], a[104:107], a[40:43], v[200:203]
    v_exp_f32 v193, v193
    v_mfma_f32_16x16x32_bf16 v[200:203], a[108:111], a[44:47], v[200:203]
    ds_read_b64_tr_b16 a[82:83], v232 offset:36864
    v_cvt_pk_bf16_f32 v162, v192, v193
    v_mfma_f32_16x16x32_bf16 v[204:207], a[108:111], a[60:63], v[220:223]
    s_add_u32 m0, s46, 20480
    v_exp_f32 v194, v194
    v_mfma_f32_16x16x32_bf16 v[204:207], a[104:107], a[56:59], v[204:207]
    buffer_load_dwordx4 v236, s[32:35], s43 offen offset:0 lds
    v_mfma_f32_16x16x32_bf16 v[204:207], a[100:103], a[52:55], v[204:207]
    v_exp_f32 v195, v195
    v_mfma_f32_16x16x32_bf16 v[204:207], a[96:99], a[48:51], v[204:207]
    ds_read_b64_tr_b16 a[84:85], v232 offset:40960
    v_cvt_pk_bf16_f32 v163, v194, v195
    v_mfma_f32_16x16x32_bf16 v[8:11], a[112:115], v[128:131], v[8:11]
    v_exp_f32 v196, v196
    v_mfma_f32_16x16x32_bf16 v[8:11], a[116:119], v[132:135], v[8:11]
    ds_read_b64_tr_b16 a[86:87], v232 offset:45056
    v_mfma_f32_16x16x32_bf16 v[40:43], a[116:119], v[140:143], v[40:43]
    v_exp_f32 v197, v197
    v_mfma_f32_16x16x32_bf16 v[40:43], a[112:115], v[136:139], v[40:43]
    ds_read_b64_tr_b16 a[88:89], v233 offset:32768
    v_cvt_pk_bf16_f32 v170, v196, v197
    v_mfma_f32_16x16x32_bf16 v[72:75], a[112:115], v[144:147], v[72:75]
    v_exp_f32 v198, v198
    v_mfma_f32_16x16x32_bf16 v[72:75], a[116:119], v[148:151], v[72:75]
    buffer_load_dwordx4 v237, s[32:35], s43 offen offset:1024 lds
    v_mfma_f32_16x16x32_bf16 v[104:107], a[116:119], v[156:159], v[104:107]
    v_exp_f32 v199, v199
    v_mfma_f32_16x16x32_bf16 v[104:107], a[112:115], v[152:155], v[104:107]
    ds_read_b64_tr_b16 a[90:91], v233 offset:36864
    v_cvt_pk_bf16_f32 v171, v198, v199
    v_mfma_f32_16x16x32_bf16 v[108:111], a[120:123], v[152:155], v[108:111]
    v_exp_f32 v200, v200
    v_mfma_f32_16x16x32_bf16 v[108:111], a[124:127], v[156:159], v[108:111]
    ds_read_b64_tr_b16 a[92:93], v233 offset:40960
    v_mfma_f32_16x16x32_bf16 v[76:79], a[124:127], v[148:151], v[76:79]
    v_exp_f32 v201, v201
    v_mfma_f32_16x16x32_bf16 v[76:79], a[120:123], v[144:147], v[76:79]
    ds_read_b64_tr_b16 a[94:95], v233 offset:45056
    v_cvt_pk_bf16_f32 v178, v200, v201
    v_mfma_f32_16x16x32_bf16 v[44:47], a[120:123], v[136:139], v[44:47]
    v_exp_f32 v202, v202
    v_mfma_f32_16x16x32_bf16 v[44:47], a[124:127], v[140:143], v[44:47]
    global_load_dword v247, v[244:245], off
    v_mfma_f32_16x16x32_bf16 v[12:15], a[124:127], v[132:135], v[12:15]
    v_exp_f32 v203, v203
    v_mfma_f32_16x16x32_bf16 v[12:15], a[120:123], v[128:131], v[12:15]
    v_cvt_pk_bf16_f32 v179, v202, v203
    v_smfmac_f32_16x16x64_bf16 a[132:135], a[144:147], v[136:143], v241
    s_waitcnt lgkmcnt(0)
    v_mfma_f32_16x16x32_bf16 v[192:195], a[64:67], a[0:3], v[208:211]
    v_exp_f32 v204, v204
    v_mfma_f32_16x16x32_bf16 v[192:195], a[68:71], a[4:7], v[192:195]
    ds_read_b128 a[96:99], v224 offset:45056
    v_mov_b32 v242, s0
    v_mfma_f32_16x16x32_bf16 v[192:195], a[72:75], a[8:11], v[192:195]
    v_exp_f32 v205, v205
    v_mfma_f32_16x16x32_bf16 v[192:195], a[76:79], a[12:15], v[192:195]
    ds_read_b128 a[100:103], v225 offset:45056
    v_cvt_pk_bf16_f32 v186, v204, v205
    v_mfma_f32_16x16x32_bf16 v[196:199], a[76:79], a[28:31], v[212:215]
    v_exp_f32 v206, v206
    v_mfma_f32_16x16x32_bf16 v[196:199], a[72:75], a[24:27], v[196:199]
    ds_read_b128 a[104:107], v226 offset:45056
    v_mfma_f32_16x16x32_bf16 v[196:199], a[68:71], a[20:23], v[196:199]
    v_exp_f32 v207, v207
    v_mfma_f32_16x16x32_bf16 v[196:199], a[64:67], a[16:19], v[196:199]
    ds_read_b128 a[108:111], v227 offset:45056
    v_cvt_pk_bf16_f32 v187, v206, v207
    v_mfma_f32_16x16x32_bf16 v[200:203], a[64:67], a[32:35], v[216:219]
    v_exp_f32 v192, v192
    v_mfma_f32_16x16x32_bf16 v[200:203], a[68:71], a[36:39], v[200:203]
    ds_read_b64_tr_b16 a[112:113], v234 offset:32768
    v_mfma_f32_16x16x32_bf16 v[200:203], a[72:75], a[40:43], v[200:203]
    v_exp_f32 v193, v193
    v_mfma_f32_16x16x32_bf16 v[200:203], a[76:79], a[44:47], v[200:203]
    ds_read_b64_tr_b16 a[114:115], v234 offset:36864
    v_cvt_pk_bf16_f32 v164, v192, v193
    v_mfma_f32_16x16x32_bf16 v[204:207], a[76:79], a[60:63], v[220:223]
    v_exp_f32 v194, v194
    v_mfma_f32_16x16x32_bf16 v[204:207], a[72:75], a[56:59], v[204:207]
    ds_read_b64_tr_b16 a[116:117], v234 offset:40960
    v_mfma_f32_16x16x32_bf16 v[204:207], a[68:71], a[52:55], v[204:207]
    v_exp_f32 v195, v195
    v_mfma_f32_16x16x32_bf16 v[204:207], a[64:67], a[48:51], v[204:207]
    ds_read_b64_tr_b16 a[118:119], v234 offset:45056
    v_cvt_pk_bf16_f32 v165, v194, v195
    v_mfma_f32_16x16x32_bf16 v[16:19], a[80:83], v[128:131], v[16:19]
    v_exp_f32 v196, v196
    v_mfma_f32_16x16x32_bf16 v[16:19], a[84:87], v[132:135], v[16:19]
    ds_read_b64_tr_b16 a[120:121], v235 offset:32768
    v_mfma_f32_16x16x32_bf16 v[48:51], a[84:87], v[140:143], v[48:51]
    v_exp_f32 v197, v197
    v_mfma_f32_16x16x32_bf16 v[48:51], a[80:83], v[136:139], v[48:51]
    ds_read_b64_tr_b16 a[122:123], v235 offset:36864
    v_cvt_pk_bf16_f32 v172, v196, v197
    v_mfma_f32_16x16x32_bf16 v[80:83], a[80:83], v[144:147], v[80:83]
    v_exp_f32 v198, v198
    v_mfma_f32_16x16x32_bf16 v[80:83], a[84:87], v[148:151], v[80:83]
    buffer_load_dwordx4 v238, s[32:35], s43 offen offset:2048 lds
    v_mfma_f32_16x16x32_bf16 v[112:115], a[84:87], v[156:159], v[112:115]
    v_exp_f32 v199, v199
    v_mfma_f32_16x16x32_bf16 v[112:115], a[80:83], v[152:155], v[112:115]
    ds_read_b64_tr_b16 a[124:125], v235 offset:40960
    v_cvt_pk_bf16_f32 v173, v198, v199
    v_mfma_f32_16x16x32_bf16 v[116:119], a[88:91], v[152:155], v[116:119]
    v_exp_f32 v200, v200
    v_mfma_f32_16x16x32_bf16 v[116:119], a[92:95], v[156:159], v[116:119]
    ds_read_b64_tr_b16 a[126:127], v235 offset:45056
    v_mfma_f32_16x16x32_bf16 v[84:87], a[92:95], v[148:151], v[84:87]
    v_exp_f32 v201, v201
    v_mfma_f32_16x16x32_bf16 v[84:87], a[88:91], v[144:147], v[84:87]
    v_cvt_pk_bf16_f32 v180, v200, v201
    v_mfma_f32_16x16x32_bf16 v[52:55], a[88:91], v[136:139], v[52:55]
    v_exp_f32 v202, v202
    v_mfma_f32_16x16x32_bf16 v[52:55], a[92:95], v[140:143], v[52:55]
    buffer_load_dwordx4 v239, s[32:35], s43 offen offset:3072 lds
    v_mfma_f32_16x16x32_bf16 v[20:23], a[92:95], v[132:135], v[20:23]
    s_add_u32 s43, s43, 12288
    v_exp_f32 v203, v203
    v_mfma_f32_16x16x32_bf16 v[20:23], a[88:91], v[128:131], v[20:23]
    s_waitcnt vmcnt(16) lgkmcnt(0)
    v_cvt_pk_bf16_f32 v181, v202, v203
    v_smfmac_f32_16x16x64_bf16 a[136:139], a[144:147], v[144:151], v241
    s_barrier
    v_mfma_f32_16x16x32_bf16 v[192:195], a[96:99], a[0:3], v[208:211]
K1_pg8:
    s_cbranch_execz K1_pg12
    v_exp_f32 v204, v204
    v_mfma_f32_16x16x32_bf16 v[192:195], a[100:103], a[4:7], v[192:195]
    ds_read_b128 a[64:67], v224 offset:49152
    v_mfma_f32_16x16x32_bf16 v[192:195], a[104:107], a[8:11], v[192:195]
    v_exp_f32 v205, v205
    v_mfma_f32_16x16x32_bf16 v[192:195], a[108:111], a[12:15], v[192:195]
    ds_read_b128 a[68:71], v225 offset:49152
    v_cvt_pk_bf16_f32 v188, v204, v205
    v_mfma_f32_16x16x32_bf16 v[196:199], a[108:111], a[28:31], v[212:215]
    v_exp_f32 v206, v206
    v_mfma_f32_16x16x32_bf16 v[196:199], a[104:107], a[24:27], v[196:199]
    ds_read_b128 a[72:75], v226 offset:49152
    v_mfma_f32_16x16x32_bf16 v[196:199], a[100:103], a[20:23], v[196:199]
    v_exp_f32 v207, v207
    v_mfma_f32_16x16x32_bf16 v[196:199], a[96:99], a[16:19], v[196:199]
    ds_read_b128 a[76:79], v227 offset:49152
    v_cvt_pk_bf16_f32 v189, v206, v207
    v_mfma_f32_16x16x32_bf16 v[200:203], a[96:99], a[32:35], v[216:219]
    v_exp_f32 v192, v192
    v_mfma_f32_16x16x32_bf16 v[200:203], a[100:103], a[36:39], v[200:203]
    ds_read_b64_tr_b16 a[80:81], v228 offset:49152
    v_mfma_f32_16x16x32_bf16 v[200:203], a[104:107], a[40:43], v[200:203]
    v_exp_f32 v193, v193
    v_mfma_f32_16x16x32_bf16 v[200:203], a[108:111], a[44:47], v[200:203]
    ds_read_b64_tr_b16 a[82:83], v228 offset:53248
    v_cvt_pk_bf16_f32 v166, v192, v193
    v_mfma_f32_16x16x32_bf16 v[204:207], a[108:111], a[60:63], v[220:223]
    s_add_u32 m0, s46, 32768
    v_exp_f32 v194, v194
    v_mfma_f32_16x16x32_bf16 v[204:207], a[104:107], a[56:59], v[204:207]
    buffer_load_dwordx4 v236, s[32:35], s43 offen offset:0 lds
    v_mfma_f32_16x16x32_bf16 v[204:207], a[100:103], a[52:55], v[204:207]
    v_exp_f32 v195, v195
    v_mfma_f32_16x16x32_bf16 v[204:207], a[96:99], a[48:51], v[204:207]
    ds_read_b64_tr_b16 a[84:85], v228 offset:57344
    v_cvt_pk_bf16_f32 v167, v194, v195
    v_mfma_f32_16x16x32_bf16 v[24:27], a[112:115], v[128:131], v[24:27]
    v_exp_f32 v196, v196
    v_mfma_f32_16x16x32_bf16 v[24:27], a[116:119], v[132:135], v[24:27]
    ds_read_b64_tr_b16 a[86:87], v228 offset:61440
    v_mfma_f32_16x16x32_bf16 v[56:59], a[116:119], v[140:143], v[56:59]
    v_exp_f32 v197, v197
    v_mfma_f32_16x16x32_bf16 v[56:59], a[112:115], v[136:139], v[56:59]
    ds_read_b64_tr_b16 a[88:89], v229 offset:49152
    v_cvt_pk_bf16_f32 v174, v196, v197
    v_mfma_f32_16x16x32_bf16 v[88:91], a[112:115], v[144:147], v[88:91]
    v_exp_f32 v198, v198
    v_mfma_f32_16x16x32_bf16 v[88:91], a[116:119], v[148:151], v[88:91]
    buffer_load_dwordx4 v237, s[32:35], s43 offen offset:1024 lds
    v_mfma_f32_16x16x32_bf16 v[120:123], a[116:119], v[156:159], v[120:123]
    v_exp_f32 v199, v199
    v_mfma_f32_16x16x32_bf16 v[120:123], a[112:115], v[152:155], v[120:123]
    ds_read_b64_tr_b16 a[90:91], v229 offset:53248
    v_cvt_pk_bf16_f32 v175, v198, v199
    v_mfma_f32_16x16x32_bf16 v[124:127], a[120:123], v[152:155], v[124:127]
    v_exp_f32 v200, v200
    v_mfma_f32_16x16x32_bf16 v[124:127], a[124:127], v[156:159], v[124:127]
    ds_read_b64_tr_b16 a[92:93], v229 offset:57344
    v_mfma_f32_16x16x32_bf16 v[92:95], a[124:127], v[148:151], v[92:95]
    v_exp_f32 v201, v201
    v_mfma_f32_16x16x32_bf16 v[92:95], a[120:123], v[144:147], v[92:95]
    ds_read_b64_tr_b16 a[94:95], v229 offset:61440
    v_cvt_pk_bf16_f32 v182, v200, v201
    v_mfma_f32_16x16x32_bf16 v[60:63], a[120:123], v[136:139], v[60:63]
    v_exp_f32 v202, v202
    v_mfma_f32_16x16x32_bf16 v[60:63], a[124:127], v[140:143], v[60:63]
    buffer_store_dword v242, v251, s[68:71], 0 offen sc1
    v_mfma_f32_16x16x32_bf16 v[28:31], a[124:127], v[132:135], v[28:31]
    v_exp_f32 v203, v203
    v_mfma_f32_16x16x32_bf16 v[28:31], a[120:123], v[128:131], v[28:31]
    v_cvt_pk_bf16_f32 v183, v202, v203
    v_smfmac_f32_16x16x64_bf16 a[140:143], a[144:147], v[152:159], v241
    s_waitcnt lgkmcnt(0)
    v_mfma_f32_16x16x32_bf16 v[192:195], a[64:67], a[0:3], v[208:211]
    v_exp_f32 v204, v204
    v_mfma_f32_16x16x32_bf16 v[192:195], a[68:71], a[4:7], v[192:195]
    ds_read_b128 a[96:99], v224 offset:53248
    v_mfma_f32_16x16x32_bf16 v[192:195], a[72:75], a[8:11], v[192:195]
    v_exp_f32 v205, v205
    v_mfma_f32_16x16x32_bf16 v[192:195], a[76:79], a[12:15], v[192:195]
    ds_read_b128 a[100:103], v225 offset:53248
    v_cvt_pk_bf16_f32 v190, v204, v205
    v_mfma_f32_16x16x32_bf16 v[196:199], a[76:79], a[28:31], v[212:215]
    v_exp_f32 v206, v206
    v_mfma_f32_16x16x32_bf16 v[196:199], a[72:75], a[24:27], v[196:199]
    ds_read_b128 a[104:107], v226 offset:53248
    v_mfma_f32_16x16x32_bf16 v[196:199], a[68:71], a[20:23], v[196:199]
    v_exp_f32 v207, v207
    v_mfma_f32_16x16x32_bf16 v[196:199], a[64:67], a[16:19], v[196:199]
    ds_read_b128 a[108:111], v227 offset:53248
    v_cvt_pk_bf16_f32 v191, v206, v207
    v_mfma_f32_16x16x32_bf16 v[200:203], a[64:67], a[32:35], v[216:219]
    v_exp_f32 v192, v192
    v_mfma_f32_16x16x32_bf16 v[200:203], a[68:71], a[36:39], v[200:203]
    ds_read_b64_tr_b16 a[112:113], v230 offset:49152
    v_mfma_f32_16x16x32_bf16 v[200:203], a[72:75], a[40:43], v[200:203]
    v_exp_f32 v193, v193
    v_mfma_f32_16x16x32_bf16 v[200:203], a[76:79], a[44:47], v[200:203]
    ds_read_b64_tr_b16 a[114:115], v230 offset:53248
    v_cvt_pk_bf16_f32 v128, v192, v193
    v_mfma_f32_16x16x32_bf16 v[204:207], a[76:79], a[60:63], v[220:223]
    v_exp_f32 v194, v194
    v_mfma_f32_16x16x32_bf16 v[204:207], a[72:75], a[56:59], v[204:207]
    ds_read_b64_tr_b16 a[116:117], v230 offset:57344
    v_mfma_f32_16x16x32_bf16 v[204:207], a[68:71], a[52:55], v[204:207]
    v_exp_f32 v195, v195
    v_mfma_f32_16x16x32_bf16 v[204:207], a[64:67], a[48:51], v[204:207]
    ds_read_b64_tr_b16 a[118:119], v230 offset:61440
    v_cvt_pk_bf16_f32 v129, v194, v195
    v_mfma_f32_16x16x32_bf16 v[0:3], a[80:83], v[160:163], v[0:3]
    v_exp_f32 v196, v196
    v_mfma_f32_16x16x32_bf16 v[0:3], a[84:87], v[164:167], v[0:3]
    ds_read_b64_tr_b16 a[120:121], v231 offset:49152
    v_mfma_f32_16x16x32_bf16 v[32:35], a[84:87], v[172:175], v[32:35]
    v_exp_f32 v197, v197
    v_mfma_f32_16x16x32_bf16 v[32:35], a[80:83], v[168:171], v[32:35]
    ds_read_b64_tr_b16 a[122:123], v231 offset:53248
    v_cvt_pk_bf16_f32 v136, v196, v197
    v_mfma_f32_16x16x32_bf16 v[64:67], a[80:83], v[176:179], v[64:67]
    v_exp_f32 v198, v198
    v_mfma_f32_16x16x32_bf16 v[64:67], a[84:87], v[180:183], v[64:67]
    buffer_load_dwordx4 v238, s[32:35], s43 offen offset:2048 lds
    v_mfma_f32_16x16x32_bf16 v[96:99], a[84:87], v[188:191], v[96:99]
    v_exp_f32 v199, v199
    v_mfma_f32_16x16x32_bf16 v[96:99], a[80:83], v[184:187], v[96:99]
    ds_read_b64_tr_b16 a[124:125], v231 offset:57344
    v_cvt_pk_bf16_f32 v137, v198, v199
    v_mfma_f32_16x16x32_bf16 v[100:103], a[88:91], v[184:187], v[100:103]
    v_exp_f32 v200, v200
    v_mfma_f32_16x16x32_bf16 v[100:103], a[92:95], v[188:191], v[100:103]
    ds_read_b64_tr_b16 a[126:127], v231 offset:61440
    v_mfma_f32_16x16x32_bf16 v[68:71], a[92:95], v[180:183], v[68:71]
    v_exp_f32 v201, v201
    v_mfma_f32_16x16x32_bf16 v[68:71], a[88:91], v[176:179], v[68:71]
    v_cvt_pk_bf16_f32 v144, v200, v201
    v_mfma_f32_16x16x32_bf16 v[36:39], a[88:91], v[168:171], v[36:39]
    v_exp_f32 v202, v202
    v_mfma_f32_16x16x32_bf16 v[36:39], a[92:95], v[172:175], v[36:39]
    buffer_load_dwordx4 v239, s[32:35], s43 offen offset:3072 lds
    v_mfma_f32_16x16x32_bf16 v[4:7], a[92:95], v[164:167], v[4:7]
    s_add_u32 s43, s43, 4096
    v_exp_f32 v203, v203
    v_mfma_f32_16x16x32_bf16 v[4:7], a[88:91], v[160:163], v[4:7]
    v_cvt_pk_bf16_f32 v145, v202, v203
    v_smfmac_f32_16x16x64_bf16 a[128:131], a[144:147], v[160:167], v241
    s_waitcnt lgkmcnt(0)
    v_mfma_f32_16x16x32_bf16 v[192:195], a[96:99], a[0:3], v[208:211]
    v_exp_f32 v204, v204
    v_mfma_f32_16x16x32_bf16 v[192:195], a[100:103], a[4:7], v[192:195]
    ds_read_b128 a[64:67], v224 offset:57344
    v_mfma_f32_16x16x32_bf16 v[192:195], a[104:107], a[8:11], v[192:195]
    v_exp_f32 v205, v205
    v_mfma_f32_16x16x32_bf16 v[192:195], a[108:111], a[12:15], v[192:195]
    ds_read_b128 a[68:71], v225 offset:57344
    v_cvt_pk_bf16_f32 v152, v204, v205
    v_mfma_f32_16x16x32_bf16 v[196:199], a[108:111], a[28:31], v[212:215]
    v_exp_f32 v206, v206
    v_mfma_f32_16x16x32_bf16 v[196:199], a[104:107], a[24:27], v[196:199]
    ds_read_b128 a[72:75], v226 offset:57344
    v_mfma_f32_16x16x32_bf16 v[196:199], a[100:103], a[20:23], v[196:199]
    v_exp_f32 v207, v207
    v_mfma_f32_16x16x32_bf16 v[196:199], a[96:99], a[16:19], v[196:199]
    ds_read_b128 a[76:79], v227 offset:57344
    v_cvt_pk_bf16_f32 v153, v206, v207
    v_mfma_f32_16x16x32_bf16 v[200:203], a[96:99], a[32:35], v[216:219]
    v_exp_f32 v192, v192
    v_mfma_f32_16x16x32_bf16 v[200:203], a[100:103], a[36:39], v[200:203]
    ds_read_b64_tr_b16 a[80:81], v232 offset:49152
    v_mfma_f32_16x16x32_bf16 v[200:203], a[104:107], a[40:43], v[200:203]
    v_exp_f32 v193, v193
    v_mfma_f32_16x16x32_bf16 v[200:203], a[108:111], a[44:47], v[200:203]
    ds_read_b64_tr_b16 a[82:83], v232 offset:53248
    v_cvt_pk_bf16_f32 v130, v192, v193
    v_mfma_f32_16x16x32_bf16 v[204:207], a[108:111], a[60:63], v[220:223]
    v_exp_f32 v194, v194
    v_mfma_f32_16x16x32_bf16 v[204:207], a[104:107], a[56:59], v[204:207]
    ds_read_b64_tr_b16 a[84:85], v232 offset:57344
    v_mfma_f32_16x16x32_bf16 v[204:207], a[100:103], a[52:55], v[204:207]
    v_exp_f32 v195, v195
    v_mfma_f32_16x16x32_bf16 v[204:207], a[96:99], a[48:51], v[204:207]
    ds_read_b64_tr_b16 a[86:87], v232 offset:61440
    v_cvt_pk_bf16_f32 v131, v194, v195
    v_mfma_f32_16x16x32_bf16 v[8:11], a[112:115], v[160:163], v[8:11]
    v_exp_f32 v196, v196
    v_mfma_f32_16x16x32_bf16 v[8:11], a[116:119], v[164:167], v[8:11]
    ds_read_b64_tr_b16 a[88:89], v233 offset:49152
    v_mfma_f32_16x16x32_bf16 v[40:43], a[116:119], v[172:175], v[40:43]
    v_exp_f32 v197, v197
    v_mfma_f32_16x16x32_bf16 v[40:43], a[112:115], v[168:171], v[40:43]
    ds_read_b64_tr_b16 a[90:91], v233 offset:53248
    v_cvt_pk_bf16_f32 v138, v196, v197
    v_mfma_f32_16x16x32_bf16 v[72:75], a[112:115], v[176:179], v[72:75]
    s_add_u32 m0, s46, 36864
    v_exp_f32 v198, v198
    v_mfma_f32_16x16x32_bf16 v[72:75], a[116:119], v[180:183], v[72:75]
    buffer_load_dwordx4 v236, s[32:35], s43 offen offset:0 lds
    v_mfma_f32_16x16x32_bf16 v[104:107], a[116:119], v[188:191], v[104:107]
    v_exp_f32 v199, v199
    v_mfma_f32_16x16x32_bf16 v[104:107], a[112:115], v[184:187], v[104:107]
    ds_read_b64_tr_b16 a[92:93], v233 offset:57344
    v_cvt_pk_bf16_f32 v139, v198, v199
    v_mfma_f32_16x16x32_bf16 v[108:111], a[120:123], v[184:187], v[108:111]
    v_exp_f32 v200, v200
    v_mfma_f32_16x16x32_bf16 v[108:111], a[124:127], v[188:191], v[108:111]
    ds_read_b64_tr_b16 a[94:95], v233 offset:61440
    v_mfma_f32_16x16x32_bf16 v[76:79], a[124:127], v[180:183], v[76:79]
    v_exp_f32 v201, v201
    v_mfma_f32_16x16x32_bf16 v[76:79], a[120:123], v[176:179], v[76:79]
    v_cvt_pk_bf16_f32 v146, v200, v201
    v_mfma_f32_16x16x32_bf16 v[44:47], a[120:123], v[168:171], v[44:47]
    v_exp_f32 v202, v202
    v_mfma_f32_16x16x32_bf16 v[44:47], a[124:127], v[172:175], v[44:47]
    buffer_load_dwordx4 v237, s[32:35], s43 offen offset:1024 lds
    v_mfma_f32_16x16x32_bf16 v[12:15], a[124:127], v[164:167], v[12:15]
    v_exp_f32 v203, v203
    v_mfma_f32_16x16x32_bf16 v[12:15], a[120:123], v[160:163], v[12:15]
    v_cvt_pk_bf16_f32 v147, v202, v203
    v_smfmac_f32_16x16x64_bf16 a[132:135], a[144:147], v[168:175], v241
    s_waitcnt lgkmcnt(0)
    v_mfma_f32_16x16x32_bf16 v[192:195], a[64:67], a[0:3], v[208:211]
    v_exp_f32 v204, v204
    v_mfma_f32_16x16x32_bf16 v[192:195], a[68:71], a[4:7], v[192:195]
    ds_read_b128 a[96:99], v224 offset:61440
    v_mfma_f32_16x16x32_bf16 v[192:195], a[72:75], a[8:11], v[192:195]
    v_exp_f32 v205, v205
    v_mfma_f32_16x16x32_bf16 v[192:195], a[76:79], a[12:15], v[192:195]
    ds_read_b128 a[100:103], v225 offset:61440
    v_cvt_pk_bf16_f32 v154, v204, v205
    v_mfma_f32_16x16x32_bf16 v[196:199], a[76:79], a[28:31], v[212:215]
    v_exp_f32 v206, v206
    v_mfma_f32_16x16x32_bf16 v[196:199], a[72:75], a[24:27], v[196:199]
    ds_read_b128 a[104:107], v226 offset:61440
    v_mfma_f32_16x16x32_bf16 v[196:199], a[68:71], a[20:23], v[196:199]
    v_exp_f32 v207, v207
    v_mfma_f32_16x16x32_bf16 v[196:199], a[64:67], a[16:19], v[196:199]
    ds_read_b128 a[108:111], v227 offset:61440
    v_cvt_pk_bf16_f32 v155, v206, v207
    v_mfma_f32_16x16x32_bf16 v[200:203], a[64:67], a[32:35], v[216:219]
    v_exp_f32 v192, v192
    v_mfma_f32_16x16x32_bf16 v[200:203], a[68:71], a[36:39], v[200:203]
    ds_read_b64_tr_b16 a[112:113], v234 offset:49152
    v_mfma_f32_16x16x32_bf16 v[200:203], a[72:75], a[40:43], v[200:203]
    v_exp_f32 v193, v193
    v_mfma_f32_16x16x32_bf16 v[200:203], a[76:79], a[44:47], v[200:203]
    ds_read_b64_tr_b16 a[114:115], v234 offset:53248
    v_cvt_pk_bf16_f32 v132, v192, v193
    v_mfma_f32_16x16x32_bf16 v[204:207], a[76:79], a[60:63], v[220:223]
    v_exp_f32 v194, v194
    v_mfma_f32_16x16x32_bf16 v[204:207], a[72:75], a[56:59], v[204:207]
    ds_read_b64_tr_b16 a[116:117], v234 offset:57344
    v_mfma_f32_16x16x32_bf16 v[204:207], a[68:71], a[52:55], v[204:207]
    v_exp_f32 v195, v195
    v_mfma_f32_16x16x32_bf16 v[204:207], a[64:67], a[48:51], v[204:207]
    ds_read_b64_tr_b16 a[118:119], v234 offset:61440
    v_cvt_pk_bf16_f32 v133, v194, v195
    v_mfma_f32_16x16x32_bf16 v[16:19], a[80:83], v[160:163], v[16:19]
    v_exp_f32 v196, v196
    v_mfma_f32_16x16x32_bf16 v[16:19], a[84:87], v[164:167], v[16:19]
    ds_read_b64_tr_b16 a[120:121], v235 offset:49152
    v_mfma_f32_16x16x32_bf16 v[48:51], a[84:87], v[172:175], v[48:51]
    v_exp_f32 v197, v197
    v_mfma_f32_16x16x32_bf16 v[48:51], a[80:83], v[168:171], v[48:51]
    ds_read_b64_tr_b16 a[122:123], v235 offset:53248
    v_cvt_pk_bf16_f32 v140, v196, v197
    v_mfma_f32_16x16x32_bf16 v[80:83], a[80:83], v[176:179], v[80:83]
    v_exp_f32 v198, v198
    v_mfma_f32_16x16x32_bf16 v[80:83], a[84:87], v[180:183], v[80:83]
    buffer_load_dwordx4 v238, s[32:35], s43 offen offset:2048 lds
    v_mfma_f32_16x16x32_bf16 v[112:115], a[84:87], v[188:191], v[112:115]
    v_exp_f32 v199, v199
    v_mfma_f32_16x16x32_bf16 v[112:115], a[80:83], v[184:187], v[112:115]
    ds_read_b64_tr_b16 a[124:125], v235 offset:57344
    v_cvt_pk_bf16_f32 v141, v198, v199
    v_mfma_f32_16x16x32_bf16 v[116:119], a[88:91], v[184:187], v[116:119]
    v_exp_f32 v200, v200
    v_mfma_f32_16x16x32_bf16 v[116:119], a[92:95], v[188:191], v[116:119]
    ds_read_b64_tr_b16 a[126:127], v235 offset:61440
    v_mfma_f32_16x16x32_bf16 v[84:87], a[92:95], v[180:183], v[84:87]
    v_exp_f32 v201, v201
    v_mfma_f32_16x16x32_bf16 v[84:87], a[88:91], v[176:179], v[84:87]
    v_cvt_pk_bf16_f32 v148, v200, v201
    v_mfma_f32_16x16x32_bf16 v[52:55], a[88:91], v[168:171], v[52:55]
    v_exp_f32 v202, v202
    v_mfma_f32_16x16x32_bf16 v[52:55], a[92:95], v[172:175], v[52:55]
    buffer_load_dwordx4 v239, s[32:35], s43 offen offset:3072 lds
    v_mfma_f32_16x16x32_bf16 v[20:23], a[92:95], v[164:167], v[20:23]
    s_add_u32 s43, s43, 12288
    v_exp_f32 v203, v203
    v_mfma_f32_16x16x32_bf16 v[20:23], a[88:91], v[160:163], v[20:23]
    s_waitcnt vmcnt(16) lgkmcnt(0)
    v_cvt_pk_bf16_f32 v149, v202, v203
    v_smfmac_f32_16x16x64_bf16 a[136:139], a[144:147], v[176:183], v241
    s_barrier
    v_mfma_f32_16x16x32_bf16 v[192:195], a[96:99], a[0:3], v[208:211]
    v_exp_f32 v204, v204
    v_mfma_f32_16x16x32_bf16 v[192:195], a[100:103], a[4:7], v[192:195]
    ds_read_b128 a[64:67], v224 offset:0
    v_mfma_f32_16x16x32_bf16 v[192:195], a[104:107], a[8:11], v[192:195]
    v_exp_f32 v205, v205
    v_mfma_f32_16x16x32_bf16 v[192:195], a[108:111], a[12:15], v[192:195]
    ds_read_b128 a[68:71], v225 offset:0
    v_cvt_pk_bf16_f32 v156, v204, v205
    v_mfma_f32_16x16x32_bf16 v[196:199], a[108:111], a[28:31], v[212:215]
    v_exp_f32 v206, v206
    v_mfma_f32_16x16x32_bf16 v[196:199], a[104:107], a[24:27], v[196:199]
    ds_read_b128 a[72:75], v226 offset:0
    v_mfma_f32_16x16x32_bf16 v[196:199], a[100:103], a[20:23], v[196:199]
    v_exp_f32 v207, v207
    v_mfma_f32_16x16x32_bf16 v[196:199], a[96:99], a[16:19], v[196:199]
    ds_read_b128 a[76:79], v227 offset:0
    v_cvt_pk_bf16_f32 v157, v206, v207
    v_mfma_f32_16x16x32_bf16 v[200:203], a[96:99], a[32:35], v[216:219]
    v_exp_f32 v192, v192
    v_mfma_f32_16x16x32_bf16 v[200:203], a[100:103], a[36:39], v[200:203]
    ds_read_b64_tr_b16 a[80:81], v228 offset:0
    v_mfma_f32_16x16x32_bf16 v[200:203], a[104:107], a[40:43], v[200:203]
    v_exp_f32 v193, v193
    v_mfma_f32_16x16x32_bf16 v[200:203], a[108:111], a[44:47], v[200:203]
    ds_read_b64_tr_b16 a[82:83], v228 offset:4096
    v_cvt_pk_bf16_f32 v134, v192, v193
    v_mfma_f32_16x16x32_bf16 v[204:207], a[108:111], a[60:63], v[220:223]
    v_exp_f32 v194, v194
    v_mfma_f32_16x16x32_bf16 v[204:207], a[104:107], a[56:59], v[204:207]
    ds_read_b64_tr_b16 a[84:85], v228 offset:8192
    v_mfma_f32_16x16x32_bf16 v[204:207], a[100:103], a[52:55], v[204:207]
    v_exp_f32 v195, v195
    v_mfma_f32_16x16x32_bf16 v[204:207], a[96:99], a[48:51], v[204:207]
    ds_read_b64_tr_b16 a[86:87], v228 offset:12288
    v_cvt_pk_bf16_f32 v135, v194, v195
    v_mfma_f32_16x16x32_bf16 v[24:27], a[112:115], v[160:163], v[24:27]
    v_exp_f32 v196, v196
    v_mfma_f32_16x16x32_bf16 v[24:27], a[116:119], v[164:167], v[24:27]
    ds_read_b64_tr_b16 a[88:89], v229 offset:0
    v_mfma_f32_16x16x32_bf16 v[56:59], a[116:119], v[172:175], v[56:59]
    v_exp_f32 v197, v197
    v_mfma_f32_16x16x32_bf16 v[56:59], a[112:115], v[168:171], v[56:59]
    ds_read_b64_tr_b16 a[90:91], v229 offset:4096
    v_cvt_pk_bf16_f32 v142, v196, v197
    v_mfma_f32_16x16x32_bf16 v[88:91], a[112:115], v[176:179], v[88:91]
    s_add_u32 m0, s46, 49152
    v_exp_f32 v198, v198
    v_mfma_f32_16x16x32_bf16 v[88:91], a[116:119], v[180:183], v[88:91]
    buffer_load_dwordx4 v236, s[32:35], s43 offen offset:0 lds
    v_mfma_f32_16x16x32_bf16 v[120:123], a[116:119], v[188:191], v[120:123]
    v_exp_f32 v199, v199
    v_mfma_f32_16x16x32_bf16 v[120:123], a[112:115], v[184:187], v[120:123]
    ds_read_b64_tr_b16 a[92:93], v229 offset:8192
    v_cvt_pk_bf16_f32 v143, v198, v199
    v_mfma_f32_16x16x32_bf16 v[124:127], a[120:123], v[184:187], v[124:127]
    v_exp_f32 v200, v200
    v_mfma_f32_16x16x32_bf16 v[124:127], a[124:127], v[188:191], v[124:127]
    ds_read_b64_tr_b16 a[94:95], v229 offset:12288
    v_mfma_f32_16x16x32_bf16 v[92:95], a[124:127], v[180:183], v[92:95]
    v_exp_f32 v201, v201
    v_mfma_f32_16x16x32_bf16 v[92:95], a[120:123], v[176:179], v[92:95]
    v_cvt_pk_bf16_f32 v150, v200, v201
    v_mfma_f32_16x16x32_bf16 v[60:63], a[120:123], v[168:171], v[60:63]
    s_add_u32 s47, s47, 1
    v_exp_f32 v202, v202
    v_mfma_f32_16x16x32_bf16 v[60:63], a[124:127], v[172:175], v[60:63]
    buffer_load_dwordx4 v237, s[32:35], s43 offen offset:1024 lds
    v_mfma_f32_16x16x32_bf16 v[28:31], a[124:127], v[164:167], v[28:31]
    s_cmp_lt_u32 s47, 6
    v_exp_f32 v203, v203
    v_mfma_f32_16x16x32_bf16 v[28:31], a[120:123], v[160:163], v[28:31]
    v_cvt_pk_bf16_f32 v151, v202, v203
    v_smfmac_f32_16x16x64_bf16 a[140:143], a[144:147], v[184:191], v241
    s_waitcnt lgkmcnt(0)
    s_cbranch_scc1 K1_loop
K1_p3:
    v_xor_b32 v252, s0, v252
    v_xor_b32 v253, s0, v253
    v_xor_b32 v254, s0, v254
    v_xor_b32 v255, s0, v255
    v_or3_b32 v252, v252, v253, v254
    v_or_b32 v252, v252, v255
    v_cmp_ne_u32 vcc, 0, v252
    v_mov_b32 v252, s0
    v_add_u32 v244, 4096, v240
    s_cbranch_vccnz K1_spin_early
K1_early_ok:
    v_mfma_f32_16x16x32_bf16 v[192:195], a[64:67], a[0:3], v[208:211]
    v_exp_f32 v204, v204
    v_mfma_f32_16x16x32_bf16 v[192:195], a[68:71], a[4:7], v[192:195]
    ds_read_b128 a[96:99], v224 offset:4096
    s_and_b32 s76, s3, 1
    v_mfma_f32_16x16x32_bf16 v[192:195], a[72:75], a[8:11], v[192:195]
    v_exp_f32 v205, v205
    v_mfma_f32_16x16x32_bf16 v[192:195], a[76:79], a[12:15], v[192:195]
    ds_read_b128 a[100:103], v225 offset:4096
    v_cvt_pk_bf16_f32 v158, v204, v205
    v_mfma_f32_16x16x32_bf16 v[196:199], a[76:79], a[28:31], v[212:215]
    v_exp_f32 v206, v206
    v_mfma_f32_16x16x32_bf16 v[196:199], a[72:75], a[24:27], v[196:199]
    ds_read_b128 a[104:107], v226 offset:4096
    s_lshl_b32 s79, s76, 1
    v_mfma_f32_16x16x32_bf16 v[196:199], a[68:71], a[20:23], v[196:199]
    v_exp_f32 v207, v207
    v_mfma_f32_16x16x32_bf16 v[196:199], a[64:67], a[16:19], v[196:199]
    ds_read_b128 a[108:111], v227 offset:4096
    v_cvt_pk_bf16_f32 v159, v206, v207
    v_mfma_f32_16x16x32_bf16 v[200:203], a[64:67], a[32:35], v[216:219]
    v_exp_f32 v192, v192
    v_mfma_f32_16x16x32_bf16 v[200:203], a[68:71], a[36:39], v[200:203]
    ds_read_b64_tr_b16 a[112:113], v230 offset:0
    s_lshr_b32 s80, s40, 1
    v_mfma_f32_16x16x32_bf16 v[200:203], a[72:75], a[40:43], v[200:203]
    v_exp_f32 v193, v193
    v_mfma_f32_16x16x32_bf16 v[200:203], a[76:79], a[44:47], v[200:203]
    ds_read_b64_tr_b16 a[114:115], v230 offset:4096
    v_cvt_pk_bf16_f32 v160, v192, v193
    v_mfma_f32_16x16x32_bf16 v[204:207], a[76:79], a[60:63], v[220:223]
    v_exp_f32 v194, v194
    v_mfma_f32_16x16x32_bf16 v[204:207], a[72:75], a[56:59], v[204:207]
    buffer_load_dwordx4 v238, s[32:35], s43 offen offset:2048 lds
    s_add_u32 s79, s79, s80
    v_mfma_f32_16x16x32_bf16 v[204:207], a[68:71], a[52:55], v[204:207]
    v_exp_f32 v195, v195
    v_mfma_f32_16x16x32_bf16 v[204:207], a[64:67], a[48:51], v[204:207]
    ds_read_b64_tr_b16 a[116:117], v230 offset:8192
    v_cvt_pk_bf16_f32 v161, v194, v195
    v_mfma_f32_16x16x32_bf16 v[0:3], a[80:83], v[128:131], v[0:3]
    v_exp_f32 v196, v196
    v_mfma_f32_16x16x32_bf16 v[0:3], a[84:87], v[132:135], v[0:3]
    ds_read_b64_tr_b16 a[118:119], v230 offset:12288
    s_lshl_b32 s79, s79, 10
    v_mfma_f32_16x16x32_bf16 v[32:35], a[84:87], v[140:143], v[32:35]
    v_exp_f32 v197, v197
    v_mfma_f32_16x16x32_bf16 v[32:35], a[80:83], v[136:139], v[32:35]
    ds_read_b64_tr_b16 a[120:121], v231 offset:0
    v_cvt_pk_bf16_f32 v168, v196, v197
    v_mfma_f32_16x16x32_bf16 v[64:67], a[80:83], v[144:147], v[64:67]
    v_exp_f32 v198, v198
    v_mfma_f32_16x16x32_bf16 v[64:67], a[84:87], v[148:151], v[64:67]
    buffer_load_dwordx4 v239, s[32:35], s43 offen offset:3072 lds
    v_add_u32 v242, s79, v240
    v_mfma_f32_16x16x32_bf16 v[96:99], a[84:87], v[156:159], v[96:99]
    s_add_u32 s43, s43, 4096
    v_exp_f32 v199, v199
    v_mfma_f32_16x16x32_bf16 v[96:99], a[80:83], v[152:155], v[96:99]
    ds_read_b64_tr_b16 a[122:123], v231 offset:4096
    v_cvt_pk_bf16_f32 v169, v198, v199
    v_mfma_f32_16x16x32_bf16 v[100:103], a[88:91], v[152:155], v[100:103]
    v_exp_f32 v200, v200
    v_mfma_f32_16x16x32_bf16 v[100:103], a[92:95], v[156:159], v[100:103]
    ds_read_b64_tr_b16 a[124:125], v231 offset:8192
    v_xor_b32 v243, 1024, v242
    v_mfma_f32_16x16x32_bf16 v[68:71], a[92:95], v[148:151], v[68:71]
    v_exp_f32 v201, v201
    v_mfma_f32_16x16x32_bf16 v[68:71], a[88:91], v[144:147], v[68:71]
    ds_read_b64_tr_b16 a[126:127], v231 offset:12288
    v_cvt_pk_bf16_f32 v176, v200, v201
    v_mfma_f32_16x16x32_bf16 v[36:39], a[88:91], v[136:139], v[36:39]
    s_mov_b32 s59, 331900
    v_exp_f32 v202, v202
    v_mfma_f32_16x16x32_bf16 v[36:39], a[92:95], v[140:143], v[36:39]
    buffer_store_dword v252, v251, s[68:71], s59 offen sc1
    s_mul_i32 s79, s40, 14
    v_mfma_f32_16x16x32_bf16 v[4:7], a[92:95], v[132:135], v[4:7]
    v_exp_f32 v203, v203
    v_mfma_f32_16x16x32_bf16 v[4:7], a[88:91], v[128:131], v[4:7]
    v_cvt_pk_bf16_f32 v177, v202, v203
    v_smfmac_f32_16x16x64_bf16 a[128:131], a[144:147], v[128:135], v241
    s_waitcnt lgkmcnt(0)
    v_mfma_f32_16x16x32_bf16 v[192:195], a[96:99], a[0:3], v[208:211]
    v_exp_f32 v204, v204
    v_mfma_f32_16x16x32_bf16 v[192:195], a[100:103], a[4:7], v[192:195]
    ds_read_b128 a[64:67], v224 offset:8192
    s_add_u32 s79, s79, 128
    v_mfma_f32_16x16x32_bf16 v[192:195], a[104:107], a[8:11], v[192:195]
    v_exp_f32 v205, v205
    v_mfma_f32_16x16x32_bf16 v[192:195], a[108:111], a[12:15], v[192:195]
    ds_read_b128 a[68:71], v225 offset:8192
    v_cvt_pk_bf16_f32 v184, v204, v205
    v_mfma_f32_16x16x32_bf16 v[196:199], a[108:111], a[28:31], v[212:215]
    v_exp_f32 v206, v206
    v_mfma_f32_16x16x32_bf16 v[196:199], a[104:107], a[24:27], v[196:199]
    ds_read_b128 a[72:75], v226 offset:8192
    s_lshl_b32 s72, s79, 12
    v_mfma_f32_16x16x32_bf16 v[196:199], a[100:103], a[20:23], v[196:199]
    v_exp_f32 v207, v207
    v_mfma_f32_16x16x32_bf16 v[196:199], a[96:99], a[16:19], v[196:199]
    ds_read_b128 a[76:79], v227 offset:8192
    v_cvt_pk_bf16_f32 v185, v206, v207
    v_mfma_f32_16x16x32_bf16 v[200:203], a[96:99], a[32:35], v[216:219]
    v_exp_f32 v192, v192
    v_mfma_f32_16x16x32_bf16 v[200:203], a[100:103], a[36:39], v[200:203]
    ds_read_b64_tr_b16 a[80:81], v232 offset:0
    s_mul_i32 s74, s79, 5120
    v_mfma_f32_16x16x32_bf16 v[200:203], a[104:107], a[40:43], v[200:203]
    v_exp_f32 v193, v193
    v_mfma_f32_16x16x32_bf16 v[200:203], a[108:111], a[44:47], v[200:203]
    ds_read_b64_tr_b16 a[82:83], v232 offset:4096
    v_cvt_pk_bf16_f32 v162, v192, v193
    v_mfma_f32_16x16x32_bf16 v[204:207], a[108:111], a[60:63], v[220:223]
    v_exp_f32 v194, v194
    v_mfma_f32_16x16x32_bf16 v[204:207], a[104:107], a[56:59], v[204:207]
    ds_read_b64_tr_b16 a[84:85], v232 offset:8192
    s_mul_i32 s76, s76, 5120
    v_mfma_f32_16x16x32_bf16 v[204:207], a[100:103], a[52:55], v[204:207]
    v_exp_f32 v195, v195
    v_mfma_f32_16x16x32_bf16 v[204:207], a[96:99], a[48:51], v[204:207]
    ds_read_b64_tr_b16 a[86:87], v232 offset:12288
    v_cvt_pk_bf16_f32 v163, v194, v195
    v_mfma_f32_16x16x32_bf16 v[8:11], a[112:115], v[128:131], v[8:11]
    v_exp_f32 v196, v196
    v_mfma_f32_16x16x32_bf16 v[8:11], a[116:119], v[132:135], v[8:11]
    ds_read_b64_tr_b16 a[88:89], v233 offset:0
    s_lshl_b32 s73, s40, 17
    v_mfma_f32_16x16x32_bf16 v[40:43], a[116:119], v[140:143], v[40:43]
    v_exp_f32 v197, v197
    v_mfma_f32_16x16x32_bf16 v[40:43], a[112:115], v[136:139], v[40:43]
    ds_read_b64_tr_b16 a[90:91], v233 offset:4096
    v_cvt_pk_bf16_f32 v170, v196, v197
    v_mfma_f32_16x16x32_bf16 v[72:75], a[112:115], v[144:147], v[72:75]
    s_add_u32 m0, s46, 53248
    v_exp_f32 v198, v198
    v_mfma_f32_16x16x32_bf16 v[72:75], a[116:119], v[148:151], v[72:75]
    buffer_load_dwordx4 v236, s[32:35], s43 offen offset:0 lds
    s_mul_i32 s75, s40, 163840
    v_mfma_f32_16x16x32_bf16 v[104:107], a[116:119], v[156:159], v[104:107]
    v_exp_f32 v199, v199
    v_mfma_f32_16x16x32_bf16 v[104:107], a[112:115], v[152:155], v[104:107]
    ds_read_b64_tr_b16 a[92:93], v233 offset:8192
    v_cvt_pk_bf16_f32 v171, v198, v199
    v_mfma_f32_16x16x32_bf16 v[108:111], a[120:123], v[152:155], v[108:111]
    v_exp_f32 v200, v200
    v_mfma_f32_16x16x32_bf16 v[108:111], a[124:127], v[156:159], v[108:111]
    ds_read_b64_tr_b16 a[94:95], v233 offset:12288
    s_lshl_b32 s77, s16, 14
    v_mfma_f32_16x16x32_bf16 v[76:79], a[124:127], v[148:151], v[76:79]
    v_exp_f32 v201, v201
    v_mfma_f32_16x16x32_bf16 v[76:79], a[120:123], v[144:147], v[76:79]
    v_cvt_pk_bf16_f32 v178, v200, v201
    v_mfma_f32_16x16x32_bf16 v[44:47], a[120:123], v[136:139], v[44:47]
    v_exp_f32 v202, v202
    v_mfma_f32_16x16x32_bf16 v[44:47], a[124:127], v[140:143], v[44:47]
    buffer_load_dwordx4 v237, s[32:35], s43 offen offset:1024 lds
    s_mov_b32 s50, 0x45000000
    v_mfma_f32_16x16x32_bf16 v[12:15], a[124:127], v[132:135], v[12:15]
    v_exp_f32 v203, v203
    v_mfma_f32_16x16x32_bf16 v[12:15], a[120:123], v[128:131], v[12:15]
    v_cvt_pk_bf16_f32 v179, v202, v203
    v_smfmac_f32_16x16x64_bf16 a[132:135], a[144:147], v[136:143], v241
    s_waitcnt lgkmcnt(0)
    v_mfma_f32_16x16x32_bf16 v[192:195], a[64:67], a[0:3], v[208:211]
    v_exp_f32 v204, v204
    v_mfma_f32_16x16x32_bf16 v[192:195], a[68:71], a[4:7], v[192:195]
    ds_read_b128 a[96:99], v224 offset:12288
    s_mov_b32 s81, 0x200000
    v_mfma_f32_16x16x32_bf16 v[192:195], a[72:75], a[8:11], v[192:195]
    v_exp_f32 v205, v205
    v_mfma_f32_16x16x32_bf16 v[192:195], a[76:79], a[12:15], v[192:195]
    ds_read_b128 a[100:103], v225 offset:12288
    v_cvt_pk_bf16_f32 v186, v204, v205
    v_mfma_f32_16x16x32_bf16 v[196:199], a[76:79], a[28:31], v[212:215]
    v_exp_f32 v206, v206
    v_mfma_f32_16x16x32_bf16 v[196:199], a[72:75], a[24:27], v[196:199]
    ds_read_b128 a[104:107], v226 offset:12288
    v_cmp_gt_u32 vcc, 16, v240
    v_mfma_f32_16x16x32_bf16 v[196:199], a[68:71], a[20:23], v[196:199]
    v_exp_f32 v207, v207
    v_mfma_f32_16x16x32_bf16 v[196:199], a[64:67], a[16:19], v[196:199]
    ds_read_b128 a[108:111], v227 offset:12288
    v_cvt_pk_bf16_f32 v187, v206, v207
    v_mfma_f32_16x16x32_bf16 v[200:203], a[64:67], a[32:35], v[216:219]
    v_exp_f32 v192, v192
    v_mfma_f32_16x16x32_bf16 v[200:203], a[68:71], a[36:39], v[200:203]
    ds_read_b64_tr_b16 a[112:113], v234 offset:0
    v_mov_b32 v245, 0x1000000
    v_mfma_f32_16x16x32_bf16 v[200:203], a[72:75], a[40:43], v[200:203]
    v_exp_f32 v193, v193
    v_mfma_f32_16x16x32_bf16 v[200:203], a[76:79], a[44:47], v[200:203]
    ds_read_b64_tr_b16 a[114:115], v234 offset:4096
    v_cvt_pk_bf16_f32 v164, v192, v193
    v_mfma_f32_16x16x32_bf16 v[204:207], a[76:79], a[60:63], v[220:223]
    v_exp_f32 v194, v194
    v_mfma_f32_16x16x32_bf16 v[204:207], a[72:75], a[56:59], v[204:207]
    buffer_load_dwordx4 v238, s[32:35], s43 offen offset:2048 lds
    v_mfma_f32_16x16x32_bf16 v[204:207], a[68:71], a[52:55], v[204:207]
    v_exp_f32 v195, v195
    v_mfma_f32_16x16x32_bf16 v[204:207], a[64:67], a[48:51], v[204:207]
    ds_read_b64_tr_b16 a[116:117], v234 offset:8192
    v_cvt_pk_bf16_f32 v165, v194, v195
    v_mfma_f32_16x16x32_bf16 v[16:19], a[80:83], v[128:131], v[16:19]
K1_pg9:
    s_cbranch_execz K1_pg13
    v_exp_f32 v196, v196
    v_mfma_f32_16x16x32_bf16 v[16:19], a[84:87], v[132:135], v[16:19]
    ds_read_b64_tr_b16 a[118:119], v234 offset:12288
    v_lshrrev_b32 v253, 2, v240
    v_mfma_f32_16x16x32_bf16 v[48:51], a[84:87], v[140:143], v[48:51]
    v_exp_f32 v197, v197
    v_mfma_f32_16x16x32_bf16 v[48:51], a[80:83], v[136:139], v[48:51]
    ds_read_b64_tr_b16 a[120:121], v235 offset:0
    v_cvt_pk_bf16_f32 v172, v196, v197
    v_mfma_f32_16x16x32_bf16 v[80:83], a[80:83], v[144:147], v[80:83]
    v_exp_f32 v198, v198
    v_mfma_f32_16x16x32_bf16 v[80:83], a[84:87], v[148:151], v[80:83]
    buffer_load_dwordx4 v239, s[32:35], s43 offen offset:3072 lds
    v_mfma_f32_16x16x32_bf16 v[112:115], a[84:87], v[156:159], v[112:115]
    s_add_u32 s43, s43, 12288
    v_exp_f32 v199, v199
    v_mfma_f32_16x16x32_bf16 v[112:115], a[80:83], v[152:155], v[112:115]
    ds_read_b64_tr_b16 a[122:123], v235 offset:4096
    v_cvt_pk_bf16_f32 v173, v198, v199
    v_mfma_f32_16x16x32_bf16 v[116:119], a[88:91], v[152:155], v[116:119]
    v_exp_f32 v200, v200
    v_mfma_f32_16x16x32_bf16 v[116:119], a[92:95], v[156:159], v[116:119]
    ds_read_b64_tr_b16 a[124:125], v235 offset:8192
    v_cndmask_b32 v245, v245, v253, vcc
    v_mfma_f32_16x16x32_bf16 v[84:87], a[92:95], v[148:151], v[84:87]
    v_exp_f32 v201, v201
    v_mfma_f32_16x16x32_bf16 v[84:87], a[88:91], v[144:147], v[84:87]
    ds_read_b64_tr_b16 a[126:127], v235 offset:12288
    v_cvt_pk_bf16_f32 v180, v200, v201
    v_mfma_f32_16x16x32_bf16 v[52:55], a[88:91], v[136:139], v[52:55]
    s_add_u32 s42, s72, 0
    v_exp_f32 v202, v202
    v_mfma_f32_16x16x32_bf16 v[52:55], a[92:95], v[140:143], v[52:55]
    buffer_load_dwordx4 a[152:155], v242, s[20:23], s42 offen sc1
    v_mfma_f32_16x16x32_bf16 v[20:23], a[92:95], v[132:135], v[20:23]
    v_exp_f32 v203, v203
    v_mfma_f32_16x16x32_bf16 v[20:23], a[88:91], v[128:131], v[20:23]
    v_cvt_pk_bf16_f32 v181, v202, v203
    v_smfmac_f32_16x16x64_bf16 a[136:139], a[144:147], v[144:151], v241
    buffer_load_dwordx4 a[156:159], v243, s[20:23], s42 offen sc1
    s_waitcnt vmcnt(20) lgkmcnt(0)
    s_barrier
    v_mfma_f32_16x16x32_bf16 v[192:195], a[96:99], a[0:3], v[208:211]
    v_exp_f32 v204, v204
    v_mfma_f32_16x16x32_bf16 v[192:195], a[100:103], a[4:7], v[192:195]
    ds_read_b128 a[64:67], v224 offset:16384
    v_bfe_u32 v253, v240, 4, 3
    v_mfma_f32_16x16x32_bf16 v[192:195], a[104:107], a[8:11], v[192:195]
    v_exp_f32 v205, v205
    v_mfma_f32_16x16x32_bf16 v[192:195], a[108:111], a[12:15], v[192:195]
    ds_read_b128 a[68:71], v225 offset:16384
    v_cvt_pk_bf16_f32 v188, v204, v205
    v_mfma_f32_16x16x32_bf16 v[196:199], a[108:111], a[28:31], v[212:215]
    v_exp_f32 v206, v206
    v_mfma_f32_16x16x32_bf16 v[196:199], a[104:107], a[24:27], v[196:199]
    ds_read_b128 a[72:75], v226 offset:16384
    v_and_b32 v254, 3, v253
    v_mfma_f32_16x16x32_bf16 v[196:199], a[100:103], a[20:23], v[196:199]
    v_exp_f32 v207, v207
    v_mfma_f32_16x16x32_bf16 v[196:199], a[96:99], a[16:19], v[196:199]
    ds_read_b128 a[76:79], v227 offset:16384
    v_cvt_pk_bf16_f32 v189, v206, v207
    v_mfma_f32_16x16x32_bf16 v[200:203], a[96:99], a[32:35], v[216:219]
    v_exp_f32 v192, v192
    v_mfma_f32_16x16x32_bf16 v[200:203], a[100:103], a[36:39], v[200:203]
    ds_read_b64_tr_b16 a[80:81], v228 offset:16384
    v_lshlrev_b32 v253, 3, v253
    v_mfma_f32_16x16x32_bf16 v[200:203], a[104:107], a[40:43], v[200:203]
    v_exp_f32 v193, v193
    v_mfma_f32_16x16x32_bf16 v[200:203], a[108:111], a[44:47], v[200:203]
    ds_read_b64_tr_b16 a[82:83], v228 offset:20480
    v_cvt_pk_bf16_f32 v166, v192, v193
    v_mfma_f32_16x16x32_bf16 v[204:207], a[108:111], a[60:63], v[220:223]
    s_add_u32 m0, s46, 0
    v_exp_f32 v194, v194
    v_mfma_f32_16x16x32_bf16 v[204:207], a[104:107], a[56:59], v[204:207]
    buffer_load_dwordx4 v236, s[32:35], s43 offen offset:0 lds
    v_mfma_f32_16x16x32_bf16 v[204:207], a[100:103], a[52:55], v[204:207]
    v_exp_f32 v195, v195
    v_mfma_f32_16x16x32_bf16 v[204:207], a[96:99], a[48:51], v[204:207]
    ds_read_b64_tr_b16 a[84:85], v228 offset:24576
    v_cvt_pk_bf16_f32 v167, v194, v195
    v_mfma_f32_16x16x32_bf16 v[24:27], a[112:115], v[128:131], v[24:27]
    v_exp_f32 v196, v196
    v_mfma_f32_16x16x32_bf16 v[24:27], a[116:119], v[132:135], v[24:27]
    ds_read_b64_tr_b16 a[86:87], v228 offset:28672
    v_lshlrev_b32 v254, 7, v254
    v_mfma_f32_16x16x32_bf16 v[56:59], a[116:119], v[140:143], v[56:59]
    v_exp_f32 v197, v197
    v_mfma_f32_16x16x32_bf16 v[56:59], a[112:115], v[136:139], v[56:59]
    ds_read_b64_tr_b16 a[88:89], v229 offset:16384
    v_cvt_pk_bf16_f32 v174, v196, v197
    v_mfma_f32_16x16x32_bf16 v[88:91], a[112:115], v[144:147], v[88:91]
    v_exp_f32 v198, v198
    v_mfma_f32_16x16x32_bf16 v[88:91], a[116:119], v[148:151], v[88:91]
    buffer_load_dwordx4 v237, s[32:35], s43 offen offset:1024 lds
    v_mfma_f32_16x16x32_bf16 v[120:123], a[116:119], v[156:159], v[120:123]
    v_exp_f32 v199, v199
    v_mfma_f32_16x16x32_bf16 v[120:123], a[112:115], v[152:155], v[120:123]
    ds_read_b64_tr_b16 a[90:91], v229 offset:20480
    v_cvt_pk_bf16_f32 v175, v198, v199
    v_mfma_f32_16x16x32_bf16 v[124:127], a[120:123], v[152:155], v[124:127]
    v_exp_f32 v200, v200
    v_mfma_f32_16x16x32_bf16 v[124:127], a[124:127], v[156:159], v[124:127]
    ds_read_b64_tr_b16 a[92:93], v229 offset:24576
    v_lshrrev_b32 v255, 1, v240
    v_mfma_f32_16x16x32_bf16 v[92:95], a[124:127], v[148:151], v[92:95]
    v_exp_f32 v201, v201
    v_mfma_f32_16x16x32_bf16 v[92:95], a[120:123], v[144:147], v[92:95]
    ds_read_b64_tr_b16 a[94:95], v229 offset:28672
    v_cvt_pk_bf16_f32 v182, v200, v201
    v_mfma_f32_16x16x32_bf16 v[60:63], a[120:123], v[136:139], v[60:63]
    s_add_u32 s42, s72, 4096
    v_exp_f32 v202, v202
    v_mfma_f32_16x16x32_bf16 v[60:63], a[124:127], v[140:143], v[60:63]
    buffer_load_dwordx4 a[160:163], v242, s[20:23], s42 offen sc1
    v_mfma_f32_16x16x32_bf16 v[28:31], a[124:127], v[132:135], v[28:31]
    v_exp_f32 v203, v203
    v_mfma_f32_16x16x32_bf16 v[28:31], a[120:123], v[128:131], v[28:31]
    v_cvt_pk_bf16_f32 v183, v202, v203
    v_smfmac_f32_16x16x64_bf16 a[140:143], a[144:147], v[152:159], v241
    buffer_load_dwordx4 a[164:167], v243, s[20:23], s42 offen sc1
    s_waitcnt lgkmcnt(0)
    v_mfma_f32_16x16x32_bf16 v[192:195], a[64:67], a[0:3], v[208:211]
    v_exp_f32 v204, v204
    v_mfma_f32_16x16x32_bf16 v[192:195], a[68:71], a[4:7], v[192:195]
    ds_read_b128 a[96:99], v224 offset:20480
    v_bfe_u32 v246, v240, 4, 4
    v_mfma_f32_16x16x32_bf16 v[192:195], a[72:75], a[8:11], v[192:195]
    v_exp_f32 v205, v205
    v_mfma_f32_16x16x32_bf16 v[192:195], a[76:79], a[12:15], v[192:195]
    ds_read_b128 a[100:103], v225 offset:20480
    v_cvt_pk_bf16_f32 v190, v204, v205
    v_mfma_f32_16x16x32_bf16 v[196:199], a[76:79], a[28:31], v[212:215]
    v_exp_f32 v206, v206
    v_mfma_f32_16x16x32_bf16 v[196:199], a[72:75], a[24:27], v[196:199]
    ds_read_b128 a[104:107], v226 offset:20480
    s_lshl_b32 s79, s45, 6
    v_mfma_f32_16x16x32_bf16 v[196:199], a[68:71], a[20:23], v[196:199]
    v_exp_f32 v207, v207
    v_mfma_f32_16x16x32_bf16 v[196:199], a[64:67], a[16:19], v[196:199]
    ds_read_b128 a[108:111], v227 offset:20480
    v_cvt_pk_bf16_f32 v191, v206, v207
    v_mfma_f32_16x16x32_bf16 v[200:203], a[64:67], a[32:35], v[216:219]
    v_exp_f32 v192, v192
    v_mfma_f32_16x16x32_bf16 v[200:203], a[68:71], a[36:39], v[200:203]
    ds_read_b64_tr_b16 a[112:113], v230 offset:16384
    v_lshrrev_b32 v248, 6, v242
    v_mfma_f32_16x16x32_bf16 v[200:203], a[72:75], a[40:43], v[200:203]
    v_exp_f32 v193, v193
    v_mfma_f32_16x16x32_bf16 v[200:203], a[76:79], a[44:47], v[200:203]
    ds_read_b64_tr_b16 a[114:115], v230 offset:20480
    v_cvt_pk_bf16_f32 v128, v192, v193
    v_mfma_f32_16x16x32_bf16 v[204:207], a[76:79], a[60:63], v[220:223]
    v_exp_f32 v194, v194
    v_mfma_f32_16x16x32_bf16 v[204:207], a[72:75], a[56:59], v[204:207]
    buffer_load_dwordx4 v238, s[32:35], s43 offen offset:2048 lds
    v_mfma_f32_16x16x32_bf16 v[204:207], a[68:71], a[52:55], v[204:207]
    v_exp_f32 v195, v195
    v_mfma_f32_16x16x32_bf16 v[204:207], a[64:67], a[48:51], v[204:207]
    ds_read_b64_tr_b16 a[116:117], v230 offset:24576
    v_cvt_pk_bf16_f32 v129, v194, v195
    v_mfma_f32_16x16x32_bf16 v[0:3], a[80:83], v[160:163], v[0:3]
    v_exp_f32 v196, v196
    v_mfma_f32_16x16x32_bf16 v[0:3], a[84:87], v[164:167], v[0:3]
    ds_read_b64_tr_b16 a[118:119], v230 offset:28672
    v_and_b32 v248, 48, v248
    v_mfma_f32_16x16x32_bf16 v[32:35], a[84:87], v[172:175], v[32:35]
    v_exp_f32 v197, v197
    v_mfma_f32_16x16x32_bf16 v[32:35], a[80:83], v[168:171], v[32:35]
    ds_read_b64_tr_b16 a[120:121], v231 offset:16384
    v_cvt_pk_bf16_f32 v136, v196, v197
    v_mfma_f32_16x16x32_bf16 v[64:67], a[80:83], v[176:179], v[64:67]
    v_exp_f32 v198, v198
    v_mfma_f32_16x16x32_bf16 v[64:67], a[84:87], v[180:183], v[64:67]
    buffer_load_dwordx4 v239, s[32:35], s43 offen offset:3072 lds
    v_mfma_f32_16x16x32_bf16 v[96:99], a[84:87], v[188:191], v[96:99]
    s_add_u32 s43, s43, 4096
    v_exp_f32 v199, v199
    v_mfma_f32_16x16x32_bf16 v[96:99], a[80:83], v[184:187], v[96:99]
    ds_read_b64_tr_b16 a[122:123], v231 offset:20480
    v_cvt_pk_bf16_f32 v137, v198, v199
    v_mfma_f32_16x16x32_bf16 v[100:103], a[88:91], v[184:187], v[100:103]
    v_exp_f32 v200, v200
    v_mfma_f32_16x16x32_bf16 v[100:103], a[92:95], v[188:191], v[100:103]
    ds_read_b64_tr_b16 a[124:125], v231 offset:24576
    v_add3_u32 v246, s79, v246, v248
    v_mfma_f32_16x16x32_bf16 v[68:71], a[92:95], v[180:183], v[68:71]
    v_exp_f32 v201, v201
    v_mfma_f32_16x16x32_bf16 v[68:71], a[88:91], v[176:179], v[68:71]
    ds_read_b64_tr_b16 a[126:127], v231 offset:28672
    v_cvt_pk_bf16_f32 v144, v200, v201
    v_mfma_f32_16x16x32_bf16 v[36:39], a[88:91], v[168:171], v[36:39]
    s_add_u32 s42, s72, 8192
    v_exp_f32 v202, v202
    v_mfma_f32_16x16x32_bf16 v[36:39], a[92:95], v[172:175], v[36:39]
    buffer_load_dwordx4 a[168:171], v242, s[20:23], s42 offen sc1
    v_mfma_f32_16x16x32_bf16 v[4:7], a[92:95], v[164:167], v[4:7]
    v_exp_f32 v203, v203
    v_mfma_f32_16x16x32_bf16 v[4:7], a[88:91], v[160:163], v[4:7]
    v_cvt_pk_bf16_f32 v145, v202, v203
    v_smfmac_f32_16x16x64_bf16 a[128:131], a[144:147], v[160:167], v241
    buffer_load_dwordx4 a[172:175], v243, s[20:23], s42 offen sc1
    s_waitcnt lgkmcnt(0)
    v_mfma_f32_16x16x32_bf16 v[192:195], a[96:99], a[0:3], v[208:211]
    v_exp_f32 v204, v204
    v_mfma_f32_16x16x32_bf16 v[192:195], a[100:103], a[4:7], v[192:195]
    ds_read_b128 a[64:67], v224 offset:24576
    v_mul_u32_u24 v246, 1280, v246
    v_mfma_f32_16x16x32_bf16 v[192:195], a[104:107], a[8:11], v[192:195]
    v_exp_f32 v205, v205
    v_mfma_f32_16x16x32_bf16 v[192:195], a[108:111], a[12:15], v[192:195]
    ds_read_b128 a[68:71], v225 offset:24576
    v_cvt_pk_bf16_f32 v152, v204, v205
    v_mfma_f32_16x16x32_bf16 v[196:199], a[108:111], a[28:31], v[212:215]
    v_exp_f32 v206, v206
    v_mfma_f32_16x16x32_bf16 v[196:199], a[104:107], a[24:27], v[196:199]
    ds_read_b128 a[72:75], v226 offset:24576
    v_lshrrev_b32 v249, 8, v240
    v_mfma_f32_16x16x32_bf16 v[196:199], a[100:103], a[20:23], v[196:199]
    v_exp_f32 v207, v207
    v_mfma_f32_16x16x32_bf16 v[196:199], a[96:99], a[16:19], v[196:199]
    ds_read_b128 a[76:79], v227 offset:24576
    v_cvt_pk_bf16_f32 v153, v206, v207
    v_mfma_f32_16x16x32_bf16 v[200:203], a[96:99], a[32:35], v[216:219]
    v_exp_f32 v192, v192
    v_mfma_f32_16x16x32_bf16 v[200:203], a[100:103], a[36:39], v[200:203]
    ds_read_b64_tr_b16 a[80:81], v232 offset:16384
    v_lshl_add_u32 v248, v249, 4, v246
    v_mfma_f32_16x16x32_bf16 v[200:203], a[104:107], a[40:43], v[200:203]
    v_exp_f32 v193, v193
    v_mfma_f32_16x16x32_bf16 v[200:203], a[108:111], a[44:47], v[200:203]
    ds_read_b64_tr_b16 a[82:83], v232 offset:20480
    v_cvt_pk_bf16_f32 v130, v192, v193
    v_mfma_f32_16x16x32_bf16 v[204:207], a[108:111], a[60:63], v[220:223]
    s_add_u32 m0, s46, 4096
    v_exp_f32 v194, v194
    v_mfma_f32_16x16x32_bf16 v[204:207], a[104:107], a[56:59], v[204:207]
    buffer_load_dwordx4 v236, s[32:35], s43 offen offset:0 lds
    v_mfma_f32_16x16x32_bf16 v[204:207], a[100:103], a[52:55], v[204:207]
    v_exp_f32 v195, v195
    v_mfma_f32_16x16x32_bf16 v[204:207], a[96:99], a[48:51], v[204:207]
    ds_read_b64_tr_b16 a[84:85], v232 offset:24576
    v_cvt_pk_bf16_f32 v131, v194, v195
    v_mfma_f32_16x16x32_bf16 v[8:11], a[112:115], v[160:163], v[8:11]
    v_exp_f32 v196, v196
    v_mfma_f32_16x16x32_bf16 v[8:11], a[116:119], v[164:167], v[8:11]
    ds_read_b64_tr_b16 a[86:87], v232 offset:28672
    v_lshl_add_u32 v246, v249, 3, v246
    v_mfma_f32_16x16x32_bf16 v[40:43], a[116:119], v[172:175], v[40:43]
    v_exp_f32 v197, v197
    v_mfma_f32_16x16x32_bf16 v[40:43], a[112:115], v[168:171], v[40:43]
    ds_read_b64_tr_b16 a[88:89], v233 offset:16384
    v_cvt_pk_bf16_f32 v138, v196, v197
    v_mfma_f32_16x16x32_bf16 v[72:75], a[112:115], v[176:179], v[72:75]
    v_exp_f32 v198, v198
    v_mfma_f32_16x16x32_bf16 v[72:75], a[116:119], v[180:183], v[72:75]
    buffer_load_dwordx4 v237, s[32:35], s43 offen offset:1024 lds
    v_mfma_f32_16x16x32_bf16 v[104:107], a[116:119], v[188:191], v[104:107]
    v_exp_f32 v199, v199
    v_mfma_f32_16x16x32_bf16 v[104:107], a[112:115], v[184:187], v[104:107]
    ds_read_b64_tr_b16 a[90:91], v233 offset:20480
    v_cvt_pk_bf16_f32 v139, v198, v199
    v_mfma_f32_16x16x32_bf16 v[108:111], a[120:123], v[184:187], v[108:111]
    v_exp_f32 v200, v200
    v_mfma_f32_16x16x32_bf16 v[108:111], a[124:127], v[188:191], v[108:111]
    ds_read_b64_tr_b16 a[92:93], v233 offset:24576
    s_lshl_b32 s19, s44, 1
    v_mfma_f32_16x16x32_bf16 v[76:79], a[124:127], v[180:183], v[76:79]
    v_exp_f32 v201, v201
    v_mfma_f32_16x16x32_bf16 v[76:79], a[120:123], v[176:179], v[76:79]
    ds_read_b64_tr_b16 a[94:95], v233 offset:28672
    v_cvt_pk_bf16_f32 v146, v200, v201
    v_mfma_f32_16x16x32_bf16 v[44:47], a[120:123], v[168:171], v[44:47]
    s_add_u32 s42, s72, 12288
    v_exp_f32 v202, v202
    v_mfma_f32_16x16x32_bf16 v[44:47], a[124:127], v[172:175], v[44:47]
    buffer_load_dwordx4 a[176:179], v242, s[20:23], s42 offen sc1
    v_mfma_f32_16x16x32_bf16 v[12:15], a[124:127], v[164:167], v[12:15]
    v_exp_f32 v203, v203
    v_mfma_f32_16x16x32_bf16 v[12:15], a[120:123], v[160:163], v[12:15]
    v_cvt_pk_bf16_f32 v147, v202, v203
    v_smfmac_f32_16x16x64_bf16 a[132:135], a[144:147], v[168:175], v241
    buffer_load_dwordx4 a[180:183], v243, s[20:23], s42 offen sc1
    s_waitcnt lgkmcnt(0)
    v_mfma_f32_16x16x32_bf16 v[192:195], a[64:67], a[0:3], v[208:211]
    v_exp_f32 v204, v204
    v_mfma_f32_16x16x32_bf16 v[192:195], a[68:71], a[4:7], v[192:195]
    ds_read_b128 a[96:99], v224 offset:28672
    s_and_b32 s79, s40, 1
    v_mfma_f32_16x16x32_bf16 v[192:195], a[72:75], a[8:11], v[192:195]
    v_exp_f32 v205, v205
    v_mfma_f32_16x16x32_bf16 v[192:195], a[76:79], a[12:15], v[192:195]
    ds_read_b128 a[100:103], v225 offset:28672
    v_cvt_pk_bf16_f32 v154, v204, v205
    v_mfma_f32_16x16x32_bf16 v[196:199], a[76:79], a[28:31], v[212:215]
    v_exp_f32 v206, v206
    v_mfma_f32_16x16x32_bf16 v[196:199], a[72:75], a[24:27], v[196:199]
    ds_read_b128 a[104:107], v226 offset:28672
    s_add_u32 s19, s19, s79
    v_mfma_f32_16x16x32_bf16 v[196:199], a[68:71], a[20:23], v[196:199]
    v_exp_f32 v207, v207
    v_mfma_f32_16x16x32_bf16 v[196:199], a[64:67], a[16:19], v[196:199]
    ds_read_b128 a[108:111], v227 offset:28672
    v_cvt_pk_bf16_f32 v155, v206, v207
    v_mfma_f32_16x16x32_bf16 v[200:203], a[64:67], a[32:35], v[216:219]
    v_exp_f32 v192, v192
    v_mfma_f32_16x16x32_bf16 v[200:203], a[68:71], a[36:39], v[200:203]
    ds_read_b64_tr_b16 a[112:113], v234 offset:16384
    s_mul_i32 s19, s19, 160
    v_mfma_f32_16x16x32_bf16 v[200:203], a[72:75], a[40:43], v[200:203]
    v_exp_f32 v193, v193
    v_mfma_f32_16x16x32_bf16 v[200:203], a[76:79], a[44:47], v[200:203]
    ds_read_b64_tr_b16 a[114:115], v234 offset:20480
    v_cvt_pk_bf16_f32 v132, v192, v193
    v_mfma_f32_16x16x32_bf16 v[204:207], a[76:79], a[60:63], v[220:223]
    v_exp_f32 v194, v194
    v_mfma_f32_16x16x32_bf16 v[204:207], a[72:75], a[56:59], v[204:207]
    buffer_load_dwordx4 v238, s[32:35], s43 offen offset:2048 lds
    v_mfma_f32_16x16x32_bf16 v[204:207], a[68:71], a[52:55], v[204:207]
    v_exp_f32 v195, v195
    v_mfma_f32_16x16x32_bf16 v[204:207], a[64:67], a[48:51], v[204:207]
    ds_read_b64_tr_b16 a[116:117], v234 offset:24576
    v_cvt_pk_bf16_f32 v133, v194, v195
    v_mfma_f32_16x16x32_bf16 v[16:19], a[80:83], v[160:163], v[16:19]
    v_exp_f32 v196, v196
    v_mfma_f32_16x16x32_bf16 v[16:19], a[84:87], v[164:167], v[16:19]
    ds_read_b64_tr_b16 a[118:119], v234 offset:28672
    s_lshl_b32 s79, s3, 2
    v_mfma_f32_16x16x32_bf16 v[48:51], a[84:87], v[172:175], v[48:51]
    v_exp_f32 v197, v197
    v_mfma_f32_16x16x32_bf16 v[48:51], a[80:83], v[168:171], v[48:51]
    ds_read_b64_tr_b16 a[120:121], v235 offset:16384
    v_cvt_pk_bf16_f32 v140, v196, v197
    v_mfma_f32_16x16x32_bf16 v[80:83], a[80:83], v[176:179], v[80:83]
    v_exp_f32 v198, v198
    v_mfma_f32_16x16x32_bf16 v[80:83], a[84:87], v[180:183], v[80:83]
    buffer_load_dwordx4 v239, s[32:35], s43 offen offset:3072 lds
    v_mfma_f32_16x16x32_bf16 v[112:115], a[84:87], v[188:191], v[112:115]
    s_add_u32 s43, s43, 12288
    v_exp_f32 v199, v199
    v_mfma_f32_16x16x32_bf16 v[112:115], a[80:83], v[184:187], v[112:115]
    ds_read_b64_tr_b16 a[122:123], v235 offset:20480
    v_cvt_pk_bf16_f32 v141, v198, v199
    v_mfma_f32_16x16x32_bf16 v[116:119], a[88:91], v[184:187], v[116:119]
    v_exp_f32 v200, v200
    v_mfma_f32_16x16x32_bf16 v[116:119], a[92:95], v[188:191], v[116:119]
    ds_read_b64_tr_b16 a[124:125], v235 offset:24576
    s_add_u32 s79, s79, 131072
    v_mfma_f32_16x16x32_bf16 v[84:87], a[92:95], v[180:183], v[84:87]
    v_exp_f32 v201, v201
    v_mfma_f32_16x16x32_bf16 v[84:87], a[88:91], v[176:179], v[84:87]
    ds_read_b64_tr_b16 a[126:127], v235 offset:28672
    v_cvt_pk_bf16_f32 v148, v200, v201
    v_mfma_f32_16x16x32_bf16 v[52:55], a[88:91], v[168:171], v[52:55]
    s_add_u32 s42, s72, 16384
    v_exp_f32 v202, v202
    v_mfma_f32_16x16x32_bf16 v[52:55], a[92:95], v[172:175], v[52:55]
    buffer_load_dwordx4 a[184:187], v242, s[20:23], s42 offen sc1
    v_mfma_f32_16x16x32_bf16 v[20:23], a[92:95], v[164:167], v[20:23]
    v_exp_f32 v203, v203
    v_mfma_f32_16x16x32_bf16 v[20:23], a[88:91], v[160:163], v[20:23]
    v_cvt_pk_bf16_f32 v149, v202, v203
    v_smfmac_f32_16x16x64_bf16 a[136:139], a[144:147], v[176:183], v241
    buffer_load_dwordx4 a[188:191], v243, s[20:23], s42 offen sc1
    s_waitcnt vmcnt(27) lgkmcnt(0)
    s_barrier
    v_mfma_f32_16x16x32_bf16 v[192:195], a[96:99], a[0:3], v[208:211]
    v_exp_f32 v204, v204
    v_mfma_f32_16x16x32_bf16 v[192:195], a[100:103], a[4:7], v[192:195]
    ds_read_b128 a[64:67], v224 offset:32768
    v_mov_b32 v249, s79
    v_mfma_f32_16x16x32_bf16 v[192:195], a[104:107], a[8:11], v[192:195]
    v_exp_f32 v205, v205
    v_mfma_f32_16x16x32_bf16 v[192:195], a[108:111], a[12:15], v[192:195]
    ds_read_b128 a[68:71], v225 offset:32768
    v_cvt_pk_bf16_f32 v156, v204, v205
    v_mfma_f32_16x16x32_bf16 v[196:199], a[108:111], a[28:31], v[212:215]
    v_exp_f32 v206, v206
    v_mfma_f32_16x16x32_bf16 v[196:199], a[104:107], a[24:27], v[196:199]
    ds_read_b128 a[72:75], v226 offset:32768
    s_lshl_b32 s52, s17, 5
    v_mfma_f32_16x16x32_bf16 v[196:199], a[100:103], a[20:23], v[196:199]
    v_exp_f32 v207, v207
    v_mfma_f32_16x16x32_bf16 v[196:199], a[96:99], a[16:19], v[196:199]
    ds_read_b128 a[76:79], v227 offset:32768
    v_cvt_pk_bf16_f32 v157, v206, v207
    v_mfma_f32_16x16x32_bf16 v[200:203], a[96:99], a[32:35], v[216:219]
    v_exp_f32 v192, v192
    v_mfma_f32_16x16x32_bf16 v[200:203], a[100:103], a[36:39], v[200:203]
    ds_read_b64_tr_b16 a[80:81], v228 offset:32768
    s_add_u32 s52, s52, s16
    v_mfma_f32_16x16x32_bf16 v[200:203], a[104:107], a[40:43], v[200:203]
    v_exp_f32 v193, v193
    v_mfma_f32_16x16x32_bf16 v[200:203], a[108:111], a[44:47], v[200:203]
    ds_read_b64_tr_b16 a[82:83], v228 offset:36864
    v_cvt_pk_bf16_f32 v134, v192, v193
    v_mfma_f32_16x16x32_bf16 v[204:207], a[108:111], a[60:63], v[220:223]
    s_add_u32 m0, s46, 16384
    v_exp_f32 v194, v194
    v_mfma_f32_16x16x32_bf16 v[204:207], a[104:107], a[56:59], v[204:207]
    buffer_load_dwordx4 v236, s[32:35], s43 offen offset:0 lds
    v_mfma_f32_16x16x32_bf16 v[204:207], a[100:103], a[52:55], v[204:207]
    v_exp_f32 v195, v195
    v_mfma_f32_16x16x32_bf16 v[204:207], a[96:99], a[48:51], v[204:207]
    ds_read_b64_tr_b16 a[84:85], v228 offset:40960
    v_cvt_pk_bf16_f32 v135, v194, v195
    v_mfma_f32_16x16x32_bf16 v[24:27], a[112:115], v[160:163], v[24:27]
    v_exp_f32 v196, v196
    v_mfma_f32_16x16x32_bf16 v[24:27], a[116:119], v[164:167], v[24:27]
    ds_read_b64_tr_b16 a[86:87], v228 offset:45056
    s_lshl_b32 s52, s52, 3
    v_mfma_f32_16x16x32_bf16 v[56:59], a[116:119], v[172:175], v[56:59]
    v_exp_f32 v197, v197
    v_mfma_f32_16x16x32_bf16 v[56:59], a[112:115], v[168:171], v[56:59]
    ds_read_b64_tr_b16 a[88:89], v229 offset:32768
    v_cvt_pk_bf16_f32 v142, v196, v197
    v_mfma_f32_16x16x32_bf16 v[88:91], a[112:115], v[176:179], v[88:91]
    v_exp_f32 v198, v198
    v_mfma_f32_16x16x32_bf16 v[88:91], a[116:119], v[180:183], v[88:91]
    buffer_load_dwordx4 v237, s[32:35], s43 offen offset:1024 lds
    v_mfma_f32_16x16x32_bf16 v[120:123], a[116:119], v[188:191], v[120:123]
    v_exp_f32 v199, v199
    v_mfma_f32_16x16x32_bf16 v[120:123], a[112:115], v[184:187], v[120:123]
    ds_read_b64_tr_b16 a[90:91], v229 offset:36864
    v_cvt_pk_bf16_f32 v143, v198, v199
    v_mfma_f32_16x16x32_bf16 v[124:127], a[120:123], v[184:187], v[124:127]
    v_exp_f32 v200, v200
    v_mfma_f32_16x16x32_bf16 v[124:127], a[124:127], v[188:191], v[124:127]
    ds_read_b64_tr_b16 a[92:93], v229 offset:40960
    s_add_u32 s52, s52, 69632
    v_mfma_f32_16x16x32_bf16 v[92:95], a[124:127], v[180:183], v[92:95]
    v_exp_f32 v201, v201
    v_mfma_f32_16x16x32_bf16 v[92:95], a[120:123], v[176:179], v[92:95]
    ds_read_b64_tr_b16 a[94:95], v229 offset:45056
    v_cvt_pk_bf16_f32 v150, v200, v201
    v_mfma_f32_16x16x32_bf16 v[60:63], a[120:123], v[168:171], v[60:63]
    s_add_u32 s42, s72, 20480
    v_exp_f32 v202, v202
    v_mfma_f32_16x16x32_bf16 v[60:63], a[124:127], v[172:175], v[60:63]
    buffer_load_dwordx4 a[192:195], v242, s[20:23], s42 offen sc1
    v_mfma_f32_16x16x32_bf16 v[28:31], a[124:127], v[164:167], v[28:31]
    v_exp_f32 v203, v203
    v_mfma_f32_16x16x32_bf16 v[28:31], a[120:123], v[160:163], v[28:31]
    v_cvt_pk_bf16_f32 v151, v202, v203
    v_smfmac_f32_16x16x64_bf16 a[140:143], a[144:147], v[184:191], v241
    s_waitcnt lgkmcnt(0)
    v_mfma_f32_16x16x32_bf16 v[192:195], a[64:67], a[0:3], v[208:211]
    v_exp_f32 v204, v204
    v_mfma_f32_16x16x32_bf16 v[192:195], a[68:71], a[4:7], v[192:195]
    ds_read_b128 a[96:99], v224 offset:36864
    s_lshl_b32 s53, s45, 2
    v_mfma_f32_16x16x32_bf16 v[192:195], a[72:75], a[8:11], v[192:195]
    v_exp_f32 v205, v205
    v_mfma_f32_16x16x32_bf16 v[192:195], a[76:79], a[12:15], v[192:195]
    ds_read_b128 a[100:103], v225 offset:36864
    v_cvt_pk_bf16_f32 v158, v204, v205
    v_mfma_f32_16x16x32_bf16 v[196:199], a[76:79], a[28:31], v[212:215]
    v_exp_f32 v206, v206
    v_mfma_f32_16x16x32_bf16 v[196:199], a[72:75], a[24:27], v[196:199]
    ds_read_b128 a[104:107], v226 offset:36864
    s_add_u32 s53, s53, s40
    v_mfma_f32_16x16x32_bf16 v[196:199], a[68:71], a[20:23], v[196:199]
    v_exp_f32 v207, v207
    v_mfma_f32_16x16x32_bf16 v[196:199], a[64:67], a[16:19], v[196:199]
    ds_read_b128 a[108:111], v227 offset:36864
    v_cvt_pk_bf16_f32 v159, v206, v207
    v_mfma_f32_16x16x32_bf16 v[200:203], a[64:67], a[32:35], v[216:219]
    v_exp_f32 v192, v192
    v_mfma_f32_16x16x32_bf16 v[200:203], a[68:71], a[36:39], v[200:203]
    ds_read_b64_tr_b16 a[112:113], v230 offset:32768
    s_lshl_b32 s53, s53, 6
    v_mfma_f32_16x16x32_bf16 v[200:203], a[72:75], a[40:43], v[200:203]
    v_exp_f32 v193, v193
    v_mfma_f32_16x16x32_bf16 v[200:203], a[76:79], a[44:47], v[200:203]
    ds_read_b64_tr_b16 a[114:115], v230 offset:36864
    v_cvt_pk_bf16_f32 v160, v192, v193
    v_mfma_f32_16x16x32_bf16 v[204:207], a[76:79], a[60:63], v[220:223]
    v_exp_f32 v194, v194
    v_mfma_f32_16x16x32_bf16 v[204:207], a[72:75], a[56:59], v[204:207]
    buffer_load_dwordx4 v238, s[32:35], s43 offen offset:2048 lds
    v_mfma_f32_16x16x32_bf16 v[204:207], a[68:71], a[52:55], v[204:207]
    v_exp_f32 v195, v195
    v_mfma_f32_16x16x32_bf16 v[204:207], a[64:67], a[48:51], v[204:207]
    ds_read_b64_tr_b16 a[116:117], v230 offset:40960
    v_cvt_pk_bf16_f32 v161, v194, v195
    v_mfma_f32_16x16x32_bf16 v[0:3], a[80:83], v[128:131], v[0:3]
    v_exp_f32 v196, v196
    v_mfma_f32_16x16x32_bf16 v[0:3], a[84:87], v[132:135], v[0:3]
    ds_read_b64_tr_b16 a[118:119], v230 offset:45056
    s_add_u32 s53, s53, 69632
    v_mfma_f32_16x16x32_bf16 v[32:35], a[84:87], v[140:143], v[32:35]
    v_exp_f32 v197, v197
    v_mfma_f32_16x16x32_bf16 v[32:35], a[80:83], v[136:139], v[32:35]
    ds_read_b64_tr_b16 a[120:121], v231 offset:32768
    v_cvt_pk_bf16_f32 v168, v196, v197
    v_mfma_f32_16x16x32_bf16 v[64:67], a[80:83], v[144:147], v[64:67]
    v_exp_f32 v198, v198
    v_mfma_f32_16x16x32_bf16 v[64:67], a[84:87], v[148:151], v[64:67]
    buffer_load_dwordx4 v239, s[32:35], s43 offen offset:3072 lds
    v_mfma_f32_16x16x32_bf16 v[96:99], a[84:87], v[156:159], v[96:99]
    s_add_u32 s43, s43, 4096
    v_exp_f32 v199, v199
    v_mfma_f32_16x16x32_bf16 v[96:99], a[80:83], v[152:155], v[96:99]
    ds_read_b64_tr_b16 a[122:123], v231 offset:36864
    v_cvt_pk_bf16_f32 v169, v198, v199
    v_mfma_f32_16x16x32_bf16 v[100:103], a[88:91], v[152:155], v[100:103]
    v_exp_f32 v200, v200
    v_mfma_f32_16x16x32_bf16 v[100:103], a[92:95], v[156:159], v[100:103]
    ds_read_b64_tr_b16 a[124:125], v231 offset:40960
    s_lshl_b32 s54, s15, 1
    v_mfma_f32_16x16x32_bf16 v[68:71], a[92:95], v[148:151], v[68:71]
    v_exp_f32 v201, v201
    v_mfma_f32_16x16x32_bf16 v[68:71], a[88:91], v[144:147], v[68:71]
    ds_read_b64_tr_b16 a[126:127], v231 offset:45056
    v_cvt_pk_bf16_f32 v176, v200, v201
    v_mfma_f32_16x16x32_bf16 v[36:39], a[88:91], v[136:139], v[36:39]
    v_exp_f32 v202, v202
    v_mfma_f32_16x16x32_bf16 v[36:39], a[92:95], v[140:143], v[36:39]
    buffer_load_dwordx4 a[196:199], v243, s[20:23], s42 offen sc1
    v_mfma_f32_16x16x32_bf16 v[4:7], a[92:95], v[132:135], v[4:7]
    v_exp_f32 v203, v203
    v_mfma_f32_16x16x32_bf16 v[4:7], a[88:91], v[128:131], v[4:7]
    v_cvt_pk_bf16_f32 v177, v202, v203
    s_add_u32 s42, s72, 24576
    v_smfmac_f32_16x16x64_bf16 a[128:131], a[144:147], v[128:135], v241
    buffer_load_dwordx4 a[200:203], v242, s[20:23], s42 offen sc1
    s_waitcnt lgkmcnt(0)
    v_mfma_f32_16x16x32_bf16 v[192:195], a[96:99], a[0:3], v[208:211]
    v_exp_f32 v204, v204
    v_mfma_f32_16x16x32_bf16 v[192:195], a[100:103], a[4:7], v[192:195]
    ds_read_b128 a[64:67], v224 offset:40960
    s_and_b32 s79, s2, 1
    v_mfma_f32_16x16x32_bf16 v[192:195], a[104:107], a[8:11], v[192:195]
    v_exp_f32 v205, v205
    v_mfma_f32_16x16x32_bf16 v[192:195], a[108:111], a[12:15], v[192:195]
    ds_read_b128 a[68:71], v225 offset:40960
    v_cvt_pk_bf16_f32 v184, v204, v205
    v_mfma_f32_16x16x32_bf16 v[196:199], a[108:111], a[28:31], v[212:215]
    v_exp_f32 v206, v206
    v_mfma_f32_16x16x32_bf16 v[196:199], a[104:107], a[24:27], v[196:199]
    ds_read_b128 a[72:75], v226 offset:40960
    s_add_u32 s54, s54, s79
    v_mfma_f32_16x16x32_bf16 v[196:199], a[100:103], a[20:23], v[196:199]
    v_exp_f32 v207, v207
    v_mfma_f32_16x16x32_bf16 v[196:199], a[96:99], a[16:19], v[196:199]
    ds_read_b128 a[76:79], v227 offset:40960
    v_cvt_pk_bf16_f32 v185, v206, v207
    v_mfma_f32_16x16x32_bf16 v[200:203], a[96:99], a[32:35], v[216:219]
    v_exp_f32 v192, v192
    v_mfma_f32_16x16x32_bf16 v[200:203], a[100:103], a[36:39], v[200:203]
    ds_read_b64_tr_b16 a[80:81], v232 offset:32768
    s_lshl_b32 s54, s54, 2
    v_mfma_f32_16x16x32_bf16 v[200:203], a[104:107], a[40:43], v[200:203]
    v_exp_f32 v193, v193
    v_mfma_f32_16x16x32_bf16 v[200:203], a[108:111], a[44:47], v[200:203]
    ds_read_b64_tr_b16 a[82:83], v232 offset:36864
    v_cvt_pk_bf16_f32 v162, v192, v193
    v_mfma_f32_16x16x32_bf16 v[204:207], a[108:111], a[60:63], v[220:223]
    s_add_u32 m0, s46, 20480
    v_exp_f32 v194, v194
    v_mfma_f32_16x16x32_bf16 v[204:207], a[104:107], a[56:59], v[204:207]
    buffer_load_dwordx4 v236, s[32:35], s43 offen offset:0 lds
    v_mfma_f32_16x16x32_bf16 v[204:207], a[100:103], a[52:55], v[204:207]
    v_exp_f32 v195, v195
    v_mfma_f32_16x16x32_bf16 v[204:207], a[96:99], a[48:51], v[204:207]
    ds_read_b64_tr_b16 a[84:85], v232 offset:40960
    v_cvt_pk_bf16_f32 v163, v194, v195
    v_mfma_f32_16x16x32_bf16 v[8:11], a[112:115], v[128:131], v[8:11]
    v_exp_f32 v196, v196
    v_mfma_f32_16x16x32_bf16 v[8:11], a[116:119], v[132:135], v[8:11]
    ds_read_b64_tr_b16 a[86:87], v232 offset:45056
    s_add_u32 s54, s54, s3
    v_mfma_f32_16x16x32_bf16 v[40:43], a[116:119], v[140:143], v[40:43]
    v_exp_f32 v197, v197
    v_mfma_f32_16x16x32_bf16 v[40:43], a[112:115], v[136:139], v[40:43]
    ds_read_b64_tr_b16 a[88:89], v233 offset:32768
    v_cvt_pk_bf16_f32 v170, v196, v197
    v_mfma_f32_16x16x32_bf16 v[72:75], a[112:115], v[144:147], v[72:75]
    v_exp_f32 v198, v198
    v_mfma_f32_16x16x32_bf16 v[72:75], a[116:119], v[148:151], v[72:75]
    buffer_load_dwordx4 v237, s[32:35], s43 offen offset:1024 lds
    v_mfma_f32_16x16x32_bf16 v[104:107], a[116:119], v[156:159], v[104:107]
    v_exp_f32 v199, v199
    v_mfma_f32_16x16x32_bf16 v[104:107], a[112:115], v[152:155], v[104:107]
    ds_read_b64_tr_b16 a[90:91], v233 offset:36864
    v_cvt_pk_bf16_f32 v171, v198, v199
    v_mfma_f32_16x16x32_bf16 v[108:111], a[120:123], v[152:155], v[108:111]
K1_pg10:
    s_cbranch_execz K1_pg14
    v_exp_f32 v200, v200
    v_mfma_f32_16x16x32_bf16 v[108:111], a[124:127], v[156:159], v[108:111]
    ds_read_b64_tr_b16 a[92:93], v233 offset:40960
    s_lshl_b32 s54, s54, 9
    v_mfma_f32_16x16x32_bf16 v[76:79], a[124:127], v[148:151], v[76:79]
    v_exp_f32 v201, v201
    v_mfma_f32_16x16x32_bf16 v[76:79], a[120:123], v[144:147], v[76:79]
    ds_read_b64_tr_b16 a[94:95], v233 offset:45056
    v_cvt_pk_bf16_f32 v178, v200, v201
    v_mfma_f32_16x16x32_bf16 v[44:47], a[120:123], v[136:139], v[44:47]
    v_exp_f32 v202, v202
    v_mfma_f32_16x16x32_bf16 v[44:47], a[124:127], v[140:143], v[44:47]
    buffer_load_dwordx4 a[204:207], v243, s[20:23], s42 offen sc1
    v_mfma_f32_16x16x32_bf16 v[12:15], a[124:127], v[132:135], v[12:15]
    v_exp_f32 v203, v203
    v_mfma_f32_16x16x32_bf16 v[12:15], a[120:123], v[128:131], v[12:15]
    v_cvt_pk_bf16_f32 v179, v202, v203
    s_add_u32 s42, s72, 28672
    v_smfmac_f32_16x16x64_bf16 a[132:135], a[144:147], v[136:143], v241
    buffer_load_dwordx4 a[208:211], v242, s[20:23], s42 offen sc1
    s_waitcnt lgkmcnt(0)
    v_mfma_f32_16x16x32_bf16 v[192:195], a[64:67], a[0:3], v[208:211]
    v_exp_f32 v204, v204
    v_mfma_f32_16x16x32_bf16 v[192:195], a[68:71], a[4:7], v[192:195]
    ds_read_b128 a[96:99], v224 offset:45056
    s_add_u32 s54, s54, 200704
    v_mfma_f32_16x16x32_bf16 v[192:195], a[72:75], a[8:11], v[192:195]
    v_exp_f32 v205, v205
    v_mfma_f32_16x16x32_bf16 v[192:195], a[76:79], a[12:15], v[192:195]
    ds_read_b128 a[100:103], v225 offset:45056
    v_cvt_pk_bf16_f32 v186, v204, v205
    v_mfma_f32_16x16x32_bf16 v[196:199], a[76:79], a[28:31], v[212:215]
    v_exp_f32 v206, v206
    v_mfma_f32_16x16x32_bf16 v[196:199], a[72:75], a[24:27], v[196:199]
    ds_read_b128 a[104:107], v226 offset:45056
    s_lshl_b32 s78, s40, 7
    v_mfma_f32_16x16x32_bf16 v[196:199], a[68:71], a[20:23], v[196:199]
    v_exp_f32 v207, v207
    v_mfma_f32_16x16x32_bf16 v[196:199], a[64:67], a[16:19], v[196:199]
    ds_read_b128 a[108:111], v227 offset:45056
    v_cvt_pk_bf16_f32 v187, v206, v207
    v_mfma_f32_16x16x32_bf16 v[200:203], a[64:67], a[32:35], v[216:219]
    v_exp_f32 v192, v192
    v_mfma_f32_16x16x32_bf16 v[200:203], a[68:71], a[36:39], v[200:203]
    ds_read_b64_tr_b16 a[112:113], v234 offset:32768
    s_add_u32 s78, s78, s54
    v_mfma_f32_16x16x32_bf16 v[200:203], a[72:75], a[40:43], v[200:203]
    v_exp_f32 v193, v193
    v_mfma_f32_16x16x32_bf16 v[200:203], a[76:79], a[44:47], v[200:203]
    ds_read_b64_tr_b16 a[114:115], v234 offset:36864
    v_cvt_pk_bf16_f32 v164, v192, v193
    v_mfma_f32_16x16x32_bf16 v[204:207], a[76:79], a[60:63], v[220:223]
    v_exp_f32 v194, v194
    v_mfma_f32_16x16x32_bf16 v[204:207], a[72:75], a[56:59], v[204:207]
    buffer_load_dwordx4 v238, s[32:35], s43 offen offset:2048 lds
    v_mfma_f32_16x16x32_bf16 v[204:207], a[68:71], a[52:55], v[204:207]
    v_exp_f32 v195, v195
    v_mfma_f32_16x16x32_bf16 v[204:207], a[64:67], a[48:51], v[204:207]
    ds_read_b64_tr_b16 a[116:117], v234 offset:40960
    v_cvt_pk_bf16_f32 v165, v194, v195
    v_mfma_f32_16x16x32_bf16 v[16:19], a[80:83], v[128:131], v[16:19]
    v_exp_f32 v196, v196
    v_mfma_f32_16x16x32_bf16 v[16:19], a[84:87], v[132:135], v[16:19]
    ds_read_b64_tr_b16 a[118:119], v234 offset:45056
    s_xor_b32 s58, s2, 0
    v_mfma_f32_16x16x32_bf16 v[48:51], a[84:87], v[140:143], v[48:51]
    v_exp_f32 v197, v197
    v_mfma_f32_16x16x32_bf16 v[48:51], a[80:83], v[136:139], v[48:51]
    ds_read_b64_tr_b16 a[120:121], v235 offset:32768
    v_cvt_pk_bf16_f32 v172, v196, v197
    v_mfma_f32_16x16x32_bf16 v[80:83], a[80:83], v[144:147], v[80:83]
    v_exp_f32 v198, v198
    v_mfma_f32_16x16x32_bf16 v[80:83], a[84:87], v[148:151], v[80:83]
    buffer_load_dwordx4 v239, s[32:35], s43 offen offset:3072 lds
    v_mfma_f32_16x16x32_bf16 v[112:115], a[84:87], v[156:159], v[112:115]
    s_add_u32 s43, s43, 12288
    v_exp_f32 v199, v199
    v_mfma_f32_16x16x32_bf16 v[112:115], a[80:83], v[152:155], v[112:115]
    ds_read_b64_tr_b16 a[122:123], v235 offset:36864
    v_cvt_pk_bf16_f32 v173, v198, v199
    v_mfma_f32_16x16x32_bf16 v[116:119], a[88:91], v[152:155], v[116:119]
    v_exp_f32 v200, v200
    v_mfma_f32_16x16x32_bf16 v[116:119], a[92:95], v[156:159], v[116:119]
    ds_read_b64_tr_b16 a[124:125], v235 offset:40960
    s_lshl_b32 s58, s58, 2
    v_mfma_f32_16x16x32_bf16 v[84:87], a[92:95], v[148:151], v[84:87]
    v_exp_f32 v201, v201
    v_mfma_f32_16x16x32_bf16 v[84:87], a[88:91], v[144:147], v[84:87]
    ds_read_b64_tr_b16 a[126:127], v235 offset:45056
    v_cvt_pk_bf16_f32 v180, v200, v201
    v_mfma_f32_16x16x32_bf16 v[52:55], a[88:91], v[136:139], v[52:55]
    v_exp_f32 v202, v202
    v_mfma_f32_16x16x32_bf16 v[52:55], a[92:95], v[140:143], v[52:55]
    buffer_load_dwordx4 a[212:215], v243, s[20:23], s42 offen sc1
    v_mfma_f32_16x16x32_bf16 v[20:23], a[92:95], v[132:135], v[20:23]
    v_exp_f32 v203, v203
    v_mfma_f32_16x16x32_bf16 v[20:23], a[88:91], v[128:131], v[20:23]
    v_cvt_pk_bf16_f32 v181, v202, v203
    s_add_u32 s42, s72, 32768
    v_smfmac_f32_16x16x64_bf16 a[136:139], a[144:147], v[144:151], v241
    buffer_load_dwordx4 a[216:219], v242, s[20:23], s42 offen sc1
    s_waitcnt vmcnt(33) lgkmcnt(0)
    s_barrier
    v_mfma_f32_16x16x32_bf16 v[192:195], a[96:99], a[0:3], v[208:211]
    v_exp_f32 v204, v204
    v_mfma_f32_16x16x32_bf16 v[192:195], a[100:103], a[4:7], v[192:195]
    ds_read_b128 a[64:67], v224 offset:49152
    s_add_u32 s58, s58, s3
    v_mfma_f32_16x16x32_bf16 v[192:195], a[104:107], a[8:11], v[192:195]
    v_exp_f32 v205, v205
    v_mfma_f32_16x16x32_bf16 v[192:195], a[108:111], a[12:15], v[192:195]
    ds_read_b128 a[68:71], v225 offset:49152
    v_cvt_pk_bf16_f32 v188, v204, v205
    v_mfma_f32_16x16x32_bf16 v[196:199], a[108:111], a[28:31], v[212:215]
    v_exp_f32 v206, v206
    v_mfma_f32_16x16x32_bf16 v[196:199], a[104:107], a[24:27], v[196:199]
    ds_read_b128 a[72:75], v226 offset:49152
    s_lshl_b32 s58, s58, 13
    v_mfma_f32_16x16x32_bf16 v[196:199], a[100:103], a[20:23], v[196:199]
    v_exp_f32 v207, v207
    v_mfma_f32_16x16x32_bf16 v[196:199], a[96:99], a[16:19], v[196:199]
    ds_read_b128 a[76:79], v227 offset:49152
    v_cvt_pk_bf16_f32 v189, v206, v207
    v_mfma_f32_16x16x32_bf16 v[200:203], a[96:99], a[32:35], v[216:219]
    v_exp_f32 v192, v192
    v_mfma_f32_16x16x32_bf16 v[200:203], a[100:103], a[36:39], v[200:203]
    ds_read_b64_tr_b16 a[80:81], v228 offset:49152
    s_xor_b32 s55, s2, 2
    v_mfma_f32_16x16x32_bf16 v[200:203], a[104:107], a[40:43], v[200:203]
    v_exp_f32 v193, v193
    v_mfma_f32_16x16x32_bf16 v[200:203], a[108:111], a[44:47], v[200:203]
    ds_read_b64_tr_b16 a[82:83], v228 offset:53248
    v_cvt_pk_bf16_f32 v166, v192, v193
    v_mfma_f32_16x16x32_bf16 v[204:207], a[108:111], a[60:63], v[220:223]
    s_add_u32 m0, s46, 32768
    v_exp_f32 v194, v194
    v_mfma_f32_16x16x32_bf16 v[204:207], a[104:107], a[56:59], v[204:207]
    buffer_load_dwordx4 v236, s[32:35], s43 offen offset:0 lds
    v_mfma_f32_16x16x32_bf16 v[204:207], a[100:103], a[52:55], v[204:207]
    v_exp_f32 v195, v195
    v_mfma_f32_16x16x32_bf16 v[204:207], a[96:99], a[48:51], v[204:207]
    ds_read_b64_tr_b16 a[84:85], v228 offset:57344
    v_cvt_pk_bf16_f32 v167, v194, v195
    v_mfma_f32_16x16x32_bf16 v[24:27], a[112:115], v[128:131], v[24:27]
    v_exp_f32 v196, v196
    v_mfma_f32_16x16x32_bf16 v[24:27], a[116:119], v[132:135], v[24:27]
    ds_read_b64_tr_b16 a[86:87], v228 offset:61440
    s_lshl_b32 s55, s55, 2
    v_mfma_f32_16x16x32_bf16 v[56:59], a[116:119], v[140:143], v[56:59]
    v_exp_f32 v197, v197
    v_mfma_f32_16x16x32_bf16 v[56:59], a[112:115], v[136:139], v[56:59]
    ds_read_b64_tr_b16 a[88:89], v229 offset:49152
    v_cvt_pk_bf16_f32 v174, v196, v197
    v_mfma_f32_16x16x32_bf16 v[88:91], a[112:115], v[144:147], v[88:91]
    v_exp_f32 v198, v198
    v_mfma_f32_16x16x32_bf16 v[88:91], a[116:119], v[148:151], v[88:91]
    buffer_load_dwordx4 v237, s[32:35], s43 offen offset:1024 lds
    v_mfma_f32_16x16x32_bf16 v[120:123], a[116:119], v[156:159], v[120:123]
    v_exp_f32 v199, v199
    v_mfma_f32_16x16x32_bf16 v[120:123], a[112:115], v[152:155], v[120:123]
    ds_read_b64_tr_b16 a[90:91], v229 offset:53248
    v_cvt_pk_bf16_f32 v175, v198, v199
    v_mfma_f32_16x16x32_bf16 v[124:127], a[120:123], v[152:155], v[124:127]
    v_exp_f32 v200, v200
    v_mfma_f32_16x16x32_bf16 v[124:127], a[124:127], v[156:159], v[124:127]
    ds_read_b64_tr_b16 a[92:93], v229 offset:57344
    s_add_u32 s55, s55, s3
    v_mfma_f32_16x16x32_bf16 v[92:95], a[124:127], v[148:151], v[92:95]
    v_exp_f32 v201, v201
    v_mfma_f32_16x16x32_bf16 v[92:95], a[120:123], v[144:147], v[92:95]
    ds_read_b64_tr_b16 a[94:95], v229 offset:61440
    v_cvt_pk_bf16_f32 v182, v200, v201
    v_mfma_f32_16x16x32_bf16 v[60:63], a[120:123], v[136:139], v[60:63]
    v_exp_f32 v202, v202
    v_mfma_f32_16x16x32_bf16 v[60:63], a[124:127], v[140:143], v[60:63]
    buffer_load_dwordx4 a[220:223], v243, s[20:23], s42 offen sc1
    v_mfma_f32_16x16x32_bf16 v[28:31], a[124:127], v[132:135], v[28:31]
    v_exp_f32 v203, v203
    v_mfma_f32_16x16x32_bf16 v[28:31], a[120:123], v[128:131], v[28:31]
    v_cvt_pk_bf16_f32 v183, v202, v203
    s_add_u32 s42, s72, 36864
    v_smfmac_f32_16x16x64_bf16 a[140:143], a[144:147], v[152:159], v241
    buffer_load_dwordx4 a[224:227], v242, s[20:23], s42 offen sc1
    s_waitcnt lgkmcnt(0)
    v_mfma_f32_16x16x32_bf16 v[192:195], a[64:67], a[0:3], v[208:211]
    v_exp_f32 v204, v204
    v_mfma_f32_16x16x32_bf16 v[192:195], a[68:71], a[4:7], v[192:195]
    ds_read_b128 a[96:99], v224 offset:53248
    s_lshl_b32 s55, s55, 13
    v_mfma_f32_16x16x32_bf16 v[192:195], a[72:75], a[8:11], v[192:195]
    v_exp_f32 v205, v205
    v_mfma_f32_16x16x32_bf16 v[192:195], a[76:79], a[12:15], v[192:195]
    ds_read_b128 a[100:103], v225 offset:53248
    v_cvt_pk_bf16_f32 v190, v204, v205
    v_mfma_f32_16x16x32_bf16 v[196:199], a[76:79], a[28:31], v[212:215]
    v_exp_f32 v206, v206
    v_mfma_f32_16x16x32_bf16 v[196:199], a[72:75], a[24:27], v[196:199]
    ds_read_b128 a[104:107], v226 offset:53248
    s_xor_b32 s56, s2, 4
    v_mfma_f32_16x16x32_bf16 v[196:199], a[68:71], a[20:23], v[196:199]
    v_exp_f32 v207, v207
    v_mfma_f32_16x16x32_bf16 v[196:199], a[64:67], a[16:19], v[196:199]
    ds_read_b128 a[108:111], v227 offset:53248
    v_cvt_pk_bf16_f32 v191, v206, v207
    v_mfma_f32_16x16x32_bf16 v[200:203], a[64:67], a[32:35], v[216:219]
    v_exp_f32 v192, v192
    v_mfma_f32_16x16x32_bf16 v[200:203], a[68:71], a[36:39], v[200:203]
    ds_read_b64_tr_b16 a[112:113], v230 offset:49152
    s_lshl_b32 s56, s56, 2
    v_mfma_f32_16x16x32_bf16 v[200:203], a[72:75], a[40:43], v[200:203]
    v_exp_f32 v193, v193
    v_mfma_f32_16x16x32_bf16 v[200:203], a[76:79], a[44:47], v[200:203]
    ds_read_b64_tr_b16 a[114:115], v230 offset:53248
    v_cvt_pk_bf16_f32 v128, v192, v193
    v_mfma_f32_16x16x32_bf16 v[204:207], a[76:79], a[60:63], v[220:223]
    v_exp_f32 v194, v194
    v_mfma_f32_16x16x32_bf16 v[204:207], a[72:75], a[56:59], v[204:207]
    buffer_load_dwordx4 v238, s[32:35], s43 offen offset:2048 lds
    v_mfma_f32_16x16x32_bf16 v[204:207], a[68:71], a[52:55], v[204:207]
    v_exp_f32 v195, v195
    v_mfma_f32_16x16x32_bf16 v[204:207], a[64:67], a[48:51], v[204:207]
    ds_read_b64_tr_b16 a[116:117], v230 offset:57344
    v_cvt_pk_bf16_f32 v129, v194, v195
    v_mfma_f32_16x16x32_bf16 v[0:3], a[80:83], v[160:163], v[0:3]
    v_exp_f32 v196, v196
    v_mfma_f32_16x16x32_bf16 v[0:3], a[84:87], v[164:167], v[0:3]
    ds_read_b64_tr_b16 a[118:119], v230 offset:61440
    s_add_u32 s56, s56, s3
    v_mfma_f32_16x16x32_bf16 v[32:35], a[84:87], v[172:175], v[32:35]
    v_exp_f32 v197, v197
    v_mfma_f32_16x16x32_bf16 v[32:35], a[80:83], v[168:171], v[32:35]
    ds_read_b64_tr_b16 a[120:121], v231 offset:49152
    v_cvt_pk_bf16_f32 v136, v196, v197
    v_mfma_f32_16x16x32_bf16 v[64:67], a[80:83], v[176:179], v[64:67]
    v_exp_f32 v198, v198
    v_mfma_f32_16x16x32_bf16 v[64:67], a[84:87], v[180:183], v[64:67]
    buffer_load_dwordx4 v239, s[32:35], s43 offen offset:3072 lds
    v_mfma_f32_16x16x32_bf16 v[96:99], a[84:87], v[188:191], v[96:99]
    s_add_u32 s43, s43, 4096
    v_exp_f32 v199, v199
    v_mfma_f32_16x16x32_bf16 v[96:99], a[80:83], v[184:187], v[96:99]
    ds_read_b64_tr_b16 a[122:123], v231 offset:53248
    v_cvt_pk_bf16_f32 v137, v198, v199
    v_mfma_f32_16x16x32_bf16 v[100:103], a[88:91], v[184:187], v[100:103]
    v_exp_f32 v200, v200
    v_mfma_f32_16x16x32_bf16 v[100:103], a[92:95], v[188:191], v[100:103]
    ds_read_b64_tr_b16 a[124:125], v231 offset:57344
    s_lshl_b32 s56, s56, 13
    v_mfma_f32_16x16x32_bf16 v[68:71], a[92:95], v[180:183], v[68:71]
    v_exp_f32 v201, v201
    v_mfma_f32_16x16x32_bf16 v[68:71], a[88:91], v[176:179], v[68:71]
    ds_read_b64_tr_b16 a[126:127], v231 offset:61440
    v_cvt_pk_bf16_f32 v144, v200, v201
    v_mfma_f32_16x16x32_bf16 v[36:39], a[88:91], v[168:171], v[36:39]
    v_exp_f32 v202, v202
    v_mfma_f32_16x16x32_bf16 v[36:39], a[92:95], v[172:175], v[36:39]
    buffer_load_dwordx4 a[228:231], v243, s[20:23], s42 offen sc1
    v_mfma_f32_16x16x32_bf16 v[4:7], a[92:95], v[164:167], v[4:7]
    v_exp_f32 v203, v203
    v_mfma_f32_16x16x32_bf16 v[4:7], a[88:91], v[160:163], v[4:7]
    v_cvt_pk_bf16_f32 v145, v202, v203
    v_smfmac_f32_16x16x64_bf16 a[128:131], a[144:147], v[160:167], v241
    s_waitcnt lgkmcnt(0)
    v_mfma_f32_16x16x32_bf16 v[192:195], a[96:99], a[0:3], v[208:211]
    v_exp_f32 v204, v204
    v_mfma_f32_16x16x32_bf16 v[192:195], a[100:103], a[4:7], v[192:195]
    ds_read_b128 a[64:67], v224 offset:57344
    s_add_u32 s56, s56, 5120
    v_mfma_f32_16x16x32_bf16 v[192:195], a[104:107], a[8:11], v[192:195]
    v_exp_f32 v205, v205
    v_mfma_f32_16x16x32_bf16 v[192:195], a[108:111], a[12:15], v[192:195]
    ds_read_b128 a[68:71], v225 offset:57344
    v_cvt_pk_bf16_f32 v152, v204, v205
    v_mfma_f32_16x16x32_bf16 v[196:199], a[108:111], a[28:31], v[212:215]
    v_exp_f32 v206, v206
    v_mfma_f32_16x16x32_bf16 v[196:199], a[104:107], a[24:27], v[196:199]
    ds_read_b128 a[72:75], v226 offset:57344
    s_xor_b32 s57, s2, 6
    v_mfma_f32_16x16x32_bf16 v[196:199], a[100:103], a[20:23], v[196:199]
    v_exp_f32 v207, v207
    v_mfma_f32_16x16x32_bf16 v[196:199], a[96:99], a[16:19], v[196:199]
    ds_read_b128 a[76:79], v227 offset:57344
    v_cvt_pk_bf16_f32 v153, v206, v207
    v_mfma_f32_16x16x32_bf16 v[200:203], a[96:99], a[32:35], v[216:219]
    v_exp_f32 v192, v192
    v_mfma_f32_16x16x32_bf16 v[200:203], a[100:103], a[36:39], v[200:203]
    ds_read_b64_tr_b16 a[80:81], v232 offset:49152
    s_lshl_b32 s57, s57, 2
    v_mfma_f32_16x16x32_bf16 v[200:203], a[104:107], a[40:43], v[200:203]
    v_exp_f32 v193, v193
    v_mfma_f32_16x16x32_bf16 v[200:203], a[108:111], a[44:47], v[200:203]
    ds_read_b64_tr_b16 a[82:83], v232 offset:53248
    v_cvt_pk_bf16_f32 v130, v192, v193
    v_mfma_f32_16x16x32_bf16 v[204:207], a[108:111], a[60:63], v[220:223]
    s_add_u32 m0, s46, 36864
    v_exp_f32 v194, v194
    v_mfma_f32_16x16x32_bf16 v[204:207], a[104:107], a[56:59], v[204:207]
    buffer_load_dwordx4 v236, s[32:35], s43 offen offset:0 lds
    v_mfma_f32_16x16x32_bf16 v[204:207], a[100:103], a[52:55], v[204:207]
    v_exp_f32 v195, v195
    v_mfma_f32_16x16x32_bf16 v[204:207], a[96:99], a[48:51], v[204:207]
    ds_read_b64_tr_b16 a[84:85], v232 offset:57344
    v_cvt_pk_bf16_f32 v131, v194, v195
    v_mfma_f32_16x16x32_bf16 v[8:11], a[112:115], v[160:163], v[8:11]
    v_exp_f32 v196, v196
    v_mfma_f32_16x16x32_bf16 v[8:11], a[116:119], v[164:167], v[8:11]
    ds_read_b64_tr_b16 a[86:87], v232 offset:61440
    s_add_u32 s57, s57, s3
    v_mfma_f32_16x16x32_bf16 v[40:43], a[116:119], v[172:175], v[40:43]
    v_exp_f32 v197, v197
    v_mfma_f32_16x16x32_bf16 v[40:43], a[112:115], v[168:171], v[40:43]
    ds_read_b64_tr_b16 a[88:89], v233 offset:49152
    v_cvt_pk_bf16_f32 v138, v196, v197
    v_mfma_f32_16x16x32_bf16 v[72:75], a[112:115], v[176:179], v[72:75]
    v_exp_f32 v198, v198
    v_mfma_f32_16x16x32_bf16 v[72:75], a[116:119], v[180:183], v[72:75]
    buffer_load_dwordx4 v237, s[32:35], s43 offen offset:1024 lds
    v_mfma_f32_16x16x32_bf16 v[104:107], a[116:119], v[188:191], v[104:107]
    v_exp_f32 v199, v199
    v_mfma_f32_16x16x32_bf16 v[104:107], a[112:115], v[184:187], v[104:107]
    ds_read_b64_tr_b16 a[90:91], v233 offset:53248
    v_cvt_pk_bf16_f32 v139, v198, v199
    v_mfma_f32_16x16x32_bf16 v[108:111], a[120:123], v[184:187], v[108:111]
    v_exp_f32 v200, v200
    v_mfma_f32_16x16x32_bf16 v[108:111], a[124:127], v[188:191], v[108:111]
    ds_read_b64_tr_b16 a[92:93], v233 offset:57344
    s_lshl_b32 s57, s57, 13
    v_mfma_f32_16x16x32_bf16 v[76:79], a[124:127], v[180:183], v[76:79]
    v_exp_f32 v201, v201
    v_mfma_f32_16x16x32_bf16 v[76:79], a[120:123], v[176:179], v[76:79]
    ds_read_b64_tr_b16 a[94:95], v233 offset:61440
    v_cvt_pk_bf16_f32 v146, v200, v201
    v_mfma_f32_16x16x32_bf16 v[44:47], a[120:123], v[168:171], v[44:47]
    s_add_u32 s42, s72, 40960
    v_exp_f32 v202, v202
    v_mfma_f32_16x16x32_bf16 v[44:47], a[124:127], v[172:175], v[44:47]
    buffer_load_dwordx4 a[232:235], v242, s[20:23], s42 offen sc1
    v_mfma_f32_16x16x32_bf16 v[12:15], a[124:127], v[164:167], v[12:15]
    v_exp_f32 v203, v203
    v_mfma_f32_16x16x32_bf16 v[12:15], a[120:123], v[160:163], v[12:15]
    v_cvt_pk_bf16_f32 v147, v202, v203
    v_smfmac_f32_16x16x64_bf16 a[132:135], a[144:147], v[168:175], v241
    buffer_load_dwordx4 a[236:239], v243, s[20:23], s42 offen sc1
    s_waitcnt lgkmcnt(0)
    v_mfma_f32_16x16x32_bf16 v[192:195], a[64:67], a[0:3], v[208:211]
    v_exp_f32 v204, v204
    v_mfma_f32_16x16x32_bf16 v[192:195], a[68:71], a[4:7], v[192:195]
    ds_read_b128 a[96:99], v224 offset:61440
    s_add_u32 s57, s57, 2048
    v_mfma_f32_16x16x32_bf16 v[192:195], a[72:75], a[8:11], v[192:195]
    v_exp_f32 v205, v205
    v_mfma_f32_16x16x32_bf16 v[192:195], a[76:79], a[12:15], v[192:195]
    ds_read_b128 a[100:103], v225 offset:61440
    v_cvt_pk_bf16_f32 v154, v204, v205
    v_mfma_f32_16x16x32_bf16 v[196:199], a[76:79], a[28:31], v[212:215]
    v_exp_f32 v206, v206
    v_mfma_f32_16x16x32_bf16 v[196:199], a[72:75], a[24:27], v[196:199]
    ds_read_b128 a[104:107], v226 offset:61440
    s_mov_b32 s60, s82
    v_mfma_f32_16x16x32_bf16 v[196:199], a[68:71], a[20:23], v[196:199]
    v_exp_f32 v207, v207
    v_mfma_f32_16x16x32_bf16 v[196:199], a[64:67], a[16:19], v[196:199]
    ds_read_b128 a[108:111], v227 offset:61440
    v_cvt_pk_bf16_f32 v155, v206, v207
    v_mfma_f32_16x16x32_bf16 v[200:203], a[64:67], a[32:35], v[216:219]
    v_exp_f32 v192, v192
    v_mfma_f32_16x16x32_bf16 v[200:203], a[68:71], a[36:39], v[200:203]
    ds_read_b64_tr_b16 a[112:113], v234 offset:49152
    s_mov_b32 s61, s83
    v_mfma_f32_16x16x32_bf16 v[200:203], a[72:75], a[40:43], v[200:203]
    v_exp_f32 v193, v193
    v_mfma_f32_16x16x32_bf16 v[200:203], a[76:79], a[44:47], v[200:203]
    ds_read_b64_tr_b16 a[114:115], v234 offset:53248
    v_cvt_pk_bf16_f32 v132, v192, v193
    v_mfma_f32_16x16x32_bf16 v[204:207], a[76:79], a[60:63], v[220:223]
    v_exp_f32 v194, v194
    v_mfma_f32_16x16x32_bf16 v[204:207], a[72:75], a[56:59], v[204:207]
    buffer_load_dwordx4 v238, s[32:35], s43 offen offset:2048 lds
    v_mfma_f32_16x16x32_bf16 v[204:207], a[68:71], a[52:55], v[204:207]
    v_exp_f32 v195, v195
    v_mfma_f32_16x16x32_bf16 v[204:207], a[64:67], a[48:51], v[204:207]
    ds_read_b64_tr_b16 a[116:117], v234 offset:57344
    v_cvt_pk_bf16_f32 v133, v194, v195
    v_mfma_f32_16x16x32_bf16 v[16:19], a[80:83], v[160:163], v[16:19]
    v_exp_f32 v196, v196
    v_mfma_f32_16x16x32_bf16 v[16:19], a[84:87], v[164:167], v[16:19]
    ds_read_b64_tr_b16 a[118:119], v234 offset:61440
    s_mov_b32 s62, 2621440
    v_mfma_f32_16x16x32_bf16 v[48:51], a[84:87], v[172:175], v[48:51]
    v_exp_f32 v197, v197
    v_mfma_f32_16x16x32_bf16 v[48:51], a[80:83], v[168:171], v[48:51]
    ds_read_b64_tr_b16 a[120:121], v235 offset:49152
    v_cvt_pk_bf16_f32 v140, v196, v197
    v_mfma_f32_16x16x32_bf16 v[80:83], a[80:83], v[176:179], v[80:83]
    v_exp_f32 v198, v198
    v_mfma_f32_16x16x32_bf16 v[80:83], a[84:87], v[180:183], v[80:83]
    buffer_load_dwordx4 v239, s[32:35], s43 offen offset:3072 lds
    v_mfma_f32_16x16x32_bf16 v[112:115], a[84:87], v[188:191], v[112:115]
    s_add_u32 s43, s43, 12288
    v_exp_f32 v199, v199
    v_mfma_f32_16x16x32_bf16 v[112:115], a[80:83], v[184:187], v[112:115]
    ds_read_b64_tr_b16 a[122:123], v235 offset:53248
    v_cvt_pk_bf16_f32 v141, v198, v199
    v_mfma_f32_16x16x32_bf16 v[116:119], a[88:91], v[184:187], v[116:119]
    v_exp_f32 v200, v200
    v_mfma_f32_16x16x32_bf16 v[116:119], a[92:95], v[188:191], v[116:119]
    ds_read_b64_tr_b16 a[124:125], v235 offset:57344
    s_mov_b32 s63, 0x20000
    v_mfma_f32_16x16x32_bf16 v[84:87], a[92:95], v[180:183], v[84:87]
    v_exp_f32 v201, v201
    v_mfma_f32_16x16x32_bf16 v[84:87], a[88:91], v[176:179], v[84:87]
    ds_read_b64_tr_b16 a[126:127], v235 offset:61440
    v_cvt_pk_bf16_f32 v148, v200, v201
    v_mfma_f32_16x16x32_bf16 v[52:55], a[88:91], v[168:171], v[52:55]
    s_add_u32 s42, s72, 45056
    v_exp_f32 v202, v202
    v_mfma_f32_16x16x32_bf16 v[52:55], a[92:95], v[172:175], v[52:55]
    buffer_load_dwordx4 a[240:243], v242, s[20:23], s42 offen sc1
    v_mfma_f32_16x16x32_bf16 v[20:23], a[92:95], v[164:167], v[20:23]
    v_exp_f32 v203, v203
    v_mfma_f32_16x16x32_bf16 v[20:23], a[88:91], v[160:163], v[20:23]
    v_cvt_pk_bf16_f32 v149, v202, v203
    v_smfmac_f32_16x16x64_bf16 a[136:139], a[144:147], v[176:183], v241
    buffer_load_dwordx4 a[244:247], v243, s[20:23], s42 offen sc1
    s_waitcnt vmcnt(32) lgkmcnt(0)
    s_barrier
    v_mfma_f32_16x16x32_bf16 v[192:195], a[96:99], a[0:3], v[208:211]
    v_exp_f32 v204, v204
    v_mfma_f32_16x16x32_bf16 v[192:195], a[100:103], a[4:7], v[192:195]
    ds_read_b128 a[64:67], v224 offset:0
    s_add_u32 s64, s12, 37748736
    s_addc_u32 s65, s13, 0
    v_mfma_f32_16x16x32_bf16 v[192:195], a[104:107], a[8:11], v[192:195]
    v_exp_f32 v205, v205
    v_mfma_f32_16x16x32_bf16 v[192:195], a[108:111], a[12:15], v[192:195]
    ds_read_b128 a[68:71], v225 offset:0
    v_cvt_pk_bf16_f32 v156, v204, v205
    v_mfma_f32_16x16x32_bf16 v[196:199], a[108:111], a[28:31], v[212:215]
    v_exp_f32 v206, v206
    v_mfma_f32_16x16x32_bf16 v[196:199], a[104:107], a[24:27], v[196:199]
    ds_read_b128 a[72:75], v226 offset:0
    s_mov_b32 s66, 16777216
    v_mfma_f32_16x16x32_bf16 v[196:199], a[100:103], a[20:23], v[196:199]
    v_exp_f32 v207, v207
    v_mfma_f32_16x16x32_bf16 v[196:199], a[96:99], a[16:19], v[196:199]
    ds_read_b128 a[76:79], v227 offset:0
    v_cvt_pk_bf16_f32 v157, v206, v207
    v_mfma_f32_16x16x32_bf16 v[200:203], a[96:99], a[32:35], v[216:219]
    v_exp_f32 v192, v192
    v_mfma_f32_16x16x32_bf16 v[200:203], a[100:103], a[36:39], v[200:203]
    ds_read_b64_tr_b16 a[80:81], v228 offset:0
    s_mov_b32 s67, 0x20000
    v_mfma_f32_16x16x32_bf16 v[200:203], a[104:107], a[40:43], v[200:203]
    v_exp_f32 v193, v193
    v_mfma_f32_16x16x32_bf16 v[200:203], a[108:111], a[44:47], v[200:203]
    ds_read_b64_tr_b16 a[82:83], v228 offset:4096
    v_cvt_pk_bf16_f32 v134, v192, v193
    v_mfma_f32_16x16x32_bf16 v[204:207], a[108:111], a[60:63], v[220:223]
    s_add_u32 m0, s46, 49152
    v_exp_f32 v194, v194
    v_mfma_f32_16x16x32_bf16 v[204:207], a[104:107], a[56:59], v[204:207]
    buffer_load_dwordx4 v236, s[32:35], s43 offen offset:0 lds
    v_mfma_f32_16x16x32_bf16 v[204:207], a[100:103], a[52:55], v[204:207]
    v_exp_f32 v195, v195
    v_mfma_f32_16x16x32_bf16 v[204:207], a[96:99], a[48:51], v[204:207]
    ds_read_b64_tr_b16 a[84:85], v228 offset:8192
    v_cvt_pk_bf16_f32 v135, v194, v195
    v_mfma_f32_16x16x32_bf16 v[24:27], a[112:115], v[160:163], v[24:27]
    v_exp_f32 v196, v196
    v_mfma_f32_16x16x32_bf16 v[24:27], a[116:119], v[164:167], v[24:27]
    ds_read_b64_tr_b16 a[86:87], v228 offset:12288
    s_and_b32 s79, s40, 1
    v_mfma_f32_16x16x32_bf16 v[56:59], a[116:119], v[172:175], v[56:59]
    v_exp_f32 v197, v197
    v_mfma_f32_16x16x32_bf16 v[56:59], a[112:115], v[168:171], v[56:59]
    ds_read_b64_tr_b16 a[88:89], v229 offset:0
    v_cvt_pk_bf16_f32 v142, v196, v197
    v_mfma_f32_16x16x32_bf16 v[88:91], a[112:115], v[176:179], v[88:91]
    v_exp_f32 v198, v198
    v_mfma_f32_16x16x32_bf16 v[88:91], a[116:119], v[180:183], v[88:91]
    buffer_load_dwordx4 v237, s[32:35], s43 offen offset:1024 lds
    v_mfma_f32_16x16x32_bf16 v[120:123], a[116:119], v[188:191], v[120:123]
    v_exp_f32 v199, v199
    v_mfma_f32_16x16x32_bf16 v[120:123], a[112:115], v[184:187], v[120:123]
    ds_read_b64_tr_b16 a[90:91], v229 offset:4096
    v_cvt_pk_bf16_f32 v143, v198, v199
    v_mfma_f32_16x16x32_bf16 v[124:127], a[120:123], v[184:187], v[124:127]
    v_exp_f32 v200, v200
    v_mfma_f32_16x16x32_bf16 v[124:127], a[124:127], v[188:191], v[124:127]
    ds_read_b64_tr_b16 a[92:93], v229 offset:8192
    s_mul_i32 s79, s79, 5120
    v_mfma_f32_16x16x32_bf16 v[92:95], a[124:127], v[180:183], v[92:95]
    v_exp_f32 v201, v201
    v_mfma_f32_16x16x32_bf16 v[92:95], a[120:123], v[176:179], v[92:95]
    ds_read_b64_tr_b16 a[94:95], v229 offset:12288
    v_cvt_pk_bf16_f32 v150, v200, v201
    v_mfma_f32_16x16x32_bf16 v[60:63], a[120:123], v[168:171], v[60:63]
    v_exp_f32 v202, v202
    v_mfma_f32_16x16x32_bf16 v[60:63], a[124:127], v[172:175], v[60:63]
    buffer_load_dwordx2 a[248:249], v246, s[28:31], s19 offen offset:0
    v_mfma_f32_16x16x32_bf16 v[28:31], a[124:127], v[164:167], v[28:31]
    v_exp_f32 v203, v203
    v_mfma_f32_16x16x32_bf16 v[28:31], a[120:123], v[160:163], v[28:31]
    v_cvt_pk_bf16_f32 v151, v202, v203
    v_smfmac_f32_16x16x64_bf16 a[140:143], a[144:147], v[184:191], v241
    buffer_load_dwordx2 a[250:251], v246, s[28:31], s19 offen offset:32
    s_waitcnt lgkmcnt(0)
    v_mfma_f32_16x16x32_bf16 v[192:195], a[64:67], a[0:3], v[208:211]
    v_exp_f32 v204, v204
    v_mfma_f32_16x16x32_bf16 v[192:195], a[68:71], a[4:7], v[192:195]
    ds_read_b128 a[96:99], v224 offset:4096
    v_max3_f32 v252, |v16|, |v17|, |v18|
    v_mfma_f32_16x16x32_bf16 v[192:195], a[72:75], a[8:11], v[192:195]
    v_exp_f32 v205, v205
    v_mfma_f32_16x16x32_bf16 v[192:195], a[76:79], a[12:15], v[192:195]
    ds_read_b128 a[100:103], v225 offset:4096
    v_cvt_pk_bf16_f32 v158, v204, v205
    v_mfma_f32_16x16x32_bf16 v[196:199], a[76:79], a[28:31], v[212:215]
    v_exp_f32 v206, v206
    v_mfma_f32_16x16x32_bf16 v[196:199], a[72:75], a[24:27], v[196:199]
    ds_read_b128 a[104:107], v226 offset:4096
    v_max3_f32 v252, v252, |v19|, |v20|
    v_mfma_f32_16x16x32_bf16 v[196:199], a[68:71], a[20:23], v[196:199]
    v_exp_f32 v207, v207
    v_mfma_f32_16x16x32_bf16 v[196:199], a[64:67], a[16:19], v[196:199]
    ds_read_b128 a[108:111], v227 offset:4096
    v_cvt_pk_bf16_f32 v159, v206, v207
    v_mfma_f32_16x16x32_bf16 v[200:203], a[64:67], a[32:35], v[216:219]
    v_exp_f32 v192, v192
    v_mfma_f32_16x16x32_bf16 v[200:203], a[68:71], a[36:39], v[200:203]
    ds_read_b64_tr_b16 a[112:113], v230 offset:0
    v_max3_f32 v252, v252, |v21|, |v22|
    v_mfma_f32_16x16x32_bf16 v[200:203], a[72:75], a[40:43], v[200:203]
    v_exp_f32 v193, v193
    v_mfma_f32_16x16x32_bf16 v[200:203], a[76:79], a[44:47], v[200:203]
    ds_read_b64_tr_b16 a[114:115], v230 offset:4096
    v_cvt_pk_bf16_f32 v160, v192, v193
    v_mfma_f32_16x16x32_bf16 v[204:207], a[76:79], a[60:63], v[220:223]
    v_exp_f32 v194, v194
    v_mfma_f32_16x16x32_bf16 v[204:207], a[72:75], a[56:59], v[204:207]
    buffer_load_dwordx4 v238, s[32:35], s43 offen offset:2048 lds
    v_mfma_f32_16x16x32_bf16 v[204:207], a[68:71], a[52:55], v[204:207]
    v_exp_f32 v195, v195
    v_mfma_f32_16x16x32_bf16 v[204:207], a[64:67], a[48:51], v[204:207]
    ds_read_b64_tr_b16 a[116:117], v230 offset:8192
    v_cvt_pk_bf16_f32 v161, v194, v195
    v_mfma_f32_16x16x32_bf16 v[0:3], a[80:83], v[128:131], v[0:3]
    v_exp_f32 v196, v196
    v_mfma_f32_16x16x32_bf16 v[0:3], a[84:87], v[132:135], v[0:3]
    ds_read_b64_tr_b16 a[118:119], v230 offset:12288
    v_max3_f32 v252, v252, |v23|, |v8|
    v_mfma_f32_16x16x32_bf16 v[32:35], a[84:87], v[140:143], v[32:35]
    v_exp_f32 v197, v197
    v_mfma_f32_16x16x32_bf16 v[32:35], a[80:83], v[136:139], v[32:35]
    ds_read_b64_tr_b16 a[120:121], v231 offset:0
    v_cvt_pk_bf16_f32 v168, v196, v197
    v_mfma_f32_16x16x32_bf16 v[64:67], a[80:83], v[144:147], v[64:67]
    v_exp_f32 v198, v198
    v_mfma_f32_16x16x32_bf16 v[64:67], a[84:87], v[148:151], v[64:67]
    buffer_load_dwordx4 v239, s[32:35], s43 offen offset:3072 lds
    v_mfma_f32_16x16x32_bf16 v[96:99], a[84:87], v[156:159], v[96:99]
    s_add_u32 s43, s43, 4096
    v_exp_f32 v199, v199
    v_mfma_f32_16x16x32_bf16 v[96:99], a[80:83], v[152:155], v[96:99]
    ds_read_b64_tr_b16 a[122:123], v231 offset:4096
    v_cvt_pk_bf16_f32 v169, v198, v199
    v_mfma_f32_16x16x32_bf16 v[100:103], a[88:91], v[152:155], v[100:103]
    v_exp_f32 v200, v200
    v_mfma_f32_16x16x32_bf16 v[100:103], a[92:95], v[156:159], v[100:103]
    ds_read_b64_tr_b16 a[124:125], v231 offset:8192
    v_cmp_ngt_f32 vcc, v252, s81
    v_mfma_f32_16x16x32_bf16 v[68:71], a[92:95], v[148:151], v[68:71]
    v_exp_f32 v201, v201
    v_mfma_f32_16x16x32_bf16 v[68:71], a[88:91], v[144:147], v[68:71]
    ds_read_b64_tr_b16 a[126:127], v231 offset:12288
    v_cvt_pk_bf16_f32 v176, v200, v201
    v_mfma_f32_16x16x32_bf16 v[36:39], a[88:91], v[136:139], v[36:39]
    v_exp_f32 v202, v202
    v_mfma_f32_16x16x32_bf16 v[36:39], a[92:95], v[140:143], v[36:39]
    buffer_load_dwordx2 a[252:253], v246, s[28:31], s19 offen offset:64
    s_mov_b64 s[6:7], vcc
    v_mfma_f32_16x16x32_bf16 v[4:7], a[92:95], v[132:135], v[4:7]
K1_pg11:
    s_cbranch_execz K1_wb0
    v_exp_f32 v203, v203
    v_mfma_f32_16x16x32_bf16 v[4:7], a[88:91], v[128:131], v[4:7]
    v_cvt_pk_bf16_f32 v177, v202, v203
    v_smfmac_f32_16x16x64_bf16 a[128:131], a[144:147], v[128:135], v241
    buffer_load_dwordx2 a[254:255], v246, s[28:31], s19 offen offset:96
    s_waitcnt lgkmcnt(0)
    v_mfma_f32_16x16x32_bf16 v[192:195], a[96:99], a[0:3], v[208:211]
    v_exp_f32 v204, v204
    v_mfma_f32_16x16x32_bf16 v[192:195], a[100:103], a[4:7], v[192:195]
    ds_read_b128 a[64:67], v224 offset:8192
    v_max3_f32 v252, |v56|, |v57|, |v58|
    v_mfma_f32_16x16x32_bf16 v[192:195], a[104:107], a[8:11], v[192:195]
    v_exp_f32 v205, v205
    v_mfma_f32_16x16x32_bf16 v[192:195], a[108:111], a[12:15], v[192:195]
    ds_read_b128 a[68:71], v225 offset:8192
    v_cvt_pk_bf16_f32 v184, v204, v205
    v_mfma_f32_16x16x32_bf16 v[196:199], a[108:111], a[28:31], v[212:215]
    v_exp_f32 v206, v206
    v_mfma_f32_16x16x32_bf16 v[196:199], a[104:107], a[24:27], v[196:199]
    ds_read_b128 a[72:75], v226 offset:8192
    v_max3_f32 v252, v252, |v59|, |v60|
    v_mfma_f32_16x16x32_bf16 v[196:199], a[100:103], a[20:23], v[196:199]
    v_exp_f32 v207, v207
    v_mfma_f32_16x16x32_bf16 v[196:199], a[96:99], a[16:19], v[196:199]
    ds_read_b128 a[76:79], v227 offset:8192
    v_cvt_pk_bf16_f32 v185, v206, v207
    v_mfma_f32_16x16x32_bf16 v[200:203], a[96:99], a[32:35], v[216:219]
    v_exp_f32 v192, v192
    v_mfma_f32_16x16x32_bf16 v[200:203], a[100:103], a[36:39], v[200:203]
    ds_read_b64_tr_b16 a[80:81], v232 offset:0
    v_max3_f32 v252, v252, |v61|, |v62|
    v_mfma_f32_16x16x32_bf16 v[200:203], a[104:107], a[40:43], v[200:203]
    v_exp_f32 v193, v193
    v_mfma_f32_16x16x32_bf16 v[200:203], a[108:111], a[44:47], v[200:203]
    ds_read_b64_tr_b16 a[82:83], v232 offset:4096
    v_cvt_pk_bf16_f32 v162, v192, v193
    v_mfma_f32_16x16x32_bf16 v[204:207], a[108:111], a[60:63], v[220:223]
    s_add_u32 m0, s46, 53248
    v_exp_f32 v194, v194
    v_mfma_f32_16x16x32_bf16 v[204:207], a[104:107], a[56:59], v[204:207]
    buffer_load_dwordx4 v236, s[32:35], s43 offen offset:0 lds
    v_mfma_f32_16x16x32_bf16 v[204:207], a[100:103], a[52:55], v[204:207]
    v_exp_f32 v195, v195
    v_mfma_f32_16x16x32_bf16 v[204:207], a[96:99], a[48:51], v[204:207]
    ds_read_b64_tr_b16 a[84:85], v232 offset:8192
    v_cvt_pk_bf16_f32 v163, v194, v195
    v_mfma_f32_16x16x32_bf16 v[8:11], a[112:115], v[128:131], v[8:11]
    v_exp_f32 v196, v196
    v_mfma_f32_16x16x32_bf16 v[8:11], a[116:119], v[132:135], v[8:11]
    ds_read_b64_tr_b16 a[86:87], v232 offset:12288
    v_max3_f32 v252, v252, |v63|, |v48|
    v_mfma_f32_16x16x32_bf16 v[40:43], a[116:119], v[140:143], v[40:43]
    v_exp_f32 v197, v197
    v_mfma_f32_16x16x32_bf16 v[40:43], a[112:115], v[136:139], v[40:43]
    ds_read_b64_tr_b16 a[88:89], v233 offset:0
    v_cvt_pk_bf16_f32 v170, v196, v197
    v_mfma_f32_16x16x32_bf16 v[72:75], a[112:115], v[144:147], v[72:75]
    v_exp_f32 v198, v198
    v_mfma_f32_16x16x32_bf16 v[72:75], a[116:119], v[148:151], v[72:75]
    buffer_load_dwordx4 v237, s[32:35], s43 offen offset:1024 lds
    v_mfma_f32_16x16x32_bf16 v[104:107], a[116:119], v[156:159], v[104:107]
    v_exp_f32 v199, v199
    v_mfma_f32_16x16x32_bf16 v[104:107], a[112:115], v[152:155], v[104:107]
    ds_read_b64_tr_b16 a[90:91], v233 offset:4096
    v_cvt_pk_bf16_f32 v171, v198, v199
    v_mfma_f32_16x16x32_bf16 v[108:111], a[120:123], v[152:155], v[108:111]
    v_exp_f32 v200, v200
    v_mfma_f32_16x16x32_bf16 v[108:111], a[124:127], v[156:159], v[108:111]
    ds_read_b64_tr_b16 a[92:93], v233 offset:8192
    v_cmp_ngt_f32 vcc, v252, s81
    v_mfma_f32_16x16x32_bf16 v[76:79], a[124:127], v[148:151], v[76:79]
    v_exp_f32 v201, v201
    v_mfma_f32_16x16x32_bf16 v[76:79], a[120:123], v[144:147], v[76:79]
    ds_read_b64_tr_b16 a[94:95], v233 offset:12288
    v_cvt_pk_bf16_f32 v178, v200, v201
    v_mfma_f32_16x16x32_bf16 v[44:47], a[120:123], v[136:139], v[44:47]
    v_exp_f32 v202, v202
    v_mfma_f32_16x16x32_bf16 v[44:47], a[124:127], v[140:143], v[44:47]
    buffer_load_dwordx2 a[148:149], v246, s[28:31], s19 offen offset:128
    s_or_b64 s[6:7], vcc, s[6:7]
    v_mfma_f32_16x16x32_bf16 v[12:15], a[124:127], v[132:135], v[12:15]
    v_exp_f32 v203, v203
    v_mfma_f32_16x16x32_bf16 v[12:15], a[120:123], v[128:131], v[12:15]
    v_cvt_pk_bf16_f32 v179, v202, v203
    v_smfmac_f32_16x16x64_bf16 a[132:135], a[144:147], v[136:143], v241
    s_waitcnt lgkmcnt(0)
    v_mfma_f32_16x16x32_bf16 v[192:195], a[64:67], a[0:3], v[208:211]
    v_exp_f32 v204, v204
    v_mfma_f32_16x16x32_bf16 v[192:195], a[68:71], a[4:7], v[192:195]
    ds_read_b128 a[96:99], v224 offset:12288
    v_max3_f32 v252, |v64|, |v65|, |v66|
    v_mfma_f32_16x16x32_bf16 v[192:195], a[72:75], a[8:11], v[192:195]
    v_exp_f32 v205, v205
    v_mfma_f32_16x16x32_bf16 v[192:195], a[76:79], a[12:15], v[192:195]
    ds_read_b128 a[100:103], v225 offset:12288
    v_cvt_pk_bf16_f32 v186, v204, v205
    v_mfma_f32_16x16x32_bf16 v[196:199], a[76:79], a[28:31], v[212:215]
    v_exp_f32 v206, v206
    v_mfma_f32_16x16x32_bf16 v[196:199], a[72:75], a[24:27], v[196:199]
    ds_read_b128 a[104:107], v226 offset:12288
    v_max3_f32 v252, v252, |v67|, |v68|
    v_mfma_f32_16x16x32_bf16 v[196:199], a[68:71], a[20:23], v[196:199]
    v_exp_f32 v207, v207
    v_mfma_f32_16x16x32_bf16 v[196:199], a[64:67], a[16:19], v[196:199]
    ds_read_b128 a[108:111], v227 offset:12288
    v_cvt_pk_bf16_f32 v187, v206, v207
    v_mfma_f32_16x16x32_bf16 v[200:203], a[64:67], a[32:35], v[216:219]
    v_exp_f32 v192, v192
    v_mfma_f32_16x16x32_bf16 v[200:203], a[68:71], a[36:39], v[200:203]
    ds_read_b64_tr_b16 a[112:113], v234 offset:0
    v_max3_f32 v252, v252, |v69|, |v70|
    v_mfma_f32_16x16x32_bf16 v[200:203], a[72:75], a[40:43], v[200:203]
    v_exp_f32 v193, v193
    v_mfma_f32_16x16x32_bf16 v[200:203], a[76:79], a[44:47], v[200:203]
    ds_read_b64_tr_b16 a[114:115], v234 offset:4096
    v_cvt_pk_bf16_f32 v164, v192, v193
    v_mfma_f32_16x16x32_bf16 v[204:207], a[76:79], a[60:63], v[220:223]
    v_exp_f32 v194, v194
    v_mfma_f32_16x16x32_bf16 v[204:207], a[72:75], a[56:59], v[204:207]
    ds_read_b64_tr_b16 a[116:117], v234 offset:8192
    v_max3_f32 v252, v252, |v71|, |v88|
    v_mfma_f32_16x16x32_bf16 v[204:207], a[68:71], a[52:55], v[204:207]
    v_exp_f32 v195, v195
    v_mfma_f32_16x16x32_bf16 v[204:207], a[64:67], a[48:51], v[204:207]
    ds_read_b64_tr_b16 a[118:119], v234 offset:12288
    v_cvt_pk_bf16_f32 v165, v194, v195
    v_mfma_f32_16x16x32_bf16 v[16:19], a[80:83], v[128:131], v[16:19]
    v_exp_f32 v196, v196
    v_mfma_f32_16x16x32_bf16 v[16:19], a[84:87], v[132:135], v[16:19]
    ds_read_b64_tr_b16 a[120:121], v235 offset:0
    v_cmp_ngt_f32 vcc, v252, s81
    v_mfma_f32_16x16x32_bf16 v[48:51], a[84:87], v[140:143], v[48:51]
    v_exp_f32 v197, v197
    v_mfma_f32_16x16x32_bf16 v[48:51], a[80:83], v[136:139], v[48:51]
    ds_read_b64_tr_b16 a[122:123], v235 offset:4096
    v_cvt_pk_bf16_f32 v172, v196, v197
    v_mfma_f32_16x16x32_bf16 v[80:83], a[80:83], v[144:147], v[80:83]
    v_exp_f32 v198, v198
    v_mfma_f32_16x16x32_bf16 v[80:83], a[84:87], v[148:151], v[80:83]
    buffer_load_dwordx4 v238, s[32:35], s43 offen offset:2048 lds
    v_mfma_f32_16x16x32_bf16 v[112:115], a[84:87], v[156:159], v[112:115]
    v_exp_f32 v199, v199
    v_mfma_f32_16x16x32_bf16 v[112:115], a[80:83], v[152:155], v[112:115]
    ds_read_b64_tr_b16 a[124:125], v235 offset:8192
    v_cvt_pk_bf16_f32 v173, v198, v199
    v_mfma_f32_16x16x32_bf16 v[116:119], a[88:91], v[152:155], v[116:119]
    v_exp_f32 v200, v200
    v_mfma_f32_16x16x32_bf16 v[116:119], a[92:95], v[156:159], v[116:119]
    ds_read_b64_tr_b16 a[126:127], v235 offset:12288
    s_or_b64 s[6:7], vcc, s[6:7]
    v_mfma_f32_16x16x32_bf16 v[84:87], a[92:95], v[148:151], v[84:87]
    v_exp_f32 v201, v201
    v_mfma_f32_16x16x32_bf16 v[84:87], a[88:91], v[144:147], v[84:87]
    v_cvt_pk_bf16_f32 v180, v200, v201
    v_mfma_f32_16x16x32_bf16 v[52:55], a[88:91], v[136:139], v[52:55]
    v_exp_f32 v202, v202
    v_mfma_f32_16x16x32_bf16 v[52:55], a[92:95], v[140:143], v[52:55]
    buffer_load_dwordx4 v239, s[32:35], s43 offen offset:3072 lds
    v_mfma_f32_16x16x32_bf16 v[20:23], a[92:95], v[132:135], v[20:23]
    s_add_u32 s43, s43, 12288
    v_exp_f32 v203, v203
    v_mfma_f32_16x16x32_bf16 v[20:23], a[88:91], v[128:131], v[20:23]
    s_waitcnt vmcnt(30) lgkmcnt(0)
    v_cvt_pk_bf16_f32 v181, v202, v203
    v_smfmac_f32_16x16x64_bf16 a[136:139], a[144:147], v[144:151], v241
    s_barrier
    v_mfma_f32_16x16x32_bf16 v[192:195], a[96:99], a[0:3], v[208:211]
    v_exp_f32 v204, v204
    v_mfma_f32_16x16x32_bf16 v[192:195], a[100:103], a[4:7], v[192:195]
    ds_read_b128 a[64:67], v224 offset:16384
    v_max3_f32 v252, |v104|, |v105|, |v106|
    v_mfma_f32_16x16x32_bf16 v[192:195], a[104:107], a[8:11], v[192:195]
    v_exp_f32 v205, v205
    v_mfma_f32_16x16x32_bf16 v[192:195], a[108:111], a[12:15], v[192:195]
    ds_read_b128 a[68:71], v225 offset:16384
    v_cvt_pk_bf16_f32 v188, v204, v205
    v_mfma_f32_16x16x32_bf16 v[196:199], a[108:111], a[28:31], v[212:215]
    v_exp_f32 v206, v206
    v_mfma_f32_16x16x32_bf16 v[196:199], a[104:107], a[24:27], v[196:199]
    ds_read_b128 a[72:75], v226 offset:16384
    v_max3_f32 v252, v252, |v107|, |v108|
    v_mfma_f32_16x16x32_bf16 v[196:199], a[100:103], a[20:23], v[196:199]
    v_exp_f32 v207, v207
    v_mfma_f32_16x16x32_bf16 v[196:199], a[96:99], a[16:19], v[196:199]
    ds_read_b128 a[76:79], v227 offset:16384
    v_cvt_pk_bf16_f32 v189, v206, v207
    v_mfma_f32_16x16x32_bf16 v[200:203], a[96:99], a[32:35], v[216:219]
    v_exp_f32 v192, v192
    v_mfma_f32_16x16x32_bf16 v[200:203], a[100:103], a[36:39], v[200:203]
    ds_read_b64_tr_b16 a[80:81], v228 offset:16384
    v_max3_f32 v252, v252, |v109|, |v110|
    v_mfma_f32_16x16x32_bf16 v[200:203], a[104:107], a[40:43], v[200:203]
    v_exp_f32 v193, v193
    v_mfma_f32_16x16x32_bf16 v[200:203], a[108:111], a[44:47], v[200:203]
    ds_read_b64_tr_b16 a[82:83], v228 offset:20480
    v_cvt_pk_bf16_f32 v166, v192, v193
    v_mfma_f32_16x16x32_bf16 v[204:207], a[108:111], a[60:63], v[220:223]
    s_add_u32 s41, s74, 0
    s_bfe_u32 s51, 0x2300208, s18
    s_lshl_b32 s51, s51, 8
    s_add_u32 m0, s51, s76
    v_exp_f32 v194, v194
    v_mfma_f32_16x16x32_bf16 v[204:207], a[104:107], a[56:59], v[204:207]
    buffer_load_dwordx4 v240, s[24:27], s41 offen offset:0 sc1 lds
    v_mfma_f32_16x16x32_bf16 v[204:207], a[100:103], a[52:55], v[204:207]
    v_exp_f32 v195, v195
    v_mfma_f32_16x16x32_bf16 v[204:207], a[96:99], a[48:51], v[204:207]
    ds_read_b64_tr_b16 a[84:85], v228 offset:24576
    v_cvt_pk_bf16_f32 v167, v194, v195
    v_mfma_f32_16x16x32_bf16 v[24:27], a[112:115], v[128:131], v[24:27]
    v_exp_f32 v196, v196
    v_mfma_f32_16x16x32_bf16 v[24:27], a[116:119], v[132:135], v[24:27]
    ds_read_b64_tr_b16 a[86:87], v228 offset:28672
    v_max3_f32 v252, v252, |v111|, |v96|
    v_mfma_f32_16x16x32_bf16 v[56:59], a[116:119], v[140:143], v[56:59]
    v_exp_f32 v197, v197
    v_mfma_f32_16x16x32_bf16 v[56:59], a[112:115], v[136:139], v[56:59]
    ds_read_b64_tr_b16 a[88:89], v229 offset:16384
    v_cvt_pk_bf16_f32 v174, v196, v197
    v_mfma_f32_16x16x32_bf16 v[88:91], a[112:115], v[144:147], v[88:91]
    v_exp_f32 v198, v198
    v_mfma_f32_16x16x32_bf16 v[88:91], a[116:119], v[148:151], v[88:91]
    buffer_load_dwordx4 v240, s[24:27], s41 offen offset:1024 sc1 lds
    v_mfma_f32_16x16x32_bf16 v[120:123], a[116:119], v[156:159], v[120:123]
    v_exp_f32 v199, v199
    v_mfma_f32_16x16x32_bf16 v[120:123], a[112:115], v[152:155], v[120:123]
    ds_read_b64_tr_b16 a[90:91], v229 offset:20480
    v_cvt_pk_bf16_f32 v175, v198, v199
    v_mfma_f32_16x16x32_bf16 v[124:127], a[120:123], v[152:155], v[124:127]
    v_exp_f32 v200, v200
    v_mfma_f32_16x16x32_bf16 v[124:127], a[124:127], v[156:159], v[124:127]
    ds_read_b64_tr_b16 a[92:93], v229 offset:24576
    v_cmp_ngt_f32 vcc, v252, s81
    v_mfma_f32_16x16x32_bf16 v[92:95], a[124:127], v[148:151], v[92:95]
    v_exp_f32 v201, v201
    v_mfma_f32_16x16x32_bf16 v[92:95], a[120:123], v[144:147], v[92:95]
    ds_read_b64_tr_b16 a[94:95], v229 offset:28672
    v_cvt_pk_bf16_f32 v182, v200, v201
    v_mfma_f32_16x16x32_bf16 v[60:63], a[120:123], v[136:139], v[60:63]
    v_exp_f32 v202, v202
    v_mfma_f32_16x16x32_bf16 v[60:63], a[124:127], v[140:143], v[60:63]
    buffer_load_dwordx4 v240, s[24:27], s41 offen offset:2048 sc1 lds
    s_or_b64 s[6:7], vcc, s[6:7]
    v_mfma_f32_16x16x32_bf16 v[28:31], a[124:127], v[132:135], v[28:31]
    v_exp_f32 v203, v203
    v_mfma_f32_16x16x32_bf16 v[28:31], a[120:123], v[128:131], v[28:31]
    buffer_load_dwordx4 v240, s[24:27], s41 offen offset:3072 sc1 lds
    v_cvt_pk_bf16_f32 v183, v202, v203
    s_add_u32 m0, m0, 4096
    v_smfmac_f32_16x16x64_bf16 a[140:143], a[144:147], v[152:159], v241
    buffer_load_dwordx4 v244, s[24:27], s41 offen sc1 lds
    s_waitcnt lgkmcnt(0)
    v_mfma_f32_16x16x32_bf16 v[192:195], a[64:67], a[0:3], v[208:211]
    v_exp_f32 v204, v204
    v_mfma_f32_16x16x32_bf16 v[192:195], a[68:71], a[4:7], v[192:195]
    ds_read_b128 a[96:99], v224 offset:20480
    v_mfma_f32_16x16x32_bf16 v[192:195], a[72:75], a[8:11], v[192:195]
    v_exp_f32 v205, v205
    v_mfma_f32_16x16x32_bf16 v[192:195], a[76:79], a[12:15], v[192:195]
    ds_read_b128 a[100:103], v225 offset:20480
    v_cvt_pk_bf16_f32 v190, v204, v205
    v_mfma_f32_16x16x32_bf16 v[196:199], a[76:79], a[28:31], v[212:215]
    v_exp_f32 v206, v206
    v_mfma_f32_16x16x32_bf16 v[196:199], a[72:75], a[24:27], v[196:199]
    ds_read_b128 a[104:107], v226 offset:20480
    v_mfma_f32_16x16x32_bf16 v[196:199], a[68:71], a[20:23], v[196:199]
    v_exp_f32 v207, v207
    v_mfma_f32_16x16x32_bf16 v[196:199], a[64:67], a[16:19], v[196:199]
    ds_read_b128 a[108:111], v227 offset:20480
    v_cvt_pk_bf16_f32 v191, v206, v207
    v_mfma_f32_16x16x32_bf16 v[200:203], a[64:67], a[32:35], v[216:219]
    v_exp_f32 v192, v192
    v_mfma_f32_16x16x32_bf16 v[200:203], a[68:71], a[36:39], v[200:203]
    ds_read_b64_tr_b16 a[112:113], v230 offset:16384
    v_mfma_f32_16x16x32_bf16 v[200:203], a[72:75], a[40:43], v[200:203]
    v_exp_f32 v193, v193
    v_mfma_f32_16x16x32_bf16 v[200:203], a[76:79], a[44:47], v[200:203]
    ds_read_b64_tr_b16 a[114:115], v230 offset:20480
    v_cvt_pk_bf16_f32 v128, v192, v193
    v_mfma_f32_16x16x32_bf16 v[204:207], a[76:79], a[60:63], v[220:223]
    s_add_u32 s41, s74, 10240
    s_bfe_u32 s51, 0x258, s18
    s_lshl_b32 s51, s51, 8
    s_add_u32 m0, s51, s76
    v_exp_f32 v194, v194
    v_mfma_f32_16x16x32_bf16 v[204:207], a[72:75], a[56:59], v[204:207]
    buffer_load_dwordx4 v240, s[24:27], s41 offen offset:0 sc1 lds
    v_mfma_f32_16x16x32_bf16 v[204:207], a[68:71], a[52:55], v[204:207]
    v_exp_f32 v195, v195
    v_mfma_f32_16x16x32_bf16 v[204:207], a[64:67], a[48:51], v[204:207]
    ds_read_b64_tr_b16 a[116:117], v230 offset:24576
    v_cvt_pk_bf16_f32 v129, v194, v195
    v_mfma_f32_16x16x32_bf16 v[0:3], a[80:83], v[160:163], v[0:3]
    v_exp_f32 v196, v196
    v_mfma_f32_16x16x32_bf16 v[0:3], a[84:87], v[164:167], v[0:3]
    ds_read_b64_tr_b16 a[118:119], v230 offset:28672
    v_mfma_f32_16x16x32_bf16 v[32:35], a[84:87], v[172:175], v[32:35]
    v_exp_f32 v197, v197
    v_mfma_f32_16x16x32_bf16 v[32:35], a[80:83], v[168:171], v[32:35]
    ds_read_b64_tr_b16 a[120:121], v231 offset:16384
    v_cvt_pk_bf16_f32 v136, v196, v197
    v_mfma_f32_16x16x32_bf16 v[64:67], a[80:83], v[176:179], v[64:67]
    v_exp_f32 v198, v198
    v_mfma_f32_16x16x32_bf16 v[64:67], a[84:87], v[180:183], v[64:67]
    buffer_load_dwordx4 v240, s[24:27], s41 offen offset:1024 sc1 lds
    v_mfma_f32_16x16x32_bf16 v[96:99], a[84:87], v[188:191], v[96:99]
    v_exp_f32 v199, v199
    v_mfma_f32_16x16x32_bf16 v[96:99], a[80:83], v[184:187], v[96:99]
    ds_read_b64_tr_b16 a[122:123], v231 offset:20480
    v_cvt_pk_bf16_f32 v137, v198, v199
    v_mfma_f32_16x16x32_bf16 v[100:103], a[88:91], v[184:187], v[100:103]
    v_exp_f32 v200, v200
    v_mfma_f32_16x16x32_bf16 v[100:103], a[92:95], v[188:191], v[100:103]
    ds_read_b64_tr_b16 a[124:125], v231 offset:24576
    v_mfma_f32_16x16x32_bf16 v[68:71], a[92:95], v[180:183], v[68:71]
    v_exp_f32 v201, v201
    v_mfma_f32_16x16x32_bf16 v[68:71], a[88:91], v[176:179], v[68:71]
    ds_read_b64_tr_b16 a[126:127], v231 offset:28672
    v_cvt_pk_bf16_f32 v144, v200, v201
    v_mfma_f32_16x16x32_bf16 v[36:39], a[88:91], v[168:171], v[36:39]
    v_exp_f32 v202, v202
    v_mfma_f32_16x16x32_bf16 v[36:39], a[92:95], v[172:175], v[36:39]
    buffer_load_dwordx4 v240, s[24:27], s41 offen offset:2048 sc1 lds
    v_mfma_f32_16x16x32_bf16 v[4:7], a[92:95], v[164:167], v[4:7]
    v_exp_f32 v203, v203
    v_mfma_f32_16x16x32_bf16 v[4:7], a[88:91], v[160:163], v[4:7]
    buffer_load_dwordx4 v240, s[24:27], s41 offen offset:3072 sc1 lds
    v_cvt_pk_bf16_f32 v145, v202, v203
    s_add_u32 m0, m0, 4096
    v_smfmac_f32_16x16x64_bf16 a[128:131], a[144:147], v[160:167], v241
    buffer_load_dwordx4 v244, s[24:27], s41 offen sc1 lds
    s_waitcnt lgkmcnt(0)
    v_mfma_f32_16x16x32_bf16 v[192:195], a[96:99], a[0:3], v[208:211]
    v_exp_f32 v204, v204
    v_mfma_f32_16x16x32_bf16 v[192:195], a[100:103], a[4:7], v[192:195]
    ds_read_b128 a[64:67], v224 offset:24576
    v_mfma_f32_16x16x32_bf16 v[192:195], a[104:107], a[8:11], v[192:195]
    v_exp_f32 v205, v205
    v_mfma_f32_16x16x32_bf16 v[192:195], a[108:111], a[12:15], v[192:195]
    ds_read_b128 a[68:71], v225 offset:24576
    v_cvt_pk_bf16_f32 v152, v204, v205
    v_mfma_f32_16x16x32_bf16 v[196:199], a[108:111], a[28:31], v[212:215]
    v_exp_f32 v206, v206
    v_mfma_f32_16x16x32_bf16 v[196:199], a[104:107], a[24:27], v[196:199]
    ds_read_b128 a[72:75], v226 offset:24576
    v_mfma_f32_16x16x32_bf16 v[196:199], a[100:103], a[20:23], v[196:199]
    v_exp_f32 v207, v207
    v_mfma_f32_16x16x32_bf16 v[196:199], a[96:99], a[16:19], v[196:199]
    ds_read_b128 a[76:79], v227 offset:24576
    v_cvt_pk_bf16_f32 v153, v206, v207
    v_mfma_f32_16x16x32_bf16 v[200:203], a[96:99], a[32:35], v[216:219]
    v_exp_f32 v192, v192
    v_mfma_f32_16x16x32_bf16 v[200:203], a[100:103], a[36:39], v[200:203]
    ds_read_b64_tr_b16 a[80:81], v232 offset:16384
    v_mfma_f32_16x16x32_bf16 v[200:203], a[104:107], a[40:43], v[200:203]
    v_exp_f32 v193, v193
    v_mfma_f32_16x16x32_bf16 v[200:203], a[108:111], a[44:47], v[200:203]
    ds_read_b64_tr_b16 a[82:83], v232 offset:20480
    v_cvt_pk_bf16_f32 v130, v192, v193
    v_mfma_f32_16x16x32_bf16 v[204:207], a[108:111], a[60:63], v[220:223]
    v_exp_f32 v194, v194
    v_mfma_f32_16x16x32_bf16 v[204:207], a[104:107], a[56:59], v[204:207]
    ds_read_b64_tr_b16 a[84:85], v232 offset:24576
    v_mfma_f32_16x16x32_bf16 v[204:207], a[100:103], a[52:55], v[204:207]
    v_exp_f32 v195, v195
    v_mfma_f32_16x16x32_bf16 v[204:207], a[96:99], a[48:51], v[204:207]
    ds_read_b64_tr_b16 a[86:87], v232 offset:28672
    v_cvt_pk_bf16_f32 v131, v194, v195
    v_mfma_f32_16x16x32_bf16 v[8:11], a[112:115], v[160:163], v[8:11]
    v_exp_f32 v196, v196
    v_mfma_f32_16x16x32_bf16 v[8:11], a[116:119], v[164:167], v[8:11]
    ds_read_b64_tr_b16 a[88:89], v233 offset:16384
    v_mfma_f32_16x16x32_bf16 v[40:43], a[116:119], v[172:175], v[40:43]
    v_exp_f32 v197, v197
    v_mfma_f32_16x16x32_bf16 v[40:43], a[112:115], v[168:171], v[40:43]
    ds_read_b64_tr_b16 a[90:91], v233 offset:20480
    v_cvt_pk_bf16_f32 v138, v196, v197
    v_mfma_f32_16x16x32_bf16 v[72:75], a[112:115], v[176:179], v[72:75]
    v_exp_f32 v198, v198
    v_mfma_f32_16x16x32_bf16 v[72:75], a[116:119], v[180:183], v[72:75]
    ds_read_b64_tr_b16 a[92:93], v233 offset:24576
    v_mfma_f32_16x16x32_bf16 v[104:107], a[116:119], v[188:191], v[104:107]
    v_exp_f32 v199, v199
    v_mfma_f32_16x16x32_bf16 v[104:107], a[112:115], v[184:187], v[104:107]
    ds_read_b64_tr_b16 a[94:95], v233 offset:28672
    v_cvt_pk_bf16_f32 v139, v198, v199
    v_mfma_f32_16x16x32_bf16 v[108:111], a[120:123], v[184:187], v[108:111]
    v_exp_f32 v200, v200
    v_mfma_f32_16x16x32_bf16 v[108:111], a[124:127], v[188:191], v[108:111]
    v_mfma_f32_16x16x32_bf16 v[76:79], a[124:127], v[180:183], v[76:79]
    v_exp_f32 v201, v201
    v_mfma_f32_16x16x32_bf16 v[76:79], a[120:123], v[176:179], v[76:79]
    v_cvt_pk_bf16_f32 v146, v200, v201
    v_mfma_f32_16x16x32_bf16 v[44:47], a[120:123], v[168:171], v[44:47]
    v_exp_f32 v202, v202
    v_mfma_f32_16x16x32_bf16 v[44:47], a[124:127], v[172:175], v[44:47]
    v_mfma_f32_16x16x32_bf16 v[12:15], a[124:127], v[164:167], v[12:15]
    v_exp_f32 v203, v203
    v_mfma_f32_16x16x32_bf16 v[12:15], a[120:123], v[160:163], v[12:15]
    v_cvt_pk_bf16_f32 v147, v202, v203
    v_smfmac_f32_16x16x64_bf16 a[132:135], a[144:147], v[168:175], v241
    s_waitcnt lgkmcnt(0)
    v_mfma_f32_16x16x32_bf16 v[192:195], a[64:67], a[0:3], v[208:211]
    v_exp_f32 v204, v204
    v_mfma_f32_16x16x32_bf16 v[192:195], a[68:71], a[4:7], v[192:195]
    ds_read_b128 a[96:99], v224 offset:28672
    v_mfma_f32_16x16x32_bf16 v[192:195], a[72:75], a[8:11], v[192:195]
    v_exp_f32 v205, v205
    v_mfma_f32_16x16x32_bf16 v[192:195], a[76:79], a[12:15], v[192:195]
    ds_read_b128 a[100:103], v225 offset:28672
    v_cvt_pk_bf16_f32 v154, v204, v205
    v_mfma_f32_16x16x32_bf16 v[196:199], a[76:79], a[28:31], v[212:215]
    v_exp_f32 v206, v206
    v_mfma_f32_16x16x32_bf16 v[196:199], a[72:75], a[24:27], v[196:199]
    ds_read_b128 a[104:107], v226 offset:28672
    v_mfma_f32_16x16x32_bf16 v[196:199], a[68:71], a[20:23], v[196:199]
    v_exp_f32 v207, v207
    v_mfma_f32_16x16x32_bf16 v[196:199], a[64:67], a[16:19], v[196:199]
    ds_read_b128 a[108:111], v227 offset:28672
    v_cvt_pk_bf16_f32 v155, v206, v207
    v_mfma_f32_16x16x32_bf16 v[200:203], a[64:67], a[32:35], v[216:219]
    v_exp_f32 v192, v192
    v_mfma_f32_16x16x32_bf16 v[200:203], a[68:71], a[36:39], v[200:203]
    ds_read_b64_tr_b16 a[112:113], v234 offset:16384
    v_mfma_f32_16x16x32_bf16 v[200:203], a[72:75], a[40:43], v[200:203]
    v_exp_f32 v193, v193
    v_mfma_f32_16x16x32_bf16 v[200:203], a[76:79], a[44:47], v[200:203]
    ds_read_b64_tr_b16 a[114:115], v234 offset:20480
    v_cvt_pk_bf16_f32 v132, v192, v193
    v_mfma_f32_16x16x32_bf16 v[204:207], a[76:79], a[60:63], v[220:223]
    v_exp_f32 v194, v194
    v_mfma_f32_16x16x32_bf16 v[204:207], a[72:75], a[56:59], v[204:207]
    ds_read_b64_tr_b16 a[116:117], v234 offset:24576
    v_mfma_f32_16x16x32_bf16 v[204:207], a[68:71], a[52:55], v[204:207]
    v_exp_f32 v195, v195
    v_mfma_f32_16x16x32_bf16 v[204:207], a[64:67], a[48:51], v[204:207]
    ds_read_b64_tr_b16 a[118:119], v234 offset:28672
    v_cvt_pk_bf16_f32 v133, v194, v195
    v_mfma_f32_16x16x32_bf16 v[16:19], a[80:83], v[160:163], v[16:19]
    v_exp_f32 v196, v196
    v_mfma_f32_16x16x32_bf16 v[16:19], a[84:87], v[164:167], v[16:19]
    ds_read_b64_tr_b16 a[120:121], v235 offset:16384
    v_mfma_f32_16x16x32_bf16 v[48:51], a[84:87], v[172:175], v[48:51]
    v_exp_f32 v197, v197
    v_mfma_f32_16x16x32_bf16 v[48:51], a[80:83], v[168:171], v[48:51]
    ds_read_b64_tr_b16 a[122:123], v235 offset:20480
    v_cvt_pk_bf16_f32 v140, v196, v197
    v_mfma_f32_16x16x32_bf16 v[80:83], a[80:83], v[176:179], v[80:83]
    v_exp_f32 v198, v198
    v_mfma_f32_16x16x32_bf16 v[80:83], a[84:87], v[180:183], v[80:83]
    ds_read_b64_tr_b16 a[124:125], v235 offset:24576
    v_mfma_f32_16x16x32_bf16 v[112:115], a[84:87], v[188:191], v[112:115]
    v_exp_f32 v199, v199
    v_mfma_f32_16x16x32_bf16 v[112:115], a[80:83], v[184:187], v[112:115]
    ds_read_b64_tr_b16 a[126:127], v235 offset:28672
    v_cvt_pk_bf16_f32 v141, v198, v199
    v_mfma_f32_16x16x32_bf16 v[116:119], a[88:91], v[184:187], v[116:119]
    v_exp_f32 v200, v200
    v_mfma_f32_16x16x32_bf16 v[116:119], a[92:95], v[188:191], v[116:119]
    v_mfma_f32_16x16x32_bf16 v[84:87], a[92:95], v[180:183], v[84:87]
    v_exp_f32 v201, v201
    v_mfma_f32_16x16x32_bf16 v[84:87], a[88:91], v[176:179], v[84:87]
    v_cvt_pk_bf16_f32 v148, v200, v201
    v_mfma_f32_16x16x32_bf16 v[52:55], a[88:91], v[168:171], v[52:55]
    v_exp_f32 v202, v202
    v_mfma_f32_16x16x32_bf16 v[52:55], a[92:95], v[172:175], v[52:55]
    v_mfma_f32_16x16x32_bf16 v[20:23], a[92:95], v[164:167], v[20:23]
    v_exp_f32 v203, v203
    v_mfma_f32_16x16x32_bf16 v[20:23], a[88:91], v[160:163], v[20:23]
    s_waitcnt vmcnt(10) lgkmcnt(0)
    v_cvt_pk_bf16_f32 v149, v202, v203
    v_smfmac_f32_16x16x64_bf16 a[136:139], a[144:147], v[176:183], v241
    s_barrier
    v_mfma_f32_16x16x32_bf16 v[192:195], a[96:99], a[0:3], v[208:211]
    v_exp_f32 v204, v204
    v_mfma_f32_16x16x32_bf16 v[192:195], a[100:103], a[4:7], v[192:195]
    ds_read_b128 a[64:67], v224 offset:32768
    v_mfma_f32_16x16x32_bf16 v[192:195], a[104:107], a[8:11], v[192:195]
    v_exp_f32 v205, v205
    v_mfma_f32_16x16x32_bf16 v[192:195], a[108:111], a[12:15], v[192:195]
    ds_read_b128 a[68:71], v225 offset:32768
    v_cvt_pk_bf16_f32 v156, v204, v205
    v_mfma_f32_16x16x32_bf16 v[196:199], a[108:111], a[28:31], v[212:215]
    v_exp_f32 v206, v206
    v_mfma_f32_16x16x32_bf16 v[196:199], a[104:107], a[24:27], v[196:199]
    ds_read_b128 a[72:75], v226 offset:32768
    v_mfma_f32_16x16x32_bf16 v[196:199], a[100:103], a[20:23], v[196:199]
    v_exp_f32 v207, v207
    v_mfma_f32_16x16x32_bf16 v[196:199], a[96:99], a[16:19], v[196:199]
    ds_read_b128 a[76:79], v227 offset:32768
    v_cvt_pk_bf16_f32 v157, v206, v207
    v_mfma_f32_16x16x32_bf16 v[200:203], a[96:99], a[32:35], v[216:219]
    v_exp_f32 v192, v192
    v_mfma_f32_16x16x32_bf16 v[200:203], a[100:103], a[36:39], v[200:203]
    ds_read_b64_tr_b16 a[80:81], v228 offset:32768
    v_mfma_f32_16x16x32_bf16 v[200:203], a[104:107], a[40:43], v[200:203]
    v_exp_f32 v193, v193
    v_mfma_f32_16x16x32_bf16 v[200:203], a[108:111], a[44:47], v[200:203]
    ds_read_b64_tr_b16 a[82:83], v228 offset:36864
    v_cvt_pk_bf16_f32 v134, v192, v193
    v_mfma_f32_16x16x32_bf16 v[204:207], a[108:111], a[60:63], v[220:223]
    s_add_u32 s41, s74, 20480
    s_bfe_u32 s51, 0x280100, s18
    s_lshl_b32 s51, s51, 8
    s_add_u32 m0, s51, s76
    v_exp_f32 v194, v194
    v_mfma_f32_16x16x32_bf16 v[204:207], a[104:107], a[56:59], v[204:207]
    buffer_load_dwordx4 v240, s[24:27], s41 offen offset:0 sc1 lds
    v_mfma_f32_16x16x32_bf16 v[204:207], a[100:103], a[52:55], v[204:207]
    v_exp_f32 v195, v195
    v_mfma_f32_16x16x32_bf16 v[204:207], a[96:99], a[48:51], v[204:207]
    ds_read_b64_tr_b16 a[84:85], v228 offset:40960
    v_cvt_pk_bf16_f32 v135, v194, v195
    v_mfma_f32_16x16x32_bf16 v[24:27], a[112:115], v[160:163], v[24:27]
    v_exp_f32 v196, v196
    v_mfma_f32_16x16x32_bf16 v[24:27], a[116:119], v[164:167], v[24:27]
    ds_read_b64_tr_b16 a[86:87], v228 offset:45056
    v_mfma_f32_16x16x32_bf16 v[56:59], a[116:119], v[172:175], v[56:59]
    v_exp_f32 v197, v197
    v_mfma_f32_16x16x32_bf16 v[56:59], a[112:115], v[168:171], v[56:59]
    ds_read_b64_tr_b16 a[88:89], v229 offset:32768
    v_cvt_pk_bf16_f32 v142, v196, v197
    v_mfma_f32_16x16x32_bf16 v[88:91], a[112:115], v[176:179], v[88:91]
    v_exp_f32 v198, v198
    v_mfma_f32_16x16x32_bf16 v[88:91], a[116:119], v[180:183], v[88:91]
    buffer_load_dwordx4 v240, s[24:27], s41 offen offset:1024 sc1 lds
    v_mfma_f32_16x16x32_bf16 v[120:123], a[116:119], v[188:191], v[120:123]
    v_exp_f32 v199, v199
    v_mfma_f32_16x16x32_bf16 v[120:123], a[112:115], v[184:187], v[120:123]
    ds_read_b64_tr_b16 a[90:91], v229 offset:36864
    v_cvt_pk_bf16_f32 v143, v198, v199
    v_mfma_f32_16x16x32_bf16 v[124:127], a[120:123], v[184:187], v[124:127]
    v_exp_f32 v200, v200
    v_mfma_f32_16x16x32_bf16 v[124:127], a[124:127], v[188:191], v[124:127]
    ds_read_b64_tr_b16 a[92:93], v229 offset:40960
    v_mfma_f32_16x16x32_bf16 v[92:95], a[124:127], v[180:183], v[92:95]
    v_exp_f32 v201, v201
    v_mfma_f32_16x16x32_bf16 v[92:95], a[120:123], v[176:179], v[92:95]
    ds_read_b64_tr_b16 a[94:95], v229 offset:45056
    v_cvt_pk_bf16_f32 v150, v200, v201
    v_mfma_f32_16x16x32_bf16 v[60:63], a[120:123], v[168:171], v[60:63]
    v_exp_f32 v202, v202
    v_mfma_f32_16x16x32_bf16 v[60:63], a[124:127], v[172:175], v[60:63]
    buffer_load_dwordx4 v240, s[24:27], s41 offen offset:2048 sc1 lds
    v_mfma_f32_16x16x32_bf16 v[28:31], a[124:127], v[164:167], v[28:31]
    v_exp_f32 v203, v203
    v_mfma_f32_16x16x32_bf16 v[28:31], a[120:123], v[160:163], v[28:31]
    buffer_load_dwordx4 v240, s[24:27], s41 offen offset:3072 sc1 lds
    v_cvt_pk_bf16_f32 v151, v202, v203
    s_add_u32 m0, m0, 4096
    v_smfmac_f32_16x16x64_bf16 a[140:143], a[144:147], v[184:191], v241
    buffer_load_dwordx4 v244, s[24:27], s41 offen sc1 lds
    s_waitcnt lgkmcnt(0)
    v_mfma_f32_16x16x32_bf16 v[192:195], a[64:67], a[0:3], v[208:211]
    v_exp_f32 v204, v204
    v_mfma_f32_16x16x32_bf16 v[192:195], a[68:71], a[4:7], v[192:195]
    ds_read_b128 a[96:99], v224 offset:36864
    v_mfma_f32_16x16x32_bf16 v[192:195], a[72:75], a[8:11], v[192:195]
    v_exp_f32 v205, v205
    v_mfma_f32_16x16x32_bf16 v[192:195], a[76:79], a[12:15], v[192:195]
    ds_read_b128 a[100:103], v225 offset:36864
    v_cvt_pk_bf16_f32 v158, v204, v205
    v_mfma_f32_16x16x32_bf16 v[196:199], a[76:79], a[28:31], v[212:215]
    v_exp_f32 v206, v206
    v_mfma_f32_16x16x32_bf16 v[196:199], a[72:75], a[24:27], v[196:199]
    ds_read_b128 a[104:107], v226 offset:36864
    v_mfma_f32_16x16x32_bf16 v[196:199], a[68:71], a[20:23], v[196:199]
    v_exp_f32 v207, v207
    v_mfma_f32_16x16x32_bf16 v[196:199], a[64:67], a[16:19], v[196:199]
    ds_read_b128 a[108:111], v227 offset:36864
    v_cvt_pk_bf16_f32 v159, v206, v207
    v_mfma_f32_16x16x32_bf16 v[200:203], a[64:67], a[32:35], v[216:219]
    v_exp_f32 v192, v192
    v_mfma_f32_16x16x32_bf16 v[200:203], a[68:71], a[36:39], v[200:203]
    ds_read_b64_tr_b16 a[112:113], v230 offset:32768
    v_mfma_f32_16x16x32_bf16 v[200:203], a[72:75], a[40:43], v[200:203]
    v_exp_f32 v193, v193
    v_mfma_f32_16x16x32_bf16 v[200:203], a[76:79], a[44:47], v[200:203]
    ds_read_b64_tr_b16 a[114:115], v230 offset:36864
    v_cvt_pk_bf16_f32 v160, v192, v193
    v_mfma_f32_16x16x32_bf16 v[204:207], a[76:79], a[60:63], v[220:223]
    s_add_u32 s41, s74, 30720
    s_bfe_u32 s51, 0x1280050, s18
    s_lshl_b32 s51, s51, 8
    s_add_u32 m0, s51, s76
    v_exp_f32 v194, v194
    v_mfma_f32_16x16x32_bf16 v[204:207], a[72:75], a[56:59], v[204:207]
    buffer_load_dwordx4 v240, s[24:27], s41 offen offset:0 sc1 lds
    v_mfma_f32_16x16x32_bf16 v[204:207], a[68:71], a[52:55], v[204:207]
K1_pg12:
    s_cbranch_execz K1_wb0
    v_exp_f32 v195, v195
    v_mfma_f32_16x16x32_bf16 v[204:207], a[64:67], a[48:51], v[204:207]
    ds_read_b64_tr_b16 a[116:117], v230 offset:40960
    v_cvt_pk_bf16_f32 v161, v194, v195
    v_mfma_f32_16x16x32_bf16 v[0:3], a[80:83], v[128:131], v[0:3]
    v_exp_f32 v196, v196
    v_mfma_f32_16x16x32_bf16 v[0:3], a[84:87], v[132:135], v[0:3]
    ds_read_b64_tr_b16 a[118:119], v230 offset:45056
    v_mfma_f32_16x16x32_bf16 v[32:35], a[84:87], v[140:143], v[32:35]
    v_exp_f32 v197, v197
    v_mfma_f32_16x16x32_bf16 v[32:35], a[80:83], v[136:139], v[32:35]
    ds_read_b64_tr_b16 a[120:121], v231 offset:32768
    v_cvt_pk_bf16_f32 v168, v196, v197
    v_mfma_f32_16x16x32_bf16 v[64:67], a[80:83], v[144:147], v[64:67]
    v_exp_f32 v198, v198
    v_mfma_f32_16x16x32_bf16 v[64:67], a[84:87], v[148:151], v[64:67]
    buffer_load_dwordx4 v240, s[24:27], s41 offen offset:1024 sc1 lds
    v_mfma_f32_16x16x32_bf16 v[96:99], a[84:87], v[156:159], v[96:99]
    v_exp_f32 v199, v199
    v_mfma_f32_16x16x32_bf16 v[96:99], a[80:83], v[152:155], v[96:99]
    ds_read_b64_tr_b16 a[122:123], v231 offset:36864
    v_cvt_pk_bf16_f32 v169, v198, v199
    v_mfma_f32_16x16x32_bf16 v[100:103], a[88:91], v[152:155], v[100:103]
    v_exp_f32 v200, v200
    v_mfma_f32_16x16x32_bf16 v[100:103], a[92:95], v[156:159], v[100:103]
    ds_read_b64_tr_b16 a[124:125], v231 offset:40960
    v_mfma_f32_16x16x32_bf16 v[68:71], a[92:95], v[148:151], v[68:71]
    v_exp_f32 v201, v201
    v_mfma_f32_16x16x32_bf16 v[68:71], a[88:91], v[144:147], v[68:71]
    ds_read_b64_tr_b16 a[126:127], v231 offset:45056
    v_cvt_pk_bf16_f32 v176, v200, v201
    v_mfma_f32_16x16x32_bf16 v[36:39], a[88:91], v[136:139], v[36:39]
    v_exp_f32 v202, v202
    v_mfma_f32_16x16x32_bf16 v[36:39], a[92:95], v[140:143], v[36:39]
    buffer_load_dwordx4 v240, s[24:27], s41 offen offset:2048 sc1 lds
    v_mfma_f32_16x16x32_bf16 v[4:7], a[92:95], v[132:135], v[4:7]
    v_exp_f32 v203, v203
    v_mfma_f32_16x16x32_bf16 v[4:7], a[88:91], v[128:131], v[4:7]
    buffer_load_dwordx4 v240, s[24:27], s41 offen offset:3072 sc1 lds
    v_cvt_pk_bf16_f32 v177, v202, v203
    s_add_u32 m0, m0, 4096
    v_smfmac_f32_16x16x64_bf16 a[128:131], a[144:147], v[128:135], v241
    buffer_load_dwordx4 v244, s[24:27], s41 offen sc1 lds
    s_waitcnt lgkmcnt(0)
    v_mfma_f32_16x16x32_bf16 v[192:195], a[96:99], a[0:3], v[208:211]
    v_exp_f32 v204, v204
    v_mfma_f32_16x16x32_bf16 v[192:195], a[100:103], a[4:7], v[192:195]
    ds_read_b128 a[64:67], v224 offset:40960
    v_mfma_f32_16x16x32_bf16 v[192:195], a[104:107], a[8:11], v[192:195]
    v_exp_f32 v205, v205
    v_mfma_f32_16x16x32_bf16 v[192:195], a[108:111], a[12:15], v[192:195]
    ds_read_b128 a[68:71], v225 offset:40960
    v_cvt_pk_bf16_f32 v184, v204, v205
    v_mfma_f32_16x16x32_bf16 v[196:199], a[108:111], a[28:31], v[212:215]
    v_exp_f32 v206, v206
    v_mfma_f32_16x16x32_bf16 v[196:199], a[104:107], a[24:27], v[196:199]
    ds_read_b128 a[72:75], v226 offset:40960
    v_mfma_f32_16x16x32_bf16 v[196:199], a[100:103], a[20:23], v[196:199]
    v_exp_f32 v207, v207
    v_mfma_f32_16x16x32_bf16 v[196:199], a[96:99], a[16:19], v[196:199]
    ds_read_b128 a[76:79], v227 offset:40960
    v_cvt_pk_bf16_f32 v185, v206, v207
    v_mfma_f32_16x16x32_bf16 v[200:203], a[96:99], a[32:35], v[216:219]
    v_exp_f32 v192, v192
    v_mfma_f32_16x16x32_bf16 v[200:203], a[100:103], a[36:39], v[200:203]
    ds_read_b64_tr_b16 a[80:81], v232 offset:32768
    v_mfma_f32_16x16x32_bf16 v[200:203], a[104:107], a[40:43], v[200:203]
    v_exp_f32 v193, v193
    v_mfma_f32_16x16x32_bf16 v[200:203], a[108:111], a[44:47], v[200:203]
    ds_read_b64_tr_b16 a[82:83], v232 offset:36864
    v_cvt_pk_bf16_f32 v162, v192, v193
    v_mfma_f32_16x16x32_bf16 v[204:207], a[108:111], a[60:63], v[220:223]
    s_add_u32 s41, s74, 40960
    s_bfe_u32 s51, 0xd80150, s18
    s_lshl_b32 s51, s51, 8
    s_add_u32 m0, s51, s76
    v_exp_f32 v194, v194
    v_mfma_f32_16x16x32_bf16 v[204:207], a[104:107], a[56:59], v[204:207]
    buffer_load_dwordx4 v240, s[24:27], s41 offen offset:0 sc1 lds
    v_mfma_f32_16x16x32_bf16 v[204:207], a[100:103], a[52:55], v[204:207]
    v_exp_f32 v195, v195
    v_mfma_f32_16x16x32_bf16 v[204:207], a[96:99], a[48:51], v[204:207]
    ds_read_b64_tr_b16 a[84:85], v232 offset:40960
    v_cvt_pk_bf16_f32 v163, v194, v195
    v_mfma_f32_16x16x32_bf16 v[8:11], a[112:115], v[128:131], v[8:11]
    v_exp_f32 v196, v196
    v_mfma_f32_16x16x32_bf16 v[8:11], a[116:119], v[132:135], v[8:11]
    ds_read_b64_tr_b16 a[86:87], v232 offset:45056
    v_mfma_f32_16x16x32_bf16 v[40:43], a[116:119], v[140:143], v[40:43]
    v_exp_f32 v197, v197
    v_mfma_f32_16x16x32_bf16 v[40:43], a[112:115], v[136:139], v[40:43]
    ds_read_b64_tr_b16 a[88:89], v233 offset:32768
    v_cvt_pk_bf16_f32 v170, v196, v197
    v_mfma_f32_16x16x32_bf16 v[72:75], a[112:115], v[144:147], v[72:75]
    v_exp_f32 v198, v198
    v_mfma_f32_16x16x32_bf16 v[72:75], a[116:119], v[148:151], v[72:75]
    buffer_load_dwordx4 v240, s[24:27], s41 offen offset:1024 sc1 lds
    v_mfma_f32_16x16x32_bf16 v[104:107], a[116:119], v[156:159], v[104:107]
    v_exp_f32 v199, v199
    v_mfma_f32_16x16x32_bf16 v[104:107], a[112:115], v[152:155], v[104:107]
    ds_read_b64_tr_b16 a[90:91], v233 offset:36864
    v_cvt_pk_bf16_f32 v171, v198, v199
    v_mfma_f32_16x16x32_bf16 v[108:111], a[120:123], v[152:155], v[108:111]
    v_exp_f32 v200, v200
    v_mfma_f32_16x16x32_bf16 v[108:111], a[124:127], v[156:159], v[108:111]
    ds_read_b64_tr_b16 a[92:93], v233 offset:40960
    v_mfma_f32_16x16x32_bf16 v[76:79], a[124:127], v[148:151], v[76:79]
    v_exp_f32 v201, v201
    v_mfma_f32_16x16x32_bf16 v[76:79], a[120:123], v[144:147], v[76:79]
    ds_read_b64_tr_b16 a[94:95], v233 offset:45056
    v_cvt_pk_bf16_f32 v178, v200, v201
    v_mfma_f32_16x16x32_bf16 v[44:47], a[120:123], v[136:139], v[44:47]
    v_exp_f32 v202, v202
    v_mfma_f32_16x16x32_bf16 v[44:47], a[124:127], v[140:143], v[44:47]
    buffer_load_dwordx4 v240, s[24:27], s41 offen offset:2048 sc1 lds
    v_mfma_f32_16x16x32_bf16 v[12:15], a[124:127], v[132:135], v[12:15]
    v_exp_f32 v203, v203
    v_mfma_f32_16x16x32_bf16 v[12:15], a[120:123], v[128:131], v[12:15]
    buffer_load_dwordx4 v240, s[24:27], s41 offen offset:3072 sc1 lds
    v_cvt_pk_bf16_f32 v179, v202, v203
    s_add_u32 m0, m0, 4096
    v_smfmac_f32_16x16x64_bf16 a[132:135], a[144:147], v[136:143], v241
    buffer_load_dwordx4 v244, s[24:27], s41 offen sc1 lds
    s_waitcnt lgkmcnt(0)
    v_mfma_f32_16x16x32_bf16 v[192:195], a[64:67], a[0:3], v[208:211]
    v_exp_f32 v204, v204
    v_mfma_f32_16x16x32_bf16 v[192:195], a[68:71], a[4:7], v[192:195]
    ds_read_b128 a[96:99], v224 offset:45056
    v_mfma_f32_16x16x32_bf16 v[192:195], a[72:75], a[8:11], v[192:195]
    v_exp_f32 v205, v205
    v_mfma_f32_16x16x32_bf16 v[192:195], a[76:79], a[12:15], v[192:195]
    ds_read_b128 a[100:103], v225 offset:45056
    v_cvt_pk_bf16_f32 v186, v204, v205
    v_mfma_f32_16x16x32_bf16 v[196:199], a[76:79], a[28:31], v[212:215]
    v_exp_f32 v206, v206
    v_mfma_f32_16x16x32_bf16 v[196:199], a[72:75], a[24:27], v[196:199]
    ds_read_b128 a[104:107], v226 offset:45056
    v_mfma_f32_16x16x32_bf16 v[196:199], a[68:71], a[20:23], v[196:199]
    v_exp_f32 v207, v207
    v_mfma_f32_16x16x32_bf16 v[196:199], a[64:67], a[16:19], v[196:199]
    ds_read_b128 a[108:111], v227 offset:45056
    v_cvt_pk_bf16_f32 v187, v206, v207
    v_mfma_f32_16x16x32_bf16 v[200:203], a[64:67], a[32:35], v[216:219]
    v_exp_f32 v192, v192
    v_mfma_f32_16x16x32_bf16 v[200:203], a[68:71], a[36:39], v[200:203]
    ds_read_b64_tr_b16 a[112:113], v234 offset:32768
    v_mfma_f32_16x16x32_bf16 v[200:203], a[72:75], a[40:43], v[200:203]
    v_exp_f32 v193, v193
    v_mfma_f32_16x16x32_bf16 v[200:203], a[76:79], a[44:47], v[200:203]
    ds_read_b64_tr_b16 a[114:115], v234 offset:36864
    v_cvt_pk_bf16_f32 v164, v192, v193
    v_mfma_f32_16x16x32_bf16 v[204:207], a[76:79], a[60:63], v[220:223]
    v_exp_f32 v194, v194
    v_mfma_f32_16x16x32_bf16 v[204:207], a[72:75], a[56:59], v[204:207]
    ds_read_b64_tr_b16 a[116:117], v234 offset:40960
    v_mfma_f32_16x16x32_bf16 v[204:207], a[68:71], a[52:55], v[204:207]
    v_exp_f32 v195, v195
    v_mfma_f32_16x16x32_bf16 v[204:207], a[64:67], a[48:51], v[204:207]
    ds_read_b64_tr_b16 a[118:119], v234 offset:45056
    v_cvt_pk_bf16_f32 v165, v194, v195
    v_mfma_f32_16x16x32_bf16 v[16:19], a[80:83], v[128:131], v[16:19]
    v_exp_f32 v196, v196
    v_mfma_f32_16x16x32_bf16 v[16:19], a[84:87], v[132:135], v[16:19]
    ds_read_b64_tr_b16 a[120:121], v235 offset:32768
    v_mfma_f32_16x16x32_bf16 v[48:51], a[84:87], v[140:143], v[48:51]
    v_exp_f32 v197, v197
    v_mfma_f32_16x16x32_bf16 v[48:51], a[80:83], v[136:139], v[48:51]
    ds_read_b64_tr_b16 a[122:123], v235 offset:36864
    v_cvt_pk_bf16_f32 v172, v196, v197
    v_mfma_f32_16x16x32_bf16 v[80:83], a[80:83], v[144:147], v[80:83]
    v_exp_f32 v198, v198
    v_mfma_f32_16x16x32_bf16 v[80:83], a[84:87], v[148:151], v[80:83]
    ds_read_b64_tr_b16 a[124:125], v235 offset:40960
    v_mfma_f32_16x16x32_bf16 v[112:115], a[84:87], v[156:159], v[112:115]
    v_exp_f32 v199, v199
    v_mfma_f32_16x16x32_bf16 v[112:115], a[80:83], v[152:155], v[112:115]
    ds_read_b64_tr_b16 a[126:127], v235 offset:45056
    v_cvt_pk_bf16_f32 v173, v198, v199
    v_mfma_f32_16x16x32_bf16 v[116:119], a[88:91], v[152:155], v[116:119]
    v_exp_f32 v200, v200
    v_mfma_f32_16x16x32_bf16 v[116:119], a[92:95], v[156:159], v[116:119]
    v_mfma_f32_16x16x32_bf16 v[84:87], a[92:95], v[148:151], v[84:87]
    v_exp_f32 v201, v201
    v_mfma_f32_16x16x32_bf16 v[84:87], a[88:91], v[144:147], v[84:87]
    v_cvt_pk_bf16_f32 v180, v200, v201
    v_mfma_f32_16x16x32_bf16 v[52:55], a[88:91], v[136:139], v[52:55]
    v_exp_f32 v202, v202
    v_mfma_f32_16x16x32_bf16 v[52:55], a[92:95], v[140:143], v[52:55]
    v_mfma_f32_16x16x32_bf16 v[20:23], a[92:95], v[132:135], v[20:23]
    v_exp_f32 v203, v203
    v_mfma_f32_16x16x32_bf16 v[20:23], a[88:91], v[128:131], v[20:23]
    s_waitcnt vmcnt(25) lgkmcnt(0)
    v_cvt_pk_bf16_f32 v181, v202, v203
    v_smfmac_f32_16x16x64_bf16 a[136:139], a[144:147], v[144:151], v241
    s_barrier
    v_mfma_f32_16x16x32_bf16 v[192:195], a[96:99], a[0:3], v[208:211]
    v_exp_f32 v204, v204
    v_mfma_f32_16x16x32_bf16 v[192:195], a[100:103], a[4:7], v[192:195]
    ds_read_b64_tr_b16 a[80:81], v228 offset:49152
    v_mfma_f32_16x16x32_bf16 v[192:195], a[104:107], a[8:11], v[192:195]
    v_exp_f32 v205, v205
    v_mfma_f32_16x16x32_bf16 v[192:195], a[108:111], a[12:15], v[192:195]
    ds_read_b64_tr_b16 a[82:83], v228 offset:53248
    v_cvt_pk_bf16_f32 v188, v204, v205
    v_mfma_f32_16x16x32_bf16 v[196:199], a[108:111], a[28:31], v[212:215]
    s_add_u32 s41, s74, 51200
    s_bfe_u32 s51, 0xa00078, s18
    s_lshl_b32 s51, s51, 8
    s_add_u32 m0, s51, s76
    v_exp_f32 v206, v206
    v_mfma_f32_16x16x32_bf16 v[196:199], a[104:107], a[24:27], v[196:199]
    buffer_load_dwordx4 v240, s[24:27], s41 offen offset:0 sc1 lds
    v_mfma_f32_16x16x32_bf16 v[196:199], a[100:103], a[20:23], v[196:199]
    v_exp_f32 v207, v207
    v_mfma_f32_16x16x32_bf16 v[196:199], a[96:99], a[16:19], v[196:199]
    ds_read_b64_tr_b16 a[84:85], v228 offset:57344
    v_cvt_pk_bf16_f32 v189, v206, v207
    v_mfma_f32_16x16x32_bf16 v[200:203], a[96:99], a[32:35], v[216:219]
    v_exp_f32 v192, v192
    v_mfma_f32_16x16x32_bf16 v[200:203], a[100:103], a[36:39], v[200:203]
    ds_read_b64_tr_b16 a[86:87], v228 offset:61440
    v_mfma_f32_16x16x32_bf16 v[200:203], a[104:107], a[40:43], v[200:203]
    v_exp_f32 v193, v193
    v_mfma_f32_16x16x32_bf16 v[200:203], a[108:111], a[44:47], v[200:203]
    ds_read_b64_tr_b16 a[88:89], v229 offset:49152
    v_cvt_pk_bf16_f32 v166, v192, v193
    v_mfma_f32_16x16x32_bf16 v[204:207], a[108:111], a[60:63], v[220:223]
    v_exp_f32 v194, v194
    v_mfma_f32_16x16x32_bf16 v[204:207], a[104:107], a[56:59], v[204:207]
    buffer_load_dwordx4 v240, s[24:27], s41 offen offset:1024 sc1 lds
    v_mfma_f32_16x16x32_bf16 v[204:207], a[100:103], a[52:55], v[204:207]
    v_exp_f32 v195, v195
    v_mfma_f32_16x16x32_bf16 v[204:207], a[96:99], a[48:51], v[204:207]
    ds_read_b64_tr_b16 a[90:91], v229 offset:53248
    v_cvt_pk_bf16_f32 v167, v194, v195
    v_mfma_f32_16x16x32_bf16 v[24:27], a[112:115], v[128:131], v[24:27]
    v_exp_f32 v196, v196
    v_mfma_f32_16x16x32_bf16 v[24:27], a[116:119], v[132:135], v[24:27]
    ds_read_b64_tr_b16 a[92:93], v229 offset:57344
    v_mfma_f32_16x16x32_bf16 v[56:59], a[116:119], v[140:143], v[56:59]
    v_exp_f32 v197, v197
    v_mfma_f32_16x16x32_bf16 v[56:59], a[112:115], v[136:139], v[56:59]
    ds_read_b64_tr_b16 a[94:95], v229 offset:61440
    v_cvt_pk_bf16_f32 v174, v196, v197
    v_mfma_f32_16x16x32_bf16 v[88:91], a[112:115], v[144:147], v[88:91]
    v_exp_f32 v198, v198
    v_mfma_f32_16x16x32_bf16 v[88:91], a[116:119], v[148:151], v[88:91]
    buffer_load_dwordx4 v240, s[24:27], s41 offen offset:2048 sc1 lds
    v_mfma_f32_16x16x32_bf16 v[120:123], a[116:119], v[156:159], v[120:123]
    v_exp_f32 v199, v199
    v_mfma_f32_16x16x32_bf16 v[120:123], a[112:115], v[152:155], v[120:123]
    v_cvt_pk_bf16_f32 v175, v198, v199
    v_mfma_f32_16x16x32_bf16 v[124:127], a[120:123], v[152:155], v[124:127]
    v_exp_f32 v200, v200
    v_mfma_f32_16x16x32_bf16 v[124:127], a[124:127], v[156:159], v[124:127]
    buffer_load_dwordx4 v240, s[24:27], s41 offen offset:3072 sc1 lds
    v_mfma_f32_16x16x32_bf16 v[92:95], a[124:127], v[148:151], v[92:95]
    v_exp_f32 v201, v201
    v_mfma_f32_16x16x32_bf16 v[92:95], a[120:123], v[144:147], v[92:95]
    v_cvt_pk_bf16_f32 v182, v200, v201
    v_mfma_f32_16x16x32_bf16 v[60:63], a[120:123], v[136:139], v[60:63]
    s_add_u32 m0, m0, 4096
    v_exp_f32 v202, v202
    v_mfma_f32_16x16x32_bf16 v[60:63], a[124:127], v[140:143], v[60:63]
    buffer_load_dwordx4 v244, s[24:27], s41 offen sc1 lds
    v_mfma_f32_16x16x32_bf16 v[28:31], a[124:127], v[132:135], v[28:31]
    v_exp_f32 v203, v203
    v_mfma_f32_16x16x32_bf16 v[28:31], a[120:123], v[128:131], v[28:31]
    v_cvt_pk_bf16_f32 v183, v202, v203
    v_smfmac_f32_16x16x64_bf16 a[140:143], a[144:147], v[152:159], v241
    s_waitcnt lgkmcnt(0)
K1_last:
    v_smfmac_f32_16x16x64_bf16 a[128:131], a[144:147], v[160:167], v241
    v_exp_f32 v204, v204
    v_smfmac_f32_16x16x64_bf16 a[132:135], a[144:147], v[168:175], v241
    v_exp_f32 v205, v205
    v_smfmac_f32_16x16x64_bf16 a[136:139], a[144:147], v[176:183], v241
    v_exp_f32 v206, v206
    v_cvt_pk_bf16_f32 v190, v204, v205
    v_exp_f32 v207, v207
    v_mov_b32 v194, 131072
    v_cvt_pk_bf16_f32 v191, v206, v207
    v_mfma_f32_16x16x32_bf16 v[0:3], a[80:83], v[160:163], v[0:3]
    ds_read_b64_tr_b16 a[112:113], v230 offset:49152
    v_accvgpr_read_b32 v200, a128
    v_accvgpr_read_b32 v201, a129
    v_mfma_f32_16x16x32_bf16 v[0:3], a[84:87], v[164:167], v[0:3]
    ds_read_b64_tr_b16 a[114:115], v230 offset:53248
    v_add_f32 v201, v200, v201
    v_cmp_nge_f32 vcc, s50, v201
    v_mfma_f32_16x16x32_bf16 v[4:7], a[88:91], v[160:163], v[4:7]
    ds_read_b64_tr_b16 a[116:117], v230 offset:57344
    v_rcp_f32 v200, v201
    s_or_b64 s[6:7], vcc, s[6:7]
    v_mfma_f32_16x16x32_bf16 v[4:7], a[92:95], v[164:167], v[4:7]
    ds_read_b64_tr_b16 a[118:119], v230 offset:61440
    v_accvgpr_read_b32 v202, a132
    v_accvgpr_read_b32 v203, a133
    v_smfmac_f32_16x16x64_bf16 a[140:143], a[144:147], v[184:191], v241
    ds_read_b64_tr_b16 a[120:121], v231 offset:49152
    v_add_f32 v203, v202, v203
    v_cmp_nge_f32 vcc, s50, v203
    v_mfma_f32_16x16x32_bf16 v[32:35], a[84:87], v[172:175], v[32:35]
    ds_read_b64_tr_b16 a[122:123], v231 offset:53248
    v_rcp_f32 v202, v203
    s_or_b64 s[6:7], vcc, s[6:7]
    v_mfma_f32_16x16x32_bf16 v[32:35], a[80:83], v[168:171], v[32:35]
    ds_read_b64_tr_b16 a[124:125], v231 offset:57344
    v_accvgpr_read_b32 v204, a136
    v_accvgpr_read_b32 v205, a137
    v_mfma_f32_16x16x32_bf16 v[36:39], a[92:95], v[172:175], v[36:39]
    ds_read_b64_tr_b16 a[126:127], v231 offset:61440
    v_add_f32 v205, v204, v205
    v_cmp_nge_f32 vcc, s50, v205
    v_mfma_f32_16x16x32_bf16 v[36:39], a[88:91], v[168:171], v[36:39]
    v_rcp_f32 v204, v205
    s_or_b64 s[6:7], vcc, s[6:7]
    v_accvgpr_read_b32 v214, a248
    v_mfma_f32_16x16x32_bf16 v[64:67], a[80:83], v[176:179], v[64:67]
    v_accvgpr_read_b32 v215, a249
    v_accvgpr_read_b32 v216, a250
    v_accvgpr_read_b32 v217, a251
    v_mfma_f32_16x16x32_bf16 v[64:67], a[84:87], v[180:183], v[64:67]
    v_mul_f32 v0, v200, v0
    v_mul_f32 v1, v200, v1
    v_mul_f32 v2, v200, v2
    v_mfma_f32_16x16x32_bf16 v[68:71], a[88:91], v[176:179], v[68:71]
    v_mul_f32 v3, v200, v3
    v_mul_f32 v4, v200, v4
    v_mul_f32 v5, v200, v5
    v_mfma_f32_16x16x32_bf16 v[68:71], a[92:95], v[180:183], v[68:71]
    v_mul_f32 v6, v200, v6
    v_mul_f32 v7, v200, v7
    v_cvt_pk_bf16_f32 v128, v0, v1
    v_mfma_f32_16x16x32_bf16 v[96:99], a[84:87], v[188:191], v[96:99]
    v_cvt_pk_bf16_f32 v129, v2, v3
    v_cvt_pk_bf16_f32 v130, v4, v5
    v_cvt_pk_bf16_f32 v131, v6, v7
    v_mfma_f32_16x16x32_bf16 v[96:99], a[80:83], v[184:187], v[96:99]
    buffer_store_dwordx4 v[128:131], v240, s[36:39], s77 offen offset:0 sc1
    v_accvgpr_read_b32 v206, a140
    v_accvgpr_read_b32 v207, a141
    v_mfma_f32_16x16x32_bf16 v[100:103], a[92:95], v[188:191], v[100:103]
    v_add_f32 v207, v206, v207
    v_cmp_nge_f32 vcc, s50, v207
    v_mfma_f32_16x16x32_bf16 v[100:103], a[88:91], v[184:187], v[100:103]
    v_rcp_f32 v206, v207
    s_or_b64 s[6:7], vcc, s[6:7]
    s_cselect_b32 s4, 1, 0
    v_mov_b32 v193, s4
    ds_write_b32 v249, v193
    s_waitcnt vmcnt(16) lgkmcnt(0)
    s_barrier
    v_mfma_f32_16x16x32_bf16 v[8:11], a[112:115], v[160:163], v[8:11]
    ds_read_b128 v[196:199], v194
    v_mul_f32 v32, v202, v32
    v_mul_f32 v33, v202, v33
    v_mfma_f32_16x16x32_bf16 v[8:11], a[116:119], v[164:167], v[8:11]
    ds_read_b64_tr_b16 a[80:81], v232 offset:49152
    v_mul_f32 v34, v202, v34
    v_mul_f32 v35, v202, v35
    v_mfma_f32_16x16x32_bf16 v[12:15], a[120:123], v[160:163], v[12:15]
    ds_read_b64_tr_b16 a[82:83], v232 offset:53248
    v_mul_f32 v36, v202, v36
    v_mul_f32 v37, v202, v37
    v_mfma_f32_16x16x32_bf16 v[12:15], a[124:127], v[164:167], v[12:15]
    ds_read_b64_tr_b16 a[84:85], v232 offset:57344
    v_mul_f32 v38, v202, v38
    v_mul_f32 v39, v202, v39
    v_mfma_f32_16x16x32_bf16 v[40:43], a[116:119], v[172:175], v[40:43]
    ds_read_b64_tr_b16 a[86:87], v232 offset:61440
    v_cvt_pk_bf16_f32 v132, v32, v33
    v_cvt_pk_bf16_f32 v133, v34, v35
    v_mfma_f32_16x16x32_bf16 v[40:43], a[112:115], v[168:171], v[40:43]
    ds_read_b64_tr_b16 a[88:89], v233 offset:49152
    v_cvt_pk_bf16_f32 v134, v36, v37
    v_cvt_pk_bf16_f32 v135, v38, v39
    v_mfma_f32_16x16x32_bf16 v[44:47], a[124:127], v[172:175], v[44:47]
    ds_read_b64_tr_b16 a[90:91], v233 offset:53248
    buffer_store_dwordx4 v[132:135], v240, s[36:39], s77 offen offset:1024 sc1
    v_accvgpr_read_b32 v218, a252
    v_mfma_f32_16x16x32_bf16 v[44:47], a[120:123], v[168:171], v[44:47]
    ds_read_b64_tr_b16 a[92:93], v233 offset:57344
    v_accvgpr_read_b32 v219, a253
    v_accvgpr_read_b32 v220, a254
    v_mfma_f32_16x16x32_bf16 v[72:75], a[112:115], v[176:179], v[72:75]
    ds_read_b64_tr_b16 a[94:95], v233 offset:61440
    v_accvgpr_read_b32 v221, a255
    v_accvgpr_read_b32 v222, a148
    v_mfma_f32_16x16x32_bf16 v[72:75], a[116:119], v[180:183], v[72:75]
    v_accvgpr_read_b32 v223, a149
    v_mul_f32 v64, v204, v64
    v_mul_f32 v65, v204, v65
    v_mfma_f32_16x16x32_bf16 v[76:79], a[120:123], v[176:179], v[76:79]
    v_mul_f32 v66, v204, v66
    v_mul_f32 v67, v204, v67
    v_mul_f32 v68, v204, v68
    v_mfma_f32_16x16x32_bf16 v[76:79], a[124:127], v[180:183], v[76:79]
    v_mul_f32 v69, v204, v69
    v_mul_f32 v70, v204, v70
    v_mul_f32 v71, v204, v71
    v_mfma_f32_16x16x32_bf16 v[104:107], a[116:119], v[188:191], v[104:107]
    v_cvt_pk_bf16_f32 v136, v64, v65
    v_cvt_pk_bf16_f32 v137, v66, v67
    v_cvt_pk_bf16_f32 v138, v68, v69
    v_mfma_f32_16x16x32_bf16 v[104:107], a[112:115], v[184:187], v[104:107]
    v_cvt_pk_bf16_f32 v139, v70, v71
    buffer_store_dwordx4 v[136:139], v240, s[36:39], s77 offen offset:2048 sc1
    v_mul_f32 v96, v206, v96
    v_mfma_f32_16x16x32_bf16 v[108:111], a[124:127], v[188:191], v[108:111]
    v_mul_f32 v97, v206, v97
    v_mul_f32 v98, v206, v98
    v_mul_f32 v99, v206, v99
    v_mfma_f32_16x16x32_bf16 v[108:111], a[120:123], v[184:187], v[108:111]
    v_mul_f32 v100, v206, v100
    v_mul_f32 v101, v206, v101
    v_mul_f32 v102, v206, v102
    s_waitcnt lgkmcnt(0)
    v_or3_b32 v196, v196, v197, v198
    v_or_b32 v196, v196, v199
    s_nop 0
    v_readfirstlane_b32 s51, v196
    s_nop 1
    s_andn2_b32 s51, s51, s48
    s_cbranch_scc1 K1_exact
    v_mfma_f32_16x16x32_bf16 v[16:19], a[80:83], v[160:163], v[16:19]
    ds_read_b64_tr_b16 a[112:113], v234 offset:49152
    v_mul_f32 v103, v206, v103
    v_cvt_pk_bf16_f32 v140, v96, v97
    v_mfma_f32_16x16x32_bf16 v[16:19], a[84:87], v[164:167], v[16:19]
    ds_read_b64_tr_b16 a[114:115], v234 offset:53248
    v_cvt_pk_bf16_f32 v141, v98, v99
    v_cvt_pk_bf16_f32 v142, v100, v101
    v_mfma_f32_16x16x32_bf16 v[20:23], a[88:91], v[160:163], v[20:23]
    ds_read_b64_tr_b16 a[116:117], v234 offset:57344
    v_cvt_pk_bf16_f32 v143, v102, v103
    buffer_store_dwordx4 v[140:143], v240, s[36:39], s77 offen offset:3072 sc1
    s_add_u32 s77, s77, 4096
    v_mfma_f32_16x16x32_bf16 v[20:23], a[92:95], v[164:167], v[20:23]
    ds_read_b64_tr_b16 a[118:119], v234 offset:61440
    v_mul_f32 v8, v200, v8
    v_mul_f32 v9, v200, v9
    v_mfma_f32_16x16x32_bf16 v[48:51], a[84:87], v[172:175], v[48:51]
    ds_read_b64_tr_b16 a[120:121], v235 offset:49152
    v_mul_f32 v10, v200, v10
    v_mul_f32 v11, v200, v11
    v_mfma_f32_16x16x32_bf16 v[48:51], a[80:83], v[168:171], v[48:51]
    ds_read_b64_tr_b16 a[122:123], v235 offset:53248
    v_mul_f32 v12, v200, v12
    v_mul_f32 v13, v200, v13
    v_mfma_f32_16x16x32_bf16 v[52:55], a[92:95], v[172:175], v[52:55]
    ds_read_b64_tr_b16 a[124:125], v235 offset:57344
    v_mul_f32 v14, v200, v14
    v_mul_f32 v15, v200, v15
    v_mfma_f32_16x16x32_bf16 v[52:55], a[88:91], v[168:171], v[52:55]
    ds_read_b64_tr_b16 a[126:127], v235 offset:61440
    v_cvt_pk_bf16_f32 v144, v8, v9
    v_cvt_pk_bf16_f32 v145, v10, v11
    v_mfma_f32_16x16x32_bf16 v[80:83], a[80:83], v[176:179], v[80:83]
    s_add_u32 s42, s72, 49152
    buffer_load_dwordx4 a[248:251], v242, s[20:23], s42 offen sc1
    v_cvt_pk_bf16_f32 v146, v12, v13
    v_cvt_pk_bf16_f32 v147, v14, v15
    v_mfma_f32_16x16x32_bf16 v[80:83], a[84:87], v[180:183], v[80:83]
    buffer_load_dwordx4 a[252:255], v243, s[20:23], s42 offen sc1
    buffer_store_dwordx4 v[144:147], v240, s[36:39], s77 offen offset:0 sc1
    v_mul_f32 v40, v202, v40
    v_mfma_f32_16x16x32_bf16 v[84:87], a[88:91], v[176:179], v[84:87]
    s_add_u32 s42, s72, 53248
    buffer_load_dwordx4 a[144:147], v242, s[20:23], s42 offen sc1
    v_mul_f32 v41, v202, v41
    v_mul_f32 v42, v202, v42
    v_mfma_f32_16x16x32_bf16 v[84:87], a[92:95], v[180:183], v[84:87]
    buffer_load_dwordx4 a[148:151], v243, s[20:23], s42 offen sc1
    v_mul_f32 v43, v202, v43
    v_mul_f32 v44, v202, v44
    v_mfma_f32_16x16x32_bf16 v[112:115], a[84:87], v[188:191], v[112:115]
    v_mul_f32 v45, v202, v45
    v_mul_f32 v46, v202, v46
    v_mul_f32 v47, v202, v47
    v_mfma_f32_16x16x32_bf16 v[112:115], a[80:83], v[184:187], v[112:115]
    v_cvt_pk_bf16_f32 v148, v40, v41
    v_cvt_pk_bf16_f32 v149, v42, v43
    v_cvt_pk_bf16_f32 v150, v44, v45
    v_mfma_f32_16x16x32_bf16 v[116:119], a[92:95], v[188:191], v[116:119]
    v_cvt_pk_bf16_f32 v151, v46, v47
    buffer_store_dwordx4 v[148:151], v240, s[36:39], s77 offen offset:1024 sc1
    v_mul_f32 v72, v204, v72
    v_mfma_f32_16x16x32_bf16 v[116:119], a[88:91], v[184:187], v[116:119]
    v_mul_f32 v73, v204, v73
    v_mul_f32 v74, v204, v74
    v_mul_f32 v75, v204, v75
    s_waitcnt lgkmcnt(0)
    v_mfma_f32_16x16x32_bf16 v[24:27], a[112:115], v[160:163], v[24:27]
    s_sub_u32 s51, 5120, s79
    v_add_u32 v231, s51, v240
    v_add_u32 v233, 131072, v231
    v_add_u32 v228, s79, v240
    v_mfma_f32_16x16x32_bf16 v[24:27], a[116:119], v[164:167], v[24:27]
    v_add_u32 v232, 65536, v231
    v_add_u32 v229, 65536, v228
    v_add_u32 v230, 131072, v228
    v_mfma_f32_16x16x32_bf16 v[28:31], a[120:123], v[160:163], v[28:31]
    v_mov_b32 v234, s0
    v_mul_f32 v76, v204, v76
    v_mul_f32 v77, v204, v77
    v_mfma_f32_16x16x32_bf16 v[28:31], a[124:127], v[164:167], v[28:31]
    ds_read_b128 a[0:3], v233 offset:2048
    v_mul_f32 v78, v204, v78
    v_mul_f32 v79, v204, v79
    v_mfma_f32_16x16x32_bf16 v[56:59], a[116:119], v[172:175], v[56:59]
    ds_read_b128 a[4:7], v233 offset:12288
    v_cvt_pk_bf16_f32 v152, v72, v73
    v_cvt_pk_bf16_f32 v153, v74, v75
    v_mfma_f32_16x16x32_bf16 v[56:59], a[112:115], v[168:171], v[56:59]
    ds_read_b128 a[8:11], v230 offset:2048
    v_cvt_pk_bf16_f32 v154, v76, v77
    v_cvt_pk_bf16_f32 v155, v78, v79
    v_mfma_f32_16x16x32_bf16 v[60:63], a[124:127], v[172:175], v[60:63]
    ds_read_b128 a[12:15], v230 offset:12288
    buffer_store_dwordx4 v[152:155], v240, s[36:39], s77 offen offset:2048 sc1
    v_mul_f32 v104, v206, v104
    v_mfma_f32_16x16x32_bf16 v[60:63], a[120:123], v[168:171], v[60:63]
    ds_read_b128 a[16:19], v233 offset:3072
    v_mul_f32 v105, v206, v105
    v_mul_f32 v106, v206, v106
    v_mfma_f32_16x16x32_bf16 v[88:91], a[112:115], v[176:179], v[88:91]
    ds_read_b128 a[20:23], v233 offset:13312
    v_mul_f32 v107, v206, v107
    v_mul_f32 v108, v206, v108
    v_mfma_f32_16x16x32_bf16 v[88:91], a[116:119], v[180:183], v[88:91]
    ds_read_b128 a[24:27], v230 offset:3072
    v_mul_f32 v109, v206, v109
    v_mul_f32 v110, v206, v110
    v_mfma_f32_16x16x32_bf16 v[92:95], a[120:123], v[176:179], v[92:95]
    ds_read_b128 a[28:31], v230 offset:13312
    v_mul_f32 v111, v206, v111
    v_cvt_pk_bf16_f32 v156, v104, v105
    v_mfma_f32_16x16x32_bf16 v[92:95], a[124:127], v[180:183], v[92:95]
    v_cvt_pk_bf16_f32 v157, v106, v107
    v_cvt_pk_bf16_f32 v158, v108, v109
    v_cvt_pk_bf16_f32 v159, v110, v111
    v_mfma_f32_16x16x32_bf16 v[120:123], a[116:119], v[188:191], v[120:123]
    buffer_store_dwordx4 v[156:159], v240, s[36:39], s77 offen offset:3072 sc1
    s_add_u32 s77, s77, 4096
    v_mul_f32 v16, v200, v16
    v_mul_f32 v17, v200, v17
    v_mfma_f32_16x16x32_bf16 v[120:123], a[112:115], v[184:187], v[120:123]
    v_mul_f32 v18, v200, v18
    v_mul_f32 v19, v200, v19
    v_mul_f32 v20, v200, v20
    v_mfma_f32_16x16x32_bf16 v[124:127], a[124:127], v[188:191], v[124:127]
    v_mul_f32 v21, v200, v21
    v_mul_f32 v22, v200, v22
    v_mul_f32 v23, v200, v23
    v_mfma_f32_16x16x32_bf16 v[124:127], a[120:123], v[184:187], v[124:127]
    v_cvt_pk_bf16_f32 v128, v16, v17
    v_cvt_pk_bf16_f32 v129, v18, v19
    v_cvt_pk_bf16_f32 v130, v20, v21
    v_cvt_pk_bf16_f32 v131, v22, v23
    v_mul_f32 v48, v202, v48
    v_mul_f32 v49, v202, v49
    v_mul_f32 v50, v202, v50
    v_mul_f32 v51, v202, v51
    v_mul_f32 v52, v202, v52
    v_mul_f32 v53, v202, v53
    v_mul_f32 v54, v202, v54
    v_mul_f32 v55, v202, v55
    v_cvt_pk_bf16_f32 v132, v48, v49
    v_cvt_pk_bf16_f32 v133, v50, v51
    v_cvt_pk_bf16_f32 v134, v52, v53
    v_cvt_pk_bf16_f32 v135, v54, v55
    v_mul_f32 v80, v204, v80
    v_mul_f32 v81, v204, v81
    v_mul_f32 v82, v204, v82
    v_mul_f32 v83, v204, v83
    v_mul_f32 v84, v204, v84
    v_mul_f32 v85, v204, v85
    v_mul_f32 v86, v204, v86
    v_mul_f32 v87, v204, v87
    v_cvt_pk_bf16_f32 v136, v80, v81
    v_cvt_pk_bf16_f32 v137, v82, v83
    v_cvt_pk_bf16_f32 v138, v84, v85
    v_cvt_pk_bf16_f32 v139, v86, v87
    v_mul_f32 v112, v206, v112
    v_mul_f32 v113, v206, v113
    v_mul_f32 v114, v206, v114
    v_mul_f32 v115, v206, v115
    v_mul_f32 v116, v206, v116
    v_mul_f32 v117, v206, v117
    v_mul_f32 v118, v206, v118
    v_mul_f32 v119, v206, v119
    v_cvt_pk_bf16_f32 v140, v112, v113
    v_cvt_pk_bf16_f32 v141, v114, v115
    v_cvt_pk_bf16_f32 v142, v116, v117
    v_cvt_pk_bf16_f32 v143, v118, v119
    s_waitcnt lgkmcnt(4)
    v_mfma_f32_16x16x32_bf16 v[32:35], a[0:3], a[152:155], 0
    buffer_store_dwordx4 v[128:131], v240, s[36:39], s77 offen offset:0 sc1
    v_mul_f32 v24, v200, v24
    v_mfma_f32_16x16x32_bf16 v[32:35], a[4:7], a[160:163], v[32:35]
    ds_read_b128 a[32:35], v233 offset:4096
    v_mul_f32 v25, v200, v25
    v_mfma_f32_16x16x32_bf16 v[96:99], a[4:7], a[164:167], 0
    ds_read_b128 a[36:39], v233 offset:14336
    v_mul_f32 v26, v200, v26
    v_mfma_f32_16x16x32_bf16 v[96:99], a[0:3], a[156:159], v[96:99]
    v_mul_f32 v27, v200, v27
    v_mul_f32 v28, v200, v28
    v_mfma_f32_16x16x32_bf16 v[64:67], a[8:11], a[156:159], 0
    ds_read_b128 a[40:43], v230 offset:4096
    v_mul_f32 v29, v200, v29
    v_mfma_f32_16x16x32_bf16 v[64:67], a[12:15], a[164:167], v[64:67]
    ds_read_b128 a[44:47], v230 offset:14336
    v_mul_f32 v30, v200, v30
K1_pg13:
    s_cbranch_execz K1_wb0
    v_mfma_f32_16x16x32_bf16 v[0:3], a[12:15], a[160:163], 0
    v_mul_f32 v31, v200, v31
    v_cvt_pk_bf16_f32 v160, v24, v25
    v_mfma_f32_16x16x32_bf16 v[0:3], a[8:11], a[152:155], v[0:3]
    v_cvt_pk_bf16_f32 v161, v26, v27
    v_cvt_pk_bf16_f32 v162, v28, v29
    s_waitcnt lgkmcnt(4)
    v_mfma_f32_16x16x32_bf16 v[36:39], a[16:19], a[152:155], 0
    ds_read_b128 a[48:51], v233 offset:5120
    v_cvt_pk_bf16_f32 v163, v30, v31
    v_mfma_f32_16x16x32_bf16 v[36:39], a[20:23], a[160:163], v[36:39]
    ds_read_b128 a[52:55], v233 offset:15360
    v_mul_f32 v56, v202, v56
    v_mfma_f32_16x16x32_bf16 v[100:103], a[20:23], a[164:167], 0
    v_mul_f32 v57, v202, v57
    v_mul_f32 v58, v202, v58
    v_mfma_f32_16x16x32_bf16 v[100:103], a[16:19], a[156:159], v[100:103]
    v_mul_f32 v59, v202, v59
    v_mul_f32 v60, v202, v60
    v_mfma_f32_16x16x32_bf16 v[68:71], a[24:27], a[156:159], 0
    ds_read_b128 a[56:59], v230 offset:5120
    v_mul_f32 v61, v202, v61
    v_mfma_f32_16x16x32_bf16 v[68:71], a[28:31], a[164:167], v[68:71]
    ds_read_b128 a[60:63], v230 offset:15360
    v_mul_f32 v62, v202, v62
    v_mfma_f32_16x16x32_bf16 v[4:7], a[28:31], a[160:163], 0
    v_mul_f32 v63, v202, v63
    v_cvt_pk_bf16_f32 v164, v56, v57
    v_mfma_f32_16x16x32_bf16 v[4:7], a[24:27], a[152:155], v[4:7]
    v_cvt_pk_bf16_f32 v165, v58, v59
    v_cvt_pk_bf16_f32 v166, v60, v61
    s_waitcnt lgkmcnt(4)
    v_mfma_f32_16x16x32_bf16 v[40:43], a[32:35], a[152:155], 0
    ds_read_b128 a[0:3], v233 offset:6144
    v_cvt_pk_bf16_f32 v167, v62, v63
    v_mfma_f32_16x16x32_bf16 v[40:43], a[36:39], a[160:163], v[40:43]
    ds_read_b128 a[4:7], v233 offset:16384
    v_mul_f32 v88, v204, v88
    v_mfma_f32_16x16x32_bf16 v[104:107], a[36:39], a[164:167], 0
    v_mul_f32 v89, v204, v89
    v_mul_f32 v90, v204, v90
    v_mfma_f32_16x16x32_bf16 v[104:107], a[32:35], a[156:159], v[104:107]
    v_mul_f32 v91, v204, v91
    v_mul_f32 v92, v204, v92
    v_mfma_f32_16x16x32_bf16 v[72:75], a[40:43], a[156:159], 0
    ds_read_b128 a[8:11], v230 offset:6144
    v_mul_f32 v93, v204, v93
    v_mfma_f32_16x16x32_bf16 v[72:75], a[44:47], a[164:167], v[72:75]
    ds_read_b128 a[12:15], v230 offset:16384
    v_mul_f32 v94, v204, v94
    v_mfma_f32_16x16x32_bf16 v[8:11], a[44:47], a[160:163], 0
    v_mul_f32 v95, v204, v95
    v_cvt_pk_bf16_f32 v168, v88, v89
    v_mfma_f32_16x16x32_bf16 v[8:11], a[40:43], a[152:155], v[8:11]
    v_cvt_pk_bf16_f32 v169, v90, v91
    v_cvt_pk_bf16_f32 v170, v92, v93
    s_barrier
    s_waitcnt lgkmcnt(4)
    v_mfma_f32_16x16x32_bf16 v[44:47], a[48:51], a[152:155], 0
    buffer_store_dwordx4 v[132:135], v240, s[36:39], s77 offen offset:1024 sc1
    s_add_u32 s41, s74, 61440
    v_mfma_f32_16x16x32_bf16 v[44:47], a[52:55], a[160:163], v[44:47]
    ds_read_b128 a[16:19], v233 offset:22528
    s_bfe_u32 s51, 0x1a00178, s18
    v_mfma_f32_16x16x32_bf16 v[108:111], a[52:55], a[164:167], 0
    ds_read_b128 a[20:23], v231 offset:0
    s_lshl_b32 s51, s51, 8
    v_mfma_f32_16x16x32_bf16 v[108:111], a[48:51], a[156:159], v[108:111]
    s_add_u32 m0, s51, s76
    v_cvt_pk_bf16_f32 v171, v94, v95
    v_mul_f32 v120, v206, v120
    v_mfma_f32_16x16x32_bf16 v[76:79], a[56:59], a[156:159], 0
    buffer_load_dwordx4 v240, s[24:27], s41 offen offset:0 sc1 lds
    v_mul_f32 v121, v206, v121
    v_mfma_f32_16x16x32_bf16 v[76:79], a[60:63], a[164:167], v[76:79]
    ds_read_b128 a[24:27], v230 offset:22528
    v_mul_f32 v122, v206, v122
    v_mfma_f32_16x16x32_bf16 v[12:15], a[60:63], a[160:163], 0
    ds_read_b128 a[28:31], v228 offset:0
    v_mul_f32 v123, v206, v123
    v_mfma_f32_16x16x32_bf16 v[12:15], a[56:59], a[152:155], v[12:15]
    buffer_load_dwordx4 v240, s[24:27], s41 offen offset:1024 sc1 lds
    v_mul_f32 v124, v206, v124
    s_waitcnt lgkmcnt(4)
    v_mfma_f32_16x16x32_bf16 v[48:51], a[0:3], a[152:155], 0
    ds_read_b128 a[32:35], v233 offset:23552
    v_mul_f32 v125, v206, v125
    v_mfma_f32_16x16x32_bf16 v[48:51], a[4:7], a[160:163], v[48:51]
    ds_read_b128 a[36:39], v231 offset:1024
    v_mul_f32 v126, v206, v126
    v_mfma_f32_16x16x32_bf16 v[112:115], a[4:7], a[164:167], 0
    buffer_load_dwordx4 v240, s[24:27], s41 offen offset:2048 sc1 lds
    v_mul_f32 v127, v206, v127
    v_mfma_f32_16x16x32_bf16 v[112:115], a[0:3], a[156:159], v[112:115]
    v_cvt_pk_bf16_f32 v172, v120, v121
    v_cvt_pk_bf16_f32 v173, v122, v123
    v_mfma_f32_16x16x32_bf16 v[80:83], a[8:11], a[156:159], 0
    ds_read_b128 a[40:43], v230 offset:23552
    v_cvt_pk_bf16_f32 v174, v124, v125
    v_mfma_f32_16x16x32_bf16 v[80:83], a[12:15], a[164:167], v[80:83]
    buffer_load_dwordx4 v240, s[24:27], s41 offen offset:3072 sc1 lds
    s_add_u32 m0, m0, 4096
    v_mfma_f32_16x16x32_bf16 v[16:19], a[12:15], a[160:163], 0
    ds_read_b128 a[44:47], v228 offset:1024
    v_cvt_pk_bf16_f32 v175, v126, v127
    v_mfma_f32_16x16x32_bf16 v[16:19], a[8:11], a[152:155], v[16:19]
    s_waitcnt lgkmcnt(4)
    v_mfma_f32_16x16x32_bf16 v[32:35], a[16:19], a[168:171], v[32:35]
    buffer_load_dwordx4 v244, s[24:27], s41 offen sc1 lds
    v_mfma_f32_16x16x32_bf16 v[32:35], a[20:23], a[176:179], v[32:35]
    ds_read_b128 a[48:51], v233 offset:24576
    v_mfma_f32_16x16x32_bf16 v[96:99], a[20:23], a[180:183], v[96:99]
    ds_read_b128 a[52:55], v231 offset:2048
    v_mfma_f32_16x16x32_bf16 v[96:99], a[16:19], a[172:175], v[96:99]
    v_mfma_f32_16x16x32_bf16 v[64:67], a[24:27], a[172:175], v[64:67]
    buffer_store_dwordx4 v[136:139], v240, s[36:39], s77 offen offset:2048 sc1
    v_mfma_f32_16x16x32_bf16 v[64:67], a[28:31], a[180:183], v[64:67]
    ds_read_b128 a[56:59], v230 offset:24576
    v_mfma_f32_16x16x32_bf16 v[0:3], a[28:31], a[176:179], v[0:3]
    ds_read_b128 a[60:63], v228 offset:2048
    v_mfma_f32_16x16x32_bf16 v[0:3], a[24:27], a[168:171], v[0:3]
    s_waitcnt lgkmcnt(4)
    v_mfma_f32_16x16x32_bf16 v[36:39], a[32:35], a[168:171], v[36:39]
    ds_read_b128 a[0:3], v233 offset:25600
    v_mfma_f32_16x16x32_bf16 v[36:39], a[36:39], a[176:179], v[36:39]
    ds_read_b128 a[4:7], v231 offset:3072
    v_mfma_f32_16x16x32_bf16 v[100:103], a[36:39], a[180:183], v[100:103]
    v_mfma_f32_16x16x32_bf16 v[100:103], a[32:35], a[172:175], v[100:103]
    v_mfma_f32_16x16x32_bf16 v[68:71], a[40:43], a[172:175], v[68:71]
    ds_read_b128 a[8:11], v230 offset:25600
    v_mfma_f32_16x16x32_bf16 v[68:71], a[44:47], a[180:183], v[68:71]
    ds_read_b128 a[12:15], v228 offset:3072
    v_mfma_f32_16x16x32_bf16 v[4:7], a[44:47], a[176:179], v[4:7]
    v_mfma_f32_16x16x32_bf16 v[4:7], a[40:43], a[168:171], v[4:7]
    s_waitcnt lgkmcnt(4)
    v_mfma_f32_16x16x32_bf16 v[40:43], a[48:51], a[168:171], v[40:43]
    ds_read_b128 a[16:19], v233 offset:26624
    s_waitcnt vmcnt(8)
    v_mfma_f32_16x16x32_bf16 v[40:43], a[52:55], a[176:179], v[40:43]
    buffer_store_dword v234, v245, s[68:71], s52 offen offset:0 sc1
    v_mfma_f32_16x16x32_bf16 v[104:107], a[52:55], a[180:183], v[104:107]
    ds_read_b128 a[20:23], v231 offset:4096
    v_mfma_f32_16x16x32_bf16 v[104:107], a[48:51], a[172:175], v[104:107]
    v_mfma_f32_16x16x32_bf16 v[72:75], a[56:59], a[172:175], v[72:75]
    ds_read_b128 a[24:27], v230 offset:26624
    v_mfma_f32_16x16x32_bf16 v[72:75], a[60:63], a[180:183], v[72:75]
    ds_read_b128 a[28:31], v228 offset:4096
    v_mfma_f32_16x16x32_bf16 v[8:11], a[60:63], a[176:179], v[8:11]
    v_mfma_f32_16x16x32_bf16 v[8:11], a[56:59], a[168:171], v[8:11]
    s_barrier
    s_waitcnt lgkmcnt(4)
    v_mfma_f32_16x16x32_bf16 v[44:47], a[0:3], a[168:171], v[44:47]
    ds_read_b128 a[32:35], v232 offset:0
    s_add_u32 s41, s75, 0
    v_mfma_f32_16x16x32_bf16 v[44:47], a[4:7], a[176:179], v[44:47]
    ds_read_b128 a[36:39], v231 offset:10240
    s_bfe_u32 s51, 0x20801c8, s18
    v_mfma_f32_16x16x32_bf16 v[108:111], a[4:7], a[180:183], v[108:111]
    s_lshl_b32 s51, s51, 8
    s_add_u32 m0, s51, s76
    v_mfma_f32_16x16x32_bf16 v[108:111], a[0:3], a[172:175], v[108:111]
    buffer_load_dwordx4 v240, s[24:27], s41 offen offset:0 sc1 lds
    v_mfma_f32_16x16x32_bf16 v[76:79], a[8:11], a[172:175], v[76:79]
    ds_read_b128 a[40:43], v229 offset:0
    v_mfma_f32_16x16x32_bf16 v[76:79], a[12:15], a[180:183], v[76:79]
    ds_read_b128 a[44:47], v228 offset:10240
    v_mfma_f32_16x16x32_bf16 v[12:15], a[12:15], a[176:179], v[12:15]
    buffer_store_dwordx4 v[140:143], v240, s[36:39], s77 offen offset:3072 sc1
    s_add_u32 s77, s77, 4096
    v_mfma_f32_16x16x32_bf16 v[12:15], a[8:11], a[168:171], v[12:15]
    s_waitcnt lgkmcnt(4)
    v_mfma_f32_16x16x32_bf16 v[48:51], a[16:19], a[168:171], v[48:51]
    ds_read_b128 a[48:51], v232 offset:1024
    v_mfma_f32_16x16x32_bf16 v[48:51], a[20:23], a[176:179], v[48:51]
    ds_read_b128 a[52:55], v231 offset:11264
    v_mfma_f32_16x16x32_bf16 v[112:115], a[20:23], a[180:183], v[112:115]
    buffer_load_dwordx4 v240, s[24:27], s41 offen offset:1024 sc1 lds
    v_mfma_f32_16x16x32_bf16 v[112:115], a[16:19], a[172:175], v[112:115]
    v_mfma_f32_16x16x32_bf16 v[80:83], a[24:27], a[172:175], v[80:83]
    ds_read_b128 a[56:59], v229 offset:1024
    v_mfma_f32_16x16x32_bf16 v[80:83], a[28:31], a[180:183], v[80:83]
    buffer_load_dwordx4 v240, s[24:27], s41 offen offset:2048 sc1 lds
    v_mfma_f32_16x16x32_bf16 v[16:19], a[28:31], a[176:179], v[16:19]
    ds_read_b128 a[60:63], v228 offset:11264
    v_mfma_f32_16x16x32_bf16 v[16:19], a[24:27], a[168:171], v[16:19]
    s_waitcnt lgkmcnt(4)
    v_mfma_f32_16x16x32_bf16 v[32:35], a[32:35], a[184:187], v[32:35]
    buffer_load_dwordx4 v240, s[24:27], s41 offen offset:3072 sc1 lds
    s_add_u32 m0, m0, 4096
    v_mfma_f32_16x16x32_bf16 v[32:35], a[36:39], a[192:195], v[32:35]
    ds_read_b128 a[0:3], v232 offset:2048
    v_mfma_f32_16x16x32_bf16 v[96:99], a[36:39], a[196:199], v[96:99]
    ds_read_b128 a[4:7], v231 offset:12288
    v_mfma_f32_16x16x32_bf16 v[96:99], a[32:35], a[188:191], v[96:99]
    buffer_load_dwordx4 v244, s[24:27], s41 offen sc1 lds
    v_mfma_f32_16x16x32_bf16 v[64:67], a[40:43], a[188:191], v[64:67]
    ds_read_b128 a[8:11], v229 offset:2048
    v_mfma_f32_16x16x32_bf16 v[64:67], a[44:47], a[196:199], v[64:67]
    ds_read_b128 a[12:15], v228 offset:12288
    v_mfma_f32_16x16x32_bf16 v[0:3], a[44:47], a[192:195], v[0:3]
    v_mfma_f32_16x16x32_bf16 v[0:3], a[40:43], a[184:187], v[0:3]
    s_waitcnt lgkmcnt(4)
    v_mfma_f32_16x16x32_bf16 v[36:39], a[48:51], a[184:187], v[36:39]
    buffer_store_dwordx4 v[160:163], v240, s[36:39], s77 offen offset:0 sc1
    v_mfma_f32_16x16x32_bf16 v[36:39], a[52:55], a[192:195], v[36:39]
    ds_read_b128 a[16:19], v232 offset:3072
    v_mfma_f32_16x16x32_bf16 v[100:103], a[52:55], a[196:199], v[100:103]
    ds_read_b128 a[20:23], v231 offset:13312
    v_mfma_f32_16x16x32_bf16 v[100:103], a[48:51], a[188:191], v[100:103]
    v_mfma_f32_16x16x32_bf16 v[68:71], a[56:59], a[188:191], v[68:71]
    ds_read_b128 a[24:27], v229 offset:3072
    v_mfma_f32_16x16x32_bf16 v[68:71], a[60:63], a[196:199], v[68:71]
    ds_read_b128 a[28:31], v228 offset:13312
    v_mfma_f32_16x16x32_bf16 v[4:7], a[60:63], a[192:195], v[4:7]
    v_mfma_f32_16x16x32_bf16 v[4:7], a[56:59], a[184:187], v[4:7]
    s_waitcnt lgkmcnt(4)
    v_mfma_f32_16x16x32_bf16 v[40:43], a[0:3], a[184:187], v[40:43]
    ds_read_b128 a[32:35], v232 offset:4096
    v_mfma_f32_16x16x32_bf16 v[40:43], a[4:7], a[192:195], v[40:43]
    ds_read_b128 a[36:39], v231 offset:14336
    v_mfma_f32_16x16x32_bf16 v[104:107], a[4:7], a[196:199], v[104:107]
    v_mfma_f32_16x16x32_bf16 v[104:107], a[0:3], a[188:191], v[104:107]
    v_mfma_f32_16x16x32_bf16 v[72:75], a[8:11], a[188:191], v[72:75]
    ds_read_b128 a[40:43], v229 offset:4096
    v_mfma_f32_16x16x32_bf16 v[72:75], a[12:15], a[196:199], v[72:75]
    ds_read_b128 a[44:47], v228 offset:14336
    v_mfma_f32_16x16x32_bf16 v[8:11], a[12:15], a[192:195], v[8:11]
    v_mfma_f32_16x16x32_bf16 v[8:11], a[8:11], a[184:187], v[8:11]
    s_barrier
    s_waitcnt lgkmcnt(4)
    v_mfma_f32_16x16x32_bf16 v[44:47], a[16:19], a[184:187], v[44:47]
    ds_read_b128 a[48:51], v231 offset:20480
    s_add_u32 s41, s75, 20480
    v_mfma_f32_16x16x32_bf16 v[44:47], a[20:23], a[192:195], v[44:47]
    ds_read_b128 a[52:55], v232 offset:10240
    s_bfe_u32 s51, 0x2580230, s18
    v_mfma_f32_16x16x32_bf16 v[108:111], a[20:23], a[196:199], v[108:111]
    s_lshl_b32 s51, s51, 8
    s_add_u32 m0, s51, s76
    v_mfma_f32_16x16x32_bf16 v[108:111], a[16:19], a[188:191], v[108:111]
    buffer_load_dwordx4 v240, s[24:27], s41 offen offset:0 sc1 lds
    v_mfma_f32_16x16x32_bf16 v[76:79], a[24:27], a[188:191], v[76:79]
    ds_read_b128 a[56:59], v228 offset:20480
    v_mfma_f32_16x16x32_bf16 v[76:79], a[28:31], a[196:199], v[76:79]
    ds_read_b128 a[60:63], v229 offset:10240
    v_mfma_f32_16x16x32_bf16 v[12:15], a[28:31], a[192:195], v[12:15]
    buffer_load_dwordx4 v240, s[24:27], s41 offen offset:1024 sc1 lds
    v_mfma_f32_16x16x32_bf16 v[12:15], a[24:27], a[184:187], v[12:15]
    s_waitcnt lgkmcnt(4)
    v_mfma_f32_16x16x32_bf16 v[48:51], a[32:35], a[184:187], v[48:51]
    ds_read_b128 a[0:3], v231 offset:21504
    v_mfma_f32_16x16x32_bf16 v[48:51], a[36:39], a[192:195], v[48:51]
    buffer_store_dwordx4 v[164:167], v240, s[36:39], s77 offen offset:1024 sc1
    v_mfma_f32_16x16x32_bf16 v[112:115], a[36:39], a[196:199], v[112:115]
    ds_read_b128 a[4:7], v232 offset:11264
    v_mfma_f32_16x16x32_bf16 v[112:115], a[32:35], a[188:191], v[112:115]
    v_mfma_f32_16x16x32_bf16 v[80:83], a[40:43], a[188:191], v[80:83]
    ds_read_b128 a[8:11], v228 offset:21504
    v_mfma_f32_16x16x32_bf16 v[80:83], a[44:47], a[196:199], v[80:83]
    buffer_load_dwordx4 v240, s[24:27], s41 offen offset:2048 sc1 lds
    v_mfma_f32_16x16x32_bf16 v[16:19], a[44:47], a[192:195], v[16:19]
    ds_read_b128 a[12:15], v229 offset:11264
    v_mfma_f32_16x16x32_bf16 v[16:19], a[40:43], a[184:187], v[16:19]
    s_waitcnt lgkmcnt(4)
    v_mfma_f32_16x16x32_bf16 v[32:35], a[48:51], a[200:203], v[32:35]
    buffer_load_dwordx4 v240, s[24:27], s41 offen offset:3072 sc1 lds
    s_add_u32 m0, m0, 4096
    v_mfma_f32_16x16x32_bf16 v[32:35], a[52:55], a[208:211], v[32:35]
    ds_read_b128 a[16:19], v231 offset:22528
    v_mfma_f32_16x16x32_bf16 v[96:99], a[52:55], a[212:215], v[96:99]
    ds_read_b128 a[20:23], v232 offset:12288
    v_mfma_f32_16x16x32_bf16 v[96:99], a[48:51], a[204:207], v[96:99]
    buffer_load_dwordx4 v244, s[24:27], s41 offen sc1 lds
    v_mfma_f32_16x16x32_bf16 v[64:67], a[56:59], a[204:207], v[64:67]
    ds_read_b128 a[24:27], v228 offset:22528
    v_mfma_f32_16x16x32_bf16 v[64:67], a[60:63], a[212:215], v[64:67]
    ds_read_b128 a[28:31], v229 offset:12288
    v_mfma_f32_16x16x32_bf16 v[0:3], a[60:63], a[208:211], v[0:3]
    v_mfma_f32_16x16x32_bf16 v[0:3], a[56:59], a[200:203], v[0:3]
    s_waitcnt lgkmcnt(4)
    v_mfma_f32_16x16x32_bf16 v[36:39], a[0:3], a[200:203], v[36:39]
    ds_read_b128 a[32:35], v231 offset:23552
    v_mfma_f32_16x16x32_bf16 v[36:39], a[4:7], a[208:211], v[36:39]
    ds_read_b128 a[36:39], v232 offset:13312
    v_mfma_f32_16x16x32_bf16 v[100:103], a[4:7], a[212:215], v[100:103]
    v_mfma_f32_16x16x32_bf16 v[100:103], a[0:3], a[204:207], v[100:103]
    v_mfma_f32_16x16x32_bf16 v[68:71], a[8:11], a[204:207], v[68:71]
    buffer_store_dwordx4 v[168:171], v240, s[36:39], s77 offen offset:2048 sc1
    v_mfma_f32_16x16x32_bf16 v[68:71], a[12:15], a[212:215], v[68:71]
    ds_read_b128 a[40:43], v228 offset:23552
    v_mfma_f32_16x16x32_bf16 v[4:7], a[12:15], a[208:211], v[4:7]
    ds_read_b128 a[44:47], v229 offset:13312
    v_mfma_f32_16x16x32_bf16 v[4:7], a[8:11], a[200:203], v[4:7]
    s_waitcnt lgkmcnt(4)
    v_mfma_f32_16x16x32_bf16 v[40:43], a[16:19], a[200:203], v[40:43]
    ds_read_b128 a[48:51], v231 offset:24576
    v_mfma_f32_16x16x32_bf16 v[40:43], a[20:23], a[208:211], v[40:43]
    ds_read_b128 a[52:55], v232 offset:14336
    v_mfma_f32_16x16x32_bf16 v[104:107], a[20:23], a[212:215], v[104:107]
    v_mfma_f32_16x16x32_bf16 v[104:107], a[16:19], a[204:207], v[104:107]
    v_mfma_f32_16x16x32_bf16 v[72:75], a[24:27], a[204:207], v[72:75]
    ds_read_b128 a[56:59], v228 offset:24576
    v_mfma_f32_16x16x32_bf16 v[72:75], a[28:31], a[212:215], v[72:75]
    ds_read_b128 a[60:63], v229 offset:14336
    v_mfma_f32_16x16x32_bf16 v[8:11], a[28:31], a[208:211], v[8:11]
    v_mfma_f32_16x16x32_bf16 v[8:11], a[24:27], a[200:203], v[8:11]
    s_barrier
    s_waitcnt lgkmcnt(4)
    v_mfma_f32_16x16x32_bf16 v[44:47], a[32:35], a[200:203], v[44:47]
    buffer_load_dword v252, v253, s[68:71], s53 offen sc1
    s_add_u32 s41, s75, 40960
    v_mfma_f32_16x16x32_bf16 v[44:47], a[36:39], a[208:211], v[44:47]
    ds_read_b128 a[0:3], v232 offset:20480
    s_bfe_u32 s51, 0x1000000, s18
    v_mfma_f32_16x16x32_bf16 v[108:111], a[36:39], a[212:215], v[108:111]
    ds_read_b128 a[4:7], v231 offset:55296
    s_lshl_b32 s51, s51, 8
    v_mfma_f32_16x16x32_bf16 v[108:111], a[32:35], a[204:207], v[108:111]
    s_add_u32 m0, s51, s76
    v_mfma_f32_16x16x32_bf16 v[76:79], a[40:43], a[204:207], v[76:79]
    buffer_load_dwordx4 v240, s[24:27], s41 offen offset:0 sc1 lds
    v_mfma_f32_16x16x32_bf16 v[76:79], a[44:47], a[212:215], v[76:79]
    ds_read_b128 a[8:11], v229 offset:20480
    v_mfma_f32_16x16x32_bf16 v[12:15], a[44:47], a[208:211], v[12:15]
    ds_read_b128 a[12:15], v228 offset:55296
    v_mfma_f32_16x16x32_bf16 v[12:15], a[40:43], a[200:203], v[12:15]
    buffer_load_dwordx4 v240, s[24:27], s41 offen offset:1024 sc1 lds
    s_waitcnt lgkmcnt(4)
    v_mfma_f32_16x16x32_bf16 v[48:51], a[48:51], a[200:203], v[48:51]
    ds_read_b128 a[16:19], v232 offset:21504
    v_mfma_f32_16x16x32_bf16 v[48:51], a[52:55], a[208:211], v[48:51]
    ds_read_b128 a[20:23], v231 offset:56320
    v_mfma_f32_16x16x32_bf16 v[112:115], a[52:55], a[212:215], v[112:115]
    buffer_load_dwordx4 v240, s[24:27], s41 offen offset:2048 sc1 lds
    v_mfma_f32_16x16x32_bf16 v[112:115], a[48:51], a[204:207], v[112:115]
    v_mfma_f32_16x16x32_bf16 v[80:83], a[56:59], a[204:207], v[80:83]
    ds_read_b128 a[24:27], v229 offset:21504
    v_mfma_f32_16x16x32_bf16 v[80:83], a[60:63], a[212:215], v[80:83]
    buffer_store_dwordx4 v[172:175], v240, s[36:39], s77 offen offset:3072 sc1
    s_add_u32 s77, s77, 4096
    v_mfma_f32_16x16x32_bf16 v[16:19], a[60:63], a[208:211], v[16:19]
    ds_read_b128 a[28:31], v228 offset:56320
    v_mfma_f32_16x16x32_bf16 v[16:19], a[56:59], a[200:203], v[16:19]
    s_waitcnt lgkmcnt(4)
    v_mfma_f32_16x16x32_bf16 v[32:35], a[0:3], a[216:219], v[32:35]
    ds_read_b128 a[32:35], v232 offset:22528
    v_mfma_f32_16x16x32_bf16 v[32:35], a[4:7], a[224:227], v[32:35]
    buffer_load_dwordx4 v240, s[24:27], s41 offen offset:3072 sc1 lds
    s_add_u32 m0, m0, 4096
    v_mfma_f32_16x16x32_bf16 v[96:99], a[4:7], a[228:231], v[96:99]
    ds_read_b128 a[36:39], v231 offset:57344
    v_mfma_f32_16x16x32_bf16 v[96:99], a[0:3], a[220:223], v[96:99]
    v_mfma_f32_16x16x32_bf16 v[64:67], a[8:11], a[220:223], v[64:67]
    buffer_load_dwordx4 v244, s[24:27], s41 offen sc1 lds
    v_mfma_f32_16x16x32_bf16 v[64:67], a[12:15], a[228:231], v[64:67]
    ds_read_b128 a[40:43], v229 offset:22528
    v_mfma_f32_16x16x32_bf16 v[0:3], a[12:15], a[224:227], v[0:3]
    ds_read_b128 a[44:47], v228 offset:57344
    v_mfma_f32_16x16x32_bf16 v[0:3], a[8:11], a[216:219], v[0:3]
    s_waitcnt lgkmcnt(4)
    v_mfma_f32_16x16x32_bf16 v[36:39], a[16:19], a[216:219], v[36:39]
    ds_read_b128 a[48:51], v232 offset:23552
    v_mfma_f32_16x16x32_bf16 v[36:39], a[20:23], a[224:227], v[36:39]
    ds_read_b128 a[52:55], v231 offset:58368
    v_mfma_f32_16x16x32_bf16 v[100:103], a[20:23], a[228:231], v[100:103]
    v_mfma_f32_16x16x32_bf16 v[100:103], a[16:19], a[220:223], v[100:103]
    v_mfma_f32_16x16x32_bf16 v[68:71], a[24:27], a[220:223], v[68:71]
    ds_read_b128 a[56:59], v229 offset:23552
    v_mfma_f32_16x16x32_bf16 v[68:71], a[28:31], a[228:231], v[68:71]
    ds_read_b128 a[60:63], v228 offset:58368
    v_mfma_f32_16x16x32_bf16 v[4:7], a[28:31], a[224:227], v[4:7]
    v_mfma_f32_16x16x32_bf16 v[4:7], a[24:27], a[216:219], v[4:7]
    s_waitcnt vmcnt(6)
    v_cmp_ne_u32 vcc, s0, v252
    s_nop 1
    s_cbranch_vccnz K1_spin_done
K1_done_ok:
    s_waitcnt lgkmcnt(4)
    v_mfma_f32_16x16x32_bf16 v[40:43], a[32:35], a[216:219], v[40:43]
    ds_read_b128 a[0:3], v232 offset:24576
    s_add_u32 s42, s73, 0
    v_mfma_f32_16x16x32_bf16 v[40:43], a[36:39], a[224:227], v[40:43]
    buffer_load_dwordx4 a[152:155], v242, s[20:23], s42 offen sc1
    v_mfma_f32_16x16x32_bf16 v[104:107], a[36:39], a[228:231], v[104:107]
    ds_read_b128 a[4:7], v231 offset:59392
    v_mfma_f32_16x16x32_bf16 v[104:107], a[32:35], a[220:223], v[104:107]
    v_mfma_f32_16x16x32_bf16 v[72:75], a[40:43], a[220:223], v[72:75]
    buffer_load_dwordx4 a[156:159], v243, s[20:23], s42 offen sc1
    s_add_u32 s42, s73, 4096
    v_mfma_f32_16x16x32_bf16 v[72:75], a[44:47], a[228:231], v[72:75]
    ds_read_b128 a[8:11], v229 offset:24576
    v_mfma_f32_16x16x32_bf16 v[8:11], a[44:47], a[224:227], v[8:11]
    ds_read_b128 a[12:15], v228 offset:59392
    v_mfma_f32_16x16x32_bf16 v[8:11], a[40:43], a[216:219], v[8:11]
    buffer_load_dwordx4 a[160:163], v242, s[20:23], s42 offen sc1
    s_barrier
    s_waitcnt lgkmcnt(4)
    v_mfma_f32_16x16x32_bf16 v[44:47], a[48:51], a[216:219], v[44:47]
    ds_read_b128 a[16:19], v231 offset:30720
    v_mfma_f32_16x16x32_bf16 v[44:47], a[52:55], a[224:227], v[44:47]
    ds_read_b128 a[20:23], v231 offset:40960
    v_mfma_f32_16x16x32_bf16 v[108:111], a[52:55], a[228:231], v[108:111]
    buffer_load_dwordx4 a[164:167], v243, s[20:23], s42 offen sc1
    s_add_u32 s42, s73, 16384
    v_mfma_f32_16x16x32_bf16 v[108:111], a[48:51], a[220:223], v[108:111]
    v_mfma_f32_16x16x32_bf16 v[76:79], a[56:59], a[220:223], v[76:79]
    ds_read_b128 a[24:27], v228 offset:30720
    v_mfma_f32_16x16x32_bf16 v[76:79], a[60:63], a[228:231], v[76:79]
    buffer_load_dwordx4 a[168:171], v242, s[20:23], s42 offen sc1
    v_mfma_f32_16x16x32_bf16 v[12:15], a[60:63], a[224:227], v[12:15]
    ds_read_b128 a[28:31], v228 offset:40960
    v_mfma_f32_16x16x32_bf16 v[12:15], a[56:59], a[216:219], v[12:15]
    s_waitcnt lgkmcnt(4)
    v_mfma_f32_16x16x32_bf16 v[48:51], a[0:3], a[216:219], v[48:51]
    buffer_load_dwordx4 a[172:175], v243, s[20:23], s42 offen sc1
    s_add_u32 s42, s73, 20480
    v_mfma_f32_16x16x32_bf16 v[48:51], a[4:7], a[224:227], v[48:51]
    ds_read_b128 a[32:35], v231 offset:31744
    v_mfma_f32_16x16x32_bf16 v[112:115], a[4:7], a[228:231], v[112:115]
    ds_read_b128 a[36:39], v231 offset:41984
    v_mfma_f32_16x16x32_bf16 v[112:115], a[0:3], a[220:223], v[112:115]
    buffer_load_dwordx4 a[176:179], v242, s[20:23], s42 offen sc1
    v_mfma_f32_16x16x32_bf16 v[80:83], a[8:11], a[220:223], v[80:83]
    ds_read_b128 a[40:43], v228 offset:31744
    v_mfma_f32_16x16x32_bf16 v[80:83], a[12:15], a[228:231], v[80:83]
    ds_read_b128 a[44:47], v228 offset:41984
    v_mfma_f32_16x16x32_bf16 v[16:19], a[12:15], a[224:227], v[16:19]
    buffer_load_dwordx4 a[180:183], v243, s[20:23], s42 offen sc1
    s_add_u32 s42, s73, 32768
    v_mfma_f32_16x16x32_bf16 v[16:19], a[8:11], a[216:219], v[16:19]
    s_waitcnt lgkmcnt(4)
    v_mfma_f32_16x16x32_bf16 v[32:35], a[16:19], a[232:235], v[32:35]
    ds_read_b128 a[48:51], v231 offset:32768
    v_mfma_f32_16x16x32_bf16 v[32:35], a[20:23], a[240:243], v[32:35]
    buffer_load_dwordx4 a[184:187], v242, s[20:23], s42 offen sc1
    v_mfma_f32_16x16x32_bf16 v[96:99], a[20:23], a[244:247], v[96:99]
    ds_read_b128 a[52:55], v231 offset:43008
    v_mfma_f32_16x16x32_bf16 v[96:99], a[16:19], a[236:239], v[96:99]
    v_mfma_f32_16x16x32_bf16 v[64:67], a[24:27], a[236:239], v[64:67]
    buffer_load_dwordx4 a[188:191], v243, s[20:23], s42 offen sc1
    s_add_u32 s42, s73, 36864
    v_mfma_f32_16x16x32_bf16 v[64:67], a[28:31], a[244:247], v[64:67]
    ds_read_b128 a[56:59], v228 offset:32768
    v_mfma_f32_16x16x32_bf16 v[0:3], a[28:31], a[240:243], v[0:3]
    ds_read_b128 a[60:63], v228 offset:43008
    v_mfma_f32_16x16x32_bf16 v[0:3], a[24:27], a[232:235], v[0:3]
    buffer_load_dwordx4 a[192:195], v242, s[20:23], s42 offen sc1
    s_waitcnt lgkmcnt(4)
    v_mfma_f32_16x16x32_bf16 v[36:39], a[32:35], a[232:235], v[36:39]
    ds_read_b128 a[0:3], v231 offset:33792
    v_mfma_f32_16x16x32_bf16 v[36:39], a[36:39], a[240:243], v[36:39]
    ds_read_b128 a[4:7], v231 offset:44032
    v_mfma_f32_16x16x32_bf16 v[100:103], a[36:39], a[244:247], v[100:103]
    buffer_load_dwordx4 a[196:199], v243, s[20:23], s42 offen sc1
    s_add_u32 s42, s73, 49152
    v_mfma_f32_16x16x32_bf16 v[100:103], a[32:35], a[236:239], v[100:103]
    v_mfma_f32_16x16x32_bf16 v[68:71], a[40:43], a[236:239], v[68:71]
    ds_read_b128 a[8:11], v228 offset:33792
    v_mfma_f32_16x16x32_bf16 v[68:71], a[44:47], a[244:247], v[68:71]
    buffer_load_dwordx4 a[200:203], v242, s[20:23], s42 offen sc1
    v_mfma_f32_16x16x32_bf16 v[4:7], a[44:47], a[240:243], v[4:7]
    ds_read_b128 a[12:15], v228 offset:44032
    v_mfma_f32_16x16x32_bf16 v[4:7], a[40:43], a[232:235], v[4:7]
    s_waitcnt lgkmcnt(4)
    v_mfma_f32_16x16x32_bf16 v[40:43], a[48:51], a[232:235], v[40:43]
    buffer_load_dwordx4 a[204:207], v243, s[20:23], s42 offen sc1
    s_add_u32 s42, s73, 53248
    v_mfma_f32_16x16x32_bf16 v[40:43], a[52:55], a[240:243], v[40:43]
    ds_read_b128 a[16:19], v231 offset:34816
    v_mfma_f32_16x16x32_bf16 v[104:107], a[52:55], a[244:247], v[104:107]
    ds_read_b128 a[20:23], v231 offset:45056
    v_mfma_f32_16x16x32_bf16 v[104:107], a[48:51], a[236:239], v[104:107]
    buffer_load_dwordx4 a[208:211], v242, s[20:23], s42 offen sc1
    v_mfma_f32_16x16x32_bf16 v[72:75], a[56:59], a[236:239], v[72:75]
    ds_read_b128 a[24:27], v228 offset:34816
    v_mfma_f32_16x16x32_bf16 v[72:75], a[60:63], a[244:247], v[72:75]
    ds_read_b128 a[28:31], v228 offset:45056
    v_mfma_f32_16x16x32_bf16 v[8:11], a[60:63], a[240:243], v[8:11]
    buffer_load_dwordx4 a[212:215], v243, s[20:23], s42 offen sc1
    s_add_u32 s41, s75, 61440
    v_mfma_f32_16x16x32_bf16 v[8:11], a[56:59], a[232:235], v[8:11]
    s_bfe_u32 s51, 0x500028, s18
    s_lshl_b32 s51, s51, 8
    s_add_u32 m0, s51, s76
    s_barrier
    s_waitcnt lgkmcnt(4)
    v_mfma_f32_16x16x32_bf16 v[44:47], a[0:3], a[232:235], v[44:47]
    ds_read_b128 a[32:35], v232 offset:30720
    v_mfma_f32_16x16x32_bf16 v[44:47], a[4:7], a[240:243], v[44:47]
    buffer_load_dwordx4 v240, s[24:27], s41 offen offset:0 sc1 lds
    v_mfma_f32_16x16x32_bf16 v[108:111], a[4:7], a[244:247], v[108:111]
    ds_read_b128 a[36:39], v232 offset:40960
    v_mfma_f32_16x16x32_bf16 v[108:111], a[0:3], a[236:239], v[108:111]
    v_mfma_f32_16x16x32_bf16 v[76:79], a[8:11], a[236:239], v[76:79]
    buffer_load_dwordx4 v240, s[24:27], s41 offen offset:1024 sc1 lds
    v_mfma_f32_16x16x32_bf16 v[76:79], a[12:15], a[244:247], v[76:79]
    ds_read_b128 a[40:43], v229 offset:30720
    v_mfma_f32_16x16x32_bf16 v[12:15], a[12:15], a[240:243], v[12:15]
    ds_read_b128 a[44:47], v229 offset:40960
    v_mfma_f32_16x16x32_bf16 v[12:15], a[8:11], a[232:235], v[12:15]
    buffer_load_dwordx4 v240, s[24:27], s41 offen offset:2048 sc1 lds
    s_waitcnt lgkmcnt(4)
    v_mfma_f32_16x16x32_bf16 v[48:51], a[16:19], a[232:235], v[48:51]
    ds_read_b128 a[48:51], v232 offset:31744
    v_mfma_f32_16x16x32_bf16 v[48:51], a[20:23], a[240:243], v[48:51]
    ds_read_b128 a[52:55], v232 offset:41984
    v_mfma_f32_16x16x32_bf16 v[112:115], a[20:23], a[244:247], v[112:115]
    buffer_load_dwordx4 v240, s[24:27], s41 offen offset:3072 sc1 lds
    s_add_u32 m0, m0, 4096
    v_mfma_f32_16x16x32_bf16 v[112:115], a[16:19], a[236:239], v[112:115]
    v_mfma_f32_16x16x32_bf16 v[80:83], a[24:27], a[236:239], v[80:83]
    ds_read_b128 a[56:59], v229 offset:31744
    v_mfma_f32_16x16x32_bf16 v[80:83], a[28:31], a[244:247], v[80:83]
    buffer_load_dwordx4 v244, s[24:27], s41 offen sc1 lds
    s_add_u32 s41, s75, 81920
    v_mfma_f32_16x16x32_bf16 v[16:19], a[28:31], a[240:243], v[16:19]
    ds_read_b128 a[60:63], v229 offset:41984
    s_bfe_u32 s51, 0x1500128, s18
    v_mfma_f32_16x16x32_bf16 v[16:19], a[24:27], a[232:235], v[16:19]
    s_lshl_b32 s51, s51, 8
    s_add_u32 m0, s51, s76
    s_waitcnt lgkmcnt(4)
    v_mfma_f32_16x16x32_bf16 v[32:35], a[32:35], a[248:251], v[32:35]
    ds_read_b128 a[0:3], v232 offset:32768
    s_waitcnt vmcnt(23)
    v_mfma_f32_16x16x32_bf16 v[32:35], a[36:39], a[144:147], v[32:35]
    buffer_store_dword v234, v245, s[68:71], s52 offen offset:4 sc1
    s_add_u32 s42, s73, 65536
    v_mfma_f32_16x16x32_bf16 v[96:99], a[36:39], a[148:151], v[96:99]
    ds_read_b128 a[4:7], v232 offset:43008
    v_mfma_f32_16x16x32_bf16 v[96:99], a[32:35], a[252:255], v[96:99]
    v_mfma_f32_16x16x32_bf16 v[64:67], a[40:43], a[252:255], v[64:67]
    buffer_load_dwordx4 a[216:219], v242, s[20:23], s42 offen sc1
    v_mfma_f32_16x16x32_bf16 v[64:67], a[44:47], a[148:151], v[64:67]
    ds_read_b128 a[8:11], v229 offset:32768
    v_mfma_f32_16x16x32_bf16 v[0:3], a[44:47], a[144:147], v[0:3]
    ds_read_b128 a[12:15], v229 offset:43008
    v_mfma_f32_16x16x32_bf16 v[0:3], a[40:43], a[248:251], v[0:3]
    buffer_load_dwordx4 a[220:223], v243, s[20:23], s42 offen sc1
    s_add_u32 s42, s73, 69632
    s_waitcnt lgkmcnt(4)
    v_mfma_f32_16x16x32_bf16 v[36:39], a[48:51], a[248:251], v[36:39]
    ds_read_b128 a[16:19], v232 offset:33792
    v_mfma_f32_16x16x32_bf16 v[36:39], a[52:55], a[144:147], v[36:39]
    ds_read_b128 a[20:23], v232 offset:44032
    v_mfma_f32_16x16x32_bf16 v[100:103], a[52:55], a[148:151], v[100:103]
    buffer_load_dwordx4 a[224:227], v242, s[20:23], s42 offen sc1
    v_mfma_f32_16x16x32_bf16 v[100:103], a[48:51], a[252:255], v[100:103]
K1_pg14:
    s_cbranch_execz K1_wb0
    v_mfma_f32_16x16x32_bf16 v[68:71], a[56:59], a[252:255], v[68:71]
    ds_read_b128 a[24:27], v229 offset:33792
    v_mfma_f32_16x16x32_bf16 v[68:71], a[60:63], a[148:151], v[68:71]
    buffer_load_dwordx4 a[228:231], v243, s[20:23], s42 offen sc1
    v_mfma_f32_16x16x32_bf16 v[4:7], a[60:63], a[144:147], v[4:7]
    ds_read_b128 a[28:31], v229 offset:44032
    v_mfma_f32_16x16x32_bf16 v[4:7], a[56:59], a[248:251], v[4:7]
    s_waitcnt lgkmcnt(4)
    v_mfma_f32_16x16x32_bf16 v[40:43], a[0:3], a[248:251], v[40:43]
    buffer_load_dwordx4 v240, s[24:27], s41 offen offset:0 sc1 lds
    v_mfma_f32_16x16x32_bf16 v[40:43], a[4:7], a[144:147], v[40:43]
    ds_read_b128 a[32:35], v232 offset:34816
    v_mfma_f32_16x16x32_bf16 v[104:107], a[4:7], a[148:151], v[104:107]
    ds_read_b128 a[36:39], v232 offset:45056
    v_mfma_f32_16x16x32_bf16 v[104:107], a[0:3], a[252:255], v[104:107]
    buffer_load_dwordx4 v240, s[24:27], s41 offen offset:1024 sc1 lds
    v_mfma_f32_16x16x32_bf16 v[72:75], a[8:11], a[252:255], v[72:75]
    ds_read_b128 a[40:43], v229 offset:34816
    v_mfma_f32_16x16x32_bf16 v[72:75], a[12:15], a[148:151], v[72:75]
    ds_read_b128 a[44:47], v229 offset:45056
    v_mfma_f32_16x16x32_bf16 v[8:11], a[12:15], a[144:147], v[8:11]
    buffer_load_dwordx4 v240, s[24:27], s41 offen offset:2048 sc1 lds
    v_mfma_f32_16x16x32_bf16 v[8:11], a[8:11], a[248:251], v[8:11]
    s_barrier
    s_waitcnt lgkmcnt(4)
    v_mfma_f32_16x16x32_bf16 v[44:47], a[16:19], a[248:251], v[44:47]
    ds_read_b128 a[48:51], v232 offset:51200
    v_mfma_f32_16x16x32_bf16 v[44:47], a[20:23], a[144:147], v[44:47]
    buffer_load_dwordx4 v240, s[24:27], s41 offen offset:3072 sc1 lds
    s_add_u32 m0, m0, 4096
    v_mfma_f32_16x16x32_bf16 v[108:111], a[20:23], a[148:151], v[108:111]
    ds_read_b128 a[52:55], v233 offset:2048
    v_mfma_f32_16x16x32_bf16 v[108:111], a[16:19], a[252:255], v[108:111]
    v_mfma_f32_16x16x32_bf16 v[76:79], a[24:27], a[252:255], v[76:79]
    buffer_load_dwordx4 v244, s[24:27], s41 offen sc1 lds
    s_add_u32 s41, s75, 102400
    v_mfma_f32_16x16x32_bf16 v[76:79], a[28:31], a[148:151], v[76:79]
    ds_read_b128 a[56:59], v229 offset:51200
    s_bfe_u32 s51, 0x7800d8, s18
    v_mfma_f32_16x16x32_bf16 v[12:15], a[28:31], a[144:147], v[12:15]
    ds_read_b128 a[60:63], v230 offset:2048
    s_lshl_b32 s51, s51, 8
    v_mfma_f32_16x16x32_bf16 v[12:15], a[24:27], a[248:251], v[12:15]
    s_add_u32 m0, s51, s76
    s_waitcnt lgkmcnt(4)
    v_mfma_f32_16x16x32_bf16 v[48:51], a[32:35], a[248:251], v[48:51]
    buffer_load_dwordx4 v240, s[24:27], s41 offen offset:0 sc1 lds
    v_mfma_f32_16x16x32_bf16 v[48:51], a[36:39], a[144:147], v[48:51]
    ds_read_b128 a[0:3], v232 offset:52224
    v_mfma_f32_16x16x32_bf16 v[112:115], a[36:39], a[148:151], v[112:115]
    ds_read_b128 a[4:7], v233 offset:3072
    v_mfma_f32_16x16x32_bf16 v[112:115], a[32:35], a[252:255], v[112:115]
    buffer_load_dwordx4 v240, s[24:27], s41 offen offset:1024 sc1 lds
    v_mfma_f32_16x16x32_bf16 v[80:83], a[40:43], a[252:255], v[80:83]
    ds_read_b128 a[8:11], v229 offset:52224
    v_mfma_f32_16x16x32_bf16 v[80:83], a[44:47], a[148:151], v[80:83]
    ds_read_b128 a[12:15], v230 offset:3072
    v_mfma_f32_16x16x32_bf16 v[16:19], a[44:47], a[144:147], v[16:19]
    buffer_load_dwordx4 v240, s[24:27], s41 offen offset:2048 sc1 lds
    v_mfma_f32_16x16x32_bf16 v[16:19], a[40:43], a[248:251], v[16:19]
    s_waitcnt vmcnt(30) lgkmcnt(4)
    v_mfma_f32_16x16x32_bf16 v[148:151], a[48:51], a[152:155], 0
    ds_read_b128 a[16:19], v232 offset:53248
    s_add_u32 s42, s73, 81920
    v_mfma_f32_16x16x32_bf16 v[148:151], a[52:55], a[160:163], v[148:151]
    buffer_load_dwordx4 a[232:235], v242, s[20:23], s42 offen sc1
    v_mfma_f32_16x16x32_bf16 v[188:191], a[52:55], a[164:167], 0
    ds_read_b128 a[20:23], v233 offset:4096
    v_mfma_f32_16x16x32_bf16 v[188:191], a[48:51], a[156:159], v[188:191]
    v_mfma_f32_16x16x32_bf16 v[168:171], a[56:59], a[156:159], 0
    buffer_load_dwordx4 a[236:239], v243, s[20:23], s42 offen sc1
    s_add_u32 s42, s73, 86016
    v_mfma_f32_16x16x32_bf16 v[168:171], a[60:63], a[164:167], v[168:171]
    ds_read_b128 a[24:27], v229 offset:53248
    v_mfma_f32_16x16x32_bf16 v[128:131], a[60:63], a[160:163], 0
    ds_read_b128 a[28:31], v230 offset:4096
    v_mfma_f32_16x16x32_bf16 v[128:131], a[56:59], a[152:155], v[128:131]
    buffer_load_dwordx4 a[240:243], v242, s[20:23], s42 offen sc1
    s_waitcnt lgkmcnt(4)
    v_mfma_f32_16x16x32_bf16 v[152:155], a[0:3], a[152:155], 0
    ds_read_b128 a[32:35], v232 offset:54272
    v_mfma_f32_16x16x32_bf16 v[152:155], a[4:7], a[160:163], v[152:155]
    ds_read_b128 a[36:39], v233 offset:5120
    v_mfma_f32_16x16x32_bf16 v[192:195], a[4:7], a[164:167], 0
    buffer_load_dwordx4 a[244:247], v243, s[20:23], s42 offen sc1
    v_mfma_f32_16x16x32_bf16 v[192:195], a[0:3], a[156:159], v[192:195]
    v_mfma_f32_16x16x32_bf16 v[172:175], a[8:11], a[156:159], 0
    ds_read_b128 a[40:43], v229 offset:54272
    v_cvt_pk_bf16_f32 v32, v32, v33
    v_mfma_f32_16x16x32_bf16 v[172:175], a[12:15], a[164:167], v[172:175]
    buffer_load_dwordx4 v240, s[24:27], s41 offen offset:3072 sc1 lds
    s_add_u32 m0, m0, 4096
    v_mfma_f32_16x16x32_bf16 v[132:135], a[12:15], a[160:163], 0
    ds_read_b128 a[44:47], v230 offset:5120
    v_cvt_pk_bf16_f32 v33, v34, v35
    v_mfma_f32_16x16x32_bf16 v[132:135], a[8:11], a[152:155], v[132:135]
    v_cvt_pk_bf16_f32 v34, v36, v37
    v_cvt_pk_bf16_f32 v35, v38, v39
    s_waitcnt lgkmcnt(4)
    v_mfma_f32_16x16x32_bf16 v[156:159], a[16:19], a[152:155], 0
    buffer_load_dwordx4 v244, s[24:27], s41 offen sc1 lds
    v_cvt_pk_bf16_f32 v36, v40, v41
    v_mfma_f32_16x16x32_bf16 v[156:159], a[20:23], a[160:163], v[156:159]
    ds_read_b128 a[48:51], v232 offset:55296
    v_cvt_pk_bf16_f32 v37, v42, v43
    v_mfma_f32_16x16x32_bf16 v[196:199], a[20:23], a[164:167], 0
    ds_read_b128 a[52:55], v233 offset:6144
    v_cvt_pk_bf16_f32 v38, v44, v45
    v_mfma_f32_16x16x32_bf16 v[196:199], a[16:19], a[156:159], v[196:199]
    v_cvt_pk_bf16_f32 v39, v46, v47
    v_cvt_pk_bf16_f32 v40, v48, v49
    v_mfma_f32_16x16x32_bf16 v[176:179], a[24:27], a[156:159], 0
    ds_read_b128 a[56:59], v229 offset:55296
    v_cvt_pk_bf16_f32 v41, v50, v51
    v_mfma_f32_16x16x32_bf16 v[176:179], a[28:31], a[164:167], v[176:179]
    ds_read_b128 a[60:63], v230 offset:6144
    v_cvt_pk_bf16_f32 v42, v112, v113
    v_mfma_f32_16x16x32_bf16 v[136:139], a[28:31], a[160:163], 0
    v_cvt_pk_bf16_f32 v43, v114, v115
    v_cvt_pk_bf16_f32 v44, v96, v97
    v_mfma_f32_16x16x32_bf16 v[136:139], a[24:27], a[152:155], v[136:139]
    v_cvt_pk_bf16_f32 v45, v98, v99
    v_cvt_pk_bf16_f32 v46, v100, v101
    s_barrier
    s_waitcnt lgkmcnt(4)
    v_mfma_f32_16x16x32_bf16 v[160:163], a[32:35], a[152:155], 0
    ds_read_b128 a[0:3], v233 offset:12288
    s_add_u32 s41, s75, 122880
    v_mfma_f32_16x16x32_bf16 v[160:163], a[36:39], a[160:163], v[160:163]
    ds_read_b128 a[4:7], v233 offset:22528
    s_bfe_u32 s51, 0x17800a0, s18
    v_mfma_f32_16x16x32_bf16 v[200:203], a[36:39], a[164:167], 0
    s_lshl_b32 s51, s51, 8
    s_add_u32 m0, s51, s76
    v_cvt_pk_bf16_f32 v47, v102, v103
    v_mfma_f32_16x16x32_bf16 v[200:203], a[32:35], a[156:159], v[200:203]
    buffer_load_dwordx4 v240, s[24:27], s41 offen offset:0 sc1 lds
    v_cvt_pk_bf16_f32 v48, v104, v105
    v_mfma_f32_16x16x32_bf16 v[180:183], a[40:43], a[156:159], 0
    ds_read_b128 a[8:11], v230 offset:12288
    v_cvt_pk_bf16_f32 v49, v106, v107
    v_mfma_f32_16x16x32_bf16 v[180:183], a[44:47], a[164:167], v[180:183]
    ds_read_b128 a[12:15], v230 offset:22528
    v_cvt_pk_bf16_f32 v50, v108, v109
    v_mfma_f32_16x16x32_bf16 v[140:143], a[44:47], a[160:163], 0
    buffer_load_dwordx4 v240, s[24:27], s41 offen offset:1024 sc1 lds
    v_cvt_pk_bf16_f32 v51, v110, v111
    v_mfma_f32_16x16x32_bf16 v[140:143], a[40:43], a[152:155], v[140:143]
    v_cvt_pk_bf16_f32 v64, v64, v65
    v_cvt_pk_bf16_f32 v65, v66, v67
    s_waitcnt lgkmcnt(4)
    v_mfma_f32_16x16x32_bf16 v[164:167], a[48:51], a[152:155], 0
    ds_read_b128 a[16:19], v233 offset:13312
    v_cvt_pk_bf16_f32 v66, v68, v69
    v_mfma_f32_16x16x32_bf16 v[164:167], a[52:55], a[160:163], v[164:167]
    buffer_load_dwordx4 v240, s[24:27], s41 offen offset:2048 sc1 lds
    v_cvt_pk_bf16_f32 v67, v70, v71
    v_mfma_f32_16x16x32_bf16 v[204:207], a[52:55], a[164:167], 0
    ds_read_b128 a[20:23], v233 offset:23552
    v_cvt_pk_bf16_f32 v68, v72, v73
    v_mfma_f32_16x16x32_bf16 v[204:207], a[48:51], a[156:159], v[204:207]
    v_cvt_pk_bf16_f32 v69, v74, v75
    v_cvt_pk_bf16_f32 v70, v76, v77
    v_mfma_f32_16x16x32_bf16 v[184:187], a[56:59], a[156:159], 0
    buffer_load_dwordx4 v240, s[24:27], s41 offen offset:3072 sc1 lds
    s_add_u32 m0, m0, 4096
    v_mfma_f32_16x16x32_bf16 v[184:187], a[60:63], a[164:167], v[184:187]
    ds_read_b128 a[24:27], v230 offset:13312
    v_cvt_pk_bf16_f32 v71, v78, v79
    v_mfma_f32_16x16x32_bf16 v[144:147], a[60:63], a[160:163], 0
    ds_read_b128 a[28:31], v230 offset:23552
    v_cvt_pk_bf16_f32 v72, v80, v81
    v_mfma_f32_16x16x32_bf16 v[144:147], a[56:59], a[152:155], v[144:147]
    buffer_load_dwordx4 v244, s[24:27], s41 offen sc1 lds
    v_cvt_pk_bf16_f32 v73, v82, v83
    s_waitcnt vmcnt(37) lgkmcnt(4)
    v_mfma_f32_16x16x32_bf16 v[148:151], a[0:3], a[168:171], v[148:151]
    ds_read_b128 a[32:35], v233 offset:14336
    s_add_u32 s42, s73, 98304
    v_mfma_f32_16x16x32_bf16 v[148:151], a[4:7], a[176:179], v[148:151]
    ds_read_b128 a[36:39], v233 offset:24576
    v_mfma_f32_16x16x32_bf16 v[188:191], a[4:7], a[180:183], v[188:191]
    buffer_load_dwordx4 a[248:251], v242, s[20:23], s42 offen sc1
    v_mfma_f32_16x16x32_bf16 v[188:191], a[0:3], a[172:175], v[188:191]
    v_mfma_f32_16x16x32_bf16 v[168:171], a[8:11], a[172:175], v[168:171]
    ds_read_b128 a[40:43], v230 offset:14336
    v_mfma_f32_16x16x32_bf16 v[168:171], a[12:15], a[180:183], v[168:171]
    buffer_load_dwordx4 a[252:255], v243, s[20:23], s42 offen sc1
    s_add_u32 s42, s73, 102400
    v_mfma_f32_16x16x32_bf16 v[128:131], a[12:15], a[176:179], v[128:131]
    ds_read_b128 a[44:47], v230 offset:24576
    v_mfma_f32_16x16x32_bf16 v[128:131], a[8:11], a[168:171], v[128:131]
    s_waitcnt lgkmcnt(4)
    v_mfma_f32_16x16x32_bf16 v[152:155], a[16:19], a[168:171], v[152:155]
    buffer_load_dword v252, v253, s[68:71], s53 offen offset:4 sc1
    v_mfma_f32_16x16x32_bf16 v[152:155], a[20:23], a[176:179], v[152:155]
    ds_read_b128 a[48:51], v233 offset:15360
    v_mfma_f32_16x16x32_bf16 v[192:195], a[20:23], a[180:183], v[192:195]
    ds_read_b128 a[52:55], v233 offset:25600
    v_mfma_f32_16x16x32_bf16 v[192:195], a[16:19], a[172:175], v[192:195]
    buffer_load_dwordx4 a[144:147], v242, s[20:23], s42 offen sc1
    v_mfma_f32_16x16x32_bf16 v[172:175], a[24:27], a[172:175], v[172:175]
    ds_read_b128 a[56:59], v230 offset:15360
    v_mfma_f32_16x16x32_bf16 v[172:175], a[28:31], a[180:183], v[172:175]
    ds_read_b128 a[60:63], v230 offset:25600
    v_mfma_f32_16x16x32_bf16 v[132:135], a[28:31], a[176:179], v[132:135]
    buffer_load_dwordx4 a[148:151], v243, s[20:23], s42 offen sc1
    v_mfma_f32_16x16x32_bf16 v[132:135], a[24:27], a[168:171], v[132:135]
    s_waitcnt lgkmcnt(4)
    v_mfma_f32_16x16x32_bf16 v[156:159], a[32:35], a[168:171], v[156:159]
    ds_read_b128 a[0:3], v233 offset:16384
    v_mfma_f32_16x16x32_bf16 v[156:159], a[36:39], a[176:179], v[156:159]
    buffer_store_dwordx4 v[32:35], v240, s[64:67], s58 offen offset:0 sc1
    v_mfma_f32_16x16x32_bf16 v[196:199], a[36:39], a[180:183], v[196:199]
    ds_read_b128 a[4:7], v233 offset:26624
    v_mfma_f32_16x16x32_bf16 v[196:199], a[32:35], a[172:175], v[196:199]
    v_mfma_f32_16x16x32_bf16 v[176:179], a[40:43], a[172:175], v[176:179]
    ds_read_b128 a[8:11], v230 offset:16384
    v_mfma_f32_16x16x32_bf16 v[176:179], a[44:47], a[180:183], v[176:179]
    ds_read_b128 a[12:15], v230 offset:26624
    v_mfma_f32_16x16x32_bf16 v[136:139], a[44:47], a[176:179], v[136:139]
    v_mfma_f32_16x16x32_bf16 v[136:139], a[40:43], a[168:171], v[136:139]
    s_barrier
    s_waitcnt lgkmcnt(4)
    v_mfma_f32_16x16x32_bf16 v[160:163], a[48:51], a[168:171], v[160:163]
    ds_read_b128 a[16:19], v231 offset:0
    s_add_u32 s41, s75, 143360
    v_mfma_f32_16x16x32_bf16 v[160:163], a[52:55], a[176:179], v[160:163]
    ds_read_b128 a[20:23], v232 offset:0
    s_bfe_u32 s51, 0x1c801a0, s18
    v_mfma_f32_16x16x32_bf16 v[200:203], a[52:55], a[180:183], v[200:203]
    s_lshl_b32 s51, s51, 8
    s_add_u32 m0, s51, s76
    v_mfma_f32_16x16x32_bf16 v[200:203], a[48:51], a[172:175], v[200:203]
    buffer_load_dwordx4 v240, s[24:27], s41 offen offset:0 sc1 lds
    v_mfma_f32_16x16x32_bf16 v[180:183], a[56:59], a[172:175], v[180:183]
    ds_read_b128 a[24:27], v228 offset:0
    v_mfma_f32_16x16x32_bf16 v[180:183], a[60:63], a[180:183], v[180:183]
    ds_read_b128 a[28:31], v229 offset:0
    v_mfma_f32_16x16x32_bf16 v[140:143], a[60:63], a[176:179], v[140:143]
    buffer_load_dwordx4 v240, s[24:27], s41 offen offset:1024 sc1 lds
    v_mfma_f32_16x16x32_bf16 v[140:143], a[56:59], a[168:171], v[140:143]
    s_waitcnt lgkmcnt(4)
    v_mfma_f32_16x16x32_bf16 v[164:167], a[0:3], a[168:171], v[164:167]
    ds_read_b128 a[32:35], v231 offset:1024
    v_mfma_f32_16x16x32_bf16 v[164:167], a[4:7], a[176:179], v[164:167]
    buffer_load_dwordx4 v240, s[24:27], s41 offen offset:2048 sc1 lds
    v_mfma_f32_16x16x32_bf16 v[204:207], a[4:7], a[180:183], v[204:207]
    ds_read_b128 a[36:39], v232 offset:1024
    v_mfma_f32_16x16x32_bf16 v[204:207], a[0:3], a[172:175], v[204:207]
    v_mfma_f32_16x16x32_bf16 v[184:187], a[8:11], a[172:175], v[184:187]
    buffer_load_dwordx4 v240, s[24:27], s41 offen offset:3072 sc1 lds
    s_add_u32 m0, m0, 4096
    v_mfma_f32_16x16x32_bf16 v[184:187], a[12:15], a[180:183], v[184:187]
    ds_read_b128 a[40:43], v228 offset:1024
    v_mfma_f32_16x16x32_bf16 v[144:147], a[12:15], a[176:179], v[144:147]
    ds_read_b128 a[44:47], v229 offset:1024
    v_mfma_f32_16x16x32_bf16 v[144:147], a[8:11], a[168:171], v[144:147]
    buffer_load_dwordx4 v244, s[24:27], s41 offen sc1 lds
    s_waitcnt vmcnt(8)
    v_cmp_ne_u32 vcc, s0, v252
    s_nop 1
    s_cbranch_vccnz K1_spin_don2
K1_don2_ok:
    s_waitcnt lgkmcnt(4)
    v_mfma_f32_16x16x32_bf16 v[148:151], a[16:19], a[184:187], v[148:151]
    ds_read_b128 a[48:51], v231 offset:2048
    s_add_u32 s42, s73, 114688
    v_mfma_f32_16x16x32_bf16 v[148:151], a[20:23], a[192:195], v[148:151]
    ds_read_b128 a[52:55], v232 offset:2048
    v_mfma_f32_16x16x32_bf16 v[188:191], a[20:23], a[196:199], v[188:191]
    buffer_load_dwordx4 a[152:155], v242, s[20:23], s42 offen sc1
    v_mfma_f32_16x16x32_bf16 v[188:191], a[16:19], a[188:191], v[188:191]
    v_mfma_f32_16x16x32_bf16 v[168:171], a[24:27], a[188:191], v[168:171]
    ds_read_b128 a[56:59], v228 offset:2048
    v_mfma_f32_16x16x32_bf16 v[168:171], a[28:31], a[196:199], v[168:171]
    buffer_load_dwordx4 a[156:159], v243, s[20:23], s42 offen sc1
    s_add_u32 s42, s73, 118784
    v_mfma_f32_16x16x32_bf16 v[128:131], a[28:31], a[192:195], v[128:131]
    ds_read_b128 a[60:63], v229 offset:2048
    v_mfma_f32_16x16x32_bf16 v[128:131], a[24:27], a[184:187], v[128:131]
    s_waitcnt lgkmcnt(4)
    v_mfma_f32_16x16x32_bf16 v[152:155], a[32:35], a[184:187], v[152:155]
    buffer_load_dwordx4 a[160:163], v242, s[20:23], s42 offen sc1
    v_mfma_f32_16x16x32_bf16 v[152:155], a[36:39], a[192:195], v[152:155]
    ds_read_b128 a[0:3], v231 offset:3072
    v_mfma_f32_16x16x32_bf16 v[192:195], a[36:39], a[196:199], v[192:195]
    ds_read_b128 a[4:7], v232 offset:3072
    v_mfma_f32_16x16x32_bf16 v[192:195], a[32:35], a[188:191], v[192:195]
    buffer_load_dwordx4 a[164:167], v243, s[20:23], s42 offen sc1
    v_mfma_f32_16x16x32_bf16 v[172:175], a[40:43], a[188:191], v[172:175]
    ds_read_b128 a[8:11], v228 offset:3072
    v_mfma_f32_16x16x32_bf16 v[172:175], a[44:47], a[196:199], v[172:175]
    ds_read_b128 a[12:15], v229 offset:3072
    v_mfma_f32_16x16x32_bf16 v[132:135], a[44:47], a[192:195], v[132:135]
    buffer_store_dwordx4 v[36:39], v240, s[64:67], s58 offen offset:1024 sc1
    v_mfma_f32_16x16x32_bf16 v[132:135], a[40:43], a[184:187], v[132:135]
    s_waitcnt lgkmcnt(4)
    v_mfma_f32_16x16x32_bf16 v[156:159], a[48:51], a[184:187], v[156:159]
    ds_read_b128 a[16:19], v231 offset:4096
    v_mfma_f32_16x16x32_bf16 v[156:159], a[52:55], a[192:195], v[156:159]
    ds_read_b128 a[20:23], v232 offset:4096
    v_mfma_f32_16x16x32_bf16 v[196:199], a[52:55], a[196:199], v[196:199]
    v_mfma_f32_16x16x32_bf16 v[196:199], a[48:51], a[188:191], v[196:199]
    v_mfma_f32_16x16x32_bf16 v[176:179], a[56:59], a[188:191], v[176:179]
    ds_read_b128 a[24:27], v228 offset:4096
    v_mfma_f32_16x16x32_bf16 v[176:179], a[60:63], a[196:199], v[176:179]
    ds_read_b128 a[28:31], v229 offset:4096
    v_mfma_f32_16x16x32_bf16 v[136:139], a[60:63], a[192:195], v[136:139]
    v_mfma_f32_16x16x32_bf16 v[136:139], a[56:59], a[184:187], v[136:139]
    s_barrier
    s_waitcnt lgkmcnt(4)
    v_mfma_f32_16x16x32_bf16 v[160:163], a[0:3], a[184:187], v[160:163]
    ds_read_b128 a[32:35], v231 offset:10240
    s_add_u32 s41, s75, 10240
    v_mfma_f32_16x16x32_bf16 v[160:163], a[4:7], a[192:195], v[160:163]
    ds_read_b128 a[36:39], v231 offset:20480
    s_bfe_u32 s51, 0x2300208, s18
    v_mfma_f32_16x16x32_bf16 v[200:203], a[4:7], a[196:199], v[200:203]
    s_lshl_b32 s51, s51, 8
    s_add_u32 m0, s51, s76
    v_mfma_f32_16x16x32_bf16 v[200:203], a[0:3], a[188:191], v[200:203]
    buffer_load_dwordx4 v240, s[24:27], s41 offen offset:0 sc1 lds
    v_mfma_f32_16x16x32_bf16 v[180:183], a[8:11], a[188:191], v[180:183]
    ds_read_b128 a[40:43], v228 offset:10240
    v_mfma_f32_16x16x32_bf16 v[180:183], a[12:15], a[196:199], v[180:183]
    ds_read_b128 a[44:47], v228 offset:20480
    v_mfma_f32_16x16x32_bf16 v[140:143], a[12:15], a[192:195], v[140:143]
    buffer_load_dwordx4 v240, s[24:27], s41 offen offset:1024 sc1 lds
    v_mfma_f32_16x16x32_bf16 v[140:143], a[8:11], a[184:187], v[140:143]
    s_waitcnt lgkmcnt(4)
    v_mfma_f32_16x16x32_bf16 v[164:167], a[16:19], a[184:187], v[164:167]
    ds_read_b128 a[48:51], v231 offset:11264
    v_mfma_f32_16x16x32_bf16 v[164:167], a[20:23], a[192:195], v[164:167]
    buffer_load_dwordx4 v240, s[24:27], s41 offen offset:2048 sc1 lds
    v_mfma_f32_16x16x32_bf16 v[204:207], a[20:23], a[196:199], v[204:207]
    ds_read_b128 a[52:55], v231 offset:21504
    v_mfma_f32_16x16x32_bf16 v[204:207], a[16:19], a[188:191], v[204:207]
    v_mfma_f32_16x16x32_bf16 v[184:187], a[24:27], a[188:191], v[184:187]
    buffer_load_dwordx4 v240, s[24:27], s41 offen offset:3072 sc1 lds
    s_add_u32 m0, m0, 4096
    v_mfma_f32_16x16x32_bf16 v[184:187], a[28:31], a[196:199], v[184:187]
    ds_read_b128 a[56:59], v228 offset:11264
    v_mfma_f32_16x16x32_bf16 v[144:147], a[28:31], a[192:195], v[144:147]
    ds_read_b128 a[60:63], v228 offset:21504
    v_mfma_f32_16x16x32_bf16 v[144:147], a[24:27], a[184:187], v[144:147]
    buffer_load_dwordx4 v244, s[24:27], s41 offen sc1 lds
    s_mov_b64 exec, 0
    s_cmp_eq_u32 s3, 0
    s_cbranch_scc1 K1_pg15
    s_cmp_eq_u32 s3, 1
    s_cbranch_scc1 K1_pg16
    s_cmp_eq_u32 s3, 2
    s_cbranch_scc1 K1_pg17
K1_wb3:
    s_mov_b64 exec, -1
    s_waitcnt lgkmcnt(4)
    v_mfma_f32_16x16x32_bf16 v[148:151], a[32:35], a[200:203], v[148:151]
    ds_read_b128 a[0:3], v231 offset:12288
    s_add_u32 s42, s73, 8192
    v_mfma_f32_16x16x32_bf16 v[148:151], a[36:39], a[208:211], v[148:151]
    ds_read_b128 a[4:7], v231 offset:22528
    v_mfma_f32_16x16x32_bf16 v[188:191], a[36:39], a[212:215], v[188:191]
    buffer_load_dwordx4 a[168:171], v242, s[20:23], s42 offen sc1
    v_mfma_f32_16x16x32_bf16 v[188:191], a[32:35], a[204:207], v[188:191]
    v_mfma_f32_16x16x32_bf16 v[168:171], a[40:43], a[204:207], v[168:171]
    ds_read_b128 a[8:11], v228 offset:12288
    v_mfma_f32_16x16x32_bf16 v[168:171], a[44:47], a[212:215], v[168:171]
    buffer_load_dwordx4 a[172:175], v243, s[20:23], s42 offen sc1
    s_add_u32 s42, s73, 12288
    v_mfma_f32_16x16x32_bf16 v[128:131], a[44:47], a[208:211], v[128:131]
    ds_read_b128 a[12:15], v228 offset:22528
    v_mfma_f32_16x16x32_bf16 v[128:131], a[40:43], a[200:203], v[128:131]
    s_waitcnt lgkmcnt(4)
    v_mfma_f32_16x16x32_bf16 v[152:155], a[48:51], a[200:203], v[152:155]
    buffer_load_dwordx4 a[176:179], v242, s[20:23], s42 offen sc1
    v_mfma_f32_16x16x32_bf16 v[152:155], a[52:55], a[208:211], v[152:155]
    ds_read_b128 a[16:19], v231 offset:13312
    v_mfma_f32_16x16x32_bf16 v[192:195], a[52:55], a[212:215], v[192:195]
    ds_read_b128 a[20:23], v231 offset:23552
    v_mfma_f32_16x16x32_bf16 v[192:195], a[48:51], a[204:207], v[192:195]
    buffer_load_dwordx4 a[180:183], v243, s[20:23], s42 offen sc1
    v_mfma_f32_16x16x32_bf16 v[172:175], a[56:59], a[204:207], v[172:175]
    ds_read_b128 a[24:27], v228 offset:13312
    v_mfma_f32_16x16x32_bf16 v[172:175], a[60:63], a[212:215], v[172:175]
    ds_read_b128 a[28:31], v228 offset:23552
    v_mfma_f32_16x16x32_bf16 v[132:135], a[60:63], a[208:211], v[132:135]
    buffer_store_dwordx4 v[40:43], v240, s[64:67], s58 offen offset:2048 sc1
    v_mfma_f32_16x16x32_bf16 v[132:135], a[56:59], a[200:203], v[132:135]
    s_waitcnt lgkmcnt(4)
    v_mfma_f32_16x16x32_bf16 v[156:159], a[0:3], a[200:203], v[156:159]
    ds_read_b128 a[32:35], v231 offset:14336
    v_mfma_f32_16x16x32_bf16 v[156:159], a[4:7], a[208:211], v[156:159]
    ds_read_b128 a[36:39], v231 offset:24576
    v_mfma_f32_16x16x32_bf16 v[196:199], a[4:7], a[212:215], v[196:199]
    v_mfma_f32_16x16x32_bf16 v[196:199], a[0:3], a[204:207], v[196:199]
    v_mfma_f32_16x16x32_bf16 v[176:179], a[8:11], a[204:207], v[176:179]
    ds_read_b128 a[40:43], v228 offset:14336
    v_mfma_f32_16x16x32_bf16 v[176:179], a[12:15], a[212:215], v[176:179]
    ds_read_b128 a[44:47], v228 offset:24576
    v_mfma_f32_16x16x32_bf16 v[136:139], a[12:15], a[208:211], v[136:139]
    v_mfma_f32_16x16x32_bf16 v[136:139], a[8:11], a[200:203], v[136:139]
    s_barrier
    s_waitcnt lgkmcnt(4)
    v_mfma_f32_16x16x32_bf16 v[160:163], a[16:19], a[200:203], v[160:163]
    ds_read_b128 a[48:51], v232 offset:10240
    s_add_u32 s41, s75, 30720
    v_mfma_f32_16x16x32_bf16 v[160:163], a[20:23], a[208:211], v[160:163]
    ds_read_b128 a[52:55], v232 offset:20480
    s_bfe_u32 s51, 0x258, s18
    v_mfma_f32_16x16x32_bf16 v[200:203], a[20:23], a[212:215], v[200:203]
    s_lshl_b32 s51, s51, 8
    s_add_u32 m0, s51, s76
    v_mfma_f32_16x16x32_bf16 v[200:203], a[16:19], a[204:207], v[200:203]
    buffer_load_dwordx4 v240, s[24:27], s41 offen offset:0 sc1 lds
    v_mfma_f32_16x16x32_bf16 v[180:183], a[24:27], a[204:207], v[180:183]
    ds_read_b128 a[56:59], v229 offset:10240
    v_mfma_f32_16x16x32_bf16 v[180:183], a[28:31], a[212:215], v[180:183]
    ds_read_b128 a[60:63], v229 offset:20480
    v_mfma_f32_16x16x32_bf16 v[140:143], a[28:31], a[208:211], v[140:143]
    buffer_load_dwordx4 v240, s[24:27], s41 offen offset:1024 sc1 lds
    v_mfma_f32_16x16x32_bf16 v[140:143], a[24:27], a[200:203], v[140:143]
    s_waitcnt lgkmcnt(4)
    v_mfma_f32_16x16x32_bf16 v[164:167], a[32:35], a[200:203], v[164:167]
    ds_read_b128 a[0:3], v232 offset:11264
    v_mfma_f32_16x16x32_bf16 v[164:167], a[36:39], a[208:211], v[164:167]
    buffer_load_dwordx4 v240, s[24:27], s41 offen offset:2048 sc1 lds
    v_mfma_f32_16x16x32_bf16 v[204:207], a[36:39], a[212:215], v[204:207]
    ds_read_b128 a[4:7], v232 offset:21504
    v_mfma_f32_16x16x32_bf16 v[204:207], a[32:35], a[204:207], v[204:207]
    v_mfma_f32_16x16x32_bf16 v[184:187], a[40:43], a[204:207], v[184:187]
    buffer_load_dwordx4 v240, s[24:27], s41 offen offset:3072 sc1 lds
    s_add_u32 m0, m0, 4096
    v_mfma_f32_16x16x32_bf16 v[184:187], a[44:47], a[212:215], v[184:187]
    ds_read_b128 a[8:11], v229 offset:11264
    v_mfma_f32_16x16x32_bf16 v[144:147], a[44:47], a[208:211], v[144:147]
    ds_read_b128 a[12:15], v229 offset:21504
    v_mfma_f32_16x16x32_bf16 v[144:147], a[40:43], a[200:203], v[144:147]
    buffer_load_dwordx4 v244, s[24:27], s41 offen sc1 lds
    s_waitcnt lgkmcnt(4)
    v_mfma_f32_16x16x32_bf16 v[148:151], a[48:51], a[216:219], v[148:151]
    ds_read_b128 a[16:19], v232 offset:12288
    s_add_u32 s42, s73, 24576
    v_mfma_f32_16x16x32_bf16 v[148:151], a[52:55], a[224:227], v[148:151]
    ds_read_b128 a[20:23], v232 offset:22528
    v_mfma_f32_16x16x32_bf16 v[188:191], a[52:55], a[228:231], v[188:191]
    buffer_load_dwordx4 a[184:187], v242, s[20:23], s42 offen sc1
    v_mfma_f32_16x16x32_bf16 v[188:191], a[48:51], a[220:223], v[188:191]
    v_mfma_f32_16x16x32_bf16 v[168:171], a[56:59], a[220:223], v[168:171]
    ds_read_b128 a[24:27], v229 offset:12288
    v_mfma_f32_16x16x32_bf16 v[168:171], a[60:63], a[228:231], v[168:171]
    buffer_load_dwordx4 a[188:191], v243, s[20:23], s42 offen sc1
    s_add_u32 s42, s73, 28672
    v_mfma_f32_16x16x32_bf16 v[128:131], a[60:63], a[224:227], v[128:131]
    ds_read_b128 a[28:31], v229 offset:22528
    v_mfma_f32_16x16x32_bf16 v[128:131], a[56:59], a[216:219], v[128:131]
    s_waitcnt lgkmcnt(4)
    v_mfma_f32_16x16x32_bf16 v[152:155], a[0:3], a[216:219], v[152:155]
    buffer_load_dwordx4 a[192:195], v242, s[20:23], s42 offen sc1
    v_mfma_f32_16x16x32_bf16 v[152:155], a[4:7], a[224:227], v[152:155]
    ds_read_b128 a[32:35], v232 offset:13312
    v_mfma_f32_16x16x32_bf16 v[192:195], a[4:7], a[228:231], v[192:195]
    ds_read_b128 a[36:39], v232 offset:23552
    v_mfma_f32_16x16x32_bf16 v[192:195], a[0:3], a[220:223], v[192:195]
    buffer_load_dwordx4 a[196:199], v243, s[20:23], s42 offen sc1
    v_mfma_f32_16x16x32_bf16 v[172:175], a[8:11], a[220:223], v[172:175]
    ds_read_b128 a[40:43], v229 offset:13312
    v_mfma_f32_16x16x32_bf16 v[172:175], a[12:15], a[228:231], v[172:175]
    ds_read_b128 a[44:47], v229 offset:23552
    v_mfma_f32_16x16x32_bf16 v[132:135], a[12:15], a[224:227], v[132:135]
    buffer_store_dwordx4 v[44:47], v240, s[64:67], s58 offen offset:3072 sc1
    s_add_u32 s58, s58, 4096
    v_mfma_f32_16x16x32_bf16 v[132:135], a[8:11], a[216:219], v[132:135]
    s_waitcnt lgkmcnt(4)
    v_mfma_f32_16x16x32_bf16 v[156:159], a[16:19], a[216:219], v[156:159]
    ds_read_b128 a[48:51], v232 offset:14336
    v_mfma_f32_16x16x32_bf16 v[156:159], a[20:23], a[224:227], v[156:159]
    ds_read_b128 a[52:55], v232 offset:24576
    v_mfma_f32_16x16x32_bf16 v[196:199], a[20:23], a[228:231], v[196:199]
    v_mfma_f32_16x16x32_bf16 v[196:199], a[16:19], a[220:223], v[196:199]
    v_mfma_f32_16x16x32_bf16 v[176:179], a[24:27], a[220:223], v[176:179]
    ds_read_b128 a[56:59], v229 offset:14336
    v_mfma_f32_16x16x32_bf16 v[176:179], a[28:31], a[228:231], v[176:179]
    ds_read_b128 a[60:63], v229 offset:24576
    v_mfma_f32_16x16x32_bf16 v[136:139], a[28:31], a[224:227], v[136:139]
    v_mfma_f32_16x16x32_bf16 v[136:139], a[24:27], a[216:219], v[136:139]
    s_barrier
    s_waitcnt lgkmcnt(4)
    v_mfma_f32_16x16x32_bf16 v[160:163], a[32:35], a[216:219], v[160:163]
    ds_read_b128 a[0:3], v231 offset:55296
    s_add_u32 s41, s75, 51200
    v_mfma_f32_16x16x32_bf16 v[160:163], a[36:39], a[224:227], v[160:163]
    ds_read_b128 a[4:7], v231 offset:30720
    s_bfe_u32 s51, 0x280100, s18
    v_mfma_f32_16x16x32_bf16 v[200:203], a[36:39], a[228:231], v[200:203]
    s_lshl_b32 s51, s51, 8
    s_add_u32 m0, s51, s76
    v_mfma_f32_16x16x32_bf16 v[200:203], a[32:35], a[220:223], v[200:203]
    buffer_load_dwordx4 v240, s[24:27], s41 offen offset:0 sc1 lds
    v_mfma_f32_16x16x32_bf16 v[180:183], a[40:43], a[220:223], v[180:183]
    ds_read_b128 a[8:11], v228 offset:55296
    v_mfma_f32_16x16x32_bf16 v[180:183], a[44:47], a[228:231], v[180:183]
    ds_read_b128 a[12:15], v228 offset:30720
    v_mfma_f32_16x16x32_bf16 v[140:143], a[44:47], a[224:227], v[140:143]
    buffer_load_dwordx4 v240, s[24:27], s41 offen offset:1024 sc1 lds
    v_mfma_f32_16x16x32_bf16 v[140:143], a[40:43], a[216:219], v[140:143]
    s_waitcnt lgkmcnt(4)
    v_mfma_f32_16x16x32_bf16 v[164:167], a[48:51], a[216:219], v[164:167]
    ds_read_b128 a[16:19], v231 offset:56320
    v_mfma_f32_16x16x32_bf16 v[164:167], a[52:55], a[224:227], v[164:167]
    buffer_load_dwordx4 v240, s[24:27], s41 offen offset:2048 sc1 lds
    v_mfma_f32_16x16x32_bf16 v[204:207], a[52:55], a[228:231], v[204:207]
    ds_read_b128 a[20:23], v231 offset:31744
    v_mfma_f32_16x16x32_bf16 v[204:207], a[48:51], a[220:223], v[204:207]
    v_mfma_f32_16x16x32_bf16 v[184:187], a[56:59], a[220:223], v[184:187]
    buffer_load_dwordx4 v240, s[24:27], s41 offen offset:3072 sc1 lds
    s_add_u32 m0, m0, 4096
    v_mfma_f32_16x16x32_bf16 v[184:187], a[60:63], a[228:231], v[184:187]
    ds_read_b128 a[24:27], v228 offset:56320
    v_mfma_f32_16x16x32_bf16 v[144:147], a[60:63], a[224:227], v[144:147]
    ds_read_b128 a[28:31], v228 offset:31744
    v_mfma_f32_16x16x32_bf16 v[144:147], a[56:59], a[216:219], v[144:147]
    buffer_load_dwordx4 v244, s[24:27], s41 offen sc1 lds
    s_waitcnt lgkmcnt(4)
    v_mfma_f32_16x16x32_bf16 v[148:151], a[0:3], a[232:235], v[148:151]
    ds_read_b128 a[32:35], v231 offset:57344
    s_add_u32 s42, s73, 40960
    v_mfma_f32_16x16x32_bf16 v[148:151], a[4:7], a[240:243], v[148:151]
    ds_read_b128 a[36:39], v231 offset:32768
    v_mfma_f32_16x16x32_bf16 v[188:191], a[4:7], a[244:247], v[188:191]
    buffer_load_dwordx4 a[200:203], v242, s[20:23], s42 offen sc1
    v_mfma_f32_16x16x32_bf16 v[188:191], a[0:3], a[236:239], v[188:191]
    v_mfma_f32_16x16x32_bf16 v[168:171], a[8:11], a[236:239], v[168:171]
    ds_read_b128 a[40:43], v228 offset:57344
    v_mfma_f32_16x16x32_bf16 v[168:171], a[12:15], a[244:247], v[168:171]
    buffer_load_dwordx4 a[204:207], v243, s[20:23], s42 offen sc1
    s_add_u32 s42, s73, 45056
    v_mfma_f32_16x16x32_bf16 v[128:131], a[12:15], a[240:243], v[128:131]
    ds_read_b128 a[44:47], v228 offset:32768
    v_mfma_f32_16x16x32_bf16 v[128:131], a[8:11], a[232:235], v[128:131]
    s_waitcnt lgkmcnt(4)
    v_mfma_f32_16x16x32_bf16 v[152:155], a[16:19], a[232:235], v[152:155]
    buffer_load_dwordx4 a[208:211], v242, s[20:23], s42 offen sc1
    v_mfma_f32_16x16x32_bf16 v[152:155], a[20:23], a[240:243], v[152:155]
    ds_read_b128 a[48:51], v231 offset:58368
    v_mfma_f32_16x16x32_bf16 v[192:195], a[20:23], a[244:247], v[192:195]
    ds_read_b128 a[52:55], v231 offset:33792
    v_mfma_f32_16x16x32_bf16 v[192:195], a[16:19], a[236:239], v[192:195]
    buffer_load_dwordx4 a[212:215], v243, s[20:23], s42 offen sc1
K1_pg15:
    s_cbranch_execz K1_wb3
    v_mfma_f32_16x16x32_bf16 v[172:175], a[24:27], a[236:239], v[172:175]
    ds_read_b128 a[56:59], v228 offset:58368
    v_mfma_f32_16x16x32_bf16 v[172:175], a[28:31], a[244:247], v[172:175]
    ds_read_b128 a[60:63], v228 offset:33792
    v_mfma_f32_16x16x32_bf16 v[132:135], a[28:31], a[240:243], v[132:135]
    buffer_store_dwordx4 v[48:51], v240, s[64:67], s58 offen offset:0 sc1
    v_mfma_f32_16x16x32_bf16 v[132:135], a[24:27], a[232:235], v[132:135]
    s_waitcnt lgkmcnt(4)
    v_mfma_f32_16x16x32_bf16 v[156:159], a[32:35], a[232:235], v[156:159]
    ds_read_b128 a[0:3], v231 offset:59392
    v_mfma_f32_16x16x32_bf16 v[156:159], a[36:39], a[240:243], v[156:159]
    ds_read_b128 a[4:7], v231 offset:34816
    v_mfma_f32_16x16x32_bf16 v[196:199], a[36:39], a[244:247], v[196:199]
    v_mfma_f32_16x16x32_bf16 v[196:199], a[32:35], a[236:239], v[196:199]
    v_mfma_f32_16x16x32_bf16 v[176:179], a[40:43], a[236:239], v[176:179]
    ds_read_b128 a[8:11], v228 offset:59392
    v_mfma_f32_16x16x32_bf16 v[176:179], a[44:47], a[244:247], v[176:179]
    ds_read_b128 a[12:15], v228 offset:34816
    v_mfma_f32_16x16x32_bf16 v[136:139], a[44:47], a[240:243], v[136:139]
    v_mfma_f32_16x16x32_bf16 v[136:139], a[40:43], a[232:235], v[136:139]
    s_barrier
    s_waitcnt lgkmcnt(4)
    v_mfma_f32_16x16x32_bf16 v[160:163], a[48:51], a[232:235], v[160:163]
    ds_read_b128 a[16:19], v231 offset:40960
    s_add_u32 s41, s75, 71680
    v_mfma_f32_16x16x32_bf16 v[160:163], a[52:55], a[240:243], v[160:163]
    ds_read_b128 a[20:23], v232 offset:30720
    s_bfe_u32 s51, 0x1280050, s18
    v_mfma_f32_16x16x32_bf16 v[200:203], a[52:55], a[244:247], v[200:203]
    s_lshl_b32 s51, s51, 8
    s_add_u32 m0, s51, s76
    v_mfma_f32_16x16x32_bf16 v[200:203], a[48:51], a[236:239], v[200:203]
    buffer_load_dwordx4 v240, s[24:27], s41 offen offset:0 sc1 lds
    v_mfma_f32_16x16x32_bf16 v[180:183], a[56:59], a[236:239], v[180:183]
    ds_read_b128 a[24:27], v228 offset:40960
    v_mfma_f32_16x16x32_bf16 v[180:183], a[60:63], a[244:247], v[180:183]
    ds_read_b128 a[28:31], v229 offset:30720
    v_mfma_f32_16x16x32_bf16 v[140:143], a[60:63], a[240:243], v[140:143]
    buffer_load_dwordx4 v240, s[24:27], s41 offen offset:1024 sc1 lds
    v_mfma_f32_16x16x32_bf16 v[140:143], a[56:59], a[232:235], v[140:143]
    s_waitcnt lgkmcnt(4)
    v_mfma_f32_16x16x32_bf16 v[164:167], a[0:3], a[232:235], v[164:167]
    ds_read_b128 a[32:35], v231 offset:41984
    v_mfma_f32_16x16x32_bf16 v[164:167], a[4:7], a[240:243], v[164:167]
    buffer_load_dwordx4 v240, s[24:27], s41 offen offset:2048 sc1 lds
    v_mfma_f32_16x16x32_bf16 v[204:207], a[4:7], a[244:247], v[204:207]
    ds_read_b128 a[36:39], v232 offset:31744
    v_mfma_f32_16x16x32_bf16 v[204:207], a[0:3], a[236:239], v[204:207]
    v_mfma_f32_16x16x32_bf16 v[184:187], a[8:11], a[236:239], v[184:187]
    buffer_load_dwordx4 v240, s[24:27], s41 offen offset:3072 sc1 lds
    s_add_u32 m0, m0, 4096
    v_mfma_f32_16x16x32_bf16 v[184:187], a[12:15], a[244:247], v[184:187]
    ds_read_b128 a[40:43], v228 offset:41984
    v_mfma_f32_16x16x32_bf16 v[144:147], a[12:15], a[240:243], v[144:147]
    ds_read_b128 a[44:47], v229 offset:31744
    v_mfma_f32_16x16x32_bf16 v[144:147], a[8:11], a[232:235], v[144:147]
    buffer_load_dwordx4 v244, s[24:27], s41 offen sc1 lds
    s_waitcnt vmcnt(46) lgkmcnt(4)
    v_mfma_f32_16x16x32_bf16 v[148:151], a[16:19], a[248:251], v[148:151]
    ds_read_b128 a[48:51], v231 offset:43008
    s_add_u32 s42, s73, 57344
    v_mfma_f32_16x16x32_bf16 v[148:151], a[20:23], a[144:147], v[148:151]
    ds_read_b128 a[52:55], v232 offset:32768
    v_mfma_f32_16x16x32_bf16 v[188:191], a[20:23], a[148:151], v[188:191]
    buffer_load_dwordx4 a[216:219], v242, s[20:23], s42 offen sc1
    v_mfma_f32_16x16x32_bf16 v[188:191], a[16:19], a[252:255], v[188:191]
    v_mfma_f32_16x16x32_bf16 v[168:171], a[24:27], a[252:255], v[168:171]
    ds_read_b128 a[56:59], v228 offset:43008
    v_mfma_f32_16x16x32_bf16 v[168:171], a[28:31], a[148:151], v[168:171]
    buffer_load_dwordx4 a[220:223], v243, s[20:23], s42 offen sc1
    s_add_u32 s42, s73, 61440
    v_mfma_f32_16x16x32_bf16 v[128:131], a[28:31], a[144:147], v[128:131]
    ds_read_b128 a[60:63], v229 offset:32768
    v_mfma_f32_16x16x32_bf16 v[128:131], a[24:27], a[248:251], v[128:131]
    s_waitcnt lgkmcnt(4)
    v_mfma_f32_16x16x32_bf16 v[152:155], a[32:35], a[248:251], v[152:155]
    buffer_load_dwordx4 a[224:227], v242, s[20:23], s42 offen sc1
    v_mfma_f32_16x16x32_bf16 v[152:155], a[36:39], a[144:147], v[152:155]
    ds_read_b128 a[0:3], v231 offset:44032
    v_mfma_f32_16x16x32_bf16 v[192:195], a[36:39], a[148:151], v[192:195]
    ds_read_b128 a[4:7], v232 offset:33792
    v_mfma_f32_16x16x32_bf16 v[192:195], a[32:35], a[252:255], v[192:195]
    buffer_load_dwordx4 a[228:231], v243, s[20:23], s42 offen sc1
    v_mfma_f32_16x16x32_bf16 v[172:175], a[40:43], a[252:255], v[172:175]
    ds_read_b128 a[8:11], v228 offset:44032
    v_mfma_f32_16x16x32_bf16 v[172:175], a[44:47], a[148:151], v[172:175]
    ds_read_b128 a[12:15], v229 offset:33792
    v_mfma_f32_16x16x32_bf16 v[132:135], a[44:47], a[144:147], v[132:135]
    buffer_store_dwordx4 v[64:67], v240, s[64:67], s58 offen offset:1024 sc1
    v_mfma_f32_16x16x32_bf16 v[132:135], a[40:43], a[248:251], v[132:135]
    s_waitcnt lgkmcnt(4)
    v_mfma_f32_16x16x32_bf16 v[156:159], a[48:51], a[248:251], v[156:159]
    ds_read_b128 a[16:19], v231 offset:45056
    v_mfma_f32_16x16x32_bf16 v[156:159], a[52:55], a[144:147], v[156:159]
    ds_read_b128 a[20:23], v232 offset:34816
    v_mfma_f32_16x16x32_bf16 v[196:199], a[52:55], a[148:151], v[196:199]
    v_mfma_f32_16x16x32_bf16 v[196:199], a[48:51], a[252:255], v[196:199]
    v_mfma_f32_16x16x32_bf16 v[176:179], a[56:59], a[252:255], v[176:179]
    ds_read_b128 a[24:27], v228 offset:45056
    v_mfma_f32_16x16x32_bf16 v[176:179], a[60:63], a[148:151], v[176:179]
    ds_read_b128 a[28:31], v229 offset:34816
    v_mfma_f32_16x16x32_bf16 v[136:139], a[60:63], a[144:147], v[136:139]
    v_mfma_f32_16x16x32_bf16 v[136:139], a[56:59], a[248:251], v[136:139]
    s_waitcnt vmcnt(45)
    s_barrier
    s_waitcnt lgkmcnt(4)
    v_mfma_f32_16x16x32_bf16 v[160:163], a[0:3], a[248:251], v[160:163]
    ds_read_b128 a[32:35], v232 offset:40960
    s_add_u32 s41, s75, 92160
    v_mfma_f32_16x16x32_bf16 v[160:163], a[4:7], a[144:147], v[160:163]
    ds_read_b128 a[36:39], v232 offset:51200
    s_bfe_u32 s51, 0xd80150, s18
    v_mfma_f32_16x16x32_bf16 v[200:203], a[4:7], a[148:151], v[200:203]
    s_lshl_b32 s51, s51, 8
    s_add_u32 m0, s51, s76
    v_mfma_f32_16x16x32_bf16 v[200:203], a[0:3], a[252:255], v[200:203]
    buffer_load_dwordx4 v240, s[24:27], s41 offen offset:0 sc1 lds
    v_mfma_f32_16x16x32_bf16 v[180:183], a[8:11], a[252:255], v[180:183]
    ds_read_b128 a[40:43], v229 offset:40960
    v_mfma_f32_16x16x32_bf16 v[180:183], a[12:15], a[148:151], v[180:183]
    ds_read_b128 a[44:47], v229 offset:51200
    v_mfma_f32_16x16x32_bf16 v[140:143], a[12:15], a[144:147], v[140:143]
    buffer_load_dwordx4 v240, s[24:27], s41 offen offset:1024 sc1 lds
    v_mfma_f32_16x16x32_bf16 v[140:143], a[8:11], a[248:251], v[140:143]
    s_waitcnt lgkmcnt(4)
    v_mfma_f32_16x16x32_bf16 v[164:167], a[16:19], a[248:251], v[164:167]
    ds_read_b128 a[48:51], v232 offset:41984
    v_mfma_f32_16x16x32_bf16 v[164:167], a[20:23], a[144:147], v[164:167]
    buffer_load_dwordx4 v240, s[24:27], s41 offen offset:2048 sc1 lds
    v_mfma_f32_16x16x32_bf16 v[204:207], a[20:23], a[148:151], v[204:207]
    ds_read_b128 a[52:55], v232 offset:52224
    v_mfma_f32_16x16x32_bf16 v[204:207], a[16:19], a[252:255], v[204:207]
    v_mfma_f32_16x16x32_bf16 v[184:187], a[24:27], a[252:255], v[184:187]
    buffer_load_dwordx4 v240, s[24:27], s41 offen offset:3072 sc1 lds
    s_add_u32 m0, m0, 4096
    v_mfma_f32_16x16x32_bf16 v[184:187], a[28:31], a[148:151], v[184:187]
    ds_read_b128 a[56:59], v229 offset:41984
    v_mfma_f32_16x16x32_bf16 v[144:147], a[28:31], a[144:147], v[144:147]
    ds_read_b128 a[60:63], v229 offset:52224
    v_mfma_f32_16x16x32_bf16 v[144:147], a[24:27], a[248:251], v[144:147]
    buffer_load_dwordx4 v244, s[24:27], s41 offen sc1 lds
    s_waitcnt vmcnt(46) lgkmcnt(4)
    v_mfma_f32_16x16x32_bf16 v[148:151], a[32:35], a[152:155], v[148:151]
    ds_read_b128 a[0:3], v232 offset:43008
    s_add_u32 s42, s73, 73728
    v_mfma_f32_16x16x32_bf16 v[148:151], a[36:39], a[160:163], v[148:151]
    ds_read_b128 a[4:7], v232 offset:53248
    v_mfma_f32_16x16x32_bf16 v[188:191], a[36:39], a[164:167], v[188:191]
    buffer_load_dwordx4 a[232:235], v242, s[20:23], s42 offen sc1
    v_mfma_f32_16x16x32_bf16 v[188:191], a[32:35], a[156:159], v[188:191]
    v_mfma_f32_16x16x32_bf16 v[168:171], a[40:43], a[156:159], v[168:171]
    ds_read_b128 a[8:11], v229 offset:43008
    v_mfma_f32_16x16x32_bf16 v[168:171], a[44:47], a[164:167], v[168:171]
    buffer_load_dwordx4 a[236:239], v243, s[20:23], s42 offen sc1
    s_add_u32 s42, s73, 77824
    v_mfma_f32_16x16x32_bf16 v[128:131], a[44:47], a[160:163], v[128:131]
    ds_read_b128 a[12:15], v229 offset:53248
    v_mfma_f32_16x16x32_bf16 v[128:131], a[40:43], a[152:155], v[128:131]
    s_waitcnt lgkmcnt(4)
    v_mfma_f32_16x16x32_bf16 v[152:155], a[48:51], a[152:155], v[152:155]
    buffer_load_dwordx4 a[240:243], v242, s[20:23], s42 offen sc1
    v_mfma_f32_16x16x32_bf16 v[152:155], a[52:55], a[160:163], v[152:155]
    ds_read_b128 a[16:19], v232 offset:44032
    v_mfma_f32_16x16x32_bf16 v[192:195], a[52:55], a[164:167], v[192:195]
    ds_read_b128 a[20:23], v232 offset:54272
    v_mfma_f32_16x16x32_bf16 v[192:195], a[48:51], a[156:159], v[192:195]
    buffer_load_dwordx4 a[244:247], v243, s[20:23], s42 offen sc1
    v_mfma_f32_16x16x32_bf16 v[172:175], a[56:59], a[156:159], v[172:175]
    ds_read_b128 a[24:27], v229 offset:44032
    v_mfma_f32_16x16x32_bf16 v[172:175], a[60:63], a[164:167], v[172:175]
    ds_read_b128 a[28:31], v229 offset:54272
    v_mfma_f32_16x16x32_bf16 v[132:135], a[60:63], a[160:163], v[132:135]
    buffer_store_dwordx4 v[68:71], v240, s[64:67], s58 offen offset:2048 sc1
    v_mfma_f32_16x16x32_bf16 v[132:135], a[56:59], a[152:155], v[132:135]
    s_waitcnt lgkmcnt(4)
    v_mfma_f32_16x16x32_bf16 v[156:159], a[0:3], a[152:155], v[156:159]
    ds_read_b128 a[32:35], v232 offset:45056
    v_mfma_f32_16x16x32_bf16 v[156:159], a[4:7], a[160:163], v[156:159]
    ds_read_b128 a[36:39], v232 offset:55296
    v_mfma_f32_16x16x32_bf16 v[196:199], a[4:7], a[164:167], v[196:199]
    v_mfma_f32_16x16x32_bf16 v[196:199], a[0:3], a[156:159], v[196:199]
    v_mfma_f32_16x16x32_bf16 v[176:179], a[8:11], a[156:159], v[176:179]
    ds_read_b128 a[40:43], v229 offset:45056
    v_mfma_f32_16x16x32_bf16 v[176:179], a[12:15], a[164:167], v[176:179]
    ds_read_b128 a[44:47], v229 offset:55296
    v_mfma_f32_16x16x32_bf16 v[136:139], a[12:15], a[160:163], v[136:139]
    v_mfma_f32_16x16x32_bf16 v[136:139], a[8:11], a[152:155], v[136:139]
    s_waitcnt vmcnt(45)
    s_barrier
    s_waitcnt lgkmcnt(4)
    v_mfma_f32_16x16x32_bf16 v[160:163], a[16:19], a[152:155], v[160:163]
    ds_read_b128 a[48:51], v233 offset:2048
    s_add_u32 s41, s75, 112640
    v_mfma_f32_16x16x32_bf16 v[160:163], a[20:23], a[160:163], v[160:163]
    ds_read_b128 a[52:55], v233 offset:12288
    s_bfe_u32 s51, 0xa00078, s18
    v_mfma_f32_16x16x32_bf16 v[200:203], a[20:23], a[164:167], v[200:203]
    s_lshl_b32 s51, s51, 8
    s_add_u32 m0, s51, s76
    v_mfma_f32_16x16x32_bf16 v[200:203], a[16:19], a[156:159], v[200:203]
    buffer_load_dwordx4 v240, s[24:27], s41 offen offset:0 sc1 lds
    v_mfma_f32_16x16x32_bf16 v[180:183], a[24:27], a[156:159], v[180:183]
    ds_read_b128 a[56:59], v230 offset:2048
    v_mfma_f32_16x16x32_bf16 v[180:183], a[28:31], a[164:167], v[180:183]
    ds_read_b128 a[60:63], v230 offset:12288
    v_mfma_f32_16x16x32_bf16 v[140:143], a[28:31], a[160:163], v[140:143]
    buffer_load_dwordx4 v240, s[24:27], s41 offen offset:1024 sc1 lds
    v_mfma_f32_16x16x32_bf16 v[140:143], a[24:27], a[152:155], v[140:143]
    s_waitcnt lgkmcnt(4)
    v_mfma_f32_16x16x32_bf16 v[164:167], a[32:35], a[152:155], v[164:167]
    ds_read_b128 a[0:3], v233 offset:3072
    v_mfma_f32_16x16x32_bf16 v[164:167], a[36:39], a[160:163], v[164:167]
    buffer_load_dwordx4 v240, s[24:27], s41 offen offset:2048 sc1 lds
    v_mfma_f32_16x16x32_bf16 v[204:207], a[36:39], a[164:167], v[204:207]
    ds_read_b128 a[4:7], v233 offset:13312
    v_mfma_f32_16x16x32_bf16 v[204:207], a[32:35], a[156:159], v[204:207]
    v_mfma_f32_16x16x32_bf16 v[184:187], a[40:43], a[156:159], v[184:187]
    buffer_load_dwordx4 v240, s[24:27], s41 offen offset:3072 sc1 lds
    s_add_u32 m0, m0, 4096
    v_mfma_f32_16x16x32_bf16 v[184:187], a[44:47], a[164:167], v[184:187]
    ds_read_b128 a[8:11], v230 offset:3072
    v_mfma_f32_16x16x32_bf16 v[144:147], a[44:47], a[160:163], v[144:147]
    ds_read_b128 a[12:15], v230 offset:13312
    v_mfma_f32_16x16x32_bf16 v[144:147], a[40:43], a[152:155], v[144:147]
    buffer_load_dwordx4 v244, s[24:27], s41 offen sc1 lds
    s_waitcnt vmcnt(46) lgkmcnt(4)
    v_mfma_f32_16x16x32_bf16 v[148:151], a[48:51], a[168:171], v[148:151]
    ds_read_b128 a[16:19], v233 offset:4096
    s_add_u32 s42, s73, 90112
    v_mfma_f32_16x16x32_bf16 v[148:151], a[52:55], a[176:179], v[148:151]
    ds_read_b128 a[20:23], v233 offset:14336
    v_mfma_f32_16x16x32_bf16 v[188:191], a[52:55], a[180:183], v[188:191]
    buffer_load_dwordx4 a[248:251], v242, s[20:23], s42 offen sc1
    v_mfma_f32_16x16x32_bf16 v[188:191], a[48:51], a[172:175], v[188:191]
    v_mfma_f32_16x16x32_bf16 v[168:171], a[56:59], a[172:175], v[168:171]
    ds_read_b128 a[24:27], v230 offset:4096
    v_mfma_f32_16x16x32_bf16 v[168:171], a[60:63], a[180:183], v[168:171]
    buffer_load_dwordx4 a[252:255], v243, s[20:23], s42 offen sc1
    s_add_u32 s42, s73, 94208
    v_mfma_f32_16x16x32_bf16 v[128:131], a[60:63], a[176:179], v[128:131]
    ds_read_b128 a[28:31], v230 offset:14336
    v_mfma_f32_16x16x32_bf16 v[128:131], a[56:59], a[168:171], v[128:131]
    s_waitcnt lgkmcnt(4)
    v_mfma_f32_16x16x32_bf16 v[152:155], a[0:3], a[168:171], v[152:155]
    buffer_load_dwordx4 a[144:147], v242, s[20:23], s42 offen sc1
    v_mfma_f32_16x16x32_bf16 v[152:155], a[4:7], a[176:179], v[152:155]
    ds_read_b128 a[32:35], v233 offset:5120
    v_mfma_f32_16x16x32_bf16 v[192:195], a[4:7], a[180:183], v[192:195]
    ds_read_b128 a[36:39], v233 offset:15360
    v_mfma_f32_16x16x32_bf16 v[192:195], a[0:3], a[172:175], v[192:195]
    buffer_load_dwordx4 a[148:151], v243, s[20:23], s42 offen sc1
    v_mfma_f32_16x16x32_bf16 v[172:175], a[8:11], a[172:175], v[172:175]
    ds_read_b128 a[40:43], v230 offset:5120
    v_mfma_f32_16x16x32_bf16 v[172:175], a[12:15], a[180:183], v[172:175]
    ds_read_b128 a[44:47], v230 offset:15360
    v_mfma_f32_16x16x32_bf16 v[132:135], a[12:15], a[176:179], v[132:135]
    buffer_store_dwordx2 v[72:73], v255, s[64:67], s58 offen offset:3072 sc1
    s_add_u32 s58, s58, 8384512
    v_mfma_f32_16x16x32_bf16 v[132:135], a[8:11], a[168:171], v[132:135]
    s_waitcnt lgkmcnt(4)
    v_mfma_f32_16x16x32_bf16 v[156:159], a[16:19], a[168:171], v[156:159]
    ds_read_b128 a[48:51], v233 offset:6144
    v_mfma_f32_16x16x32_bf16 v[156:159], a[20:23], a[176:179], v[156:159]
    ds_read_b128 a[52:55], v233 offset:16384
    v_mfma_f32_16x16x32_bf16 v[196:199], a[20:23], a[180:183], v[196:199]
    v_mfma_f32_16x16x32_bf16 v[196:199], a[16:19], a[172:175], v[196:199]
    v_mfma_f32_16x16x32_bf16 v[176:179], a[24:27], a[172:175], v[176:179]
    ds_read_b128 a[56:59], v230 offset:6144
    v_mfma_f32_16x16x32_bf16 v[176:179], a[28:31], a[180:183], v[176:179]
    ds_read_b128 a[60:63], v230 offset:16384
    v_mfma_f32_16x16x32_bf16 v[136:139], a[28:31], a[176:179], v[136:139]
    v_mfma_f32_16x16x32_bf16 v[136:139], a[24:27], a[168:171], v[136:139]
    s_waitcnt vmcnt(45)
    s_barrier
    s_waitcnt lgkmcnt(4)
    v_mfma_f32_16x16x32_bf16 v[160:163], a[32:35], a[168:171], v[160:163]
    ds_read_b128 a[0:3], v233 offset:22528
    s_add_u32 s41, s75, 133120
    v_mfma_f32_16x16x32_bf16 v[160:163], a[36:39], a[176:179], v[160:163]
    ds_read_b128 a[4:7], v231 offset:0
    s_bfe_u32 s51, 0x1a00178, s18
    v_mfma_f32_16x16x32_bf16 v[200:203], a[36:39], a[180:183], v[200:203]
    s_lshl_b32 s51, s51, 8
    s_add_u32 m0, s51, s76
    v_mfma_f32_16x16x32_bf16 v[200:203], a[32:35], a[172:175], v[200:203]
    buffer_load_dwordx4 v240, s[24:27], s41 offen offset:0 sc1 lds
    v_mfma_f32_16x16x32_bf16 v[180:183], a[40:43], a[172:175], v[180:183]
    ds_read_b128 a[8:11], v233 offset:23552
    v_mfma_f32_16x16x32_bf16 v[180:183], a[44:47], a[180:183], v[180:183]
    ds_read_b128 a[12:15], v231 offset:1024
    v_mfma_f32_16x16x32_bf16 v[140:143], a[44:47], a[176:179], v[140:143]
    buffer_load_dwordx4 v240, s[24:27], s41 offen offset:1024 sc1 lds
    v_mfma_f32_16x16x32_bf16 v[140:143], a[40:43], a[168:171], v[140:143]
    s_waitcnt lgkmcnt(4)
    v_mfma_f32_16x16x32_bf16 v[164:167], a[48:51], a[168:171], v[164:167]
    ds_read_b128 a[16:19], v233 offset:24576
    v_mfma_f32_16x16x32_bf16 v[164:167], a[52:55], a[176:179], v[164:167]
    buffer_load_dwordx4 v240, s[24:27], s41 offen offset:2048 sc1 lds
    v_mfma_f32_16x16x32_bf16 v[204:207], a[52:55], a[180:183], v[204:207]
    ds_read_b128 a[20:23], v231 offset:2048
    v_mfma_f32_16x16x32_bf16 v[204:207], a[48:51], a[172:175], v[204:207]
    v_mfma_f32_16x16x32_bf16 v[184:187], a[56:59], a[172:175], v[184:187]
    buffer_load_dwordx4 v240, s[24:27], s41 offen offset:3072 sc1 lds
    s_add_u32 m0, m0, 4096
    v_mfma_f32_16x16x32_bf16 v[184:187], a[60:63], a[180:183], v[184:187]
    ds_read_b128 a[24:27], v233 offset:25600
    v_mfma_f32_16x16x32_bf16 v[144:147], a[60:63], a[176:179], v[144:147]
    ds_read_b128 a[28:31], v231 offset:3072
    v_mfma_f32_16x16x32_bf16 v[144:147], a[56:59], a[168:171], v[144:147]
    buffer_load_dwordx4 v244, s[24:27], s41 offen sc1 lds
    s_waitcnt vmcnt(46) lgkmcnt(4)
    v_mfma_f32_16x16x32_bf16 v[148:151], a[0:3], a[184:187], v[148:151]
    ds_read_b128 a[32:35], v233 offset:26624
    s_add_u32 s42, s73, 106496
    v_mfma_f32_16x16x32_bf16 v[148:151], a[4:7], a[192:195], v[148:151]
    ds_read_b128 a[36:39], v231 offset:4096
    v_mfma_f32_16x16x32_bf16 v[188:191], a[4:7], a[196:199], v[188:191]
    buffer_load_dwordx4 a[152:155], v242, s[20:23], s42 offen sc1
    v_mfma_f32_16x16x32_bf16 v[188:191], a[0:3], a[188:191], v[188:191]
    s_waitcnt vmcnt(41)
    s_barrier
    v_mfma_f32_16x16x32_bf16 v[192:195], a[8:11], a[188:191], v[192:195]
    ds_read_b128 a[40:43], v232 offset:0
    v_mfma_f32_16x16x32_bf16 v[192:195], a[12:15], a[196:199], v[192:195]
    buffer_load_dwordx4 a[156:159], v243, s[20:23], s42 offen sc1
    s_add_u32 s42, s73, 110592
    v_mfma_f32_16x16x32_bf16 v[152:155], a[12:15], a[192:195], v[152:155]
    ds_read_b128 a[44:47], v231 offset:10240
    v_mfma_f32_16x16x32_bf16 v[152:155], a[8:11], a[184:187], v[152:155]
    s_waitcnt lgkmcnt(4)
    v_mfma_f32_16x16x32_bf16 v[156:159], a[16:19], a[184:187], v[156:159]
    buffer_load_dwordx4 a[160:163], v242, s[20:23], s42 offen sc1
    v_mfma_f32_16x16x32_bf16 v[156:159], a[20:23], a[192:195], v[156:159]
    ds_read_b128 a[48:51], v232 offset:1024
    v_mfma_f32_16x16x32_bf16 v[196:199], a[20:23], a[196:199], v[196:199]
    ds_read_b128 a[52:55], v231 offset:11264
    v_mfma_f32_16x16x32_bf16 v[196:199], a[16:19], a[188:191], v[196:199]
    buffer_load_dwordx4 a[164:167], v243, s[20:23], s42 offen sc1
    s_add_u32 s41, s75, 153600
    v_mfma_f32_16x16x32_bf16 v[200:203], a[24:27], a[188:191], v[200:203]
    ds_read_b128 a[56:59], v232 offset:2048
    s_bfe_u32 s51, 0x20801c8, s18
    v_mfma_f32_16x16x32_bf16 v[200:203], a[28:31], a[196:199], v[200:203]
    ds_read_b128 a[60:63], v231 offset:12288
    s_lshl_b32 s51, s51, 8
    v_mfma_f32_16x16x32_bf16 v[160:163], a[28:31], a[192:195], v[160:163]
    s_add_u32 m0, s51, s76
    v_mfma_f32_16x16x32_bf16 v[160:163], a[24:27], a[184:187], v[160:163]
    buffer_load_dwordx4 v240, s[24:27], s41 offen offset:0 sc1 lds
    s_waitcnt lgkmcnt(4)
    v_mfma_f32_16x16x32_bf16 v[164:167], a[32:35], a[184:187], v[164:167]
    ds_read_b128 a[0:3], v232 offset:3072
    v_mfma_f32_16x16x32_bf16 v[164:167], a[36:39], a[192:195], v[164:167]
    ds_read_b128 a[4:7], v231 offset:13312
    v_mfma_f32_16x16x32_bf16 v[204:207], a[36:39], a[196:199], v[204:207]
    buffer_load_dwordx4 v240, s[24:27], s41 offen offset:1024 sc1 lds
    v_mfma_f32_16x16x32_bf16 v[204:207], a[32:35], a[188:191], v[204:207]
    s_waitcnt vmcnt(42)
    v_mfma_f32_16x16x32_bf16 v[148:151], a[40:43], a[200:203], v[148:151]
    ds_read_b128 a[8:11], v232 offset:4096
    s_waitcnt vmcnt(11)
    v_mfma_f32_16x16x32_bf16 v[148:151], a[44:47], a[208:211], v[148:151]
    buffer_store_dword v234, v245, s[68:71], s78 offen offset:0 sc1
    s_add_u32 s42, s73, 122880
    v_mfma_f32_16x16x32_bf16 v[188:191], a[44:47], a[212:215], v[188:191]
    ds_read_b128 a[12:15], v231 offset:14336
    v_mfma_f32_16x16x32_bf16 v[188:191], a[40:43], a[204:207], v[188:191]
    s_barrier
    s_waitcnt lgkmcnt(4)
    v_mfma_f32_16x16x32_bf16 v[192:195], a[48:51], a[204:207], v[192:195]
    buffer_load_dwordx4 a[168:171], v242, s[20:23], s42 offen sc1
    v_mfma_f32_16x16x32_bf16 v[192:195], a[52:55], a[212:215], v[192:195]
    ds_read_b128 a[16:19], v231 offset:20480
    v_mfma_f32_16x16x32_bf16 v[152:155], a[52:55], a[208:211], v[152:155]
    ds_read_b128 a[20:23], v232 offset:10240
    v_mfma_f32_16x16x32_bf16 v[152:155], a[48:51], a[200:203], v[152:155]
    buffer_load_dwordx4 a[172:175], v243, s[20:23], s42 offen sc1
    s_add_u32 s42, s73, 126976
    v_mfma_f32_16x16x32_bf16 v[156:159], a[56:59], a[200:203], v[156:159]
    ds_read_b128 a[24:27], v231 offset:21504
    v_mfma_f32_16x16x32_bf16 v[156:159], a[60:63], a[208:211], v[156:159]
    ds_read_b128 a[28:31], v232 offset:11264
    v_mfma_f32_16x16x32_bf16 v[196:199], a[60:63], a[212:215], v[196:199]
    buffer_load_dwordx4 a[176:179], v242, s[20:23], s42 offen sc1
    v_mfma_f32_16x16x32_bf16 v[196:199], a[56:59], a[204:207], v[196:199]
    s_waitcnt lgkmcnt(4)
    v_mfma_f32_16x16x32_bf16 v[200:203], a[0:3], a[204:207], v[200:203]
    ds_read_b128 a[32:35], v231 offset:22528
    v_mfma_f32_16x16x32_bf16 v[200:203], a[4:7], a[212:215], v[200:203]
    buffer_load_dwordx4 a[180:183], v243, s[20:23], s42 offen sc1
    v_mfma_f32_16x16x32_bf16 v[160:163], a[4:7], a[208:211], v[160:163]
    ds_read_b128 a[36:39], v232 offset:12288
    v_mfma_f32_16x16x32_bf16 v[160:163], a[0:3], a[200:203], v[160:163]
    v_mfma_f32_16x16x32_bf16 v[164:167], a[8:11], a[200:203], v[164:167]
    buffer_load_dwordx4 v240, s[24:27], s41 offen offset:2048 sc1 lds
    v_mfma_f32_16x16x32_bf16 v[164:167], a[12:15], a[208:211], v[164:167]
    ds_read_b128 a[40:43], v231 offset:23552
    v_mfma_f32_16x16x32_bf16 v[204:207], a[12:15], a[212:215], v[204:207]
    ds_read_b128 a[44:47], v232 offset:13312
    v_mfma_f32_16x16x32_bf16 v[204:207], a[8:11], a[204:207], v[204:207]
    buffer_load_dwordx4 v240, s[24:27], s41 offen offset:3072 sc1 lds
    s_add_u32 m0, m0, 4096
    s_waitcnt lgkmcnt(4)
    v_mfma_f32_16x16x32_bf16 v[148:151], a[16:19], a[216:219], v[148:151]
    ds_read_b128 a[48:51], v231 offset:24576
    v_mfma_f32_16x16x32_bf16 v[148:151], a[20:23], a[224:227], v[148:151]
    ds_read_b128 a[52:55], v232 offset:14336
    v_mfma_f32_16x16x32_bf16 v[188:191], a[20:23], a[228:231], v[188:191]
    buffer_load_dwordx4 v244, s[24:27], s41 offen sc1 lds
    v_mfma_f32_16x16x32_bf16 v[188:191], a[16:19], a[220:223], v[188:191]
    s_barrier
    v_mfma_f32_16x16x32_bf16 v[192:195], a[24:27], a[220:223], v[192:195]
    ds_read_b128 a[56:59], v232 offset:20480
    v_mfma_f32_16x16x32_bf16 v[192:195], a[28:31], a[228:231], v[192:195]
    ds_read_b128 a[60:63], v231 offset:55296
    v_mfma_f32_16x16x32_bf16 v[152:155], a[28:31], a[224:227], v[152:155]
    v_mfma_f32_16x16x32_bf16 v[152:155], a[24:27], a[216:219], v[152:155]
    s_waitcnt lgkmcnt(4)
    v_mfma_f32_16x16x32_bf16 v[156:159], a[32:35], a[216:219], v[156:159]
    ds_read_b128 a[0:3], v232 offset:21504
    v_mfma_f32_16x16x32_bf16 v[156:159], a[36:39], a[224:227], v[156:159]
    ds_read_b128 a[4:7], v231 offset:56320
    v_mfma_f32_16x16x32_bf16 v[196:199], a[36:39], a[228:231], v[196:199]
    v_mfma_f32_16x16x32_bf16 v[196:199], a[32:35], a[220:223], v[196:199]
    v_mfma_f32_16x16x32_bf16 v[200:203], a[40:43], a[220:223], v[200:203]
    ds_read_b128 a[8:11], v232 offset:22528
    v_mfma_f32_16x16x32_bf16 v[200:203], a[44:47], a[228:231], v[200:203]
    ds_read_b128 a[12:15], v231 offset:57344
    v_mfma_f32_16x16x32_bf16 v[160:163], a[44:47], a[224:227], v[160:163]
    v_mfma_f32_16x16x32_bf16 v[160:163], a[40:43], a[216:219], v[160:163]
    s_waitcnt lgkmcnt(4)
    v_mfma_f32_16x16x32_bf16 v[164:167], a[48:51], a[216:219], v[164:167]
    ds_read_b128 a[16:19], v232 offset:23552
    v_mfma_f32_16x16x32_bf16 v[164:167], a[52:55], a[224:227], v[164:167]
    ds_read_b128 a[20:23], v231 offset:58368
    v_mfma_f32_16x16x32_bf16 v[204:207], a[52:55], a[228:231], v[204:207]
    v_mfma_f32_16x16x32_bf16 v[204:207], a[48:51], a[220:223], v[204:207]
    v_mfma_f32_16x16x32_bf16 v[148:151], a[56:59], a[232:235], v[148:151]
    ds_read_b128 a[24:27], v232 offset:24576
    v_mfma_f32_16x16x32_bf16 v[148:151], a[60:63], a[240:243], v[148:151]
    ds_read_b128 a[28:31], v231 offset:59392
    v_mfma_f32_16x16x32_bf16 v[188:191], a[60:63], a[244:247], v[188:191]
    v_mfma_f32_16x16x32_bf16 v[188:191], a[56:59], a[236:239], v[188:191]
    s_barrier
    s_waitcnt lgkmcnt(4)
    v_mfma_f32_16x16x32_bf16 v[192:195], a[0:3], a[236:239], v[192:195]
    ds_read_b128 a[32:35], v231 offset:30720
    v_mfma_f32_16x16x32_bf16 v[192:195], a[4:7], a[244:247], v[192:195]
    ds_read_b128 a[36:39], v231 offset:40960
    v_mfma_f32_16x16x32_bf16 v[152:155], a[4:7], a[240:243], v[152:155]
    v_mfma_f32_16x16x32_bf16 v[152:155], a[0:3], a[232:235], v[152:155]
    v_mfma_f32_16x16x32_bf16 v[156:159], a[8:11], a[232:235], v[156:159]
    ds_read_b128 a[40:43], v231 offset:31744
    v_mfma_f32_16x16x32_bf16 v[156:159], a[12:15], a[240:243], v[156:159]
    ds_read_b128 a[44:47], v231 offset:41984
    v_mfma_f32_16x16x32_bf16 v[196:199], a[12:15], a[244:247], v[196:199]
    v_mfma_f32_16x16x32_bf16 v[196:199], a[8:11], a[236:239], v[196:199]
    s_waitcnt lgkmcnt(4)
    v_mfma_f32_16x16x32_bf16 v[200:203], a[16:19], a[236:239], v[200:203]
    ds_read_b128 a[48:51], v231 offset:32768
    v_mfma_f32_16x16x32_bf16 v[200:203], a[20:23], a[244:247], v[200:203]
    ds_read_b128 a[52:55], v231 offset:43008
    v_mfma_f32_16x16x32_bf16 v[160:163], a[20:23], a[240:243], v[160:163]
    v_mfma_f32_16x16x32_bf16 v[160:163], a[16:19], a[232:235], v[160:163]
    v_mfma_f32_16x16x32_bf16 v[164:167], a[24:27], a[232:235], v[164:167]
    ds_read_b128 a[56:59], v231 offset:33792
    v_mfma_f32_16x16x32_bf16 v[164:167], a[28:31], a[240:243], v[164:167]
    ds_read_b128 a[60:63], v231 offset:44032
    v_mfma_f32_16x16x32_bf16 v[204:207], a[28:31], a[244:247], v[204:207]
    v_mfma_f32_16x16x32_bf16 v[204:207], a[24:27], a[236:239], v[204:207]
    s_waitcnt lgkmcnt(4)
    v_mfma_f32_16x16x32_bf16 v[148:151], a[32:35], a[248:251], v[148:151]
    buffer_load_dword v252, v254, s[68:71], s54 offen sc1
    v_mfma_f32_16x16x32_bf16 v[148:151], a[36:39], a[144:147], v[148:151]
    ds_read_b128 a[0:3], v231 offset:34816
    v_mfma_f32_16x16x32_bf16 v[188:191], a[36:39], a[148:151], v[188:191]
    ds_read_b128 a[4:7], v231 offset:45056
    v_mfma_f32_16x16x32_bf16 v[188:191], a[32:35], a[252:255], v[188:191]
    s_waitcnt vmcnt(15)
    s_barrier
    v_mfma_f32_16x16x32_bf16 v[192:195], a[40:43], a[252:255], v[192:195]
    ds_read_b128 a[8:11], v232 offset:30720
    v_mfma_f32_16x16x32_bf16 v[192:195], a[44:47], a[148:151], v[192:195]
    ds_read_b128 a[12:15], v232 offset:40960
    v_mfma_f32_16x16x32_bf16 v[152:155], a[44:47], a[144:147], v[152:155]
    v_mfma_f32_16x16x32_bf16 v[152:155], a[40:43], a[248:251], v[152:155]
    s_waitcnt lgkmcnt(4)
    v_mfma_f32_16x16x32_bf16 v[156:159], a[48:51], a[248:251], v[156:159]
    ds_read_b128 a[16:19], v232 offset:31744
    v_mfma_f32_16x16x32_bf16 v[156:159], a[52:55], a[144:147], v[156:159]
    ds_read_b128 a[20:23], v232 offset:41984
    v_mfma_f32_16x16x32_bf16 v[196:199], a[52:55], a[148:151], v[196:199]
    v_mfma_f32_16x16x32_bf16 v[196:199], a[48:51], a[252:255], v[196:199]
    v_mfma_f32_16x16x32_bf16 v[200:203], a[56:59], a[252:255], v[200:203]
    ds_read_b128 a[24:27], v232 offset:32768
    v_mfma_f32_16x16x32_bf16 v[200:203], a[60:63], a[148:151], v[200:203]
    ds_read_b128 a[28:31], v232 offset:43008
    v_mfma_f32_16x16x32_bf16 v[160:163], a[60:63], a[144:147], v[160:163]
    v_mfma_f32_16x16x32_bf16 v[160:163], a[56:59], a[248:251], v[160:163]
    s_waitcnt lgkmcnt(4)
    v_mfma_f32_16x16x32_bf16 v[164:167], a[0:3], a[248:251], v[164:167]
    ds_read_b128 a[32:35], v232 offset:33792
    v_mfma_f32_16x16x32_bf16 v[164:167], a[4:7], a[144:147], v[164:167]
    ds_read_b128 a[36:39], v232 offset:44032
    v_mfma_f32_16x16x32_bf16 v[204:207], a[4:7], a[148:151], v[204:207]
    v_mfma_f32_16x16x32_bf16 v[204:207], a[0:3], a[252:255], v[204:207]
    s_waitcnt vmcnt(0)
    v_cmp_ne_u32 vcc, s0, v252
    s_nop 1
    s_cbranch_vccnz K1_spin_pf
K1_pf_ok:
    v_mfma_f32_16x16x32_bf16 v[148:151], a[8:11], a[152:155], v[148:151]
    buffer_load_dwordx4 v[32:35], v240, s[64:67], s55 offen offset:0 sc1
    v_mfma_f32_16x16x32_bf16 v[148:151], a[12:15], a[160:163], v[148:151]
    ds_read_b128 a[40:43], v232 offset:34816
    v_mfma_f32_16x16x32_bf16 v[188:191], a[12:15], a[164:167], v[188:191]
    ds_read_b128 a[44:47], v232 offset:45056
    v_mfma_f32_16x16x32_bf16 v[188:191], a[8:11], a[156:159], v[188:191]
    buffer_load_dwordx4 v[36:39], v240, s[64:67], s55 offen offset:1024 sc1
    s_barrier
    s_waitcnt lgkmcnt(4)
    v_mfma_f32_16x16x32_bf16 v[192:195], a[16:19], a[156:159], v[192:195]
    ds_read_b128 a[48:51], v232 offset:51200
    v_mfma_f32_16x16x32_bf16 v[192:195], a[20:23], a[164:167], v[192:195]
    ds_read_b128 a[52:55], v233 offset:2048
    v_mfma_f32_16x16x32_bf16 v[152:155], a[20:23], a[160:163], v[152:155]
    buffer_load_dwordx2 v[40:41], v240, s[64:67], s55 offen offset:2048 sc1
    s_add_u32 s55, s55, 8388608
    v_mfma_f32_16x16x32_bf16 v[152:155], a[16:19], a[152:155], v[152:155]
    v_mfma_f32_16x16x32_bf16 v[156:159], a[24:27], a[152:155], v[156:159]
    ds_read_b128 a[56:59], v232 offset:52224
    v_mfma_f32_16x16x32_bf16 v[156:159], a[28:31], a[160:163], v[156:159]
    buffer_load_dwordx4 v[44:47], v240, s[64:67], s57 offen offset:1024 sc1
    v_mfma_f32_16x16x32_bf16 v[196:199], a[28:31], a[164:167], v[196:199]
    ds_read_b128 a[60:63], v233 offset:3072
    v_mfma_f32_16x16x32_bf16 v[196:199], a[24:27], a[156:159], v[196:199]
    s_waitcnt lgkmcnt(4)
    v_mfma_f32_16x16x32_bf16 v[200:203], a[32:35], a[156:159], v[200:203]
    buffer_load_dwordx4 v[48:51], v240, s[64:67], s57 offen offset:2048 sc1
    v_mfma_f32_16x16x32_bf16 v[200:203], a[36:39], a[164:167], v[200:203]
    ds_read_b128 a[0:3], v232 offset:53248
    v_mfma_f32_16x16x32_bf16 v[160:163], a[36:39], a[160:163], v[160:163]
    ds_read_b128 a[4:7], v233 offset:4096
    v_mfma_f32_16x16x32_bf16 v[160:163], a[32:35], a[152:155], v[160:163]
    buffer_load_dwordx2 v[52:53], v240, s[64:67], s57 offen offset:8 sc1
K1_pg16:
    s_cbranch_execz K1_wb3
    s_add_u32 s57, s57, 8388608
    v_mfma_f32_16x16x32_bf16 v[164:167], a[40:43], a[152:155], v[164:167]
    ds_read_b128 a[8:11], v232 offset:54272
    v_mfma_f32_16x16x32_bf16 v[164:167], a[44:47], a[160:163], v[164:167]
    ds_read_b128 a[12:15], v233 offset:5120
    v_mfma_f32_16x16x32_bf16 v[204:207], a[44:47], a[164:167], v[204:207]
    buffer_load_dwordx4 v[56:59], v240, s[64:67], s56 offen offset:0 sc1
    v_mfma_f32_16x16x32_bf16 v[204:207], a[40:43], a[156:159], v[204:207]
    s_waitcnt lgkmcnt(4)
    v_mfma_f32_16x16x32_bf16 v[148:151], a[48:51], a[168:171], v[148:151]
    ds_read_b128 a[16:19], v232 offset:55296
    v_mfma_f32_16x16x32_bf16 v[148:151], a[52:55], a[176:179], v[148:151]
    buffer_load_dwordx4 v[60:63], v240, s[64:67], s56 offen offset:1024 sc1
    v_mfma_f32_16x16x32_bf16 v[188:191], a[52:55], a[180:183], v[188:191]
    ds_read_b128 a[20:23], v233 offset:6144
    v_mfma_f32_16x16x32_bf16 v[188:191], a[48:51], a[172:175], v[188:191]
    v_mfma_f32_16x16x32_bf16 v[192:195], a[56:59], a[172:175], v[192:195]
    buffer_load_dwordx2 v[64:65], v255, s[64:67], s56 offen offset:2048 sc1
    s_add_u32 s56, s56, 8388608
    v_mfma_f32_16x16x32_bf16 v[192:195], a[60:63], a[180:183], v[192:195]
    ds_read_b128 a[24:27], v230 offset:22528
    v_mfma_f32_16x16x32_bf16 v[152:155], a[60:63], a[176:179], v[152:155]
    ds_read_b128 a[28:31], v228 offset:0
    v_mfma_f32_16x16x32_bf16 v[152:155], a[56:59], a[168:171], v[152:155]
    s_waitcnt lgkmcnt(4)
    v_mfma_f32_16x16x32_bf16 v[156:159], a[0:3], a[168:171], v[156:159]
    ds_read_b128 a[32:35], v230 offset:23552
    v_mfma_f32_16x16x32_bf16 v[156:159], a[4:7], a[176:179], v[156:159]
    ds_read_b128 a[36:39], v228 offset:1024
    v_mfma_f32_16x16x32_bf16 v[196:199], a[4:7], a[180:183], v[196:199]
    v_mfma_f32_16x16x32_bf16 v[196:199], a[0:3], a[172:175], v[196:199]
    v_mfma_f32_16x16x32_bf16 v[200:203], a[8:11], a[172:175], v[200:203]
    ds_read_b128 a[40:43], v230 offset:24576
    v_mfma_f32_16x16x32_bf16 v[200:203], a[12:15], a[180:183], v[200:203]
    ds_read_b128 a[44:47], v228 offset:2048
    v_mfma_f32_16x16x32_bf16 v[160:163], a[12:15], a[176:179], v[160:163]
    v_mfma_f32_16x16x32_bf16 v[160:163], a[8:11], a[168:171], v[160:163]
    s_waitcnt lgkmcnt(4)
    v_mfma_f32_16x16x32_bf16 v[164:167], a[16:19], a[168:171], v[164:167]
    ds_read_b128 a[48:51], v230 offset:25600
    v_mfma_f32_16x16x32_bf16 v[164:167], a[20:23], a[176:179], v[164:167]
    ds_read_b128 a[52:55], v228 offset:3072
    v_mfma_f32_16x16x32_bf16 v[204:207], a[20:23], a[180:183], v[204:207]
    v_mfma_f32_16x16x32_bf16 v[204:207], a[16:19], a[172:175], v[204:207]
    v_mfma_f32_16x16x32_bf16 v[168:171], a[28:31], a[196:199], v[168:171]
    ds_read_b128 a[56:59], v230 offset:26624
    v_mfma_f32_16x16x32_bf16 v[168:171], a[24:27], a[188:191], v[168:171]
    ds_read_b128 a[60:63], v228 offset:4096
    s_waitcnt lgkmcnt(4)
    v_mfma_f32_16x16x32_bf16 v[172:175], a[32:35], a[188:191], v[172:175]
    ds_read_b128 a[0:3], v229 offset:0
    v_cvt_pk_bf16_f32 v148, v148, v149
    v_cvt_pk_bf16_f32 v149, v150, v151
    v_mfma_f32_16x16x32_bf16 v[172:175], a[36:39], a[196:199], v[172:175]
    ds_read_b128 a[4:7], v228 offset:10240
    v_cvt_pk_bf16_f32 v150, v152, v153
    v_cvt_pk_bf16_f32 v151, v154, v155
    v_mfma_f32_16x16x32_bf16 v[176:179], a[44:47], a[196:199], v[176:179]
    ds_read_b128 a[8:11], v229 offset:1024
    v_cvt_pk_bf16_f32 v152, v156, v157
    v_cvt_pk_bf16_f32 v153, v158, v159
    v_mfma_f32_16x16x32_bf16 v[176:179], a[40:43], a[188:191], v[176:179]
    ds_read_b128 a[12:15], v228 offset:11264
    v_cvt_pk_bf16_f32 v154, v160, v161
    v_cvt_pk_bf16_f32 v155, v162, v163
    s_waitcnt lgkmcnt(4)
    v_mfma_f32_16x16x32_bf16 v[180:183], a[48:51], a[188:191], v[180:183]
    ds_read_b128 a[16:19], v229 offset:2048
    v_cvt_pk_bf16_f32 v156, v164, v165
    v_cvt_pk_bf16_f32 v157, v166, v167
    v_mfma_f32_16x16x32_bf16 v[180:183], a[52:55], a[196:199], v[180:183]
    ds_read_b128 a[20:23], v228 offset:12288
    buffer_store_dwordx4 v[148:151], v240, s[64:67], s58 offen offset:0 sc1
    buffer_store_dwordx4 v[152:155], v240, s[64:67], s58 offen offset:1024 sc1
    v_mfma_f32_16x16x32_bf16 v[184:187], a[60:63], a[196:199], v[184:187]
    ds_read_b128 a[24:27], v229 offset:3072
    v_cvt_pk_bf16_f32 v158, v204, v205
    v_cvt_pk_bf16_f32 v159, v206, v207
    v_mfma_f32_16x16x32_bf16 v[184:187], a[56:59], a[188:191], v[184:187]
    ds_read_b128 a[28:31], v228 offset:13312
    v_cvt_pk_bf16_f32 v160, v188, v189
    v_cvt_pk_bf16_f32 v161, v190, v191
    s_waitcnt lgkmcnt(4)
    v_mfma_f32_16x16x32_bf16 v[168:171], a[4:7], a[212:215], v[168:171]
    ds_read_b128 a[32:35], v229 offset:4096
    v_cvt_pk_bf16_f32 v162, v192, v193
    v_cvt_pk_bf16_f32 v163, v194, v195
    v_mfma_f32_16x16x32_bf16 v[168:171], a[0:3], a[204:207], v[168:171]
    ds_read_b128 a[36:39], v228 offset:14336
    v_cvt_pk_bf16_f32 v164, v196, v197
    v_cvt_pk_bf16_f32 v165, v198, v199
    v_mfma_f32_16x16x32_bf16 v[172:175], a[8:11], a[204:207], v[172:175]
    ds_read_b128 a[40:43], v228 offset:20480
    v_cvt_pk_bf16_f32 v166, v200, v201
    v_cvt_pk_bf16_f32 v167, v202, v203
    v_mfma_f32_16x16x32_bf16 v[172:175], a[12:15], a[212:215], v[172:175]
    ds_read_b128 a[44:47], v229 offset:10240
    buffer_store_dwordx4 v[156:159], v240, s[64:67], s58 offen offset:2048 sc1
    buffer_store_dwordx4 v[160:163], v240, s[64:67], s58 offen offset:3072 sc1
    s_add_u32 s58, s58, 4096
    s_waitcnt lgkmcnt(4)
    v_mfma_f32_16x16x32_bf16 v[176:179], a[20:23], a[212:215], v[176:179]
    ds_read_b128 a[48:51], v228 offset:21504
    buffer_store_dwordx4 v[164:167], v240, s[64:67], s58 offen offset:0 sc1
    v_mfma_f32_16x16x32_bf16 v[176:179], a[16:19], a[204:207], v[176:179]
    ds_read_b128 a[52:55], v229 offset:11264
    v_mfma_f32_16x16x32_bf16 v[180:183], a[24:27], a[204:207], v[180:183]
    ds_read_b128 a[56:59], v228 offset:22528
    v_mfma_f32_16x16x32_bf16 v[180:183], a[28:31], a[212:215], v[180:183]
    ds_read_b128 a[60:63], v229 offset:12288
    s_waitcnt lgkmcnt(4)
    v_mfma_f32_16x16x32_bf16 v[184:187], a[36:39], a[212:215], v[184:187]
    ds_read_b128 a[0:3], v228 offset:23552
    v_mfma_f32_16x16x32_bf16 v[184:187], a[32:35], a[204:207], v[184:187]
    ds_read_b128 a[4:7], v229 offset:13312
    v_mfma_f32_16x16x32_bf16 v[168:171], a[44:47], a[228:231], v[168:171]
    ds_read_b128 a[8:11], v228 offset:24576
    v_mfma_f32_16x16x32_bf16 v[168:171], a[40:43], a[220:223], v[168:171]
    ds_read_b128 a[12:15], v229 offset:14336
    s_waitcnt lgkmcnt(4)
    v_mfma_f32_16x16x32_bf16 v[172:175], a[48:51], a[220:223], v[172:175]
    ds_read_b128 a[16:19], v229 offset:20480
    v_mfma_f32_16x16x32_bf16 v[172:175], a[52:55], a[228:231], v[172:175]
    ds_read_b128 a[20:23], v228 offset:55296
    v_mfma_f32_16x16x32_bf16 v[176:179], a[60:63], a[228:231], v[176:179]
    ds_read_b128 a[24:27], v229 offset:21504
    v_mfma_f32_16x16x32_bf16 v[176:179], a[56:59], a[220:223], v[176:179]
    ds_read_b128 a[28:31], v228 offset:56320
    s_waitcnt lgkmcnt(4)
    v_mfma_f32_16x16x32_bf16 v[180:183], a[0:3], a[220:223], v[180:183]
    ds_read_b128 a[32:35], v229 offset:22528
    v_mfma_f32_16x16x32_bf16 v[180:183], a[4:7], a[228:231], v[180:183]
    ds_read_b128 a[36:39], v228 offset:57344
    v_mfma_f32_16x16x32_bf16 v[184:187], a[12:15], a[228:231], v[184:187]
    ds_read_b128 a[40:43], v229 offset:23552
    v_mfma_f32_16x16x32_bf16 v[184:187], a[8:11], a[220:223], v[184:187]
    ds_read_b128 a[44:47], v228 offset:58368
    s_waitcnt lgkmcnt(4)
    v_mfma_f32_16x16x32_bf16 v[168:171], a[20:23], a[244:247], v[168:171]
    ds_read_b128 a[48:51], v229 offset:24576
    v_mfma_f32_16x16x32_bf16 v[168:171], a[16:19], a[236:239], v[168:171]
    ds_read_b128 a[52:55], v228 offset:59392
    v_mfma_f32_16x16x32_bf16 v[172:175], a[24:27], a[236:239], v[172:175]
    ds_read_b128 a[56:59], v228 offset:30720
    v_mfma_f32_16x16x32_bf16 v[172:175], a[28:31], a[244:247], v[172:175]
    ds_read_b128 a[60:63], v228 offset:40960
    s_waitcnt lgkmcnt(4)
    v_mfma_f32_16x16x32_bf16 v[176:179], a[36:39], a[244:247], v[176:179]
    ds_read_b128 a[0:3], v228 offset:31744
    v_mfma_f32_16x16x32_bf16 v[176:179], a[32:35], a[236:239], v[176:179]
    ds_read_b128 a[4:7], v228 offset:41984
    v_mfma_f32_16x16x32_bf16 v[180:183], a[40:43], a[236:239], v[180:183]
    ds_read_b128 a[8:11], v228 offset:32768
    v_mfma_f32_16x16x32_bf16 v[180:183], a[44:47], a[244:247], v[180:183]
    ds_read_b128 a[12:15], v228 offset:43008
    s_waitcnt lgkmcnt(4)
    v_mfma_f32_16x16x32_bf16 v[184:187], a[52:55], a[244:247], v[184:187]
    ds_read_b128 a[16:19], v228 offset:33792
    v_mfma_f32_16x16x32_bf16 v[184:187], a[48:51], a[236:239], v[184:187]
    ds_read_b128 a[20:23], v228 offset:44032
    v_mfma_f32_16x16x32_bf16 v[168:171], a[60:63], a[148:151], v[168:171]
    ds_read_b128 a[24:27], v228 offset:34816
    v_mfma_f32_16x16x32_bf16 v[168:171], a[56:59], a[252:255], v[168:171]
    ds_read_b128 a[28:31], v228 offset:45056
    s_waitcnt lgkmcnt(4)
    v_mfma_f32_16x16x32_bf16 v[172:175], a[0:3], a[252:255], v[172:175]
    ds_read_b128 a[32:35], v229 offset:30720
    v_mfma_f32_16x16x32_bf16 v[172:175], a[4:7], a[148:151], v[172:175]
    ds_read_b128 a[36:39], v229 offset:40960
    v_mfma_f32_16x16x32_bf16 v[176:179], a[12:15], a[148:151], v[176:179]
    ds_read_b128 a[40:43], v229 offset:31744
    v_mfma_f32_16x16x32_bf16 v[176:179], a[8:11], a[252:255], v[176:179]
    ds_read_b128 a[44:47], v229 offset:41984
    s_waitcnt lgkmcnt(4)
    v_mfma_f32_16x16x32_bf16 v[180:183], a[16:19], a[252:255], v[180:183]
    ds_read_b128 a[48:51], v229 offset:32768
    v_mfma_f32_16x16x32_bf16 v[180:183], a[20:23], a[148:151], v[180:183]
    ds_read_b128 a[52:55], v229 offset:43008
    v_mfma_f32_16x16x32_bf16 v[184:187], a[28:31], a[148:151], v[184:187]
    ds_read_b128 a[56:59], v229 offset:33792
    v_mfma_f32_16x16x32_bf16 v[184:187], a[24:27], a[252:255], v[184:187]
    ds_read_b128 a[60:63], v229 offset:44032
    s_waitcnt lgkmcnt(4)
    v_mfma_f32_16x16x32_bf16 v[168:171], a[36:39], a[164:167], v[168:171]
    ds_read_b128 a[0:3], v229 offset:34816
    v_mfma_f32_16x16x32_bf16 v[168:171], a[32:35], a[156:159], v[168:171]
    ds_read_b128 a[4:7], v229 offset:45056
    v_mfma_f32_16x16x32_bf16 v[172:175], a[40:43], a[156:159], v[172:175]
    ds_read_b128 a[8:11], v229 offset:51200
    v_mfma_f32_16x16x32_bf16 v[172:175], a[44:47], a[164:167], v[172:175]
    ds_read_b128 a[12:15], v230 offset:2048
    s_waitcnt lgkmcnt(4)
    v_mfma_f32_16x16x32_bf16 v[176:179], a[52:55], a[164:167], v[176:179]
    ds_read_b128 a[16:19], v229 offset:52224
    v_mfma_f32_16x16x32_bf16 v[176:179], a[48:51], a[156:159], v[176:179]
    ds_read_b128 a[20:23], v230 offset:3072
    v_mfma_f32_16x16x32_bf16 v[180:183], a[56:59], a[156:159], v[180:183]
    ds_read_b128 a[24:27], v229 offset:53248
    v_mfma_f32_16x16x32_bf16 v[180:183], a[60:63], a[164:167], v[180:183]
    ds_read_b128 a[28:31], v230 offset:4096
    s_waitcnt lgkmcnt(4)
    v_mfma_f32_16x16x32_bf16 v[184:187], a[4:7], a[164:167], v[184:187]
    ds_read_b128 a[32:35], v229 offset:54272
    v_mfma_f32_16x16x32_bf16 v[184:187], a[0:3], a[156:159], v[184:187]
    ds_read_b128 a[36:39], v230 offset:5120
    v_mfma_f32_16x16x32_bf16 v[168:171], a[12:15], a[180:183], v[168:171]
    ds_read_b128 a[40:43], v229 offset:55296
    v_mfma_f32_16x16x32_bf16 v[168:171], a[8:11], a[172:175], v[168:171]
    ds_read_b128 a[44:47], v230 offset:6144
    s_waitcnt lgkmcnt(4)
    v_mfma_f32_16x16x32_bf16 v[172:175], a[16:19], a[172:175], v[172:175]
    ds_read_b128 a[48:51], v230 offset:22528
    v_mfma_f32_16x16x32_bf16 v[172:175], a[20:23], a[180:183], v[172:175]
    ds_read_b128 a[52:55], v228 offset:0
    v_mfma_f32_16x16x32_bf16 v[176:179], a[28:31], a[180:183], v[176:179]
    ds_read_b128 a[56:59], v230 offset:23552
    v_mfma_f32_16x16x32_bf16 v[176:179], a[24:27], a[172:175], v[176:179]
    ds_read_b128 a[60:63], v228 offset:1024
    s_waitcnt lgkmcnt(4)
    v_mfma_f32_16x16x32_bf16 v[180:183], a[32:35], a[172:175], v[180:183]
    ds_read_b128 a[0:3], v230 offset:24576
    v_mfma_f32_16x16x32_bf16 v[180:183], a[36:39], a[180:183], v[180:183]
    ds_read_b128 a[4:7], v228 offset:2048
    v_mfma_f32_16x16x32_bf16 v[184:187], a[44:47], a[180:183], v[184:187]
    ds_read_b128 a[8:11], v230 offset:25600
    v_mfma_f32_16x16x32_bf16 v[184:187], a[40:43], a[172:175], v[184:187]
    ds_read_b128 a[12:15], v228 offset:3072
    s_waitcnt lgkmcnt(4)
    v_mfma_f32_16x16x32_bf16 v[128:131], a[48:51], a[184:187], v[128:131]
    ds_read_b128 a[16:19], v230 offset:26624
    v_mfma_f32_16x16x32_bf16 v[128:131], a[52:55], a[192:195], v[128:131]
    ds_read_b128 a[20:23], v228 offset:4096
    v_mfma_f32_16x16x32_bf16 v[132:135], a[60:63], a[192:195], v[132:135]
    ds_read_b128 a[24:27], v229 offset:0
    v_mfma_f32_16x16x32_bf16 v[132:135], a[56:59], a[184:187], v[132:135]
    ds_read_b128 a[28:31], v228 offset:10240
    s_waitcnt lgkmcnt(4)
    v_mfma_f32_16x16x32_bf16 v[136:139], a[0:3], a[184:187], v[136:139]
    ds_read_b128 a[32:35], v229 offset:1024
    v_cvt_pk_bf16_f32 v168, v168, v169
    v_cvt_pk_bf16_f32 v169, v170, v171
    v_mfma_f32_16x16x32_bf16 v[136:139], a[4:7], a[192:195], v[136:139]
    ds_read_b128 a[36:39], v228 offset:11264
    v_cvt_pk_bf16_f32 v170, v172, v173
    v_cvt_pk_bf16_f32 v171, v174, v175
    v_mfma_f32_16x16x32_bf16 v[140:143], a[12:15], a[192:195], v[140:143]
    ds_read_b128 a[40:43], v229 offset:2048
    v_cvt_pk_bf16_f32 v172, v176, v177
    v_cvt_pk_bf16_f32 v173, v178, v179
    v_mfma_f32_16x16x32_bf16 v[140:143], a[8:11], a[184:187], v[140:143]
    ds_read_b128 a[44:47], v228 offset:12288
    v_cvt_pk_bf16_f32 v174, v180, v181
    v_cvt_pk_bf16_f32 v175, v182, v183
    s_waitcnt lgkmcnt(4)
    v_mfma_f32_16x16x32_bf16 v[144:147], a[16:19], a[184:187], v[144:147]
    ds_read_b128 a[48:51], v229 offset:3072
    v_cvt_pk_bf16_f32 v176, v184, v185
    v_cvt_pk_bf16_f32 v177, v186, v187
    v_mfma_f32_16x16x32_bf16 v[144:147], a[20:23], a[192:195], v[144:147]
    ds_read_b128 a[52:55], v228 offset:13312
    buffer_store_dwordx4 v[168:171], v240, s[64:67], s58 offen offset:1024 sc1
    buffer_store_dwordx4 v[172:175], v240, s[64:67], s58 offen offset:2048 sc1
    v_mfma_f32_16x16x32_bf16 v[128:131], a[24:27], a[200:203], v[128:131]
    ds_read_b128 a[56:59], v229 offset:4096
    buffer_store_dwordx2 v[176:177], v255, s[64:67], s58 offen offset:3072 sc1
    s_add_u32 s58, s58, 8384512
    v_mfma_f32_16x16x32_bf16 v[128:131], a[28:31], a[208:211], v[128:131]
    ds_read_b128 a[60:63], v228 offset:14336
    s_waitcnt lgkmcnt(4)
    v_mfma_f32_16x16x32_bf16 v[132:135], a[36:39], a[208:211], v[132:135]
    ds_read_b128 a[0:3], v228 offset:20480
    v_mfma_f32_16x16x32_bf16 v[132:135], a[32:35], a[200:203], v[132:135]
    ds_read_b128 a[4:7], v229 offset:10240
    v_mfma_f32_16x16x32_bf16 v[136:139], a[40:43], a[200:203], v[136:139]
    ds_read_b128 a[8:11], v228 offset:21504
    v_mfma_f32_16x16x32_bf16 v[136:139], a[44:47], a[208:211], v[136:139]
    ds_read_b128 a[12:15], v229 offset:11264
    s_waitcnt lgkmcnt(4)
    v_mfma_f32_16x16x32_bf16 v[140:143], a[52:55], a[208:211], v[140:143]
    ds_read_b128 a[16:19], v228 offset:22528
    v_mfma_f32_16x16x32_bf16 v[140:143], a[48:51], a[200:203], v[140:143]
    ds_read_b128 a[20:23], v229 offset:12288
    v_mfma_f32_16x16x32_bf16 v[144:147], a[56:59], a[200:203], v[144:147]
    ds_read_b128 a[24:27], v228 offset:23552
    v_mfma_f32_16x16x32_bf16 v[144:147], a[60:63], a[208:211], v[144:147]
    ds_read_b128 a[28:31], v229 offset:13312
    s_waitcnt lgkmcnt(4)
    v_mfma_f32_16x16x32_bf16 v[128:131], a[0:3], a[216:219], v[128:131]
    ds_read_b128 a[32:35], v228 offset:24576
    v_mfma_f32_16x16x32_bf16 v[128:131], a[4:7], a[224:227], v[128:131]
    ds_read_b128 a[36:39], v229 offset:14336
    v_mfma_f32_16x16x32_bf16 v[132:135], a[12:15], a[224:227], v[132:135]
    ds_read_b128 a[40:43], v229 offset:20480
    v_mfma_f32_16x16x32_bf16 v[132:135], a[8:11], a[216:219], v[132:135]
    ds_read_b128 a[44:47], v228 offset:55296
    s_waitcnt lgkmcnt(4)
    v_mfma_f32_16x16x32_bf16 v[136:139], a[16:19], a[216:219], v[136:139]
    ds_read_b128 a[48:51], v229 offset:21504
    v_mfma_f32_16x16x32_bf16 v[136:139], a[20:23], a[224:227], v[136:139]
    ds_read_b128 a[52:55], v228 offset:56320
    v_mfma_f32_16x16x32_bf16 v[140:143], a[28:31], a[224:227], v[140:143]
    ds_read_b128 a[56:59], v229 offset:22528
    v_mfma_f32_16x16x32_bf16 v[140:143], a[24:27], a[216:219], v[140:143]
    ds_read_b128 a[60:63], v228 offset:57344
    s_waitcnt lgkmcnt(4)
    v_mfma_f32_16x16x32_bf16 v[144:147], a[32:35], a[216:219], v[144:147]
    ds_read_b128 a[0:3], v229 offset:23552
    v_mfma_f32_16x16x32_bf16 v[144:147], a[36:39], a[224:227], v[144:147]
    ds_read_b128 a[4:7], v228 offset:58368
    v_mfma_f32_16x16x32_bf16 v[128:131], a[40:43], a[232:235], v[128:131]
    ds_read_b128 a[8:11], v229 offset:24576
    v_mfma_f32_16x16x32_bf16 v[128:131], a[44:47], a[240:243], v[128:131]
    ds_read_b128 a[12:15], v228 offset:59392
    s_waitcnt lgkmcnt(4)
    v_mfma_f32_16x16x32_bf16 v[132:135], a[52:55], a[240:243], v[132:135]
    ds_read_b128 a[16:19], v228 offset:30720
    v_mfma_f32_16x16x32_bf16 v[132:135], a[48:51], a[232:235], v[132:135]
    ds_read_b128 a[20:23], v228 offset:40960
    v_mfma_f32_16x16x32_bf16 v[136:139], a[56:59], a[232:235], v[136:139]
    ds_read_b128 a[24:27], v228 offset:31744
    v_mfma_f32_16x16x32_bf16 v[136:139], a[60:63], a[240:243], v[136:139]
    ds_read_b128 a[28:31], v228 offset:41984
    s_waitcnt lgkmcnt(4)
    v_mfma_f32_16x16x32_bf16 v[140:143], a[4:7], a[240:243], v[140:143]
    ds_read_b128 a[32:35], v228 offset:32768
    v_mfma_f32_16x16x32_bf16 v[140:143], a[0:3], a[232:235], v[140:143]
    ds_read_b128 a[36:39], v228 offset:43008
    v_mfma_f32_16x16x32_bf16 v[144:147], a[8:11], a[232:235], v[144:147]
    ds_read_b128 a[40:43], v228 offset:33792
    v_mfma_f32_16x16x32_bf16 v[144:147], a[12:15], a[240:243], v[144:147]
    ds_read_b128 a[44:47], v228 offset:44032
    s_waitcnt lgkmcnt(4)
    v_mfma_f32_16x16x32_bf16 v[128:131], a[16:19], a[248:251], v[128:131]
    ds_read_b128 a[48:51], v228 offset:34816
    v_mfma_f32_16x16x32_bf16 v[128:131], a[20:23], a[144:147], v[128:131]
    ds_read_b128 a[52:55], v228 offset:45056
    v_mfma_f32_16x16x32_bf16 v[132:135], a[28:31], a[144:147], v[132:135]
    ds_read_b128 a[56:59], v229 offset:30720
    v_mfma_f32_16x16x32_bf16 v[132:135], a[24:27], a[248:251], v[132:135]
    ds_read_b128 a[60:63], v229 offset:40960
    s_waitcnt lgkmcnt(4)
    v_mfma_f32_16x16x32_bf16 v[136:139], a[32:35], a[248:251], v[136:139]
    ds_read_b128 a[0:3], v229 offset:31744
    v_mfma_f32_16x16x32_bf16 v[136:139], a[36:39], a[144:147], v[136:139]
    ds_read_b128 a[4:7], v229 offset:41984
    v_mfma_f32_16x16x32_bf16 v[140:143], a[44:47], a[144:147], v[140:143]
    ds_read_b128 a[8:11], v229 offset:32768
    v_mfma_f32_16x16x32_bf16 v[140:143], a[40:43], a[248:251], v[140:143]
    ds_read_b128 a[12:15], v229 offset:43008
    s_waitcnt lgkmcnt(4)
    v_mfma_f32_16x16x32_bf16 v[144:147], a[48:51], a[248:251], v[144:147]
    ds_read_b128 a[16:19], v229 offset:33792
    v_mfma_f32_16x16x32_bf16 v[144:147], a[52:55], a[144:147], v[144:147]
    ds_read_b128 a[20:23], v229 offset:44032
    v_mfma_f32_16x16x32_bf16 v[128:131], a[56:59], a[152:155], v[128:131]
    ds_read_b128 a[24:27], v229 offset:34816
    v_mfma_f32_16x16x32_bf16 v[128:131], a[60:63], a[160:163], v[128:131]
    ds_read_b128 a[28:31], v229 offset:45056
    s_waitcnt lgkmcnt(4)
    v_mfma_f32_16x16x32_bf16 v[132:135], a[4:7], a[160:163], v[132:135]
    ds_read_b128 a[32:35], v229 offset:51200
    v_mfma_f32_16x16x32_bf16 v[132:135], a[0:3], a[152:155], v[132:135]
    ds_read_b128 a[36:39], v230 offset:2048
    v_mfma_f32_16x16x32_bf16 v[136:139], a[8:11], a[152:155], v[136:139]
    ds_read_b128 a[40:43], v229 offset:52224
    v_mfma_f32_16x16x32_bf16 v[136:139], a[12:15], a[160:163], v[136:139]
    ds_read_b128 a[44:47], v230 offset:3072
    s_waitcnt lgkmcnt(4)
    v_mfma_f32_16x16x32_bf16 v[140:143], a[20:23], a[160:163], v[140:143]
    ds_read_b128 a[48:51], v229 offset:53248
    v_mfma_f32_16x16x32_bf16 v[140:143], a[16:19], a[152:155], v[140:143]
    ds_read_b128 a[52:55], v230 offset:4096
    v_mfma_f32_16x16x32_bf16 v[144:147], a[24:27], a[152:155], v[144:147]
    ds_read_b128 a[56:59], v229 offset:54272
    v_mfma_f32_16x16x32_bf16 v[144:147], a[28:31], a[160:163], v[144:147]
    ds_read_b128 a[60:63], v230 offset:5120
    s_waitcnt lgkmcnt(4)
    v_mfma_f32_16x16x32_bf16 v[128:131], a[32:35], a[168:171], v[128:131]
    ds_read_b128 a[0:3], v229 offset:55296
    v_mfma_f32_16x16x32_bf16 v[128:131], a[36:39], a[176:179], v[128:131]
    ds_read_b128 a[4:7], v230 offset:6144
    v_mfma_f32_16x16x32_bf16 v[132:135], a[44:47], a[176:179], v[132:135]
    v_mfma_f32_16x16x32_bf16 v[132:135], a[40:43], a[168:171], v[132:135]
    s_waitcnt lgkmcnt(2)
    v_mfma_f32_16x16x32_bf16 v[136:139], a[48:51], a[168:171], v[136:139]
    v_mfma_f32_16x16x32_bf16 v[136:139], a[52:55], a[176:179], v[136:139]
    v_mfma_f32_16x16x32_bf16 v[140:143], a[60:63], a[176:179], v[140:143]
    v_mfma_f32_16x16x32_bf16 v[140:143], a[56:59], a[168:171], v[140:143]
    s_waitcnt lgkmcnt(0)
    v_mfma_f32_16x16x32_bf16 v[144:147], a[0:3], a[168:171], v[144:147]
    v_mfma_f32_16x16x32_bf16 v[144:147], a[4:7], a[176:179], v[144:147]
    s_waitcnt vmcnt(14)
    v_lshlrev_b32 v68, 16, v32
    v_and_b32 v69, 0xffff0000, v32
    v_lshlrev_b32 v70, 16, v33
    v_and_b32 v71, 0xffff0000, v33
    v_lshlrev_b32 v72, 16, v34
    v_and_b32 v73, 0xffff0000, v34
    v_lshlrev_b32 v74, 16, v35
    v_and_b32 v75, 0xffff0000, v35
    v_lshlrev_b32 v76, 16, v36
    v_and_b32 v77, 0xffff0000, v36
    v_lshlrev_b32 v78, 16, v37
    v_and_b32 v79, 0xffff0000, v37
    v_lshlrev_b32 v80, 16, v38
    v_and_b32 v81, 0xffff0000, v38
    v_lshlrev_b32 v82, 16, v39
    v_and_b32 v83, 0xffff0000, v39
    v_lshlrev_b32 v84, 16, v40
    v_and_b32 v85, 0xffff0000, v40
    v_lshlrev_b32 v86, 16, v41
    v_and_b32 v87, 0xffff0000, v41
    v_pk_add_f32 v[0:1], v[0:1], v[68:69]
    v_pk_add_f32 v[2:3], v[2:3], v[70:71]
    v_pk_add_f32 v[4:5], v[4:5], v[72:73]
    v_pk_add_f32 v[6:7], v[6:7], v[74:75]
    v_pk_add_f32 v[8:9], v[8:9], v[76:77]
    v_pk_add_f32 v[10:11], v[10:11], v[78:79]
    v_pk_add_f32 v[12:13], v[12:13], v[80:81]
    v_pk_add_f32 v[14:15], v[14:15], v[82:83]
    v_pk_add_f32 v[16:17], v[16:17], v[84:85]
    v_pk_add_f32 v[18:19], v[18:19], v[86:87]
    s_waitcnt vmcnt(11)
    v_lshlrev_b32 v68, 16, v44
    v_and_b32 v69, 0xffff0000, v44
    v_lshlrev_b32 v70, 16, v45
    v_and_b32 v71, 0xffff0000, v45
    v_lshlrev_b32 v72, 16, v46
    v_and_b32 v73, 0xffff0000, v46
    v_lshlrev_b32 v74, 16, v47
    v_and_b32 v75, 0xffff0000, v47
    v_lshlrev_b32 v76, 16, v48
    v_and_b32 v77, 0xffff0000, v48
    v_lshlrev_b32 v78, 16, v49
    v_and_b32 v79, 0xffff0000, v49
    v_lshlrev_b32 v80, 16, v50
    v_and_b32 v81, 0xffff0000, v50
    v_lshlrev_b32 v82, 16, v51
    v_and_b32 v83, 0xffff0000, v51
    v_lshlrev_b32 v84, 16, v52
    v_and_b32 v85, 0xffff0000, v52
    v_lshlrev_b32 v86, 16, v53
    v_and_b32 v87, 0xffff0000, v53
    v_pk_add_f32 v[0:1], v[0:1], v[68:69]
    v_pk_add_f32 v[2:3], v[2:3], v[70:71]
    v_pk_add_f32 v[4:5], v[4:5], v[72:73]
    v_pk_add_f32 v[6:7], v[6:7], v[74:75]
    v_pk_add_f32 v[8:9], v[8:9], v[76:77]
    v_pk_add_f32 v[10:11], v[10:11], v[78:79]
    v_pk_add_f32 v[12:13], v[12:13], v[80:81]
    v_pk_add_f32 v[14:15], v[14:15], v[82:83]
    v_pk_add_f32 v[16:17], v[16:17], v[84:85]
    v_pk_add_f32 v[18:19], v[18:19], v[86:87]
    s_waitcnt vmcnt(8)
    v_lshlrev_b32 v68, 16, v56
    v_and_b32 v69, 0xffff0000, v56
    v_lshlrev_b32 v70, 16, v57
    v_and_b32 v71, 0xffff0000, v57
    v_lshlrev_b32 v72, 16, v58
    v_and_b32 v73, 0xffff0000, v58
    v_lshlrev_b32 v74, 16, v59
    v_and_b32 v75, 0xffff0000, v59
    v_lshlrev_b32 v76, 16, v60
    v_and_b32 v77, 0xffff0000, v60
    v_lshlrev_b32 v78, 16, v61
    v_and_b32 v79, 0xffff0000, v61
    v_lshlrev_b32 v80, 16, v62
    v_and_b32 v81, 0xffff0000, v62
    v_lshlrev_b32 v82, 16, v63
    v_and_b32 v83, 0xffff0000, v63
    v_lshlrev_b32 v84, 16, v64
    v_and_b32 v85, 0xffff0000, v64
    v_lshlrev_b32 v86, 16, v65
    v_and_b32 v87, 0xffff0000, v65
    v_pk_add_f32 v[0:1], v[0:1], v[68:69]
    v_pk_add_f32 v[2:3], v[2:3], v[70:71]
    v_pk_add_f32 v[4:5], v[4:5], v[72:73]
    v_pk_add_f32 v[6:7], v[6:7], v[74:75]
    v_pk_add_f32 v[8:9], v[8:9], v[76:77]
    v_pk_add_f32 v[10:11], v[10:11], v[78:79]
    v_pk_add_f32 v[12:13], v[12:13], v[80:81]
    v_pk_add_f32 v[14:15], v[14:15], v[82:83]
    v_pk_add_f32 v[16:17], v[16:17], v[84:85]
    v_pk_add_f32 v[18:19], v[18:19], v[86:87]
    buffer_load_dwordx4 v[188:191], v240, s[64:67], s55 offen offset:0 sc1
    buffer_load_dwordx4 v[192:195], v240, s[64:67], s55 offen offset:1024 sc1
    buffer_load_dwordx2 v[196:197], v240, s[64:67], s55 offen offset:2048 sc1
    buffer_load_dwordx4 v[198:201], v240, s[64:67], s57 offen offset:1024 sc1
    buffer_load_dwordx4 v[202:205], v240, s[64:67], s57 offen offset:2048 sc1
    buffer_load_dwordx2 v[206:207], v240, s[64:67], s57 offen offset:8 sc1
    buffer_load_dwordx4 v[148:151], v240, s[64:67], s56 offen offset:0 sc1
    buffer_load_dwordx4 v[152:155], v240, s[64:67], s56 offen offset:1024 sc1
    buffer_load_dwordx2 v[156:157], v255, s[64:67], s56 offen offset:2048 sc1
    v_mul_f32 v88, 0xc13504f3, v0
    v_mul_f32 v89, 0xc13504f3, v1
    v_mul_f32 v90, 0xc13504f3, v2
    v_mul_f32 v91, 0xc13504f3, v3
    v_mul_f32 v92, 0xc13504f3, v4
    v_mul_f32 v93, 0xc13504f3, v5
    v_mul_f32 v94, 0xc13504f3, v6
    v_mul_f32 v95, 0xc13504f3, v7
    v_mul_f32 v96, 0xc13504f3, v8
    v_mul_f32 v97, 0xc13504f3, v9
    v_mul_f32 v98, 0xc13504f3, v10
    v_mul_f32 v99, 0xc13504f3, v11
    v_mul_f32 v100, 0xc13504f3, v12
    v_mul_f32 v101, 0xc13504f3, v13
    v_mul_f32 v102, 0xc13504f3, v14
    v_mul_f32 v103, 0xc13504f3, v15
    v_mul_f32 v104, 0xc13504f3, v16
    v_mul_f32 v105, 0xc13504f3, v17
    v_mul_f32 v106, 0xc13504f3, v18
    v_mul_f32 v107, 0xc13504f3, v19
    v_exp_f32 v88, v88
    v_exp_f32 v89, v89
    v_exp_f32 v90, v90
    v_exp_f32 v91, v91
    v_exp_f32 v92, v92
    v_exp_f32 v93, v93
    v_exp_f32 v94, v94
    v_exp_f32 v95, v95
    v_exp_f32 v96, v96
    v_exp_f32 v97, v97
    v_exp_f32 v98, v98
    v_exp_f32 v99, v99
    v_exp_f32 v100, v100
    v_exp_f32 v101, v101
    v_exp_f32 v102, v102
    v_exp_f32 v103, v103
    v_exp_f32 v104, v104
    v_exp_f32 v105, v105
    v_exp_f32 v106, v106
    v_exp_f32 v107, v107
    v_add_f32 v88, 1.0, v88
    v_add_f32 v89, 1.0, v89
    v_add_f32 v90, 1.0, v90
    v_add_f32 v91, 1.0, v91
    v_add_f32 v92, 1.0, v92
    v_add_f32 v93, 1.0, v93
    v_add_f32 v94, 1.0, v94
    v_add_f32 v95, 1.0, v95
    v_add_f32 v96, 1.0, v96
    v_add_f32 v97, 1.0, v97
    v_add_f32 v98, 1.0, v98
    v_add_f32 v99, 1.0, v99
    v_add_f32 v100, 1.0, v100
    v_add_f32 v101, 1.0, v101
    v_add_f32 v102, 1.0, v102
    v_add_f32 v103, 1.0, v103
    v_add_f32 v104, 1.0, v104
    v_add_f32 v105, 1.0, v105
    v_add_f32 v106, 1.0, v106
    v_add_f32 v107, 1.0, v107
    v_rcp_f32 v88, v88
    v_rcp_f32 v89, v89
    v_rcp_f32 v90, v90
    v_rcp_f32 v91, v91
    v_rcp_f32 v92, v92
    v_rcp_f32 v93, v93
    v_rcp_f32 v94, v94
    v_rcp_f32 v95, v95
    v_rcp_f32 v96, v96
    v_rcp_f32 v97, v97
    v_rcp_f32 v98, v98
    v_rcp_f32 v99, v99
    v_rcp_f32 v100, v100
    v_rcp_f32 v101, v101
    v_rcp_f32 v102, v102
    v_rcp_f32 v103, v103
    v_rcp_f32 v104, v104
    v_rcp_f32 v105, v105
    v_rcp_f32 v106, v106
    v_rcp_f32 v107, v107
    v_mul_f32 v0, 0x40faf233, v0
    v_mul_f32 v1, 0x40faf233, v1
    v_mul_f32 v2, 0x40faf233, v2
    v_mul_f32 v3, 0x40faf233, v3
K1_pg17:
    s_cbranch_execz K1_wb3
    v_mul_f32 v4, 0x40faf233, v4
    v_mul_f32 v5, 0x40faf233, v5
    v_mul_f32 v6, 0x40faf233, v6
    v_mul_f32 v7, 0x40faf233, v7
    v_mul_f32 v8, 0x40faf233, v8
    v_mul_f32 v9, 0x40faf233, v9
    v_mul_f32 v10, 0x40faf233, v10
    v_mul_f32 v11, 0x40faf233, v11
    v_mul_f32 v12, 0x40faf233, v12
    v_mul_f32 v13, 0x40faf233, v13
    v_mul_f32 v14, 0x40faf233, v14
    v_mul_f32 v15, 0x40faf233, v15
    v_mul_f32 v16, 0x40faf233, v16
    v_mul_f32 v17, 0x40faf233, v17
    v_mul_f32 v18, 0x40faf233, v18
    v_mul_f32 v19, 0x40faf233, v19
    v_mul_f32 v0, v0, v88
    v_mul_f32 v1, v1, v89
    v_mul_f32 v2, v2, v90
    v_mul_f32 v3, v3, v91
    v_mul_f32 v4, v4, v92
    v_mul_f32 v5, v5, v93
    v_mul_f32 v6, v6, v94
    v_mul_f32 v7, v7, v95
    v_mul_f32 v8, v8, v96
    v_mul_f32 v9, v9, v97
    v_mul_f32 v10, v10, v98
    v_mul_f32 v11, v11, v99
    v_mul_f32 v12, v12, v100
    v_mul_f32 v13, v13, v101
    v_mul_f32 v14, v14, v102
    v_mul_f32 v15, v15, v103
    v_mul_f32 v16, v16, v104
    v_mul_f32 v17, v17, v105
    v_mul_f32 v18, v18, v106
    v_mul_f32 v19, v19, v107
    v_lshlrev_b32 v88, 16, v214
    v_and_b32 v89, 0xffff0000, v214
    v_lshlrev_b32 v90, 16, v215
    v_and_b32 v91, 0xffff0000, v215
    v_lshlrev_b32 v92, 16, v216
    v_and_b32 v93, 0xffff0000, v216
    v_lshlrev_b32 v94, 16, v217
    v_and_b32 v95, 0xffff0000, v217
    v_lshlrev_b32 v96, 16, v218
    v_and_b32 v97, 0xffff0000, v218
    v_lshlrev_b32 v98, 16, v219
    v_and_b32 v99, 0xffff0000, v219
    v_lshlrev_b32 v100, 16, v220
    v_and_b32 v101, 0xffff0000, v220
    v_lshlrev_b32 v102, 16, v221
    v_and_b32 v103, 0xffff0000, v221
    v_lshlrev_b32 v104, 16, v222
    v_and_b32 v105, 0xffff0000, v222
    v_lshlrev_b32 v106, 16, v223
    v_and_b32 v107, 0xffff0000, v223
    s_waitcnt vmcnt(6)
    v_max3_u32 v252, v188, v189, v190
    v_max3_u32 v252, v252, v191, v192
    v_max3_u32 v252, v252, v193, v194
    v_max3_u32 v252, v252, v195, v196
    v_max_u32 v252, v252, v197
    v_cmp_eq_u32 vcc, -1, v252
    s_nop 1
    s_cbranch_vccnz K1_spin_g1
K1_g1_ok:
    v_lshlrev_b32 v68, 16, v188
    v_and_b32 v69, 0xffff0000, v188
    v_lshlrev_b32 v70, 16, v189
    v_and_b32 v71, 0xffff0000, v189
    v_lshlrev_b32 v72, 16, v190
    v_and_b32 v73, 0xffff0000, v190
    v_lshlrev_b32 v74, 16, v191
    v_and_b32 v75, 0xffff0000, v191
    v_lshlrev_b32 v76, 16, v192
    v_and_b32 v77, 0xffff0000, v192
    v_lshlrev_b32 v78, 16, v193
    v_and_b32 v79, 0xffff0000, v193
    v_lshlrev_b32 v80, 16, v194
    v_and_b32 v81, 0xffff0000, v194
    v_lshlrev_b32 v82, 16, v195
    v_and_b32 v83, 0xffff0000, v195
    v_lshlrev_b32 v84, 16, v196
    v_and_b32 v85, 0xffff0000, v196
    v_lshlrev_b32 v86, 16, v197
    v_and_b32 v87, 0xffff0000, v197
    v_pk_add_f32 v[128:129], v[128:129], v[68:69]
    v_pk_add_f32 v[130:131], v[130:131], v[70:71]
    v_pk_add_f32 v[132:133], v[132:133], v[72:73]
    v_pk_add_f32 v[134:135], v[134:135], v[74:75]
    v_pk_add_f32 v[136:137], v[136:137], v[76:77]
    v_pk_add_f32 v[138:139], v[138:139], v[78:79]
    v_pk_add_f32 v[140:141], v[140:141], v[80:81]
    v_pk_add_f32 v[142:143], v[142:143], v[82:83]
    v_pk_add_f32 v[144:145], v[144:145], v[84:85]
    v_pk_add_f32 v[146:147], v[146:147], v[86:87]
    s_waitcnt vmcnt(3)
    v_max3_u32 v252, v198, v199, v200
    v_max3_u32 v252, v252, v201, v202
    v_max3_u32 v252, v252, v203, v204
    v_max3_u32 v252, v252, v205, v206
    v_max_u32 v252, v252, v207
    v_cmp_eq_u32 vcc, -1, v252
    s_nop 1
    s_cbranch_vccnz K1_spin_g3
K1_g3_ok:
    v_lshlrev_b32 v68, 16, v198
    v_and_b32 v69, 0xffff0000, v198
    v_lshlrev_b32 v70, 16, v199
    v_and_b32 v71, 0xffff0000, v199
    v_lshlrev_b32 v72, 16, v200
    v_and_b32 v73, 0xffff0000, v200
    v_lshlrev_b32 v74, 16, v201
    v_and_b32 v75, 0xffff0000, v201
    v_lshlrev_b32 v76, 16, v202
    v_and_b32 v77, 0xffff0000, v202
    v_lshlrev_b32 v78, 16, v203
    v_and_b32 v79, 0xffff0000, v203
    v_lshlrev_b32 v80, 16, v204
    v_and_b32 v81, 0xffff0000, v204
    v_lshlrev_b32 v82, 16, v205
    v_and_b32 v83, 0xffff0000, v205
    v_lshlrev_b32 v84, 16, v206
    v_and_b32 v85, 0xffff0000, v206
    v_lshlrev_b32 v86, 16, v207
    v_and_b32 v87, 0xffff0000, v207
    v_pk_add_f32 v[128:129], v[128:129], v[68:69]
    v_pk_add_f32 v[130:131], v[130:131], v[70:71]
    v_pk_add_f32 v[132:133], v[132:133], v[72:73]
    v_pk_add_f32 v[134:135], v[134:135], v[74:75]
    v_pk_add_f32 v[136:137], v[136:137], v[76:77]
    v_pk_add_f32 v[138:139], v[138:139], v[78:79]
    v_pk_add_f32 v[140:141], v[140:141], v[80:81]
    v_pk_add_f32 v[142:143], v[142:143], v[82:83]
    v_pk_add_f32 v[144:145], v[144:145], v[84:85]
    v_pk_add_f32 v[146:147], v[146:147], v[86:87]
    s_waitcnt vmcnt(0)
    v_max3_u32 v252, v148, v149, v150
    v_max3_u32 v252, v252, v151, v152
    v_max3_u32 v252, v252, v153, v154
    v_max3_u32 v252, v252, v155, v156
    v_max_u32 v252, v252, v157
    v_cmp_eq_u32 vcc, -1, v252
    s_nop 1
    s_cbranch_vccnz K1_spin_g2
K1_g2_ok:
    v_lshlrev_b32 v68, 16, v148
    v_and_b32 v69, 0xffff0000, v148
    v_lshlrev_b32 v70, 16, v149
    v_and_b32 v71, 0xffff0000, v149
    v_lshlrev_b32 v72, 16, v150
    v_and_b32 v73, 0xffff0000, v150
    v_lshlrev_b32 v74, 16, v151
    v_and_b32 v75, 0xffff0000, v151
    v_lshlrev_b32 v76, 16, v152
    v_and_b32 v77, 0xffff0000, v152
    v_lshlrev_b32 v78, 16, v153
    v_and_b32 v79, 0xffff0000, v153
    v_lshlrev_b32 v80, 16, v154
    v_and_b32 v81, 0xffff0000, v154
    v_lshlrev_b32 v82, 16, v155
    v_and_b32 v83, 0xffff0000, v155
    v_lshlrev_b32 v84, 16, v156
    v_and_b32 v85, 0xffff0000, v156
    v_lshlrev_b32 v86, 16, v157
    v_and_b32 v87, 0xffff0000, v157
    v_pk_add_f32 v[128:129], v[128:129], v[68:69]
    v_pk_add_f32 v[130:131], v[130:131], v[70:71]
    v_pk_add_f32 v[132:133], v[132:133], v[72:73]
    v_pk_add_f32 v[134:135], v[134:135], v[74:75]
    v_pk_add_f32 v[136:137], v[136:137], v[76:77]
    v_pk_add_f32 v[138:139], v[138:139], v[78:79]
    v_pk_add_f32 v[140:141], v[140:141], v[80:81]
    v_pk_add_f32 v[142:143], v[142:143], v[82:83]
    v_pk_add_f32 v[144:145], v[144:145], v[84:85]
    v_pk_add_f32 v[146:147], v[146:147], v[86:87]
    v_fmac_f32 v104, v144, v16
    v_fmac_f32 v105, v145, v17
    v_fmac_f32 v106, v146, v18
    v_fmac_f32 v107, v147, v19
    v_cvt_pk_bf16_f32 v116, v104, v105
    v_cvt_pk_bf16_f32 v117, v106, v107
    buffer_store_dwordx2 v[116:117], v246, s[60:63], s19 offen offset:128
    v_fmac_f32 v88, v128, v0
    v_fmac_f32 v89, v129, v1
    v_fmac_f32 v90, v130, v2
    v_fmac_f32 v91, v131, v3
    v_cvt_pk_bf16_f32 v108, v88, v89
    v_cvt_pk_bf16_f32 v109, v90, v91
    v_fmac_f32 v92, v132, v4
    v_fmac_f32 v93, v133, v5
    v_fmac_f32 v94, v134, v6
    v_fmac_f32 v95, v135, v7
    v_cvt_pk_bf16_f32 v110, v92, v93
    v_cvt_pk_bf16_f32 v111, v94, v95
    v_fmac_f32 v96, v136, v8
    v_fmac_f32 v97, v137, v9
    v_fmac_f32 v98, v138, v10
    v_fmac_f32 v99, v139, v11
    v_cvt_pk_bf16_f32 v112, v96, v97
    v_cvt_pk_bf16_f32 v113, v98, v99
    v_fmac_f32 v100, v140, v12
    v_fmac_f32 v101, v141, v13
    v_fmac_f32 v102, v142, v14
    v_fmac_f32 v103, v143, v15
    v_cvt_pk_bf16_f32 v114, v100, v101
    v_cvt_pk_bf16_f32 v115, v102, v103
    v_permlane32_swap_b32 v108, v110
    v_permlane32_swap_b32 v109, v111
    v_permlane32_swap_b32 v112, v114
    v_permlane32_swap_b32 v113, v115
    v_permlane16_swap_b32 v108, v110
    v_permlane16_swap_b32 v109, v111
    v_permlane16_swap_b32 v112, v114
    v_permlane16_swap_b32 v113, v115
    buffer_store_dwordx4 v[108:111], v248, s[60:63], s19 offen offset:0
    buffer_store_dwordx4 v[112:115], v248, s[60:63], s19 offen offset:64
    s_endpgm
K1_spin_early:
    s_mov_b32 s47, 0
    s_waitcnt vmcnt(0)
K1_spin_early_l:
    buffer_load_dwordx4 v[252:255], v240, s[68:71], 0 offen sc1
    s_waitcnt vmcnt(0)
    v_xor_b32 v252, s0, v252
    v_xor_b32 v253, s0, v253
    v_xor_b32 v254, s0, v254
    v_xor_b32 v255, s0, v255
    v_or3_b32 v252, v252, v253, v254
    v_or_b32 v252, v252, v255
    v_cmp_ne_u32 vcc, 0, v252
    v_mov_b32 v252, s0
    s_add_u32 s47, s47, 1
    s_cmp_lt_u32 s47, 65536
    s_cbranch_vccz K1_early_ok
    s_cbranch_scc1 K1_spin_early_l
    s_branch K1_early_ok
K1_spin_done:
    s_mov_b32 s47, 0
    s_waitcnt vmcnt(0)
K1_spin_done_l:
    buffer_load_dword v252, v253, s[68:71], s53 offen sc1
    s_waitcnt vmcnt(0)
    v_cmp_ne_u32 vcc, s0, v252
    s_add_u32 s47, s47, 1
    s_cmp_lt_u32 s47, 65536
    s_cbranch_vccz K1_done_ok
    s_cbranch_scc1 K1_spin_done_l
    s_branch K1_done_ok
K1_spin_don2:
    s_mov_b32 s47, 0
    s_waitcnt vmcnt(0)
K1_spin_don2_l:
    buffer_load_dword v252, v253, s[68:71], s53 offen offset:4 sc1
    s_waitcnt vmcnt(0)
    v_cmp_ne_u32 vcc, s0, v252
    s_add_u32 s47, s47, 1
    s_cmp_lt_u32 s47, 65536
    s_cbranch_vccz K1_don2_ok
    s_cbranch_scc1 K1_spin_don2_l
    s_branch K1_don2_ok
K1_spin_pf:
    s_mov_b32 s47, 0
    s_waitcnt vmcnt(0)
K1_spin_pf_l:
    buffer_load_dword v252, v254, s[68:71], s54 offen sc1
    s_waitcnt vmcnt(0)
    v_cmp_ne_u32 vcc, s0, v252
    s_add_u32 s47, s47, 1
    s_cmp_lt_u32 s47, 65536
    s_cbranch_vccz K1_pf_ok
    s_cbranch_scc1 K1_spin_pf_l
    s_branch K1_pf_ok
K1_spin_g1:
    s_mov_b32 s47, 0
    s_waitcnt vmcnt(0)
K1_spin_g1_l:
    buffer_load_dwordx4 v[188:191], v240, s[64:67], s55 offen offset:0 sc1
    buffer_load_dwordx4 v[192:195], v240, s[64:67], s55 offen offset:1024 sc1
    buffer_load_dwordx2 v[196:197], v240, s[64:67], s55 offen offset:2048 sc1
    buffer_load_dwordx4 v[198:201], v240, s[64:67], s57 offen offset:1024 sc1
    buffer_load_dwordx4 v[202:205], v240, s[64:67], s57 offen offset:2048 sc1
    buffer_load_dwordx2 v[206:207], v240, s[64:67], s57 offen offset:8 sc1
    buffer_load_dwordx4 v[148:151], v240, s[64:67], s56 offen offset:0 sc1
    buffer_load_dwordx4 v[152:155], v240, s[64:67], s56 offen offset:1024 sc1
    buffer_load_dwordx2 v[156:157], v255, s[64:67], s56 offen offset:2048 sc1
    s_waitcnt vmcnt(0)
    v_max3_u32 v252, v188, v189, v190
    v_max3_u32 v252, v252, v191, v192
    v_max3_u32 v252, v252, v193, v194
    v_max3_u32 v252, v252, v195, v196
    v_max_u32 v252, v252, v197
    v_cmp_eq_u32 vcc, -1, v252
    s_add_u32 s47, s47, 1
    s_cmp_lt_u32 s47, 65536
    s_cbranch_vccz K1_g1_ok
    s_cbranch_scc1 K1_spin_g1_l
    s_branch K1_g1_ok
K1_spin_g3:
    s_mov_b32 s47, 0
    s_waitcnt vmcnt(0)
K1_spin_g3_l:
    buffer_load_dwordx4 v[198:201], v240, s[64:67], s57 offen offset:1024 sc1
    buffer_load_dwordx4 v[202:205], v240, s[64:67], s57 offen offset:2048 sc1
    buffer_load_dwordx2 v[206:207], v240, s[64:67], s57 offen offset:8 sc1
    buffer_load_dwordx4 v[148:151], v240, s[64:67], s56 offen offset:0 sc1
    buffer_load_dwordx4 v[152:155], v240, s[64:67], s56 offen offset:1024 sc1
    buffer_load_dwordx2 v[156:157], v255, s[64:67], s56 offen offset:2048 sc1
    s_waitcnt vmcnt(0)
    v_max3_u32 v252, v198, v199, v200
    v_max3_u32 v252, v252, v201, v202
    v_max3_u32 v252, v252, v203, v204
    v_max3_u32 v252, v252, v205, v206
    v_max_u32 v252, v252, v207
    v_cmp_eq_u32 vcc, -1, v252
    s_add_u32 s47, s47, 1
    s_cmp_lt_u32 s47, 65536
    s_cbranch_vccz K1_g3_ok
    s_cbranch_scc1 K1_spin_g3_l
    s_branch K1_g3_ok
K1_spin_g2:
    s_mov_b32 s47, 0
    s_waitcnt vmcnt(0)
K1_spin_g2_l:
    buffer_load_dwordx4 v[148:151], v240, s[64:67], s56 offen offset:0 sc1
    buffer_load_dwordx4 v[152:155], v240, s[64:67], s56 offen offset:1024 sc1
    buffer_load_dwordx2 v[156:157], v255, s[64:67], s56 offen offset:2048 sc1
    s_waitcnt vmcnt(0)
    v_max3_u32 v252, v148, v149, v150
    v_max3_u32 v252, v252, v151, v152
    v_max3_u32 v252, v252, v153, v154
    v_max3_u32 v252, v252, v155, v156
    v_max_u32 v252, v252, v157
    v_cmp_eq_u32 vcc, -1, v252
    s_add_u32 s47, s47, 1
    s_cmp_lt_u32 s47, 65536
    s_cbranch_vccz K1_g2_ok
    s_cbranch_scc1 K1_spin_g2_l
    s_branch K1_g2_ok
K1_exact:
    s_mov_b32 s48, 1
    s_mov_b32 s47, 0
    s_and_b32 s43, s46, 8192
    s_waitcnt vmcnt(0)
    v_accvgpr_write_b32 a148, 0
    v_accvgpr_write_b32 a149, 0
    v_accvgpr_write_b32 a150, 0
    v_accvgpr_write_b32 a151, 0
    v_mov_b32 v242, 0xff800000
    v_mov_b32 v243, 0xff800000
    v_mov_b32 v244, 0xff800000
    v_mov_b32 v245, 0xff800000
    v_mfma_f32_32x32x16_bf16 v[0:15], a[148:151], a[148:151], 0
    v_mfma_f32_32x32x16_bf16 v[16:31], a[148:151], a[148:151], 0
    v_mfma_f32_32x32x16_bf16 v[32:47], a[148:151], a[148:151], 0
    v_mfma_f32_32x32x16_bf16 v[48:63], a[148:151], a[148:151], 0
    v_mfma_f32_32x32x16_bf16 v[64:79], a[148:151], a[148:151], 0
    v_mfma_f32_32x32x16_bf16 v[80:95], a[148:151], a[148:151], 0
    v_mfma_f32_32x32x16_bf16 v[96:111], a[148:151], a[148:151], 0
    v_mfma_f32_32x32x16_bf16 v[112:127], a[148:151], a[148:151], 0
    v_mfma_f32_32x32x16_bf16 a[128:143], a[148:151], a[148:151], 0
K1_maxloop:
    s_waitcnt vmcnt(0)
    s_barrier
    s_add_u32 m0, s46, 0
    s_nop 0
    buffer_load_dwordx4 v236, s[32:35], s43 offen offset:0 lds
    buffer_load_dwordx4 v237, s[32:35], s43 offen offset:1024 lds
    buffer_load_dwordx4 v238, s[32:35], s43 offen offset:2048 lds
    buffer_load_dwordx4 v239, s[32:35], s43 offen offset:3072 lds
    s_add_u32 s43, s43, 4096
    s_add_u32 m0, s46, 4096
    s_nop 0
    buffer_load_dwordx4 v236, s[32:35], s43 offen offset:0 lds
    buffer_load_dwordx4 v237, s[32:35], s43 offen offset:1024 lds
    buffer_load_dwordx4 v238, s[32:35], s43 offen offset:2048 lds
    buffer_load_dwordx4 v239, s[32:35], s43 offen offset:3072 lds
    s_add_u32 s43, s43, 12288
    s_waitcnt vmcnt(0)
    s_barrier
    ds_read_b128 a[64:67], v224 offset:0
    ds_read_b128 a[68:71], v225 offset:0
    ds_read_b128 a[72:75], v226 offset:0
    ds_read_b128 a[76:79], v227 offset:0
    s_waitcnt lgkmcnt(0)
    v_mfma_f32_16x16x32_bf16 v[192:195], a[64:67], a[0:3], 0
    v_mfma_f32_16x16x32_bf16 v[192:195], a[68:71], a[4:7], v[192:195]
    v_mfma_f32_16x16x32_bf16 v[192:195], a[72:75], a[8:11], v[192:195]
    v_mfma_f32_16x16x32_bf16 v[192:195], a[76:79], a[12:15], v[192:195]
    v_mfma_f32_16x16x32_bf16 v[196:199], a[76:79], a[28:31], 0
    v_mfma_f32_16x16x32_bf16 v[196:199], a[72:75], a[24:27], v[196:199]
    v_mfma_f32_16x16x32_bf16 v[196:199], a[68:71], a[20:23], v[196:199]
    v_mfma_f32_16x16x32_bf16 v[196:199], a[64:67], a[16:19], v[196:199]
    v_mfma_f32_16x16x32_bf16 v[200:203], a[64:67], a[32:35], 0
    v_mfma_f32_16x16x32_bf16 v[200:203], a[68:71], a[36:39], v[200:203]
    v_mfma_f32_16x16x32_bf16 v[200:203], a[72:75], a[40:43], v[200:203]
    v_mfma_f32_16x16x32_bf16 v[200:203], a[76:79], a[44:47], v[200:203]
    v_mfma_f32_16x16x32_bf16 v[204:207], a[76:79], a[60:63], 0
    v_mfma_f32_16x16x32_bf16 v[204:207], a[72:75], a[56:59], v[204:207]
    v_mfma_f32_16x16x32_bf16 v[204:207], a[68:71], a[52:55], v[204:207]
    v_mfma_f32_16x16x32_bf16 v[204:207], a[64:67], a[48:51], v[204:207]
    s_nop 7
    v_max3_f32 v242, v242, v192, v193
    v_max3_f32 v242, v242, v194, v195
    v_max3_f32 v243, v243, v196, v197
    v_max3_f32 v243, v243, v198, v199
    v_max3_f32 v244, v244, v200, v201
    v_max3_f32 v244, v244, v202, v203
    v_max3_f32 v245, v245, v204, v205
    v_max3_f32 v245, v245, v206, v207
    ds_read_b128 a[64:67], v224 offset:4096
    ds_read_b128 a[68:71], v225 offset:4096
    ds_read_b128 a[72:75], v226 offset:4096
    ds_read_b128 a[76:79], v227 offset:4096
    s_waitcnt lgkmcnt(0)
    v_mfma_f32_16x16x32_bf16 v[192:195], a[64:67], a[0:3], 0
    v_mfma_f32_16x16x32_bf16 v[192:195], a[68:71], a[4:7], v[192:195]
    v_mfma_f32_16x16x32_bf16 v[192:195], a[72:75], a[8:11], v[192:195]
    v_mfma_f32_16x16x32_bf16 v[192:195], a[76:79], a[12:15], v[192:195]
    v_mfma_f32_16x16x32_bf16 v[196:199], a[76:79], a[28:31], 0
    v_mfma_f32_16x16x32_bf16 v[196:199], a[72:75], a[24:27], v[196:199]
    v_mfma_f32_16x16x32_bf16 v[196:199], a[68:71], a[20:23], v[196:199]
    v_mfma_f32_16x16x32_bf16 v[196:199], a[64:67], a[16:19], v[196:199]
    v_mfma_f32_16x16x32_bf16 v[200:203], a[64:67], a[32:35], 0
    v_mfma_f32_16x16x32_bf16 v[200:203], a[68:71], a[36:39], v[200:203]
    v_mfma_f32_16x16x32_bf16 v[200:203], a[72:75], a[40:43], v[200:203]
    v_mfma_f32_16x16x32_bf16 v[200:203], a[76:79], a[44:47], v[200:203]
    v_mfma_f32_16x16x32_bf16 v[204:207], a[76:79], a[60:63], 0
    v_mfma_f32_16x16x32_bf16 v[204:207], a[72:75], a[56:59], v[204:207]
    v_mfma_f32_16x16x32_bf16 v[204:207], a[68:71], a[52:55], v[204:207]
    v_mfma_f32_16x16x32_bf16 v[204:207], a[64:67], a[48:51], v[204:207]
    s_nop 7
    v_max3_f32 v242, v242, v192, v193
    v_max3_f32 v242, v242, v194, v195
    v_max3_f32 v243, v243, v196, v197
    v_max3_f32 v243, v243, v198, v199
    v_max3_f32 v244, v244, v200, v201
    v_max3_f32 v244, v244, v202, v203
    v_max3_f32 v245, v245, v204, v205
    v_max3_f32 v245, v245, v206, v207
    ds_read_b128 a[64:67], v224 offset:8192
    ds_read_b128 a[68:71], v225 offset:8192
    ds_read_b128 a[72:75], v226 offset:8192
    ds_read_b128 a[76:79], v227 offset:8192
    s_waitcnt lgkmcnt(0)
    v_mfma_f32_16x16x32_bf16 v[192:195], a[64:67], a[0:3], 0
    v_mfma_f32_16x16x32_bf16 v[192:195], a[68:71], a[4:7], v[192:195]
    v_mfma_f32_16x16x32_bf16 v[192:195], a[72:75], a[8:11], v[192:195]
    v_mfma_f32_16x16x32_bf16 v[192:195], a[76:79], a[12:15], v[192:195]
    v_mfma_f32_16x16x32_bf16 v[196:199], a[76:79], a[28:31], 0
    v_mfma_f32_16x16x32_bf16 v[196:199], a[72:75], a[24:27], v[196:199]
    v_mfma_f32_16x16x32_bf16 v[196:199], a[68:71], a[20:23], v[196:199]
    v_mfma_f32_16x16x32_bf16 v[196:199], a[64:67], a[16:19], v[196:199]
    v_mfma_f32_16x16x32_bf16 v[200:203], a[64:67], a[32:35], 0
    v_mfma_f32_16x16x32_bf16 v[200:203], a[68:71], a[36:39], v[200:203]
    v_mfma_f32_16x16x32_bf16 v[200:203], a[72:75], a[40:43], v[200:203]
    v_mfma_f32_16x16x32_bf16 v[200:203], a[76:79], a[44:47], v[200:203]
    v_mfma_f32_16x16x32_bf16 v[204:207], a[76:79], a[60:63], 0
    v_mfma_f32_16x16x32_bf16 v[204:207], a[72:75], a[56:59], v[204:207]
    v_mfma_f32_16x16x32_bf16 v[204:207], a[68:71], a[52:55], v[204:207]
    v_mfma_f32_16x16x32_bf16 v[204:207], a[64:67], a[48:51], v[204:207]
    s_nop 7
    v_max3_f32 v242, v242, v192, v193
    v_max3_f32 v242, v242, v194, v195
    v_max3_f32 v243, v243, v196, v197
    v_max3_f32 v243, v243, v198, v199
    v_max3_f32 v244, v244, v200, v201
    v_max3_f32 v244, v244, v202, v203
    v_max3_f32 v245, v245, v204, v205
    v_max3_f32 v245, v245, v206, v207
    ds_read_b128 a[64:67], v224 offset:12288
    ds_read_b128 a[68:71], v225 offset:12288
    ds_read_b128 a[72:75], v226 offset:12288
    ds_read_b128 a[76:79], v227 offset:12288
    s_waitcnt lgkmcnt(0)
    v_mfma_f32_16x16x32_bf16 v[192:195], a[64:67], a[0:3], 0
    v_mfma_f32_16x16x32_bf16 v[192:195], a[68:71], a[4:7], v[192:195]
    v_mfma_f32_16x16x32_bf16 v[192:195], a[72:75], a[8:11], v[192:195]
    v_mfma_f32_16x16x32_bf16 v[192:195], a[76:79], a[12:15], v[192:195]
    v_mfma_f32_16x16x32_bf16 v[196:199], a[76:79], a[28:31], 0
    v_mfma_f32_16x16x32_bf16 v[196:199], a[72:75], a[24:27], v[196:199]
    v_mfma_f32_16x16x32_bf16 v[196:199], a[68:71], a[20:23], v[196:199]
    v_mfma_f32_16x16x32_bf16 v[196:199], a[64:67], a[16:19], v[196:199]
    v_mfma_f32_16x16x32_bf16 v[200:203], a[64:67], a[32:35], 0
    v_mfma_f32_16x16x32_bf16 v[200:203], a[68:71], a[36:39], v[200:203]
    v_mfma_f32_16x16x32_bf16 v[200:203], a[72:75], a[40:43], v[200:203]
    v_mfma_f32_16x16x32_bf16 v[200:203], a[76:79], a[44:47], v[200:203]
    v_mfma_f32_16x16x32_bf16 v[204:207], a[76:79], a[60:63], 0
    v_mfma_f32_16x16x32_bf16 v[204:207], a[72:75], a[56:59], v[204:207]
    v_mfma_f32_16x16x32_bf16 v[204:207], a[68:71], a[52:55], v[204:207]
    v_mfma_f32_16x16x32_bf16 v[204:207], a[64:67], a[48:51], v[204:207]
    s_nop 7
    v_max3_f32 v242, v242, v192, v193
    v_max3_f32 v242, v242, v194, v195
    v_max3_f32 v243, v243, v196, v197
    v_max3_f32 v243, v243, v198, v199
    v_max3_f32 v244, v244, v200, v201
    v_max3_f32 v244, v244, v202, v203
    v_max3_f32 v245, v245, v204, v205
    v_max3_f32 v245, v245, v206, v207
    s_add_u32 s47, s47, 1
    s_cmp_lt_u32 s47, 32
    s_cbranch_scc1 K1_maxloop
    v_mov_b32 v246, v242
    v_mov_b32 v247, v243
    v_mov_b32 v248, v244
    v_mov_b32 v249, v245
    v_permlane16_swap_b32 v242, v246
    v_permlane16_swap_b32 v243, v247
    v_permlane16_swap_b32 v244, v248
    v_permlane16_swap_b32 v245, v249
    v_max_f32 v242, v242, v246
    v_max_f32 v243, v243, v247
    v_max_f32 v244, v244, v248
    v_max_f32 v245, v245, v249
    v_mov_b32 v246, v242
    v_mov_b32 v247, v243
    v_mov_b32 v248, v244
    v_mov_b32 v249, v245
    v_permlane32_swap_b32 v242, v246
    v_permlane32_swap_b32 v243, v247
    v_permlane32_swap_b32 v244, v248
    v_permlane32_swap_b32 v245, v249
    v_max_f32 v242, v242, v246
    v_max_f32 v243, v243, v247
    v_max_f32 v244, v244, v248
    v_max_f32 v245, v245, v249
    v_sub_f32 v208, 0, v242
    v_sub_f32 v209, 0, v242
    v_sub_f32 v210, 0, v242
    v_sub_f32 v211, 0, v242
    v_sub_f32 v212, 0, v243
    v_sub_f32 v213, 0, v243
    v_sub_f32 v214, 0, v243
    v_sub_f32 v215, 0, v243
    v_sub_f32 v216, 0, v244
    v_sub_f32 v217, 0, v244
    v_sub_f32 v218, 0, v244
    v_sub_f32 v219, 0, v244
    v_sub_f32 v220, 0, v245
    v_sub_f32 v221, 0, v245
    v_sub_f32 v222, 0, v245
    v_sub_f32 v223, 0, v245
    s_barrier
    s_and_b32 s43, s46, 8192
    s_add_u32 m0, s46, 49152
    s_nop 0
    buffer_load_dwordx4 v236, s[32:35], s43 offen offset:0 lds
    buffer_load_dwordx4 v237, s[32:35], s43 offen offset:1024 lds
    buffer_load_dwordx4 v238, s[32:35], s43 offen offset:2048 lds
    buffer_load_dwordx4 v239, s[32:35], s43 offen offset:3072 lds
    s_add_u32 s43, s43, 4096
    s_add_u32 m0, s46, 53248
    s_nop 0
    buffer_load_dwordx4 v236, s[32:35], s43 offen offset:0 lds
    buffer_load_dwordx4 v237, s[32:35], s43 offen offset:1024 lds
    buffer_load_dwordx4 v238, s[32:35], s43 offen offset:2048 lds
    buffer_load_dwordx4 v239, s[32:35], s43 offen offset:3072 lds
    s_add_u32 s43, s43, s49
    s_add_u32 m0, s46, 0
    s_nop 0
    buffer_load_dwordx4 v236, s[32:35], s43 offen offset:0 lds
    buffer_load_dwordx4 v237, s[32:35], s43 offen offset:1024 lds
    buffer_load_dwordx4 v238, s[32:35], s43 offen offset:2048 lds
    buffer_load_dwordx4 v239, s[32:35], s43 offen offset:3072 lds
    s_add_u32 s43, s43, 4096
    s_add_u32 m0, s46, 4096
    s_nop 0
    buffer_load_dwordx4 v236, s[32:35], s43 offen offset:0 lds
    buffer_load_dwordx4 v237, s[32:35], s43 offen offset:1024 lds
    buffer_load_dwordx4 v238, s[32:35], s43 offen offset:2048 lds
    buffer_load_dwordx4 v239, s[32:35], s43 offen offset:3072 lds
    s_add_u32 s43, s43, 12288
    s_add_u32 m0, s46, 16384
    s_nop 0
    buffer_load_dwordx4 v236, s[32:35], s43 offen offset:0 lds
    buffer_load_dwordx4 v237, s[32:35], s43 offen offset:1024 lds
    buffer_load_dwordx4 v238, s[32:35], s43 offen offset:2048 lds
    buffer_load_dwordx4 v239, s[32:35], s43 offen offset:3072 lds
    s_add_u32 s43, s43, 4096
    s_add_u32 m0, s46, 20480
    s_nop 0
    buffer_load_dwordx4 v236, s[32:35], s43 offen offset:0 lds
    buffer_load_dwordx4 v237, s[32:35], s43 offen offset:1024 lds
    buffer_load_dwordx4 v238, s[32:35], s43 offen offset:2048 lds
    buffer_load_dwordx4 v239, s[32:35], s43 offen offset:3072 lds
    s_add_u32 s43, s43, 12288
    s_add_u32 m0, s46, 32768
    s_nop 0
    buffer_load_dwordx4 v236, s[32:35], s43 offen offset:0 lds
    buffer_load_dwordx4 v237, s[32:35], s43 offen offset:1024 lds
    s_waitcnt vmcnt(18)
    s_barrier
    ds_read_b128 a[64:67], v224 offset:49152
    ds_read_b128 a[68:71], v225 offset:49152
    ds_read_b128 a[72:75], v226 offset:49152
    ds_read_b128 a[76:79], v227 offset:49152
    s_waitcnt lgkmcnt(0)
    v_mfma_f32_16x16x32_bf16 v[192:195], a[64:67], a[0:3], v[208:211]
    ds_read_b128 a[96:99], v224 offset:53248
    v_mfma_f32_16x16x32_bf16 v[192:195], a[68:71], a[4:7], v[192:195]
    ds_read_b128 a[100:103], v225 offset:53248
    v_mfma_f32_16x16x32_bf16 v[192:195], a[72:75], a[8:11], v[192:195]
    ds_read_b128 a[104:107], v226 offset:53248
    v_mfma_f32_16x16x32_bf16 v[192:195], a[76:79], a[12:15], v[192:195]
    ds_read_b128 a[108:111], v227 offset:53248
    v_mfma_f32_16x16x32_bf16 v[196:199], a[76:79], a[28:31], v[212:215]
    buffer_load_dwordx4 v238, s[32:35], s43 offen offset:2048 lds
    s_nop 0
    v_mfma_f32_16x16x32_bf16 v[196:199], a[72:75], a[24:27], v[196:199]
    buffer_load_dwordx4 v239, s[32:35], s43 offen offset:3072 lds
    s_add_u32 s43, s43, 4096
    s_nop 0
    v_mfma_f32_16x16x32_bf16 v[196:199], a[68:71], a[20:23], v[196:199]
    s_nop 0
    v_mfma_f32_16x16x32_bf16 v[196:199], a[64:67], a[16:19], v[196:199]
    s_nop 0
    v_mfma_f32_16x16x32_bf16 v[200:203], a[64:67], a[32:35], v[216:219]
    v_exp_f32 v192, v192
    v_mfma_f32_16x16x32_bf16 v[200:203], a[68:71], a[36:39], v[200:203]
    v_exp_f32 v193, v193
    v_mfma_f32_16x16x32_bf16 v[200:203], a[72:75], a[40:43], v[200:203]
    v_exp_f32 v194, v194
    v_cvt_pk_bf16_f32 v128, v192, v193
    v_mfma_f32_16x16x32_bf16 v[200:203], a[76:79], a[44:47], v[200:203]
    v_exp_f32 v195, v195
    v_mfma_f32_16x16x32_bf16 v[204:207], a[76:79], a[60:63], v[220:223]
    v_exp_f32 v196, v196
    v_cvt_pk_bf16_f32 v129, v194, v195
    v_mfma_f32_16x16x32_bf16 v[204:207], a[72:75], a[56:59], v[204:207]
    v_exp_f32 v197, v197
    v_mfma_f32_16x16x32_bf16 v[204:207], a[68:71], a[52:55], v[204:207]
    v_exp_f32 v198, v198
    v_cvt_pk_bf16_f32 v136, v196, v197
    v_mfma_f32_16x16x32_bf16 v[204:207], a[64:67], a[48:51], v[204:207]
    v_exp_f32 v199, v199
    s_waitcnt lgkmcnt(0)
    v_mfma_f32_16x16x32_bf16 v[192:195], a[96:99], a[0:3], v[208:211]
    ds_read_b128 a[64:67], v224 offset:57344
    v_exp_f32 v200, v200
    v_cvt_pk_bf16_f32 v137, v198, v199
    v_mfma_f32_16x16x32_bf16 v[192:195], a[100:103], a[4:7], v[192:195]
    ds_read_b128 a[68:71], v225 offset:57344
    v_exp_f32 v201, v201
    v_mfma_f32_16x16x32_bf16 v[192:195], a[104:107], a[8:11], v[192:195]
    ds_read_b128 a[72:75], v226 offset:57344
    v_exp_f32 v202, v202
    v_cvt_pk_bf16_f32 v144, v200, v201
    v_mfma_f32_16x16x32_bf16 v[192:195], a[108:111], a[12:15], v[192:195]
    ds_read_b128 a[76:79], v227 offset:57344
    v_exp_f32 v203, v203
    s_add_u32 m0, s46, 36864
    v_mfma_f32_16x16x32_bf16 v[196:199], a[108:111], a[28:31], v[212:215]
    buffer_load_dwordx4 v236, s[32:35], s43 offen offset:0 lds
    v_exp_f32 v204, v204
    v_cvt_pk_bf16_f32 v145, v202, v203
    v_mfma_f32_16x16x32_bf16 v[196:199], a[104:107], a[24:27], v[196:199]
    buffer_load_dwordx4 v237, s[32:35], s43 offen offset:1024 lds
    v_exp_f32 v205, v205
    v_mfma_f32_16x16x32_bf16 v[196:199], a[100:103], a[20:23], v[196:199]
    v_exp_f32 v206, v206
    v_cvt_pk_bf16_f32 v152, v204, v205
    v_mfma_f32_16x16x32_bf16 v[196:199], a[96:99], a[16:19], v[196:199]
    v_exp_f32 v207, v207
    v_mfma_f32_16x16x32_bf16 v[200:203], a[96:99], a[32:35], v[216:219]
    v_exp_f32 v192, v192
    v_cvt_pk_bf16_f32 v153, v206, v207
    v_mfma_f32_16x16x32_bf16 v[200:203], a[100:103], a[36:39], v[200:203]
    v_exp_f32 v193, v193
    v_mfma_f32_16x16x32_bf16 v[200:203], a[104:107], a[40:43], v[200:203]
    v_exp_f32 v194, v194
    v_cvt_pk_bf16_f32 v130, v192, v193
    v_mfma_f32_16x16x32_bf16 v[200:203], a[108:111], a[44:47], v[200:203]
    v_exp_f32 v195, v195
    v_mfma_f32_16x16x32_bf16 v[204:207], a[108:111], a[60:63], v[220:223]
    v_exp_f32 v196, v196
    v_cvt_pk_bf16_f32 v131, v194, v195
    v_mfma_f32_16x16x32_bf16 v[204:207], a[104:107], a[56:59], v[204:207]
    v_exp_f32 v197, v197
    v_mfma_f32_16x16x32_bf16 v[204:207], a[100:103], a[52:55], v[204:207]
    v_exp_f32 v198, v198
    v_cvt_pk_bf16_f32 v138, v196, v197
    v_mfma_f32_16x16x32_bf16 v[204:207], a[96:99], a[48:51], v[204:207]
    v_exp_f32 v199, v199
    s_waitcnt lgkmcnt(0)
    v_mfma_f32_16x16x32_bf16 v[192:195], a[64:67], a[0:3], v[208:211]
    ds_read_b128 a[96:99], v224 offset:61440
    v_exp_f32 v200, v200
    v_cvt_pk_bf16_f32 v139, v198, v199
    v_mfma_f32_16x16x32_bf16 v[192:195], a[68:71], a[4:7], v[192:195]
    ds_read_b128 a[100:103], v225 offset:61440
    v_exp_f32 v201, v201
    v_mfma_f32_16x16x32_bf16 v[192:195], a[72:75], a[8:11], v[192:195]
    ds_read_b128 a[104:107], v226 offset:61440
    v_exp_f32 v202, v202
    v_cvt_pk_bf16_f32 v146, v200, v201
    v_mfma_f32_16x16x32_bf16 v[192:195], a[76:79], a[12:15], v[192:195]
    ds_read_b128 a[108:111], v227 offset:61440
    v_exp_f32 v203, v203
    v_mfma_f32_16x16x32_bf16 v[196:199], a[76:79], a[28:31], v[212:215]
    buffer_load_dwordx4 v238, s[32:35], s43 offen offset:2048 lds
    v_exp_f32 v204, v204
    v_cvt_pk_bf16_f32 v147, v202, v203
    v_mfma_f32_16x16x32_bf16 v[196:199], a[72:75], a[24:27], v[196:199]
    buffer_load_dwordx4 v239, s[32:35], s43 offen offset:3072 lds
    s_add_u32 s43, s43, 12288
    v_exp_f32 v205, v205
    v_mfma_f32_16x16x32_bf16 v[196:199], a[68:71], a[20:23], v[196:199]
    v_exp_f32 v206, v206
    v_cvt_pk_bf16_f32 v154, v204, v205
    v_mfma_f32_16x16x32_bf16 v[196:199], a[64:67], a[16:19], v[196:199]
    v_exp_f32 v207, v207
    v_mfma_f32_16x16x32_bf16 v[200:203], a[64:67], a[32:35], v[216:219]
    v_exp_f32 v192, v192
    v_cvt_pk_bf16_f32 v155, v206, v207
    v_mfma_f32_16x16x32_bf16 v[200:203], a[68:71], a[36:39], v[200:203]
    v_exp_f32 v193, v193
    v_mfma_f32_16x16x32_bf16 v[200:203], a[72:75], a[40:43], v[200:203]
    v_exp_f32 v194, v194
    v_cvt_pk_bf16_f32 v132, v192, v193
    v_mfma_f32_16x16x32_bf16 v[200:203], a[76:79], a[44:47], v[200:203]
    v_exp_f32 v195, v195
    v_mfma_f32_16x16x32_bf16 v[204:207], a[76:79], a[60:63], v[220:223]
    v_exp_f32 v196, v196
    v_cvt_pk_bf16_f32 v133, v194, v195
    v_mfma_f32_16x16x32_bf16 v[204:207], a[72:75], a[56:59], v[204:207]
    v_exp_f32 v197, v197
    v_mfma_f32_16x16x32_bf16 v[204:207], a[68:71], a[52:55], v[204:207]
    v_exp_f32 v198, v198
    v_cvt_pk_bf16_f32 v140, v196, v197
    v_mfma_f32_16x16x32_bf16 v[204:207], a[64:67], a[48:51], v[204:207]
    v_exp_f32 v199, v199
    s_waitcnt vmcnt(16) lgkmcnt(0)
    s_barrier
    v_mfma_f32_16x16x32_bf16 v[192:195], a[96:99], a[0:3], v[208:211]
    ds_read_b128 a[64:67], v224 offset:0
    v_exp_f32 v200, v200
    v_cvt_pk_bf16_f32 v141, v198, v199
    v_mfma_f32_16x16x32_bf16 v[192:195], a[100:103], a[4:7], v[192:195]
    ds_read_b128 a[68:71], v225 offset:0
    v_exp_f32 v201, v201
    v_mfma_f32_16x16x32_bf16 v[192:195], a[104:107], a[8:11], v[192:195]
    ds_read_b128 a[72:75], v226 offset:0
    v_exp_f32 v202, v202
    v_cvt_pk_bf16_f32 v148, v200, v201
    v_mfma_f32_16x16x32_bf16 v[192:195], a[108:111], a[12:15], v[192:195]
    ds_read_b128 a[76:79], v227 offset:0
    v_exp_f32 v203, v203
    v_mfma_f32_16x16x32_bf16 v[196:199], a[108:111], a[28:31], v[212:215]
    ds_read_b64_tr_b16 a[80:81], v228 offset:0
    v_exp_f32 v204, v204
    v_cvt_pk_bf16_f32 v149, v202, v203
    v_mfma_f32_16x16x32_bf16 v[196:199], a[104:107], a[24:27], v[196:199]
    ds_read_b64_tr_b16 a[82:83], v228 offset:4096
    v_exp_f32 v205, v205
    v_mfma_f32_16x16x32_bf16 v[196:199], a[100:103], a[20:23], v[196:199]
    ds_read_b64_tr_b16 a[84:85], v228 offset:8192
    v_exp_f32 v206, v206
    v_cvt_pk_bf16_f32 v156, v204, v205
    v_mfma_f32_16x16x32_bf16 v[196:199], a[96:99], a[16:19], v[196:199]
    ds_read_b64_tr_b16 a[86:87], v228 offset:12288
    v_exp_f32 v207, v207
    v_mfma_f32_16x16x32_bf16 v[200:203], a[96:99], a[32:35], v[216:219]
    ds_read_b64_tr_b16 a[88:89], v229 offset:0
    v_exp_f32 v192, v192
    v_cvt_pk_bf16_f32 v157, v206, v207
    v_mfma_f32_16x16x32_bf16 v[200:203], a[100:103], a[36:39], v[200:203]
    ds_read_b64_tr_b16 a[90:91], v229 offset:4096
    v_exp_f32 v193, v193
    v_mfma_f32_16x16x32_bf16 v[200:203], a[104:107], a[40:43], v[200:203]
    ds_read_b64_tr_b16 a[92:93], v229 offset:8192
    v_exp_f32 v194, v194
    v_cvt_pk_bf16_f32 v134, v192, v193
    v_mfma_f32_16x16x32_bf16 v[200:203], a[108:111], a[44:47], v[200:203]
    ds_read_b64_tr_b16 a[94:95], v229 offset:12288
    v_exp_f32 v195, v195
    s_add_u32 m0, s46, 49152
    v_mfma_f32_16x16x32_bf16 v[204:207], a[108:111], a[60:63], v[220:223]
    buffer_load_dwordx4 v236, s[32:35], s43 offen offset:0 lds
    v_exp_f32 v196, v196
    v_cvt_pk_bf16_f32 v135, v194, v195
    v_mfma_f32_16x16x32_bf16 v[204:207], a[104:107], a[56:59], v[204:207]
    buffer_load_dwordx4 v237, s[32:35], s43 offen offset:1024 lds
    v_exp_f32 v197, v197
    v_mfma_f32_16x16x32_bf16 v[204:207], a[100:103], a[52:55], v[204:207]
    v_exp_f32 v198, v198
    v_cvt_pk_bf16_f32 v142, v196, v197
    v_mfma_f32_16x16x32_bf16 v[204:207], a[96:99], a[48:51], v[204:207]
    v_exp_f32 v199, v199
    v_exp_f32 v200, v200
    v_cvt_pk_bf16_f32 v143, v198, v199
    v_exp_f32 v201, v201
    v_exp_f32 v202, v202
    v_cvt_pk_bf16_f32 v150, v200, v201
    v_exp_f32 v203, v203
    s_nop 0
    v_cvt_pk_bf16_f32 v151, v202, v203
    s_waitcnt lgkmcnt(0)
    s_mov_b32 s47, 0
    s_branch K1_loop
K1_end:
    s_endpgm
.section .rodata,"a"
.p2align 6
.amdhsa_kernel recurrent_scan__gqa_block_cached__dense_activation_silu__prompt_kernel
  .amdhsa_next_free_vgpr 512
  .amdhsa_next_free_sgpr 102
  .amdhsa_accum_offset 256
  .amdhsa_group_segment_fixed_size 0
  .amdhsa_kernarg_size 88
  .amdhsa_user_sgpr_count 2
  .amdhsa_user_sgpr_kernarg_segment_ptr 1
  .amdhsa_system_sgpr_workgroup_id_x 1
  .amdhsa_float_denorm_mode_32 3
.end_amdhsa_kernel
```
